```python
import torch

def _softmax(x, axis=-1):
    return torch.softmax(x, dim=axis)
def _gelu(x):
    return torch.nn.functional.gelu(x, approximate="tanh")
def _silu(x):
    return torch.nn.functional.silu(x)
def _sigmoid(x):
    return torch.sigmoid(x)
def _layernorm(x, axis=-1, eps=1e-5):
    m = x.mean(dim=axis, keepdim=True)
    v = x.var(dim=axis, keepdim=True, unbiased=False)
    return (x - m) / torch.sqrt(v + eps)
def _scatter_add(tgt, idx, src, axis=0):
    return tgt.clone().index_add_(axis, idx, src)
def _segment_sum(src, seg, n):
    out = torch.zeros((n,) + src.shape[1:], dtype=src.dtype)
    return out.index_add_(0, seg, src)
def _pad(x, pw):
    flat = tuple(v for pair in reversed(pw) for v in pair)
    return torch.nn.functional.pad(x, flat)

kernel_name = 'sequential_preLN__ssm_conv_s4d__glu_gated_swiglu__prompt'

def setup_inputs():

    _w = (lambda a: (lambda t: t.to(torch.bfloat16) if t.is_floating_point() else t)(torch.as_tensor(a)))
    def _A_setup():
        Bsz, L, D, N = 1, 2048, 640, 192
        return {
            "u": _w((lambda *s: torch.randn(*s, dtype=torch.bfloat16) * 0.05)(Bsz, L, D)),
            "log_A_real": _w((lambda *s: torch.randn(*s, dtype=torch.bfloat16) * 6.4)(D, N) * 0.5),
            "A_imag": _w((lambda *s: torch.randn(*s, dtype=torch.bfloat16) * 0.05)(D, N) * 3.14),
            "C_real": _w((lambda *s: torch.randn(*s, dtype=torch.bfloat16) * 0.05)(D, N) / N ** 0.5),
            "C_imag": _w((lambda *s: torch.randn(*s, dtype=torch.bfloat16) * 0.05)(D, N) / N ** 0.5),
            "log_dt": _w((lambda *s: torch.randn(*s, dtype=torch.bfloat16) * 0.05)(D) * 0.5 - 4.0),
            "D_skip": _w((lambda *s: torch.randn(*s, dtype=torch.bfloat16) * 0.05)(D)),
        }
    _A_in = _A_setup()

    def _B_setup():
        B, S, D, F = 1, 2048, 640, 1536
        return {
            "x": _w((lambda *s: torch.randn(*s, dtype=torch.bfloat16) * 0.05)(B, S, D)),
            "w1": _w((lambda *s: torch.randn(*s, dtype=torch.bfloat16) * 0.4)(D, F) * (2.0 / D) ** 0.5),
            "w3": _w((lambda *s: torch.randn(*s, dtype=torch.bfloat16) * 0.4)(D, F) * (2.0 / D) ** 0.5),
            "w2": _w((lambda *s: torch.randn(*s, dtype=torch.bfloat16) * 0.4)(F, D) * (2.0 / F) ** 0.5),
        }
    _B_in = _B_setup()

    return {
        "A_u": _A_in["u"],
        "A_log_A_real": _A_in["log_A_real"],
        "A_A_imag": _A_in["A_imag"],
        "A_C_real": _A_in["C_real"],
        "A_C_imag": _A_in["C_imag"],
        "A_log_dt": _A_in["log_dt"],
        "A_D_skip": _A_in["D_skip"],
        "B_x": _B_in["x"],
        "B_w1": _B_in["w1"],
        "B_w3": _B_in["w3"],
        "B_w2": _B_in["w2"],
    }

def reference(A_u, A_log_A_real, A_A_imag, A_C_real, A_C_imag, A_log_dt, A_D_skip, B_x, B_w1, B_w3, B_w2):
    def _A_ref(u, log_A_real, A_imag, C_real, C_imag, log_dt, D_skip):
        L = u.shape[1]
        dt = torch.exp(log_dt)
        A = -torch.exp(log_A_real) + 1j * A_imag
        C = (C_real + 1j * C_imag) * dt[:, None]
        pos = (lambda x, dt: x.to(dt))(torch.arange(L), log_dt.dtype)
        P = torch.exp((A * dt[:, None])[:, :, None] * pos[None, None, :])
        K = 2.0 * torch.einsum("dn,dnl->dl", C, P).real
        L2 = 2 * L
        u_t = (lambda x, *d: x.permute(*d))(u, 0, 2, 1)
        Kf = (lambda x, *a, **k: torch.fft.rfft(x.float(), *a, **k))(K, L2)
        Uf = (lambda x, *a, **k: torch.fft.rfft(x.float(), *a, **k))(u_t, L2)
        y = (lambda x, *a, **k: torch.fft.irfft(x, *a, **k).to(torch.bfloat16))(Uf * Kf[None, :, :], L2)[:, :, :L]
        y = (lambda x, *d: x.permute(*d))(y, 0, 2, 1)
        return y + u * D_skip[None, None, :]

    def _B_ref(x, w1, w3, w2):
        gate = torch.einsum("bsd,df->bsf", x, w1)
        up = torch.einsum("bsd,df->bsf", x, w3)
        h = _silu(gate) * up
        out = torch.einsum("bsf,fd->bsd", h, w2)
        return out

    x = A_u
    h = x + _A_ref(_layernorm(x, axis=-1), A_log_A_real, A_A_imag, A_C_real, A_C_imag, A_log_dt, A_D_skip)
    h2 = h + _B_ref(_layernorm(h, axis=-1), B_w1, B_w3, B_w2)
    return h2
```

```asm
; @launch grid=(256,1,1) block=(256,1,1) lds=163840
.amdgcn_target "amdgcn-amd-amdhsa--gfx950"
.text
ALL_BEG:
.globl sequential_preLN__ssm_conv_s4d__glu_gated_swiglu__prompt_kernel
.p2align 8
.type sequential_preLN__ssm_conv_s4d__glu_gated_swiglu__prompt_kernel,@function
sequential_preLN__ssm_conv_s4d__glu_gated_swiglu__prompt_kernel:
  s_cmp_ge_u32 s2, 256
  s_cbranch_scc1 K3_END
  s_getpc_b64 s[92:93]
PC_F4:
  s_sub_u32 s92, s92, PC_F4-ALL_BEG
  s_subb_u32 s93, s93, 0
  s_lshr_b32 s94, s2, 3
  s_mul_i32 s94, s94, 4096
  v_lshlrev_b32 v132, 4, v0
  v_add_u32 v132, s94, v132
  v_min_u32 v132, CODE_END-ALL_BEG-16, v132
  global_load_dwordx4 v[132:135], v132, s[92:93]
  s_load_dwordx16 s[16:31], s[0:1], 0
  s_load_dwordx8 s[32:39], s[0:1], 64
  s_load_dwordx4 s[40:43], s[0:1], 96
  v_lshrrev_b32 v2, 6, v0
  v_and_b32 v1, 63, v0
  v_readfirstlane_b32 s3, v2
  s_cmp_lt_u32 s2, 96
  s_nop 3
  s_cbranch_scc1 F_LN
  s_sub_u32 s5, s2, 96
  s_and_b32 s6, s5, 7
  s_mul_i32 s6, s6, 20
  s_lshr_b32 s4, s5, 3
  s_add_u32 s4, s4, s6
  s_lshl_b32 s7, s4, 2
  s_add_u32 s7, s7, s3
  s_mul_i32 s8, s7, 384
  v_lshlrev_b32 v2, 1, v1
  v_add_u32 v2, s8, v2
  s_lshr_b32 s9, s7, 1
  s_lshl_b32 s9, s9, 2
  s_lshl_b32 s12, s4, 3
  s_waitcnt lgkmcnt(0)
  s_load_dword s10, s[26:27], s9
  s_load_dwordx2 s[68:69], s[28:29], s12
  global_load_ushort v16, v2, s[18:19] offset:0
  global_load_ushort v17, v2, s[20:21] offset:0
  global_load_ushort v18, v2, s[22:23] offset:0
  global_load_ushort v19, v2, s[24:25] offset:0
  global_load_ushort v86, v2, s[18:19] offset:128
  global_load_ushort v87, v2, s[20:21] offset:128
  global_load_ushort v88, v2, s[22:23] offset:128
  global_load_ushort v89, v2, s[24:25] offset:128
  global_load_ushort v156, v2, s[18:19] offset:256
  global_load_ushort v157, v2, s[20:21] offset:256
  global_load_ushort v158, v2, s[22:23] offset:256
  global_load_ushort v159, v2, s[24:25] offset:256
  s_mov_b32 s60, s36
  s_mov_b32 s61, s37
  s_add_u32 s44, s42, 0x1350000
  s_addc_u32 s45, s43, 0
  s_mov_b32 s46, 0x4000
  s_mov_b32 s47, 0x20000
  s_mov_b32 s48, s40
  s_mov_b32 s49, s41
  s_mov_b32 s50, 0x8
  s_mov_b32 s51, 0x20000
  s_add_u32 s56, s42, 0x500000
  s_addc_u32 s57, s43, 0
  s_mov_b32 s58, 0x280000
  s_mov_b32 s59, 0x20000
  s_add_u32 s36, s42, 0x1400000
  s_addc_u32 s37, s43, 0
  s_mov_b32 s38, 0x280000
  s_mov_b32 s39, 0x20000
  s_mul_i32 s11, s3, 1536
  s_add_u32 s11, s11, 156928
  s_mul_i32 s13, s3, 4416
  s_add_u32 s13, s13, 139264
  v_lshlrev_b32 v2, 4, v1
  v_add_u32 v226, s13, v2
  s_lshl_b32 s9, s5, 2
  s_add_u32 s9, s9, s3
  s_mul_i32 s9, s9, 3072
  v_add_u32 v227, s9, v2
  v_lshlrev_b32 v228, 6, v0
  v_and_b32 v233, 15, v1
  s_lshl_b32 s9, s3, 4
  v_add_u32 v233, s9, v233
  v_lshlrev_b32 v233, 8, v233
  v_mov_b32 v229, 0
  s_mov_b32 s15, 8192
  v_accvgpr_write_b32 a192, 0
  v_accvgpr_write_b32 a193, 0
  v_accvgpr_write_b32 a194, 0
  v_accvgpr_write_b32 a195, 0
  v_accvgpr_write_b32 a196, 0
  v_accvgpr_write_b32 a197, 0
  v_accvgpr_write_b32 a198, 0
  v_accvgpr_write_b32 a199, 0
  v_accvgpr_write_b32 a200, 0
  v_accvgpr_write_b32 a201, 0
  v_accvgpr_write_b32 a202, 0
  v_accvgpr_write_b32 a203, 0
  v_and_b32 v5, 15, v1
  v_lshrrev_b32 v6, 4, v1
  v_lshrrev_b32 v236, 1, v6
  v_lshlrev_b32 v236, 8, v236
  v_and_b32 v7, 1, v6
  v_lshl_add_u32 v236, v7, 3, v236
  v_lshl_add_u32 v236, v5, 4, v236
  v_add_u32 v236, s11, v236
  v_cmp_gt_u32 vcc, 2, v6
  v_lshlrev_b32 v237, 3, v5
  v_lshlrev_b32 v7, 2, v5
  v_mov_b32 v238, 64
  v_cndmask_b32 v237, v7, v237, vcc
  v_cndmask_b32 v238, v238, 4, vcc
  v_lshl_add_u32 v237, v6, 7, v237
  v_add_u32 v237, s11, v237
  v_add_u32 v238, v238, v237
  v_lshlrev_b32 v239, 1, v5
  v_lshl_add_u32 v239, v6, 7, v239
  v_add_u32 v239, s11, v239
  v_cmp_gt_u32 vcc, 32, v1
  v_lshlrev_b32 v240, 4, v1
  v_lshlrev_b32 v7, 3, v1
  v_add_u32 v7, 256, v7
  v_cndmask_b32 v240, v7, v240, vcc
  v_add_u32 v240, s11, v240
  v_lshlrev_b32 v241, 2, v1
  v_add_u32 v241, s11, v241
  v_lshlrev_b32 v242, 1, v1
  v_add_u32 v242, s11, v242
  v_mov_b32 v7, 0x01000100
  v_mov_b32 v8, 0x03020100
  v_cndmask_b32 v243, v7, v8, vcc
  v_mov_b32 v7, 0x05040302
  v_mov_b32 v8, 0x07060504
  v_cndmask_b32 v244, v7, v8, vcc
  v_mov_b32 v7, 0x01000100
  v_cndmask_b32 v245, v7, v8, vcc
  v_and_b32 v7, 1, v1
  v_cmp_eq_u32 vcc, 0, v7
  v_mov_b32 v7, 0x05040504
  v_mov_b32 v8, 0x05040100
  v_cndmask_b32 v246, v7, v8, vcc
  v_lshrrev_b32 v10, 4, v1
  v_bfe_u32 v11, v1, 2, 2
  v_and_b32 v12, 3, v1
  v_lshlrev_b32 v247, 6, v10
  v_lshl_add_u32 v247, v11, 3, v247
  v_lshl_add_u32 v247, v12, 5, v247
  v_add_u32 v247, s13, v247
  s_lshr_b32 s14, s3, 1
  s_and_b32 s12, s3, 1
  s_lshl_b32 s12, s12, 3
  v_add_u32 v6, 44, v12
  v_sub_u32 v6, v6, v11
  v_lshlrev_b32 v7, 3, v10
  v_sub_u32 v6, v6, v7
  v_lshrrev_b32 v7, 2, v6
  v_add_u32 v7, s14, v7
  v_and_b32 v7, 3, v7
  v_lshlrev_b32 v6, 6, v6
  v_lshl_add_u32 v6, v7, 4, v6
  v_add_u32 v248, s12, v6
  v_add_u32 v6, 40, v12
  v_sub_u32 v6, v6, v11
  v_lshlrev_b32 v7, 3, v10
  v_sub_u32 v6, v6, v7
  v_lshrrev_b32 v7, 2, v6
  v_add_u32 v7, s14, v7
  v_and_b32 v7, 3, v7
  v_lshlrev_b32 v6, 6, v6
  v_lshl_add_u32 v6, v7, 4, v6
  v_add_u32 v249, s12, v6
  v_and_b32 v250, 1, v1
  v_lshlrev_b32 v250, 7, v250
  v_and_b32 v6, 62, v1
  v_add3_u32 v250, s13, v250, v6
  v_lshrrev_b32 v6, 1, v0
  v_lshlrev_b32 v7, 7, v0
  v_add_u32 v7, 2048, v7
  v_add_u32 v8, 0, v6
  v_and_b32 v8, 3, v8
  v_lshl_add_u32 v251, v8, 4, v7
  v_add_u32 v8, 1, v6
  v_and_b32 v8, 3, v8
  v_lshl_add_u32 v252, v8, 4, v7
  v_add_u32 v8, 2, v6
  v_and_b32 v8, 3, v8
  v_lshl_add_u32 v253, v8, 4, v7
  v_add_u32 v8, 3, v6
  v_and_b32 v8, 3, v8
  v_lshl_add_u32 v254, v8, 4, v7
  s_mul_i32 s8, s3, 8704
  s_add_u32 s8, s8, 34816
  s_mov_b32 s14, s8
  v_lshlrev_b32 v3, 2, v1
  v_add_u32 v3, s8, v3
  v_and_b32 v4, 15, v1
  v_mul_u32_u24 v4, 272, v4
  v_lshrrev_b32 v5, 4, v1
  v_lshl_add_u32 v4, v5, 4, v4
  v_add_u32 v4, s8, v4
  v_add_u32 v234, 69632, v3
  v_add_u32 v235, 69632, v4
  s_mov_b32 m0, s14
  v_mov_b32 v7, 0
  v_lshlrev_b32 v6, 3, v0
  v_mov_b32 v8, 0
  v_mov_b32 v9, 0
  ds_write_b64 v6, v[8:9] offset:0
  v_and_b32 v6, 31, v1
  v_lshlrev_b32 v6, 2, v6
  v_add_u32 v6, s13, v6
  ds_write_b32 v6, v7
  s_waitcnt lgkmcnt(0)
  s_lshl_b32 s9, s10, 16
  s_and_b32 s10, s10, 0xffff0000
  s_bitcmp1_b32 s7, 0
  s_cselect_b32 s10, s10, s9
  s_lshl_b32 s84, s68, 16
  s_and_b32 s85, s68, 0xffff0000
  s_lshl_b32 s86, s69, 16
  s_and_b32 s87, s69, 0xffff0000
  v_mov_b32 v15, 0x3fb8aa3b
  v_mul_f32 v14, s10, v15
  v_exp_f32 v14, v14
  s_nop 0
  v_cvt_pk_bf16_f32 v14, v14, v14
  v_lshlrev_b32 v14, 16, v14
  v_add_f32 v9, v14, v14
  v_mov_b32 v13, 0x3f80
  s_waitcnt vmcnt(8)
  v_lshlrev_b32 v16, 16, v16
  v_lshlrev_b32 v17, 16, v17
  v_lshlrev_b32 v18, 16, v18
  v_lshlrev_b32 v19, 16, v19
  v_mul_f32 v16, v16, v15
  v_exp_f32 v16, v16
  v_mul_f32 v17, v17, v14
  v_mul_f32 v52, v18, v9
  v_mul_f32 v53, v19, v9
  v_cvt_pk_bf16_f32 v16, v16, v16
  v_mul_f32 v17, 0x3e22f983, v17
  v_lshlrev_b32 v16, 16, v16
  v_mul_f32 v16, v16, v14
  s_waitcnt vmcnt(4)
  v_lshlrev_b32 v86, 16, v86
  v_mul_f32 v16, v16, v15
  v_lshlrev_b32 v87, 16, v87
  v_mul_f32 v32, 0x3f800000, v17
  v_lshlrev_b32 v88, 16, v88
  v_mul_f32 v28, 0xbf800000, v16
  v_lshlrev_b32 v89, 16, v89
  v_mul_f32 v33, 0x41000000, v17
  v_mul_f32 v86, v86, v15
  v_mul_f32 v29, 0xc1000000, v16
  v_exp_f32 v86, v86
  v_mul_f32 v34, 0x43000000, v17
  v_mul_f32 v87, v87, v14
  v_mul_f32 v30, 0xc3000000, v16
  v_mul_f32 v122, v88, v9
  v_fract_f32 v32, v32
  v_mul_f32 v123, v89, v9
  v_exp_f32 v28, v28
  v_cvt_pk_bf16_f32 v86, v86, v86
  v_fract_f32 v33, v33
  v_mul_f32 v87, 0x3e22f983, v87
  v_exp_f32 v29, v29
  v_lshlrev_b32 v86, 16, v86
  v_fract_f32 v34, v34
  v_mul_f32 v86, v86, v14
  s_waitcnt vmcnt(0)
  v_lshlrev_b32 v156, 16, v156
  v_exp_f32 v30, v30
  v_mul_f32 v86, v86, v15
  v_lshlrev_b32 v157, 16, v157
  v_cos_f32 v20, v32
  v_mul_f32 v102, 0x3f800000, v87
  v_lshlrev_b32 v158, 16, v158
  v_sin_f32 v21, v32
  v_mul_f32 v98, 0xbf800000, v86
  v_lshlrev_b32 v159, 16, v159
  v_cos_f32 v22, v33
  v_mul_f32 v103, 0x41000000, v87
  v_mul_f32 v156, v156, v15
  v_sin_f32 v23, v33
  v_mul_f32 v99, 0xc1000000, v86
  v_exp_f32 v156, v156
  v_cos_f32 v24, v34
  v_mul_f32 v104, 0x43000000, v87
  v_mul_f32 v157, v157, v14
  v_sin_f32 v25, v34
  v_mul_f32 v100, 0xc3000000, v86
  v_mul_f32 v192, v158, v9
  v_mul_f32 v20, v20, v28
  v_fract_f32 v102, v102
  v_mul_f32 v193, v159, v9
  v_mul_f32 v21, v21, v28
  v_exp_f32 v98, v98
  v_cvt_pk_bf16_f32 v156, v156, v156
  v_mul_f32 v22, v22, v29
  v_fract_f32 v103, v103
  v_mul_f32 v157, 0x3e22f983, v157
  v_mul_f32 v23, v23, v29
  v_exp_f32 v99, v99
  v_lshlrev_b32 v156, 16, v156
  v_mul_f32 v24, v24, v30
  v_fract_f32 v104, v104
  v_mul_f32 v156, v156, v14
  v_mul_f32 v25, v25, v30
  v_exp_f32 v100, v100
  v_mul_f32 v156, v156, v15
  ds_write_addtid_b32 v13 offset:0
  v_cos_f32 v90, v102
  v_mul_f32 v172, 0x3f800000, v157
  v_pk_mul_f32 v[40:41], v[20:21], v[20:21] op_sel:[0,0] op_sel_hi:[0,1]
  v_sin_f32 v91, v102
  v_mul_f32 v168, 0xbf800000, v156
  v_pk_mul_f32 v[26:27], v[22:23], v[22:23] op_sel:[0,0] op_sel_hi:[0,1]
  v_cos_f32 v92, v103
  v_mul_f32 v173, 0x41000000, v157
  v_pk_fma_f32 v[40:41], v[20:21], v[20:21], v[40:41] op_sel:[1,1,0] op_sel_hi:[1,0,1] neg_lo:[1,0,0]
  v_sin_f32 v93, v103
  v_mul_f32 v169, 0xc1000000, v156
  v_pk_fma_f32 v[26:27], v[22:23], v[22:23], v[26:27] op_sel:[1,1,0] op_sel_hi:[1,0,1] neg_lo:[1,0,0]
  v_cos_f32 v94, v104
  v_mul_f32 v174, 0x43000000, v157
  v_pk_mul_f32 v[42:43], v[40:41], v[20:21] op_sel:[0,0] op_sel_hi:[0,1]
  v_sin_f32 v95, v104
  v_mul_f32 v170, 0xc3000000, v156
  v_cvt_pk_bf16_f32 v28, v22, -v23
  v_mul_f32 v90, v90, v98
  v_fract_f32 v172, v172
  v_pk_fma_f32 v[42:43], v[40:41], v[20:21], v[42:43] op_sel:[1,1,0] op_sel_hi:[1,0,1] neg_lo:[1,0,0]
  v_mul_f32 v91, v91, v98
  v_exp_f32 v168, v168
  ds_write_addtid_b32 v28 offset:272
  v_mul_f32 v92, v92, v99
  v_fract_f32 v173, v173
  v_pk_mul_f32 v[44:45], v[40:41], v[40:41] op_sel:[0,0] op_sel_hi:[0,1]
  v_mul_f32 v93, v93, v99
  v_exp_f32 v169, v169
  v_cvt_pk_bf16_f32 v29, v26, -v27
  v_mul_f32 v94, v94, v100
  v_fract_f32 v174, v174
  v_pk_fma_f32 v[44:45], v[40:41], v[40:41], v[44:45] op_sel:[1,1,0] op_sel_hi:[1,0,1] neg_lo:[1,0,0]
  v_mul_f32 v95, v95, v100
  v_exp_f32 v170, v170
  ds_write_addtid_b32 v29 offset:544
  ds_write_addtid_b32 v13 offset:34816
  v_cos_f32 v160, v172
  v_pk_mul_f32 v[46:47], v[44:45], v[20:21] op_sel:[0,0] op_sel_hi:[0,1]
  v_pk_mul_f32 v[110:111], v[90:91], v[90:91] op_sel:[0,0] op_sel_hi:[0,1]
  v_sin_f32 v161, v172
  v_pk_mul_f32 v[38:39], v[22:23], v[26:27] op_sel:[0,0] op_sel_hi:[0,1]
  v_pk_mul_f32 v[96:97], v[92:93], v[92:93] op_sel:[0,0] op_sel_hi:[0,1]
  v_cos_f32 v162, v173
  v_pk_fma_f32 v[46:47], v[44:45], v[20:21], v[46:47] op_sel:[1,1,0] op_sel_hi:[1,0,1] neg_lo:[1,0,0]
  v_pk_fma_f32 v[110:111], v[90:91], v[90:91], v[110:111] op_sel:[1,1,0] op_sel_hi:[1,0,1] neg_lo:[1,0,0]
  v_sin_f32 v163, v173
  v_pk_fma_f32 v[38:39], v[22:23], v[26:27], v[38:39] op_sel:[1,1,0] op_sel_hi:[1,0,1] neg_lo:[1,0,0]
  v_pk_fma_f32 v[96:97], v[92:93], v[92:93], v[96:97] op_sel:[1,1,0] op_sel_hi:[1,0,1] neg_lo:[1,0,0]
  v_cos_f32 v164, v174
  v_pk_mul_f32 v[48:49], v[44:45], v[40:41] op_sel:[0,0] op_sel_hi:[0,1]
  v_pk_mul_f32 v[112:113], v[110:111], v[90:91] op_sel:[0,0] op_sel_hi:[0,1]
  v_sin_f32 v165, v174
  v_cvt_pk_bf16_f32 v30, v38, -v39
  v_cvt_pk_bf16_f32 v98, v92, -v93
  v_mul_f32 v160, v160, v168
  v_pk_fma_f32 v[48:49], v[44:45], v[40:41], v[48:49] op_sel:[1,1,0] op_sel_hi:[1,0,1] neg_lo:[1,0,0]
  v_pk_fma_f32 v[112:113], v[110:111], v[90:91], v[112:113] op_sel:[1,1,0] op_sel_hi:[1,0,1] neg_lo:[1,0,0]
  v_mul_f32 v161, v161, v168
  ds_write_addtid_b32 v30 offset:816
  ds_write_addtid_b32 v98 offset:35088
  v_mul_f32 v162, v162, v169
  v_pk_mul_f32 v[50:51], v[44:45], v[42:43] op_sel:[0,0] op_sel_hi:[0,1]
  v_pk_mul_f32 v[114:115], v[110:111], v[110:111] op_sel:[0,0] op_sel_hi:[0,1]
  v_mul_f32 v163, v163, v169
  v_pk_mul_f32 v[32:33], v[26:27], v[26:27] op_sel:[0,0] op_sel_hi:[0,1]
  v_cvt_pk_bf16_f32 v99, v96, -v97
  v_mul_f32 v164, v164, v170
  v_pk_fma_f32 v[50:51], v[44:45], v[42:43], v[50:51] op_sel:[1,1,0] op_sel_hi:[1,0,1] neg_lo:[1,0,0]
  v_pk_fma_f32 v[114:115], v[110:111], v[110:111], v[114:115] op_sel:[1,1,0] op_sel_hi:[1,0,1] neg_lo:[1,0,0]
  v_mul_f32 v165, v165, v170
  v_pk_fma_f32 v[32:33], v[26:27], v[26:27], v[32:33] op_sel:[1,1,0] op_sel_hi:[1,0,1] neg_lo:[1,0,0]
  ds_write_addtid_b32 v99 offset:35360
  ds_write_b32 v234, v13 offset:0
  v_pk_mul_f32 v[54:55], v[52:53], v[24:25] op_sel:[0,0] op_sel_hi:[0,1]
  v_pk_mul_f32 v[116:117], v[114:115], v[90:91] op_sel:[0,0] op_sel_hi:[0,1]
  v_pk_mul_f32 v[180:181], v[160:161], v[160:161] op_sel:[0,0] op_sel_hi:[0,1]
  v_cvt_pk_bf16_f32 v31, v32, -v33
  v_pk_mul_f32 v[108:109], v[92:93], v[96:97] op_sel:[0,0] op_sel_hi:[0,1]
  v_pk_mul_f32 v[166:167], v[162:163], v[162:163] op_sel:[0,0] op_sel_hi:[0,1]
  v_pk_fma_f32 v[54:55], v[52:53], v[24:25], v[54:55] op_sel:[1,1,0] op_sel_hi:[1,0,1] neg_lo:[1,0,0]
  v_pk_fma_f32 v[116:117], v[114:115], v[90:91], v[116:117] op_sel:[1,1,0] op_sel_hi:[1,0,1] neg_lo:[1,0,0]
  v_pk_fma_f32 v[180:181], v[160:161], v[160:161], v[180:181] op_sel:[1,1,0] op_sel_hi:[1,0,1] neg_lo:[1,0,0]
  ds_write_addtid_b32 v31 offset:1088
  v_pk_fma_f32 v[108:109], v[92:93], v[96:97], v[108:109] op_sel:[1,1,0] op_sel_hi:[1,0,1] neg_lo:[1,0,0]
  v_pk_fma_f32 v[166:167], v[162:163], v[162:163], v[166:167] op_sel:[1,1,0] op_sel_hi:[1,0,1] neg_lo:[1,0,0]
  v_pk_mul_f32 v[56:57], v[54:55], v[24:25] op_sel:[0,0] op_sel_hi:[0,1]
  v_pk_mul_f32 v[118:119], v[114:115], v[110:111] op_sel:[0,0] op_sel_hi:[0,1]
  v_pk_mul_f32 v[182:183], v[180:181], v[160:161] op_sel:[0,0] op_sel_hi:[0,1]
  v_pk_mul_f32 v[34:35], v[38:39], v[26:27] op_sel:[0,0] op_sel_hi:[0,1]
  v_cvt_pk_bf16_f32 v100, v108, -v109
  v_cvt_pk_bf16_f32 v168, v162, -v163
  v_pk_fma_f32 v[56:57], v[54:55], v[24:25], v[56:57] op_sel:[1,1,0] op_sel_hi:[1,0,1] neg_lo:[1,0,0]
  v_pk_fma_f32 v[118:119], v[114:115], v[110:111], v[118:119] op_sel:[1,1,0] op_sel_hi:[1,0,1] neg_lo:[1,0,0]
  v_pk_fma_f32 v[182:183], v[180:181], v[160:161], v[182:183] op_sel:[1,1,0] op_sel_hi:[1,0,1] neg_lo:[1,0,0]
  v_pk_fma_f32 v[34:35], v[38:39], v[26:27], v[34:35] op_sel:[1,1,0] op_sel_hi:[1,0,1] neg_lo:[1,0,0]
  ds_write_addtid_b32 v100 offset:35632
  ds_write_b32 v234, v168 offset:272
  v_pk_mul_f32 v[58:59], v[56:57], v[24:25] op_sel:[0,0] op_sel_hi:[0,1]
  v_pk_mul_f32 v[120:121], v[114:115], v[112:113] op_sel:[0,0] op_sel_hi:[0,1]
  v_pk_mul_f32 v[184:185], v[180:181], v[180:181] op_sel:[0,0] op_sel_hi:[0,1]
  v_cvt_pk_bf16_f32 v28, v34, -v35
  v_pk_mul_f32 v[102:103], v[96:97], v[96:97] op_sel:[0,0] op_sel_hi:[0,1]
  v_cvt_pk_bf16_f32 v169, v166, -v167
  v_pk_fma_f32 v[58:59], v[56:57], v[24:25], v[58:59] op_sel:[1,1,0] op_sel_hi:[1,0,1] neg_lo:[1,0,0]
  v_pk_fma_f32 v[120:121], v[114:115], v[112:113], v[120:121] op_sel:[1,1,0] op_sel_hi:[1,0,1] neg_lo:[1,0,0]
  v_pk_fma_f32 v[184:185], v[180:181], v[180:181], v[184:185] op_sel:[1,1,0] op_sel_hi:[1,0,1] neg_lo:[1,0,0]
  ds_write_addtid_b32 v28 offset:1360
  v_pk_fma_f32 v[102:103], v[96:97], v[96:97], v[102:103] op_sel:[1,1,0] op_sel_hi:[1,0,1] neg_lo:[1,0,0]
  ds_write_b32 v234, v169 offset:544
  v_pk_mul_f32 v[60:61], v[58:59], v[24:25] op_sel:[0,0] op_sel_hi:[0,1]
  v_pk_mul_f32 v[124:125], v[122:123], v[94:95] op_sel:[0,0] op_sel_hi:[0,1]
  v_pk_mul_f32 v[186:187], v[184:185], v[160:161] op_sel:[0,0] op_sel_hi:[0,1]
  v_pk_mul_f32 v[36:37], v[32:33], v[26:27] op_sel:[0,0] op_sel_hi:[0,1]
  v_cvt_pk_bf16_f32 v101, v102, -v103
  v_pk_mul_f32 v[178:179], v[162:163], v[166:167] op_sel:[0,0] op_sel_hi:[0,1]
  v_pk_fma_f32 v[60:61], v[58:59], v[24:25], v[60:61] op_sel:[1,1,0] op_sel_hi:[1,0,1] neg_lo:[1,0,0]
  v_pk_fma_f32 v[124:125], v[122:123], v[94:95], v[124:125] op_sel:[1,1,0] op_sel_hi:[1,0,1] neg_lo:[1,0,0]
  v_pk_fma_f32 v[186:187], v[184:185], v[160:161], v[186:187] op_sel:[1,1,0] op_sel_hi:[1,0,1] neg_lo:[1,0,0]
  v_pk_fma_f32 v[36:37], v[32:33], v[26:27], v[36:37] op_sel:[1,1,0] op_sel_hi:[1,0,1] neg_lo:[1,0,0]
  ds_write_addtid_b32 v101 offset:35904
  v_pk_fma_f32 v[178:179], v[162:163], v[166:167], v[178:179] op_sel:[1,1,0] op_sel_hi:[1,0,1] neg_lo:[1,0,0]
  v_pk_mul_f32 v[62:63], v[60:61], v[24:25] op_sel:[0,0] op_sel_hi:[0,1]
  v_pk_mul_f32 v[126:127], v[124:125], v[94:95] op_sel:[0,0] op_sel_hi:[0,1]
  v_pk_mul_f32 v[188:189], v[184:185], v[180:181] op_sel:[0,0] op_sel_hi:[0,1]
  v_cvt_pk_bf16_f32 v29, v36, -v37
  v_pk_mul_f32 v[104:105], v[108:109], v[96:97] op_sel:[0,0] op_sel_hi:[0,1]
  v_cvt_pk_bf16_f32 v170, v178, -v179
  v_pk_fma_f32 v[62:63], v[60:61], v[24:25], v[62:63] op_sel:[1,1,0] op_sel_hi:[1,0,1] neg_lo:[1,0,0]
  v_pk_fma_f32 v[126:127], v[124:125], v[94:95], v[126:127] op_sel:[1,1,0] op_sel_hi:[1,0,1] neg_lo:[1,0,0]
  v_pk_fma_f32 v[188:189], v[184:185], v[180:181], v[188:189] op_sel:[1,1,0] op_sel_hi:[1,0,1] neg_lo:[1,0,0]
  ds_write_addtid_b32 v29 offset:1632
  v_pk_fma_f32 v[104:105], v[108:109], v[96:97], v[104:105] op_sel:[1,1,0] op_sel_hi:[1,0,1] neg_lo:[1,0,0]
  ds_write_b32 v234, v170 offset:816
  v_pk_mul_f32 v[64:65], v[62:63], v[24:25] op_sel:[0,0] op_sel_hi:[0,1]
  v_pk_mul_f32 v[128:129], v[126:127], v[94:95] op_sel:[0,0] op_sel_hi:[0,1]
  v_pk_mul_f32 v[190:191], v[184:185], v[182:183] op_sel:[0,0] op_sel_hi:[0,1]
  v_pk_mul_f32 v[38:39], v[34:35], v[26:27] op_sel:[0,0] op_sel_hi:[0,1]
  v_cvt_pk_bf16_f32 v98, v104, -v105
  v_pk_mul_f32 v[172:173], v[166:167], v[166:167] op_sel:[0,0] op_sel_hi:[0,1]
  v_pk_fma_f32 v[64:65], v[62:63], v[24:25], v[64:65] op_sel:[1,1,0] op_sel_hi:[1,0,1] neg_lo:[1,0,0]
  v_pk_fma_f32 v[128:129], v[126:127], v[94:95], v[128:129] op_sel:[1,1,0] op_sel_hi:[1,0,1] neg_lo:[1,0,0]
  v_pk_fma_f32 v[190:191], v[184:185], v[182:183], v[190:191] op_sel:[1,1,0] op_sel_hi:[1,0,1] neg_lo:[1,0,0]
  v_pk_fma_f32 v[38:39], v[34:35], v[26:27], v[38:39] op_sel:[1,1,0] op_sel_hi:[1,0,1] neg_lo:[1,0,0]
  ds_write_addtid_b32 v98 offset:36176
  v_pk_fma_f32 v[172:173], v[166:167], v[166:167], v[172:173] op_sel:[1,1,0] op_sel_hi:[1,0,1] neg_lo:[1,0,0]
  v_pk_mul_f32 v[66:67], v[64:65], v[24:25] op_sel:[0,0] op_sel_hi:[0,1]
  v_pk_mul_f32 v[130:131], v[128:129], v[94:95] op_sel:[0,0] op_sel_hi:[0,1]
  v_pk_mul_f32 v[194:195], v[192:193], v[164:165] op_sel:[0,0] op_sel_hi:[0,1]
  v_cvt_pk_bf16_f32 v30, v38, -v39
  v_pk_mul_f32 v[106:107], v[102:103], v[96:97] op_sel:[0,0] op_sel_hi:[0,1]
  v_cvt_pk_bf16_f32 v171, v172, -v173
  v_pk_fma_f32 v[66:67], v[64:65], v[24:25], v[66:67] op_sel:[1,1,0] op_sel_hi:[1,0,1] neg_lo:[1,0,0]
  v_pk_fma_f32 v[130:131], v[128:129], v[94:95], v[130:131] op_sel:[1,1,0] op_sel_hi:[1,0,1] neg_lo:[1,0,0]
  v_pk_fma_f32 v[194:195], v[192:193], v[164:165], v[194:195] op_sel:[1,1,0] op_sel_hi:[1,0,1] neg_lo:[1,0,0]
  ds_write_addtid_b32 v30 offset:1904
  v_pk_fma_f32 v[106:107], v[102:103], v[96:97], v[106:107] op_sel:[1,1,0] op_sel_hi:[1,0,1] neg_lo:[1,0,0]
  ds_write_b32 v234, v171 offset:1088
  v_pk_mul_f32 v[68:69], v[66:67], v[24:25] op_sel:[0,0] op_sel_hi:[0,1]
  v_pk_mul_f32 v[132:133], v[130:131], v[94:95] op_sel:[0,0] op_sel_hi:[0,1]
  v_pk_mul_f32 v[196:197], v[194:195], v[164:165] op_sel:[0,0] op_sel_hi:[0,1]
  v_pk_mul_f32 v[32:33], v[36:37], v[26:27] op_sel:[0,0] op_sel_hi:[0,1]
  v_cvt_pk_bf16_f32 v99, v106, -v107
  v_pk_mul_f32 v[174:175], v[178:179], v[166:167] op_sel:[0,0] op_sel_hi:[0,1]
  v_pk_fma_f32 v[68:69], v[66:67], v[24:25], v[68:69] op_sel:[1,1,0] op_sel_hi:[1,0,1] neg_lo:[1,0,0]
  v_pk_fma_f32 v[132:133], v[130:131], v[94:95], v[132:133] op_sel:[1,1,0] op_sel_hi:[1,0,1] neg_lo:[1,0,0]
  v_pk_fma_f32 v[196:197], v[194:195], v[164:165], v[196:197] op_sel:[1,1,0] op_sel_hi:[1,0,1] neg_lo:[1,0,0]
  v_pk_fma_f32 v[32:33], v[36:37], v[26:27], v[32:33] op_sel:[1,1,0] op_sel_hi:[1,0,1] neg_lo:[1,0,0]
  ds_write_addtid_b32 v99 offset:36448
  global_load_dwordx4 a[208:211], v227, s[32:33] offset:0
  v_pk_fma_f32 v[174:175], v[178:179], v[166:167], v[174:175] op_sel:[1,1,0] op_sel_hi:[1,0,1] neg_lo:[1,0,0]
  global_load_dwordx4 a[212:215], v227, s[32:33] offset:1024
  v_pk_mul_f32 v[70:71], v[68:69], v[24:25] op_sel:[0,0] op_sel_hi:[0,1]
  global_load_dwordx4 a[216:219], v227, s[32:33] offset:2048
  v_pk_mul_f32 v[134:135], v[132:133], v[94:95] op_sel:[0,0] op_sel_hi:[0,1]
  global_load_dwordx4 a[220:223], v227, s[34:35] offset:0
  v_pk_mul_f32 v[198:199], v[196:197], v[164:165] op_sel:[0,0] op_sel_hi:[0,1]
  global_load_dwordx4 a[224:227], v227, s[34:35] offset:1024
  v_cvt_pk_bf16_f32 v31, v32, -v33
  global_load_dwordx4 a[228:231], v227, s[34:35] offset:2048
  v_pk_mul_f32 v[108:109], v[104:105], v[96:97] op_sel:[0,0] op_sel_hi:[0,1]
  global_load_dwordx4 a[232:235], v227, s[60:61] offset:0
  v_cvt_pk_bf16_f32 v168, v174, -v175
  global_load_dwordx4 a[236:239], v227, s[60:61] offset:1024
  v_pk_fma_f32 v[70:71], v[68:69], v[24:25], v[70:71] op_sel:[1,1,0] op_sel_hi:[1,0,1] neg_lo:[1,0,0]
  global_load_dwordx4 a[240:243], v227, s[60:61] offset:2048
  v_pk_fma_f32 v[134:135], v[132:133], v[94:95], v[134:135] op_sel:[1,1,0] op_sel_hi:[1,0,1] neg_lo:[1,0,0]
  v_pk_fma_f32 v[198:199], v[196:197], v[164:165], v[198:199] op_sel:[1,1,0] op_sel_hi:[1,0,1] neg_lo:[1,0,0]
  ds_write_addtid_b32 v31 offset:2176
  v_pk_fma_f32 v[108:109], v[104:105], v[96:97], v[108:109] op_sel:[1,1,0] op_sel_hi:[1,0,1] neg_lo:[1,0,0]
  ds_write_b32 v234, v168 offset:1360
  v_pk_mul_f32 v[72:73], v[70:71], v[24:25] op_sel:[0,0] op_sel_hi:[0,1]
  v_pk_mul_f32 v[136:137], v[134:135], v[94:95] op_sel:[0,0] op_sel_hi:[0,1]
  v_pk_mul_f32 v[200:201], v[198:199], v[164:165] op_sel:[0,0] op_sel_hi:[0,1]
  v_pk_mul_f32 v[34:35], v[38:39], v[26:27] op_sel:[0,0] op_sel_hi:[0,1]
  v_cvt_pk_bf16_f32 v100, v108, -v109
  v_pk_mul_f32 v[176:177], v[172:173], v[166:167] op_sel:[0,0] op_sel_hi:[0,1]
  v_pk_fma_f32 v[72:73], v[70:71], v[24:25], v[72:73] op_sel:[1,1,0] op_sel_hi:[1,0,1] neg_lo:[1,0,0]
  v_pk_fma_f32 v[136:137], v[134:135], v[94:95], v[136:137] op_sel:[1,1,0] op_sel_hi:[1,0,1] neg_lo:[1,0,0]
  v_pk_fma_f32 v[200:201], v[198:199], v[164:165], v[200:201] op_sel:[1,1,0] op_sel_hi:[1,0,1] neg_lo:[1,0,0]
  v_pk_fma_f32 v[34:35], v[38:39], v[26:27], v[34:35] op_sel:[1,1,0] op_sel_hi:[1,0,1] neg_lo:[1,0,0]
  ds_write_addtid_b32 v100 offset:36720
  v_pk_fma_f32 v[176:177], v[172:173], v[166:167], v[176:177] op_sel:[1,1,0] op_sel_hi:[1,0,1] neg_lo:[1,0,0]
  v_pk_mul_f32 v[74:75], v[72:73], v[24:25] op_sel:[0,0] op_sel_hi:[0,1]
  v_pk_mul_f32 v[138:139], v[136:137], v[94:95] op_sel:[0,0] op_sel_hi:[0,1]
  v_pk_mul_f32 v[202:203], v[200:201], v[164:165] op_sel:[0,0] op_sel_hi:[0,1]
  v_cvt_pk_bf16_f32 v28, v34, -v35
  v_pk_mul_f32 v[102:103], v[106:107], v[96:97] op_sel:[0,0] op_sel_hi:[0,1]
  v_cvt_pk_bf16_f32 v169, v176, -v177
  v_pk_fma_f32 v[74:75], v[72:73], v[24:25], v[74:75] op_sel:[1,1,0] op_sel_hi:[1,0,1] neg_lo:[1,0,0]
  v_pk_fma_f32 v[138:139], v[136:137], v[94:95], v[138:139] op_sel:[1,1,0] op_sel_hi:[1,0,1] neg_lo:[1,0,0]
  v_pk_fma_f32 v[202:203], v[200:201], v[164:165], v[202:203] op_sel:[1,1,0] op_sel_hi:[1,0,1] neg_lo:[1,0,0]
  ds_write_addtid_b32 v28 offset:2448
  v_pk_fma_f32 v[102:103], v[106:107], v[96:97], v[102:103] op_sel:[1,1,0] op_sel_hi:[1,0,1] neg_lo:[1,0,0]
  ds_write_b32 v234, v169 offset:1632
  v_pk_mul_f32 v[76:77], v[74:75], v[24:25] op_sel:[0,0] op_sel_hi:[0,1]
  v_pk_mul_f32 v[140:141], v[138:139], v[94:95] op_sel:[0,0] op_sel_hi:[0,1]
  v_pk_mul_f32 v[204:205], v[202:203], v[164:165] op_sel:[0,0] op_sel_hi:[0,1]
  v_pk_mul_f32 v[36:37], v[32:33], v[26:27] op_sel:[0,0] op_sel_hi:[0,1]
  v_cvt_pk_bf16_f32 v101, v102, -v103
  v_pk_mul_f32 v[178:179], v[174:175], v[166:167] op_sel:[0,0] op_sel_hi:[0,1]
  v_pk_fma_f32 v[76:77], v[74:75], v[24:25], v[76:77] op_sel:[1,1,0] op_sel_hi:[1,0,1] neg_lo:[1,0,0]
  v_pk_fma_f32 v[140:141], v[138:139], v[94:95], v[140:141] op_sel:[1,1,0] op_sel_hi:[1,0,1] neg_lo:[1,0,0]
  v_pk_fma_f32 v[204:205], v[202:203], v[164:165], v[204:205] op_sel:[1,1,0] op_sel_hi:[1,0,1] neg_lo:[1,0,0]
  v_pk_fma_f32 v[36:37], v[32:33], v[26:27], v[36:37] op_sel:[1,1,0] op_sel_hi:[1,0,1] neg_lo:[1,0,0]
  ds_write_addtid_b32 v101 offset:36992
  v_pk_fma_f32 v[178:179], v[174:175], v[166:167], v[178:179] op_sel:[1,1,0] op_sel_hi:[1,0,1] neg_lo:[1,0,0]
  v_pk_mul_f32 v[78:79], v[76:77], v[24:25] op_sel:[0,0] op_sel_hi:[0,1]
  v_pk_mul_f32 v[142:143], v[140:141], v[94:95] op_sel:[0,0] op_sel_hi:[0,1]
  v_pk_mul_f32 v[206:207], v[204:205], v[164:165] op_sel:[0,0] op_sel_hi:[0,1]
  v_cvt_pk_bf16_f32 v29, v36, -v37
  v_pk_mul_f32 v[104:105], v[108:109], v[96:97] op_sel:[0,0] op_sel_hi:[0,1]
  v_cvt_pk_bf16_f32 v170, v178, -v179
  v_pk_fma_f32 v[78:79], v[76:77], v[24:25], v[78:79] op_sel:[1,1,0] op_sel_hi:[1,0,1] neg_lo:[1,0,0]
  v_pk_fma_f32 v[142:143], v[140:141], v[94:95], v[142:143] op_sel:[1,1,0] op_sel_hi:[1,0,1] neg_lo:[1,0,0]
  v_pk_fma_f32 v[206:207], v[204:205], v[164:165], v[206:207] op_sel:[1,1,0] op_sel_hi:[1,0,1] neg_lo:[1,0,0]
  ds_write_addtid_b32 v29 offset:2720
  v_pk_fma_f32 v[104:105], v[108:109], v[96:97], v[104:105] op_sel:[1,1,0] op_sel_hi:[1,0,1] neg_lo:[1,0,0]
  ds_write_b32 v234, v170 offset:1904
  v_pk_mul_f32 v[80:81], v[78:79], v[24:25] op_sel:[0,0] op_sel_hi:[0,1]
  v_pk_mul_f32 v[144:145], v[142:143], v[94:95] op_sel:[0,0] op_sel_hi:[0,1]
  v_pk_mul_f32 v[208:209], v[206:207], v[164:165] op_sel:[0,0] op_sel_hi:[0,1]
  v_pk_mul_f32 v[38:39], v[34:35], v[26:27] op_sel:[0,0] op_sel_hi:[0,1]
  v_cvt_pk_bf16_f32 v98, v104, -v105
  v_pk_mul_f32 v[172:173], v[176:177], v[166:167] op_sel:[0,0] op_sel_hi:[0,1]
  v_pk_fma_f32 v[80:81], v[78:79], v[24:25], v[80:81] op_sel:[1,1,0] op_sel_hi:[1,0,1] neg_lo:[1,0,0]
  v_pk_fma_f32 v[144:145], v[142:143], v[94:95], v[144:145] op_sel:[1,1,0] op_sel_hi:[1,0,1] neg_lo:[1,0,0]
  v_pk_fma_f32 v[208:209], v[206:207], v[164:165], v[208:209] op_sel:[1,1,0] op_sel_hi:[1,0,1] neg_lo:[1,0,0]
  v_pk_fma_f32 v[38:39], v[34:35], v[26:27], v[38:39] op_sel:[1,1,0] op_sel_hi:[1,0,1] neg_lo:[1,0,0]
  ds_write_addtid_b32 v98 offset:37264
  v_pk_fma_f32 v[172:173], v[176:177], v[166:167], v[172:173] op_sel:[1,1,0] op_sel_hi:[1,0,1] neg_lo:[1,0,0]
  v_pk_mul_f32 v[82:83], v[80:81], v[24:25] op_sel:[0,0] op_sel_hi:[0,1]
  v_pk_mul_f32 v[146:147], v[144:145], v[94:95] op_sel:[0,0] op_sel_hi:[0,1]
  v_pk_mul_f32 v[210:211], v[208:209], v[164:165] op_sel:[0,0] op_sel_hi:[0,1]
  v_cvt_pk_bf16_f32 v30, v38, -v39
  v_pk_mul_f32 v[106:107], v[102:103], v[96:97] op_sel:[0,0] op_sel_hi:[0,1]
  v_cvt_pk_bf16_f32 v171, v172, -v173
  v_pk_fma_f32 v[82:83], v[80:81], v[24:25], v[82:83] op_sel:[1,1,0] op_sel_hi:[1,0,1] neg_lo:[1,0,0]
  v_pk_fma_f32 v[146:147], v[144:145], v[94:95], v[146:147] op_sel:[1,1,0] op_sel_hi:[1,0,1] neg_lo:[1,0,0]
  v_pk_fma_f32 v[210:211], v[208:209], v[164:165], v[210:211] op_sel:[1,1,0] op_sel_hi:[1,0,1] neg_lo:[1,0,0]
  ds_write_addtid_b32 v30 offset:2992
  v_pk_fma_f32 v[106:107], v[102:103], v[96:97], v[106:107] op_sel:[1,1,0] op_sel_hi:[1,0,1] neg_lo:[1,0,0]
  ds_write_b32 v234, v171 offset:2176
  v_pk_mul_f32 v[84:85], v[82:83], v[24:25] op_sel:[0,0] op_sel_hi:[0,1]
  v_pk_mul_f32 v[148:149], v[146:147], v[94:95] op_sel:[0,0] op_sel_hi:[0,1]
  v_pk_mul_f32 v[212:213], v[210:211], v[164:165] op_sel:[0,0] op_sel_hi:[0,1]
  v_pk_mul_f32 v[32:33], v[36:37], v[26:27] op_sel:[0,0] op_sel_hi:[0,1]
  v_cvt_pk_bf16_f32 v99, v106, -v107
  v_pk_mul_f32 v[174:175], v[178:179], v[166:167] op_sel:[0,0] op_sel_hi:[0,1]
  v_pk_fma_f32 v[84:85], v[82:83], v[24:25], v[84:85] op_sel:[1,1,0] op_sel_hi:[1,0,1] neg_lo:[1,0,0]
  v_pk_fma_f32 v[148:149], v[146:147], v[94:95], v[148:149] op_sel:[1,1,0] op_sel_hi:[1,0,1] neg_lo:[1,0,0]
  v_pk_fma_f32 v[212:213], v[210:211], v[164:165], v[212:213] op_sel:[1,1,0] op_sel_hi:[1,0,1] neg_lo:[1,0,0]
  v_pk_fma_f32 v[32:33], v[36:37], v[26:27], v[32:33] op_sel:[1,1,0] op_sel_hi:[1,0,1] neg_lo:[1,0,0]
  ds_write_addtid_b32 v99 offset:37536
  v_pk_fma_f32 v[174:175], v[178:179], v[166:167], v[174:175] op_sel:[1,1,0] op_sel_hi:[1,0,1] neg_lo:[1,0,0]
  v_cvt_pk_bf16_f32 v31, v32, -v33
  v_pk_mul_f32 v[150:151], v[148:149], v[94:95] op_sel:[0,0] op_sel_hi:[0,1]
  v_pk_mul_f32 v[214:215], v[212:213], v[164:165] op_sel:[0,0] op_sel_hi:[0,1]
  ds_write_addtid_b32 v31 offset:3264
  v_pk_mul_f32 v[108:109], v[104:105], v[96:97] op_sel:[0,0] op_sel_hi:[0,1]
  v_cvt_pk_bf16_f32 v168, v174, -v175
  v_pk_mul_f32 v[34:35], v[38:39], v[26:27] op_sel:[0,0] op_sel_hi:[0,1]
  v_pk_fma_f32 v[150:151], v[148:149], v[94:95], v[150:151] op_sel:[1,1,0] op_sel_hi:[1,0,1] neg_lo:[1,0,0]
  v_pk_fma_f32 v[214:215], v[212:213], v[164:165], v[214:215] op_sel:[1,1,0] op_sel_hi:[1,0,1] neg_lo:[1,0,0]
  v_pk_fma_f32 v[34:35], v[38:39], v[26:27], v[34:35] op_sel:[1,1,0] op_sel_hi:[1,0,1] neg_lo:[1,0,0]
  v_pk_fma_f32 v[108:109], v[104:105], v[96:97], v[108:109] op_sel:[1,1,0] op_sel_hi:[1,0,1] neg_lo:[1,0,0]
  ds_write_b32 v234, v168 offset:2448
  v_cvt_pk_bf16_f32 v28, v34, -v35
  v_pk_mul_f32 v[152:153], v[150:151], v[94:95] op_sel:[0,0] op_sel_hi:[0,1]
  v_pk_mul_f32 v[216:217], v[214:215], v[164:165] op_sel:[0,0] op_sel_hi:[0,1]
  ds_write_addtid_b32 v28 offset:3536
  v_cvt_pk_bf16_f32 v100, v108, -v109
  v_pk_mul_f32 v[176:177], v[172:173], v[166:167] op_sel:[0,0] op_sel_hi:[0,1]
  v_pk_mul_f32 v[36:37], v[32:33], v[26:27] op_sel:[0,0] op_sel_hi:[0,1]
  v_pk_fma_f32 v[152:153], v[150:151], v[94:95], v[152:153] op_sel:[1,1,0] op_sel_hi:[1,0,1] neg_lo:[1,0,0]
  v_pk_fma_f32 v[216:217], v[214:215], v[164:165], v[216:217] op_sel:[1,1,0] op_sel_hi:[1,0,1] neg_lo:[1,0,0]
  v_pk_fma_f32 v[36:37], v[32:33], v[26:27], v[36:37] op_sel:[1,1,0] op_sel_hi:[1,0,1] neg_lo:[1,0,0]
  ds_write_addtid_b32 v100 offset:37808
  v_pk_fma_f32 v[176:177], v[172:173], v[166:167], v[176:177] op_sel:[1,1,0] op_sel_hi:[1,0,1] neg_lo:[1,0,0]
  v_cvt_pk_bf16_f32 v29, v36, -v37
  v_pk_mul_f32 v[154:155], v[152:153], v[94:95] op_sel:[0,0] op_sel_hi:[0,1]
  v_pk_mul_f32 v[218:219], v[216:217], v[164:165] op_sel:[0,0] op_sel_hi:[0,1]
  ds_write_addtid_b32 v29 offset:3808
  v_pk_mul_f32 v[102:103], v[106:107], v[96:97] op_sel:[0,0] op_sel_hi:[0,1]
  v_cvt_pk_bf16_f32 v169, v176, -v177
  v_pk_mul_f32 v[38:39], v[34:35], v[26:27] op_sel:[0,0] op_sel_hi:[0,1]
  v_pk_fma_f32 v[154:155], v[152:153], v[94:95], v[154:155] op_sel:[1,1,0] op_sel_hi:[1,0,1] neg_lo:[1,0,0]
  v_pk_fma_f32 v[218:219], v[216:217], v[164:165], v[218:219] op_sel:[1,1,0] op_sel_hi:[1,0,1] neg_lo:[1,0,0]
  v_pk_fma_f32 v[38:39], v[34:35], v[26:27], v[38:39] op_sel:[1,1,0] op_sel_hi:[1,0,1] neg_lo:[1,0,0]
  v_pk_fma_f32 v[102:103], v[106:107], v[96:97], v[102:103] op_sel:[1,1,0] op_sel_hi:[1,0,1] neg_lo:[1,0,0]
  ds_write_b32 v234, v169 offset:2720
  v_cvt_pk_bf16_f32 v30, v38, -v39
  v_cvt_pk_bf16_f32 v101, v102, -v103
  v_pk_mul_f32 v[220:221], v[218:219], v[164:165] op_sel:[0,0] op_sel_hi:[0,1]
  ds_write_addtid_b32 v30 offset:4080
  ds_write_addtid_b32 v101 offset:38080
  v_pk_mul_f32 v[178:179], v[174:175], v[166:167] op_sel:[0,0] op_sel_hi:[0,1]
  ds_read_b128 a[0:3], v4 offset:0
  v_pk_mul_f32 v[104:105], v[108:109], v[96:97] op_sel:[0,0] op_sel_hi:[0,1]
  v_pk_fma_f32 v[220:221], v[218:219], v[164:165], v[220:221] op_sel:[1,1,0] op_sel_hi:[1,0,1] neg_lo:[1,0,0]
  ds_read_b128 a[4:7], v4 offset:64
  v_pk_fma_f32 v[104:105], v[108:109], v[96:97], v[104:105] op_sel:[1,1,0] op_sel_hi:[1,0,1] neg_lo:[1,0,0]
  v_pk_fma_f32 v[178:179], v[174:175], v[166:167], v[178:179] op_sel:[1,1,0] op_sel_hi:[1,0,1] neg_lo:[1,0,0]
  ds_read_b128 a[8:11], v4 offset:128
  v_cvt_pk_bf16_f32 v98, v104, -v105
  v_pk_mul_f32 v[222:223], v[220:221], v[164:165] op_sel:[0,0] op_sel_hi:[0,1]
  ds_read_b128 a[12:15], v4 offset:192
  ds_write_addtid_b32 v98 offset:38352
  v_cvt_pk_bf16_f32 v170, v178, -v179
  v_cvt_pk_bf16_f32 v31, v52, v53
  v_pk_mul_f32 v[106:107], v[102:103], v[96:97] op_sel:[0,0] op_sel_hi:[0,1]
  v_pk_fma_f32 v[222:223], v[220:221], v[164:165], v[222:223] op_sel:[1,1,0] op_sel_hi:[1,0,1] neg_lo:[1,0,0]
  ds_write_addtid_b32 v31 offset:4352
  v_pk_fma_f32 v[106:107], v[102:103], v[96:97], v[106:107] op_sel:[1,1,0] op_sel_hi:[1,0,1] neg_lo:[1,0,0]
  ds_write_b32 v234, v170 offset:2992
  v_pk_mul_f32 v[32:33], v[52:53], v[20:21] op_sel:[0,0] op_sel_hi:[0,1]
  v_cvt_pk_bf16_f32 v99, v106, -v107
  v_pk_mul_f32 v[224:225], v[222:223], v[164:165] op_sel:[0,0] op_sel_hi:[0,1]
  v_pk_fma_f32 v[32:33], v[52:53], v[20:21], v[32:33] op_sel:[1,1,0] op_sel_hi:[1,0,1] neg_lo:[1,0,0]
  ds_write_addtid_b32 v99 offset:38624
  v_pk_mul_f32 v[172:173], v[176:177], v[166:167] op_sel:[0,0] op_sel_hi:[0,1]
  v_cvt_pk_bf16_f32 v28, v32, v33
  v_pk_mul_f32 v[108:109], v[104:105], v[96:97] op_sel:[0,0] op_sel_hi:[0,1]
  v_pk_fma_f32 v[224:225], v[222:223], v[164:165], v[224:225] op_sel:[1,1,0] op_sel_hi:[1,0,1] neg_lo:[1,0,0]
  ds_write_addtid_b32 v28 offset:4624
  v_pk_fma_f32 v[108:109], v[104:105], v[96:97], v[108:109] op_sel:[1,1,0] op_sel_hi:[1,0,1] neg_lo:[1,0,0]
  v_pk_fma_f32 v[172:173], v[176:177], v[166:167], v[172:173] op_sel:[1,1,0] op_sel_hi:[1,0,1] neg_lo:[1,0,0]
  v_pk_mul_f32 v[34:35], v[52:53], v[40:41] op_sel:[0,0] op_sel_hi:[0,1]
  v_cvt_pk_bf16_f32 v100, v108, -v109
  v_cvt_pk_bf16_f32 v171, v172, -v173
  v_pk_fma_f32 v[34:35], v[52:53], v[40:41], v[34:35] op_sel:[1,1,0] op_sel_hi:[1,0,1] neg_lo:[1,0,0]
  ds_write_addtid_b32 v100 offset:38896
  ds_write_b32 v234, v171 offset:3264
  v_cvt_pk_bf16_f32 v29, v34, v35
  ds_read_b128 a[64:67], v4 offset:34816
  v_pk_mul_f32 v[174:175], v[178:179], v[166:167] op_sel:[0,0] op_sel_hi:[0,1]
  ds_write_addtid_b32 v29 offset:4896
  ds_read_b128 a[68:71], v4 offset:34880
  v_pk_fma_f32 v[174:175], v[178:179], v[166:167], v[174:175] op_sel:[1,1,0] op_sel_hi:[1,0,1] neg_lo:[1,0,0]
  v_pk_mul_f32 v[36:37], v[52:53], v[42:43] op_sel:[0,0] op_sel_hi:[0,1]
  ds_read_b128 a[72:75], v4 offset:34944
  v_cvt_pk_bf16_f32 v168, v174, -v175
  v_pk_fma_f32 v[36:37], v[52:53], v[42:43], v[36:37] op_sel:[1,1,0] op_sel_hi:[1,0,1] neg_lo:[1,0,0]
  ds_read_b128 a[76:79], v4 offset:35008
  ds_write_b32 v234, v168 offset:3536
  v_cvt_pk_bf16_f32 v30, v36, v37
  v_cvt_pk_bf16_f32 v101, v122, v123
  v_pk_mul_f32 v[176:177], v[172:173], v[166:167] op_sel:[0,0] op_sel_hi:[0,1]
  ds_write_addtid_b32 v30 offset:5168
  ds_write_addtid_b32 v101 offset:39168
  v_pk_fma_f32 v[176:177], v[172:173], v[166:167], v[176:177] op_sel:[1,1,0] op_sel_hi:[1,0,1] neg_lo:[1,0,0]
  v_pk_mul_f32 v[38:39], v[52:53], v[44:45] op_sel:[0,0] op_sel_hi:[0,1]
  v_pk_mul_f32 v[102:103], v[122:123], v[90:91] op_sel:[0,0] op_sel_hi:[0,1]
  v_cvt_pk_bf16_f32 v169, v176, -v177
  v_pk_fma_f32 v[38:39], v[52:53], v[44:45], v[38:39] op_sel:[1,1,0] op_sel_hi:[1,0,1] neg_lo:[1,0,0]
  v_pk_fma_f32 v[102:103], v[122:123], v[90:91], v[102:103] op_sel:[1,1,0] op_sel_hi:[1,0,1] neg_lo:[1,0,0]
  ds_write_b32 v234, v169 offset:3808
  v_cvt_pk_bf16_f32 v31, v38, v39
  v_cvt_pk_bf16_f32 v98, v102, v103
  v_pk_mul_f32 v[178:179], v[174:175], v[166:167] op_sel:[0,0] op_sel_hi:[0,1]
  ds_write_addtid_b32 v31 offset:5440
  ds_write_addtid_b32 v98 offset:39440
  v_pk_fma_f32 v[178:179], v[174:175], v[166:167], v[178:179] op_sel:[1,1,0] op_sel_hi:[1,0,1] neg_lo:[1,0,0]
  v_pk_mul_f32 v[32:33], v[52:53], v[46:47] op_sel:[0,0] op_sel_hi:[0,1]
  v_pk_mul_f32 v[104:105], v[122:123], v[110:111] op_sel:[0,0] op_sel_hi:[0,1]
  v_cvt_pk_bf16_f32 v170, v178, -v179
  v_pk_fma_f32 v[32:33], v[52:53], v[46:47], v[32:33] op_sel:[1,1,0] op_sel_hi:[1,0,1] neg_lo:[1,0,0]
  v_pk_fma_f32 v[104:105], v[122:123], v[110:111], v[104:105] op_sel:[1,1,0] op_sel_hi:[1,0,1] neg_lo:[1,0,0]
  ds_write_b32 v234, v170 offset:4080
  v_cvt_pk_bf16_f32 v28, v32, v33
  v_cvt_pk_bf16_f32 v99, v104, v105
  ds_read_b128 a[128:131], v235 offset:0
  ds_write_addtid_b32 v28 offset:5712
  ds_write_addtid_b32 v99 offset:39712
  ds_read_b128 a[132:135], v235 offset:64
  v_pk_mul_f32 v[34:35], v[52:53], v[48:49] op_sel:[0,0] op_sel_hi:[0,1]
  v_pk_mul_f32 v[106:107], v[122:123], v[112:113] op_sel:[0,0] op_sel_hi:[0,1]
  ds_read_b128 a[136:139], v235 offset:128
  v_pk_fma_f32 v[34:35], v[52:53], v[48:49], v[34:35] op_sel:[1,1,0] op_sel_hi:[1,0,1] neg_lo:[1,0,0]
  v_pk_fma_f32 v[106:107], v[122:123], v[112:113], v[106:107] op_sel:[1,1,0] op_sel_hi:[1,0,1] neg_lo:[1,0,0]
  ds_read_b128 a[140:143], v235 offset:192
  v_cvt_pk_bf16_f32 v29, v34, v35
  v_cvt_pk_bf16_f32 v100, v106, v107
  v_cvt_pk_bf16_f32 v171, v192, v193
  ds_write_addtid_b32 v29 offset:5984
  ds_write_addtid_b32 v100 offset:39984
  ds_write_b32 v234, v171 offset:4352
  v_pk_mul_f32 v[36:37], v[52:53], v[50:51] op_sel:[0,0] op_sel_hi:[0,1]
  v_pk_mul_f32 v[108:109], v[122:123], v[114:115] op_sel:[0,0] op_sel_hi:[0,1]
  v_pk_mul_f32 v[172:173], v[192:193], v[160:161] op_sel:[0,0] op_sel_hi:[0,1]
  v_pk_fma_f32 v[36:37], v[52:53], v[50:51], v[36:37] op_sel:[1,1,0] op_sel_hi:[1,0,1] neg_lo:[1,0,0]
  v_pk_fma_f32 v[108:109], v[122:123], v[114:115], v[108:109] op_sel:[1,1,0] op_sel_hi:[1,0,1] neg_lo:[1,0,0]
  v_pk_fma_f32 v[172:173], v[192:193], v[160:161], v[172:173] op_sel:[1,1,0] op_sel_hi:[1,0,1] neg_lo:[1,0,0]
  v_cvt_pk_bf16_f32 v30, v36, v37
  v_cvt_pk_bf16_f32 v101, v108, v109
  v_cvt_pk_bf16_f32 v168, v172, v173
  ds_write_addtid_b32 v30 offset:6256
  ds_write_addtid_b32 v101 offset:40256
  ds_write_b32 v234, v168 offset:4624
  v_cvt_pk_bf16_f32 v31, v54, v55
  v_pk_mul_f32 v[102:103], v[122:123], v[116:117] op_sel:[0,0] op_sel_hi:[0,1]
  v_pk_mul_f32 v[174:175], v[192:193], v[180:181] op_sel:[0,0] op_sel_hi:[0,1]
  ds_write_addtid_b32 v31 offset:6528
  v_pk_fma_f32 v[102:103], v[122:123], v[116:117], v[102:103] op_sel:[1,1,0] op_sel_hi:[1,0,1] neg_lo:[1,0,0]
  v_pk_fma_f32 v[174:175], v[192:193], v[180:181], v[174:175] op_sel:[1,1,0] op_sel_hi:[1,0,1] neg_lo:[1,0,0]
  v_pk_mul_f32 v[38:39], v[54:55], v[20:21] op_sel:[0,0] op_sel_hi:[0,1]
  v_cvt_pk_bf16_f32 v98, v102, v103
  v_cvt_pk_bf16_f32 v169, v174, v175
  v_pk_fma_f32 v[38:39], v[54:55], v[20:21], v[38:39] op_sel:[1,1,0] op_sel_hi:[1,0,1] neg_lo:[1,0,0]
  ds_write_addtid_b32 v98 offset:40528
  ds_write_b32 v234, v169 offset:4896
  v_cvt_pk_bf16_f32 v28, v38, v39
  v_pk_mul_f32 v[104:105], v[122:123], v[118:119] op_sel:[0,0] op_sel_hi:[0,1]
  v_pk_mul_f32 v[176:177], v[192:193], v[182:183] op_sel:[0,0] op_sel_hi:[0,1]
  ds_write_addtid_b32 v28 offset:6800
  v_pk_fma_f32 v[104:105], v[122:123], v[118:119], v[104:105] op_sel:[1,1,0] op_sel_hi:[1,0,1] neg_lo:[1,0,0]
  v_pk_fma_f32 v[176:177], v[192:193], v[182:183], v[176:177] op_sel:[1,1,0] op_sel_hi:[1,0,1] neg_lo:[1,0,0]
  v_pk_mul_f32 v[32:33], v[54:55], v[40:41] op_sel:[0,0] op_sel_hi:[0,1]
  v_cvt_pk_bf16_f32 v99, v104, v105
  v_cvt_pk_bf16_f32 v170, v176, v177
  v_pk_fma_f32 v[32:33], v[54:55], v[40:41], v[32:33] op_sel:[1,1,0] op_sel_hi:[1,0,1] neg_lo:[1,0,0]
  ds_write_addtid_b32 v99 offset:40800
  ds_write_b32 v234, v170 offset:5168
  v_cvt_pk_bf16_f32 v29, v32, v33
  v_pk_mul_f32 v[106:107], v[122:123], v[120:121] op_sel:[0,0] op_sel_hi:[0,1]
  v_pk_mul_f32 v[178:179], v[192:193], v[184:185] op_sel:[0,0] op_sel_hi:[0,1]
  ds_write_addtid_b32 v29 offset:7072
  v_pk_fma_f32 v[106:107], v[122:123], v[120:121], v[106:107] op_sel:[1,1,0] op_sel_hi:[1,0,1] neg_lo:[1,0,0]
  v_pk_fma_f32 v[178:179], v[192:193], v[184:185], v[178:179] op_sel:[1,1,0] op_sel_hi:[1,0,1] neg_lo:[1,0,0]
  v_pk_mul_f32 v[34:35], v[54:55], v[42:43] op_sel:[0,0] op_sel_hi:[0,1]
  v_cvt_pk_bf16_f32 v100, v106, v107
  v_cvt_pk_bf16_f32 v171, v178, v179
  v_pk_fma_f32 v[34:35], v[54:55], v[42:43], v[34:35] op_sel:[1,1,0] op_sel_hi:[1,0,1] neg_lo:[1,0,0]
  ds_write_addtid_b32 v100 offset:41072
  ds_write_b32 v234, v171 offset:5440
  v_cvt_pk_bf16_f32 v30, v34, v35
  v_cvt_pk_bf16_f32 v101, v124, v125
  v_pk_mul_f32 v[172:173], v[192:193], v[186:187] op_sel:[0,0] op_sel_hi:[0,1]
  ds_write_addtid_b32 v30 offset:7344
  ds_write_addtid_b32 v101 offset:41344
  v_pk_fma_f32 v[172:173], v[192:193], v[186:187], v[172:173] op_sel:[1,1,0] op_sel_hi:[1,0,1] neg_lo:[1,0,0]
  v_pk_mul_f32 v[36:37], v[54:55], v[44:45] op_sel:[0,0] op_sel_hi:[0,1]
  v_pk_mul_f32 v[108:109], v[124:125], v[90:91] op_sel:[0,0] op_sel_hi:[0,1]
  v_cvt_pk_bf16_f32 v168, v172, v173
  v_pk_fma_f32 v[36:37], v[54:55], v[44:45], v[36:37] op_sel:[1,1,0] op_sel_hi:[1,0,1] neg_lo:[1,0,0]
  v_pk_fma_f32 v[108:109], v[124:125], v[90:91], v[108:109] op_sel:[1,1,0] op_sel_hi:[1,0,1] neg_lo:[1,0,0]
  ds_write_b32 v234, v168 offset:5712
  v_cvt_pk_bf16_f32 v31, v36, v37
  v_cvt_pk_bf16_f32 v98, v108, v109
  v_pk_mul_f32 v[174:175], v[192:193], v[188:189] op_sel:[0,0] op_sel_hi:[0,1]
  ds_write_addtid_b32 v31 offset:7616
  ds_write_addtid_b32 v98 offset:41616
  v_pk_fma_f32 v[174:175], v[192:193], v[188:189], v[174:175] op_sel:[1,1,0] op_sel_hi:[1,0,1] neg_lo:[1,0,0]
  v_pk_mul_f32 v[38:39], v[54:55], v[46:47] op_sel:[0,0] op_sel_hi:[0,1]
  v_pk_mul_f32 v[102:103], v[124:125], v[110:111] op_sel:[0,0] op_sel_hi:[0,1]
  v_cvt_pk_bf16_f32 v169, v174, v175
  v_pk_fma_f32 v[38:39], v[54:55], v[46:47], v[38:39] op_sel:[1,1,0] op_sel_hi:[1,0,1] neg_lo:[1,0,0]
  v_pk_fma_f32 v[102:103], v[124:125], v[110:111], v[102:103] op_sel:[1,1,0] op_sel_hi:[1,0,1] neg_lo:[1,0,0]
  ds_write_b32 v234, v169 offset:5984
  v_cvt_pk_bf16_f32 v28, v38, v39
  v_cvt_pk_bf16_f32 v99, v102, v103
  v_pk_mul_f32 v[176:177], v[192:193], v[190:191] op_sel:[0,0] op_sel_hi:[0,1]
  ds_write_addtid_b32 v28 offset:7888
  ds_write_addtid_b32 v99 offset:41888
  v_pk_fma_f32 v[176:177], v[192:193], v[190:191], v[176:177] op_sel:[1,1,0] op_sel_hi:[1,0,1] neg_lo:[1,0,0]
  v_pk_mul_f32 v[32:33], v[54:55], v[48:49] op_sel:[0,0] op_sel_hi:[0,1]
  v_pk_mul_f32 v[104:105], v[124:125], v[112:113] op_sel:[0,0] op_sel_hi:[0,1]
  v_cvt_pk_bf16_f32 v170, v176, v177
  v_pk_fma_f32 v[32:33], v[54:55], v[48:49], v[32:33] op_sel:[1,1,0] op_sel_hi:[1,0,1] neg_lo:[1,0,0]
  v_pk_fma_f32 v[104:105], v[124:125], v[112:113], v[104:105] op_sel:[1,1,0] op_sel_hi:[1,0,1] neg_lo:[1,0,0]
  ds_write_b32 v234, v170 offset:6256
  v_cvt_pk_bf16_f32 v29, v32, v33
  v_cvt_pk_bf16_f32 v100, v104, v105
  v_cvt_pk_bf16_f32 v171, v194, v195
  ds_write_addtid_b32 v29 offset:8160
  ds_write_addtid_b32 v100 offset:42160
  ds_write_b32 v234, v171 offset:6528
  v_pk_mul_f32 v[34:35], v[54:55], v[50:51] op_sel:[0,0] op_sel_hi:[0,1]
  v_pk_mul_f32 v[106:107], v[124:125], v[114:115] op_sel:[0,0] op_sel_hi:[0,1]
  v_pk_mul_f32 v[178:179], v[194:195], v[160:161] op_sel:[0,0] op_sel_hi:[0,1]
  v_pk_fma_f32 v[34:35], v[54:55], v[50:51], v[34:35] op_sel:[1,1,0] op_sel_hi:[1,0,1] neg_lo:[1,0,0]
  v_pk_fma_f32 v[106:107], v[124:125], v[114:115], v[106:107] op_sel:[1,1,0] op_sel_hi:[1,0,1] neg_lo:[1,0,0]
  v_pk_fma_f32 v[178:179], v[194:195], v[160:161], v[178:179] op_sel:[1,1,0] op_sel_hi:[1,0,1] neg_lo:[1,0,0]
  v_cvt_pk_bf16_f32 v30, v34, v35
  v_cvt_pk_bf16_f32 v101, v106, v107
  v_cvt_pk_bf16_f32 v168, v178, v179
  ds_write_addtid_b32 v30 offset:8432
  ds_write_addtid_b32 v101 offset:42432
  ds_write_b32 v234, v168 offset:6800
  ds_read_b128 a[16:19], v4 offset:4352
  v_pk_mul_f32 v[108:109], v[124:125], v[116:117] op_sel:[0,0] op_sel_hi:[0,1]
  v_pk_mul_f32 v[172:173], v[194:195], v[180:181] op_sel:[0,0] op_sel_hi:[0,1]
  ds_read_b128 a[20:23], v4 offset:4416
  v_pk_fma_f32 v[108:109], v[124:125], v[116:117], v[108:109] op_sel:[1,1,0] op_sel_hi:[1,0,1] neg_lo:[1,0,0]
  v_pk_fma_f32 v[172:173], v[194:195], v[180:181], v[172:173] op_sel:[1,1,0] op_sel_hi:[1,0,1] neg_lo:[1,0,0]
  ds_read_b128 a[24:27], v4 offset:4480
  v_cvt_pk_bf16_f32 v98, v108, v109
  v_cvt_pk_bf16_f32 v169, v172, v173
  ds_read_b128 a[28:31], v4 offset:4544
  ds_write_addtid_b32 v98 offset:42704
  ds_write_b32 v234, v169 offset:7072
  v_cvt_pk_bf16_f32 v31, v56, v57
  v_pk_mul_f32 v[102:103], v[124:125], v[118:119] op_sel:[0,0] op_sel_hi:[0,1]
  v_pk_mul_f32 v[174:175], v[194:195], v[182:183] op_sel:[0,0] op_sel_hi:[0,1]
  ds_write_addtid_b32 v31 offset:0
  v_pk_fma_f32 v[102:103], v[124:125], v[118:119], v[102:103] op_sel:[1,1,0] op_sel_hi:[1,0,1] neg_lo:[1,0,0]
  v_pk_fma_f32 v[174:175], v[194:195], v[182:183], v[174:175] op_sel:[1,1,0] op_sel_hi:[1,0,1] neg_lo:[1,0,0]
  v_pk_mul_f32 v[36:37], v[56:57], v[40:41] op_sel:[0,0] op_sel_hi:[0,1]
  v_cvt_pk_bf16_f32 v99, v102, v103
  v_cvt_pk_bf16_f32 v170, v174, v175
  v_pk_fma_f32 v[36:37], v[56:57], v[40:41], v[36:37] op_sel:[1,1,0] op_sel_hi:[1,0,1] neg_lo:[1,0,0]
  ds_write_addtid_b32 v99 offset:42976
  ds_write_b32 v234, v170 offset:7344
  v_cvt_pk_bf16_f32 v28, v36, v37
  v_pk_mul_f32 v[104:105], v[124:125], v[120:121] op_sel:[0,0] op_sel_hi:[0,1]
  v_pk_mul_f32 v[176:177], v[194:195], v[184:185] op_sel:[0,0] op_sel_hi:[0,1]
  ds_write_addtid_b32 v28 offset:272
  v_pk_fma_f32 v[104:105], v[124:125], v[120:121], v[104:105] op_sel:[1,1,0] op_sel_hi:[1,0,1] neg_lo:[1,0,0]
  v_pk_fma_f32 v[176:177], v[194:195], v[184:185], v[176:177] op_sel:[1,1,0] op_sel_hi:[1,0,1] neg_lo:[1,0,0]
  v_pk_mul_f32 v[38:39], v[56:57], v[44:45] op_sel:[0,0] op_sel_hi:[0,1]
  v_cvt_pk_bf16_f32 v100, v104, v105
  v_cvt_pk_bf16_f32 v171, v176, v177
  v_pk_fma_f32 v[38:39], v[56:57], v[44:45], v[38:39] op_sel:[1,1,0] op_sel_hi:[1,0,1] neg_lo:[1,0,0]
  ds_write_addtid_b32 v100 offset:43248
  ds_write_b32 v234, v171 offset:7616
  v_cvt_pk_bf16_f32 v29, v38, v39
  ds_read_b128 a[80:83], v4 offset:39168
  v_pk_mul_f32 v[178:179], v[194:195], v[186:187] op_sel:[0,0] op_sel_hi:[0,1]
  ds_write_addtid_b32 v29 offset:544
  ds_read_b128 a[84:87], v4 offset:39232
  v_pk_fma_f32 v[178:179], v[194:195], v[186:187], v[178:179] op_sel:[1,1,0] op_sel_hi:[1,0,1] neg_lo:[1,0,0]
  v_pk_mul_f32 v[32:33], v[56:57], v[48:49] op_sel:[0,0] op_sel_hi:[0,1]
  ds_read_b128 a[88:91], v4 offset:39296
  v_cvt_pk_bf16_f32 v168, v178, v179
  v_pk_fma_f32 v[32:33], v[56:57], v[48:49], v[32:33] op_sel:[1,1,0] op_sel_hi:[1,0,1] neg_lo:[1,0,0]
  ds_read_b128 a[92:95], v4 offset:39360
  ds_write_b32 v234, v168 offset:7888
  v_cvt_pk_bf16_f32 v30, v32, v33
  v_cvt_pk_bf16_f32 v101, v126, v127
  v_pk_mul_f32 v[172:173], v[194:195], v[188:189] op_sel:[0,0] op_sel_hi:[0,1]
  ds_write_addtid_b32 v30 offset:816
  ds_write_addtid_b32 v101 offset:34816
  v_pk_fma_f32 v[172:173], v[194:195], v[188:189], v[172:173] op_sel:[1,1,0] op_sel_hi:[1,0,1] neg_lo:[1,0,0]
  v_cvt_pk_bf16_f32 v31, v58, v59
  v_pk_mul_f32 v[106:107], v[126:127], v[110:111] op_sel:[0,0] op_sel_hi:[0,1]
  v_cvt_pk_bf16_f32 v169, v172, v173
  ds_write_addtid_b32 v31 offset:1088
  v_pk_fma_f32 v[106:107], v[126:127], v[110:111], v[106:107] op_sel:[1,1,0] op_sel_hi:[1,0,1] neg_lo:[1,0,0]
  ds_write_b32 v234, v169 offset:8160
  v_pk_mul_f32 v[34:35], v[58:59], v[40:41] op_sel:[0,0] op_sel_hi:[0,1]
  v_cvt_pk_bf16_f32 v98, v106, v107
  v_pk_mul_f32 v[174:175], v[194:195], v[190:191] op_sel:[0,0] op_sel_hi:[0,1]
  v_pk_fma_f32 v[34:35], v[58:59], v[40:41], v[34:35] op_sel:[1,1,0] op_sel_hi:[1,0,1] neg_lo:[1,0,0]
  ds_write_addtid_b32 v98 offset:35088
  v_pk_fma_f32 v[174:175], v[194:195], v[190:191], v[174:175] op_sel:[1,1,0] op_sel_hi:[1,0,1] neg_lo:[1,0,0]
  v_cvt_pk_bf16_f32 v28, v34, v35
  v_pk_mul_f32 v[108:109], v[126:127], v[114:115] op_sel:[0,0] op_sel_hi:[0,1]
  v_cvt_pk_bf16_f32 v170, v174, v175
  ds_write_addtid_b32 v28 offset:1360
  v_pk_fma_f32 v[108:109], v[126:127], v[114:115], v[108:109] op_sel:[1,1,0] op_sel_hi:[1,0,1] neg_lo:[1,0,0]
  ds_write_b32 v234, v170 offset:8432
  v_pk_mul_f32 v[36:37], v[58:59], v[44:45] op_sel:[0,0] op_sel_hi:[0,1]
  v_cvt_pk_bf16_f32 v99, v108, v109
  ds_read_b128 a[144:147], v235 offset:4352
  v_pk_fma_f32 v[36:37], v[58:59], v[44:45], v[36:37] op_sel:[1,1,0] op_sel_hi:[1,0,1] neg_lo:[1,0,0]
  ds_write_addtid_b32 v99 offset:35360
  ds_read_b128 a[148:151], v235 offset:4416
  v_cvt_pk_bf16_f32 v29, v36, v37
  v_pk_mul_f32 v[102:103], v[126:127], v[118:119] op_sel:[0,0] op_sel_hi:[0,1]
  ds_read_b128 a[152:155], v235 offset:4480
  ds_write_addtid_b32 v29 offset:1632
  v_pk_fma_f32 v[102:103], v[126:127], v[118:119], v[102:103] op_sel:[1,1,0] op_sel_hi:[1,0,1] neg_lo:[1,0,0]
  ds_read_b128 a[156:159], v235 offset:4544
  v_pk_mul_f32 v[38:39], v[58:59], v[48:49] op_sel:[0,0] op_sel_hi:[0,1]
  v_cvt_pk_bf16_f32 v100, v102, v103
  v_cvt_pk_bf16_f32 v171, v196, v197
  v_pk_fma_f32 v[38:39], v[58:59], v[48:49], v[38:39] op_sel:[1,1,0] op_sel_hi:[1,0,1] neg_lo:[1,0,0]
  ds_write_addtid_b32 v100 offset:35632
  ds_write_b32 v234, v171 offset:0
  v_cvt_pk_bf16_f32 v30, v38, v39
  v_cvt_pk_bf16_f32 v101, v128, v129
  v_pk_mul_f32 v[176:177], v[196:197], v[180:181] op_sel:[0,0] op_sel_hi:[0,1]
  ds_write_addtid_b32 v30 offset:1904
  ds_write_addtid_b32 v101 offset:35904
  v_pk_fma_f32 v[176:177], v[196:197], v[180:181], v[176:177] op_sel:[1,1,0] op_sel_hi:[1,0,1] neg_lo:[1,0,0]
  s_waitcnt lgkmcnt(15)
  v_mfma_f32_16x16x32_bf16 a[192:195], a[16:19], a[0:3], a[192:195]
  v_pk_mul_f32 v[104:105], v[128:129], v[110:111] op_sel:[0,0] op_sel_hi:[0,1]
  v_cvt_pk_bf16_f32 v168, v176, v177
  v_mfma_f32_16x16x32_bf16 a[192:195], a[20:23], a[4:7], a[192:195]
  v_pk_fma_f32 v[104:105], v[128:129], v[110:111], v[104:105] op_sel:[1,1,0] op_sel_hi:[1,0,1] neg_lo:[1,0,0]
  ds_write_b32 v234, v168 offset:272
  v_mfma_f32_16x16x32_bf16 a[192:195], a[24:27], a[8:11], a[192:195]
  v_cvt_pk_bf16_f32 v98, v104, v105
  v_pk_mul_f32 v[178:179], v[196:197], v[184:185] op_sel:[0,0] op_sel_hi:[0,1]
  v_mfma_f32_16x16x32_bf16 a[192:195], a[28:31], a[12:15], a[192:195]
  ds_write_addtid_b32 v98 offset:36176
  v_pk_fma_f32 v[178:179], v[196:197], v[184:185], v[178:179] op_sel:[1,1,0] op_sel_hi:[1,0,1] neg_lo:[1,0,0]
  v_cvt_pk_bf16_f32 v31, v60, v61
  v_pk_mul_f32 v[106:107], v[128:129], v[114:115] op_sel:[0,0] op_sel_hi:[0,1]
  v_cvt_pk_bf16_f32 v169, v178, v179
  ds_write_addtid_b32 v31 offset:2176
  v_pk_fma_f32 v[106:107], v[128:129], v[114:115], v[106:107] op_sel:[1,1,0] op_sel_hi:[1,0,1] neg_lo:[1,0,0]
  ds_write_b32 v234, v169 offset:544
  v_pk_mul_f32 v[32:33], v[60:61], v[44:45] op_sel:[0,0] op_sel_hi:[0,1]
  v_cvt_pk_bf16_f32 v99, v106, v107
  v_pk_mul_f32 v[172:173], v[196:197], v[188:189] op_sel:[0,0] op_sel_hi:[0,1]
  v_pk_fma_f32 v[32:33], v[60:61], v[44:45], v[32:33] op_sel:[1,1,0] op_sel_hi:[1,0,1] neg_lo:[1,0,0]
  ds_write_addtid_b32 v99 offset:36448
  v_pk_fma_f32 v[172:173], v[196:197], v[188:189], v[172:173] op_sel:[1,1,0] op_sel_hi:[1,0,1] neg_lo:[1,0,0]
  v_cvt_pk_bf16_f32 v28, v32, v33
  v_pk_mul_f32 v[108:109], v[128:129], v[118:119] op_sel:[0,0] op_sel_hi:[0,1]
  v_cvt_pk_bf16_f32 v170, v172, v173
  ds_write_addtid_b32 v28 offset:2448
  v_pk_fma_f32 v[108:109], v[128:129], v[118:119], v[108:109] op_sel:[1,1,0] op_sel_hi:[1,0,1] neg_lo:[1,0,0]
  ds_write_b32 v234, v170 offset:816
  v_cvt_pk_bf16_f32 v29, v62, v63
  v_cvt_pk_bf16_f32 v100, v108, v109
  v_cvt_pk_bf16_f32 v171, v198, v199
  ds_write_addtid_b32 v29 offset:2720
  ds_write_addtid_b32 v100 offset:36720
  ds_write_b32 v234, v171 offset:1088
  v_pk_mul_f32 v[34:35], v[62:63], v[44:45] op_sel:[0,0] op_sel_hi:[0,1]
  v_mfma_f32_16x16x32_bf16 a[192:195], a[80:83], a[64:67], a[192:195]
  v_pk_mul_f32 v[174:175], v[198:199], v[180:181] op_sel:[0,0] op_sel_hi:[0,1]
  v_pk_fma_f32 v[34:35], v[62:63], v[44:45], v[34:35] op_sel:[1,1,0] op_sel_hi:[1,0,1] neg_lo:[1,0,0]
  v_mfma_f32_16x16x32_bf16 a[192:195], a[84:87], a[68:71], a[192:195]
  v_pk_fma_f32 v[174:175], v[198:199], v[180:181], v[174:175] op_sel:[1,1,0] op_sel_hi:[1,0,1] neg_lo:[1,0,0]
  v_cvt_pk_bf16_f32 v30, v34, v35
  v_mfma_f32_16x16x32_bf16 a[192:195], a[88:91], a[72:75], a[192:195]
  v_cvt_pk_bf16_f32 v168, v174, v175
  ds_write_addtid_b32 v30 offset:2992
  v_mfma_f32_16x16x32_bf16 a[192:195], a[92:95], a[76:79], a[192:195]
  ds_write_b32 v234, v168 offset:1360
  v_cvt_pk_bf16_f32 v31, v64, v65
  v_cvt_pk_bf16_f32 v101, v130, v131
  v_pk_mul_f32 v[176:177], v[198:199], v[184:185] op_sel:[0,0] op_sel_hi:[0,1]
  ds_write_addtid_b32 v31 offset:3264
  ds_write_addtid_b32 v101 offset:36992
  v_pk_fma_f32 v[176:177], v[198:199], v[184:185], v[176:177] op_sel:[1,1,0] op_sel_hi:[1,0,1] neg_lo:[1,0,0]
  v_pk_mul_f32 v[36:37], v[64:65], v[44:45] op_sel:[0,0] op_sel_hi:[0,1]
  v_pk_mul_f32 v[102:103], v[130:131], v[114:115] op_sel:[0,0] op_sel_hi:[0,1]
  v_cvt_pk_bf16_f32 v169, v176, v177
  v_pk_fma_f32 v[36:37], v[64:65], v[44:45], v[36:37] op_sel:[1,1,0] op_sel_hi:[1,0,1] neg_lo:[1,0,0]
  v_pk_fma_f32 v[102:103], v[130:131], v[114:115], v[102:103] op_sel:[1,1,0] op_sel_hi:[1,0,1] neg_lo:[1,0,0]
  ds_write_b32 v234, v169 offset:1632
  v_cvt_pk_bf16_f32 v28, v36, v37
  v_cvt_pk_bf16_f32 v98, v102, v103
  v_pk_mul_f32 v[178:179], v[198:199], v[188:189] op_sel:[0,0] op_sel_hi:[0,1]
  ds_write_addtid_b32 v28 offset:3536
  ds_write_addtid_b32 v98 offset:37264
  v_pk_fma_f32 v[178:179], v[198:199], v[188:189], v[178:179] op_sel:[1,1,0] op_sel_hi:[1,0,1] neg_lo:[1,0,0]
  v_cvt_pk_bf16_f32 v29, v66, v67
  v_cvt_pk_bf16_f32 v99, v132, v133
  v_cvt_pk_bf16_f32 v170, v178, v179
  ds_write_addtid_b32 v29 offset:3808
  ds_write_addtid_b32 v99 offset:37536
  ds_write_b32 v234, v170 offset:1904
  v_pk_mul_f32 v[38:39], v[66:67], v[44:45] op_sel:[0,0] op_sel_hi:[0,1]
  v_pk_mul_f32 v[104:105], v[132:133], v[114:115] op_sel:[0,0] op_sel_hi:[0,1]
  s_waitcnt lgkmcnt(15)
  v_mfma_f32_16x16x32_bf16 a[192:195], a[144:147], a[128:131], a[192:195]
  v_pk_fma_f32 v[38:39], v[66:67], v[44:45], v[38:39] op_sel:[1,1,0] op_sel_hi:[1,0,1] neg_lo:[1,0,0]
  v_pk_fma_f32 v[104:105], v[132:133], v[114:115], v[104:105] op_sel:[1,1,0] op_sel_hi:[1,0,1] neg_lo:[1,0,0]
  v_mfma_f32_16x16x32_bf16 a[192:195], a[148:151], a[132:135], a[192:195]
  v_cvt_pk_bf16_f32 v30, v38, v39
  v_cvt_pk_bf16_f32 v100, v104, v105
  v_mfma_f32_16x16x32_bf16 a[192:195], a[152:155], a[136:139], a[192:195]
  ds_write_addtid_b32 v30 offset:4080
  ds_write_addtid_b32 v100 offset:37808
  v_mfma_f32_16x16x32_bf16 a[192:195], a[156:159], a[140:143], a[192:195]
  ds_read_b128 a[32:35], v4 offset:0
  v_cvt_pk_bf16_f32 v101, v134, v135
  v_cvt_pk_bf16_f32 v171, v200, v201
  ds_read_b128 a[36:39], v4 offset:64
  ds_write_addtid_b32 v101 offset:38080
  ds_write_b32 v234, v171 offset:2176
  ds_read_b128 a[40:43], v4 offset:128
  v_pk_mul_f32 v[106:107], v[134:135], v[114:115] op_sel:[0,0] op_sel_hi:[0,1]
  v_pk_mul_f32 v[172:173], v[200:201], v[184:185] op_sel:[0,0] op_sel_hi:[0,1]
  ds_read_b128 a[44:47], v4 offset:192
  v_pk_fma_f32 v[106:107], v[134:135], v[114:115], v[106:107] op_sel:[1,1,0] op_sel_hi:[1,0,1] neg_lo:[1,0,0]
  v_pk_fma_f32 v[172:173], v[200:201], v[184:185], v[172:173] op_sel:[1,1,0] op_sel_hi:[1,0,1] neg_lo:[1,0,0]
  v_cvt_pk_bf16_f32 v31, v68, v69
  v_cvt_pk_bf16_f32 v98, v106, v107
  v_cvt_pk_bf16_f32 v168, v172, v173
  ds_write_addtid_b32 v31 offset:4352
  ds_write_addtid_b32 v98 offset:38352
  ds_write_b32 v234, v168 offset:2448
  v_cvt_pk_bf16_f32 v28, v70, v71
  v_cvt_pk_bf16_f32 v99, v136, v137
  v_cvt_pk_bf16_f32 v169, v202, v203
  ds_write_addtid_b32 v28 offset:4624
  ds_write_addtid_b32 v99 offset:38624
  ds_write_b32 v234, v169 offset:2720
  v_cvt_pk_bf16_f32 v29, v72, v73
  v_pk_mul_f32 v[108:109], v[136:137], v[114:115] op_sel:[0,0] op_sel_hi:[0,1]
  v_pk_mul_f32 v[174:175], v[202:203], v[184:185] op_sel:[0,0] op_sel_hi:[0,1]
  ds_write_addtid_b32 v29 offset:4896
  v_pk_fma_f32 v[108:109], v[136:137], v[114:115], v[108:109] op_sel:[1,1,0] op_sel_hi:[1,0,1] neg_lo:[1,0,0]
  v_pk_fma_f32 v[174:175], v[202:203], v[184:185], v[174:175] op_sel:[1,1,0] op_sel_hi:[1,0,1] neg_lo:[1,0,0]
  v_cvt_pk_bf16_f32 v30, v74, v75
  v_cvt_pk_bf16_f32 v100, v108, v109
  v_cvt_pk_bf16_f32 v170, v174, v175
  ds_write_addtid_b32 v30 offset:5168
  ds_write_addtid_b32 v100 offset:38896
  ds_write_b32 v234, v170 offset:2992
  v_cvt_pk_bf16_f32 v31, v76, v77
  ds_read_b128 a[96:99], v4 offset:34816
  v_cvt_pk_bf16_f32 v171, v204, v205
  ds_write_addtid_b32 v31 offset:5440
  ds_read_b128 a[100:103], v4 offset:34880
  ds_write_b32 v234, v171 offset:3264
  v_cvt_pk_bf16_f32 v28, v78, v79
  ds_read_b128 a[104:107], v4 offset:34944
  v_pk_mul_f32 v[176:177], v[204:205], v[184:185] op_sel:[0,0] op_sel_hi:[0,1]
  ds_write_addtid_b32 v28 offset:5712
  ds_read_b128 a[108:111], v4 offset:35008
  v_pk_fma_f32 v[176:177], v[204:205], v[184:185], v[176:177] op_sel:[1,1,0] op_sel_hi:[1,0,1] neg_lo:[1,0,0]
  v_cvt_pk_bf16_f32 v29, v80, v81
  v_cvt_pk_bf16_f32 v101, v138, v139
  v_cvt_pk_bf16_f32 v168, v176, v177
  ds_write_addtid_b32 v29 offset:5984
  ds_write_addtid_b32 v101 offset:39168
  ds_write_b32 v234, v168 offset:3536
  v_cvt_pk_bf16_f32 v30, v82, v83
  v_cvt_pk_bf16_f32 v98, v140, v141
  v_cvt_pk_bf16_f32 v169, v206, v207
  ds_write_addtid_b32 v30 offset:6256
  ds_write_addtid_b32 v98 offset:39440
  ds_write_b32 v234, v169 offset:3808
  v_cvt_pk_bf16_f32 v31, v84, v85
  v_cvt_pk_bf16_f32 v99, v142, v143
  v_pk_mul_f32 v[178:179], v[206:207], v[184:185] op_sel:[0,0] op_sel_hi:[0,1]
  ds_write_addtid_b32 v31 offset:6528
  ds_write_addtid_b32 v99 offset:39712
  v_pk_fma_f32 v[178:179], v[206:207], v[184:185], v[178:179] op_sel:[1,1,0] op_sel_hi:[1,0,1] neg_lo:[1,0,0]
  ds_read_b128 a[48:51], v4 offset:4352
  v_cvt_pk_bf16_f32 v100, v144, v145
  v_cvt_pk_bf16_f32 v170, v178, v179
  ds_read_b128 a[52:55], v4 offset:4416
  ds_write_addtid_b32 v100 offset:39984
  ds_write_b32 v234, v170 offset:4080
  ds_read_b128 a[56:59], v4 offset:4480
  v_cvt_pk_bf16_f32 v101, v146, v147
  ds_read_b128 a[160:163], v235 offset:0
  ds_read_b128 a[60:63], v4 offset:4544
  ds_write_addtid_b32 v101 offset:40256
  ds_read_b128 a[164:167], v235 offset:64
  s_waitcnt lgkmcnt(15)
  v_mfma_f32_16x16x32_bf16 a[196:199], a[32:35], a[0:3], a[196:199]
  v_cvt_pk_bf16_f32 v98, v148, v149
  ds_read_b128 a[168:171], v235 offset:128
  v_mfma_f32_16x16x32_bf16 a[196:199], a[36:39], a[4:7], a[196:199]
  ds_write_addtid_b32 v98 offset:40528
  ds_read_b128 a[172:175], v235 offset:192
  v_mfma_f32_16x16x32_bf16 a[196:199], a[40:43], a[8:11], a[196:199]
  v_cvt_pk_bf16_f32 v99, v150, v151
  v_cvt_pk_bf16_f32 v171, v208, v209
  v_mfma_f32_16x16x32_bf16 a[196:199], a[44:47], a[12:15], a[196:199]
  ds_write_addtid_b32 v99 offset:40800
  ds_write_b32 v234, v171 offset:4352
  s_waitcnt lgkmcnt(7)
  v_mfma_f32_16x16x32_bf16 a[200:203], a[48:51], a[0:3], a[200:203]
  v_cvt_pk_bf16_f32 v100, v152, v153
  v_cvt_pk_bf16_f32 v168, v210, v211
  v_mfma_f32_16x16x32_bf16 a[200:203], a[52:55], a[4:7], a[200:203]
  ds_write_addtid_b32 v100 offset:41072
  ds_write_b32 v234, v168 offset:4624
  v_mfma_f32_16x16x32_bf16 a[200:203], a[56:59], a[8:11], a[200:203]
  v_cvt_pk_bf16_f32 v101, v154, v155
  v_cvt_pk_bf16_f32 v169, v212, v213
  v_mfma_f32_16x16x32_bf16 a[200:203], a[60:63], a[12:15], a[200:203]
  ds_write_addtid_b32 v101 offset:41344
  ds_write_b32 v234, v169 offset:4896
  ds_read_b128 a[112:115], v4 offset:39168
  v_cvt_pk_bf16_f32 v170, v214, v215
  ds_read_b128 a[116:119], v4 offset:39232
  ds_write_b32 v234, v170 offset:5168
  ds_read_b128 a[120:123], v4 offset:39296
  v_cvt_pk_bf16_f32 v171, v216, v217
  ds_read_b128 a[124:127], v4 offset:39360
  ds_write_b32 v234, v171 offset:5440
  v_mfma_f32_16x16x32_bf16 a[196:199], a[96:99], a[64:67], a[196:199]
  v_cvt_pk_bf16_f32 v168, v218, v219
  v_mfma_f32_16x16x32_bf16 a[196:199], a[100:103], a[68:71], a[196:199]
  ds_write_b32 v234, v168 offset:5712
  v_mfma_f32_16x16x32_bf16 a[196:199], a[104:107], a[72:75], a[196:199]
  v_cvt_pk_bf16_f32 v169, v220, v221
  v_mfma_f32_16x16x32_bf16 a[196:199], a[108:111], a[76:79], a[196:199]
  ds_write_b32 v234, v169 offset:5984
  s_waitcnt lgkmcnt(3)
  v_mfma_f32_16x16x32_bf16 a[200:203], a[112:115], a[64:67], a[200:203]
  v_cvt_pk_bf16_f32 v170, v222, v223
  v_mfma_f32_16x16x32_bf16 a[200:203], a[116:119], a[68:71], a[200:203]
  ds_write_b32 v234, v170 offset:6256
  v_mfma_f32_16x16x32_bf16 a[200:203], a[120:123], a[72:75], a[200:203]
  v_cvt_pk_bf16_f32 v171, v224, v225
  v_mfma_f32_16x16x32_bf16 a[200:203], a[124:127], a[76:79], a[200:203]
  ds_write_b32 v234, v171 offset:6528
  ds_read_b128 a[176:179], v235 offset:4352
  ds_read_b128 a[180:183], v235 offset:4416
  ds_read_b128 a[184:187], v235 offset:4480
  ds_read_b128 a[188:191], v235 offset:4544
  v_mfma_f32_16x16x32_bf16 a[196:199], a[160:163], a[128:131], a[196:199]
  v_mfma_f32_16x16x32_bf16 a[196:199], a[164:167], a[132:135], a[196:199]
  v_mfma_f32_16x16x32_bf16 a[196:199], a[168:171], a[136:139], a[196:199]
  v_mfma_f32_16x16x32_bf16 a[196:199], a[172:175], a[140:143], a[196:199]
  s_waitcnt lgkmcnt(0)
  v_mfma_f32_16x16x32_bf16 a[200:203], a[176:179], a[128:131], a[200:203]
  v_mfma_f32_16x16x32_bf16 a[200:203], a[180:183], a[132:135], a[200:203]
  v_mfma_f32_16x16x32_bf16 a[200:203], a[184:187], a[136:139], a[200:203]
  v_mfma_f32_16x16x32_bf16 a[200:203], a[188:191], a[140:143], a[200:203]
  v_accvgpr_read_b32 v16, a192
  v_accvgpr_read_b32 v17, a193
  v_accvgpr_read_b32 v18, a194
  v_accvgpr_read_b32 v19, a195
  v_accvgpr_read_b32 v20, a196
  v_accvgpr_read_b32 v21, a197
  v_accvgpr_read_b32 v22, a198
  v_accvgpr_read_b32 v23, a199
  v_accvgpr_read_b32 v24, a200
  v_accvgpr_read_b32 v25, a201
  v_accvgpr_read_b32 v26, a202
  v_accvgpr_read_b32 v27, a203
  buffer_load_dwordx2 v[120:121], v229, s[48:51], 0 offen sc1
  buffer_load_dwordx4 v[124:127], v228, s[44:47], 0 offen offset:0 sc1
  buffer_load_dwordx4 v[128:131], v228, s[44:47], 0 offen offset:16 sc1
  buffer_load_dwordx4 v[136:139], v228, s[44:47], 0 offen offset:32 sc1
  buffer_load_dwordx4 v[140:143], v228, s[44:47], 0 offen offset:48 sc1
  v_cvt_pk_bf16_f32 v28, v16, v17
  v_cvt_pk_bf16_f32 v29, v18, v19
  v_cvt_pk_bf16_f32 v30, v20, v21
  v_cvt_pk_bf16_f32 v31, v22, v23
  v_cvt_pk_bf16_f32 v32, v24, v25
  v_cvt_pk_bf16_f32 v33, v26, v27
  ds_write_b64 v236, v[28:29]
  ds_write_b32 v237, v30 offset:512
  ds_write_b32 v238, v31 offset:512
  ds_write_b16 v239, v32 offset:1024
  ds_write_b16_d16_hi v239, v32 offset:1056
  ds_write_b16 v239, v33 offset:1088
  ds_write_b16_d16_hi v239, v33 offset:1120
  ds_read2_b64 v[40:43], v240 offset0:0 offset1:1
  ds_read2_b32 v[44:45], v241 offset0:192 offset1:193
  ds_read_u16 v46, v242 offset:1024
  ds_read_u16 v47, v242 offset:1026
  ds_read_u16 v48, v242 offset:1152
  ds_read_u16 v49, v242 offset:1154
  v_mov_b32 v16, v247
  v_mov_b32 v17, v248
  v_mov_b32 v18, v249
  v_mov_b32 v19, v250
  v_mov_b32 v20, v251
  v_mov_b32 v21, v252
  v_mov_b32 v22, v253
  v_mov_b32 v23, v254
  v_mov_b32 v3, v10
  v_mov_b32 v4, v11
  v_mov_b32 v5, v12
  s_mov_b32 s8, 0x01000100
  s_mov_b32 s9, 0x03020100
  s_mov_b32 s10, 0x03020302
  s_mov_b32 s12, 0x05040302
  v_cmp_gt_u32 vcc, 32, v1
  s_waitcnt lgkmcnt(5)
  v_perm_b32 v52, v40, v40, v243
  v_perm_b32 v53, v41, v40, v244
  v_perm_b32 v54, v42, v41, v245
  v_perm_b32 v55, v42, v41, s12
  v_cndmask_b32 v55, v55, v43, vcc
  ds_write_b128 v226, v[52:55] offset:128
  s_waitcnt lgkmcnt(5)
  v_perm_b32 v56, v44, v44, s8
  v_mov_b32 v57, v44
  v_perm_b32 v58, v44, v44, s10
  v_perm_b32 v59, v45, v45, s8
  ds_write_b128 v226, v[56:59] offset:1152
  s_waitcnt lgkmcnt(2)
  v_perm_b32 v60, v46, v46, s8
  v_mov_b32 v61, v60
  v_perm_b32 v62, v47, v46, v246
  v_perm_b32 v63, v47, v47, s8
  ds_write_b128 v226, v[60:63] offset:2176
  v_perm_b32 v64, v48, v48, s8
  v_mov_b32 v65, v64
  v_perm_b32 v66, v49, v48, v246
  v_perm_b32 v67, v49, v49, s8
  ds_write_b128 v226, v[64:67] offset:3200
  ds_read_b64_tr_b16 v[84:85], v16 offset:3872
  ds_read_b64_tr_b16 v[86:87], v16 offset:3904
  ds_read_b64_tr_b16 v[80:81], v16 offset:3616
  ds_read_b64_tr_b16 v[82:83], v16 offset:3648
  ds_read_b64_tr_b16 v[76:77], v16 offset:3360
  ds_read_b64_tr_b16 v[78:79], v16 offset:3392
  ds_read_b64_tr_b16 v[72:73], v16 offset:3104
  ds_read_b64_tr_b16 v[74:75], v16 offset:3136
  ds_read_b64_tr_b16 v[68:69], v16 offset:2848
  ds_read_b64_tr_b16 v[70:71], v16 offset:2880
  ds_read_b64_tr_b16 v[64:65], v16 offset:2592
  ds_read_b64_tr_b16 v[66:67], v16 offset:2624
  ds_read_b64_tr_b16 v[60:61], v16 offset:2336
  ds_read_b64_tr_b16 v[62:63], v16 offset:2368
  ds_read_b64_tr_b16 v[56:57], v16 offset:2080
  ds_read_b64_tr_b16 v[58:59], v16 offset:2112
  ds_read_b64_tr_b16 v[52:53], v16 offset:1824
  ds_read_b64_tr_b16 v[54:55], v16 offset:1856
  ds_read_b64_tr_b16 v[48:49], v16 offset:1568
  ds_read_b64_tr_b16 v[50:51], v16 offset:1600
  ds_read_b64_tr_b16 v[44:45], v16 offset:1312
  ds_read_b64_tr_b16 v[46:47], v16 offset:1344
  ds_read_b64_tr_b16 v[40:41], v16 offset:1056
  ds_read_b64_tr_b16 v[42:43], v16 offset:1088
  ds_read_b64_tr_b16 v[36:37], v16 offset:800
  ds_read_b64_tr_b16 v[38:39], v16 offset:832
  ds_read_b64_tr_b16 v[32:33], v16 offset:544
  ds_read_b64_tr_b16 v[34:35], v16 offset:576
  ds_read_b64_tr_b16 v[28:29], v16 offset:288
  ds_read_b64_tr_b16 v[30:31], v16 offset:320
  ds_read_b64_tr_b16 v[24:25], v16 offset:32
  ds_read_b64_tr_b16 v[26:27], v16 offset:64
  s_lshl_b32 s9, s4, 14
  s_add_u32 s12, s9, 8192
  s_mov_b32 s52, 0
F_STW:
  s_waitcnt vmcnt(0)
  v_cmp_eq_u32 vcc, 0, v120
  v_cmp_ne_u64 s[10:11], v[120:121], v[126:127]
  s_nop 0
  s_or_b64 vcc, vcc, s[10:11]
  v_cmp_ne_u64 s[10:11], v[120:121], v[130:131]
  s_nop 0
  s_or_b64 vcc, vcc, s[10:11]
  v_cmp_ne_u64 s[10:11], v[120:121], v[138:139]
  s_nop 0
  s_or_b64 vcc, vcc, s[10:11]
  v_cmp_ne_u64 s[10:11], v[120:121], v[142:143]
  s_nop 0
  s_or_b64 vcc, vcc, s[10:11]
  s_nop 2
  s_cbranch_vccz F_STOK
  s_add_u32 s52, s52, 1
  s_cmp_ge_u32 s52, 0x8000
  s_cbranch_scc1 F_STOK
  s_sleep 2
  buffer_load_dwordx2 v[120:121], v229, s[48:51], 0 offen sc1
  buffer_load_dwordx4 v[124:127], v228, s[44:47], 0 offen offset:0 sc1
  buffer_load_dwordx4 v[128:131], v228, s[44:47], 0 offen offset:16 sc1
  buffer_load_dwordx4 v[136:139], v228, s[44:47], 0 offen offset:32 sc1
  buffer_load_dwordx4 v[140:143], v228, s[44:47], 0 offen offset:48 sc1
  s_branch F_STW
F_STOK:
  buffer_load_dwordx4 v[152:155], v228, s[36:39], s9 offen offset:0 sc1
  buffer_load_dwordx4 v[156:159], v228, s[36:39], s9 offen offset:16 sc1
  buffer_load_dwordx4 v[160:163], v228, s[36:39], s9 offen offset:32 sc1
  buffer_load_dwordx4 v[164:167], v228, s[36:39], s9 offen offset:48 sc1
  v_mul_u32_u24 v12, 4416, v4
  v_lshl_add_u32 v12, v3, 5, v12
  v_lshl_add_u32 v12, v5, 3, v12
  s_lshl_b32 s13, s3, 8
  s_add_u32 s13, s13, 139264
  v_add_u32 v12, s13, v12
  v_lshl_add_u32 v6, v3, 2, v5
  v_lshrrev_b32 v7, 1, v6
  v_lshlrev_b32 v6, 7, v6
  v_and_b32 v9, 1, v4
  v_lshl_add_u32 v6, v9, 3, v6
  s_lshl_b32 s12, s3, 11
  v_add_u32 v6, s12, v6
  v_lshrrev_b32 v9, 1, v4
  v_add3_u32 v7, v7, v9, 2
  v_and_b32 v7, 3, v7
  v_lshl_add_u32 v13, v7, 4, v6
  v_bfe_u32 v14, v1, 3, 2
  v_lshrrev_b32 v6, 5, v1
  v_lshl_add_u32 v14, v6, 3, v14
  v_mul_u32_u24 v14, 20480, v14
  v_and_b32 v6, 7, v1
  v_lshl_add_u32 v14, v6, 4, v14
  s_mul_i32 s13, s3, 327680
  s_lshr_b32 s14, s4, 3
  s_lshl_b32 s14, s14, 10
  s_add_u32 s13, s13, s14
  s_and_b32 s14, s4, 1
  s_lshl_b32 s14, s14, 9
  s_add_u32 s13, s13, s14
  s_bfe_u32 s14, s4, 0x20001
  s_lshl_b32 s14, s14, 7
  s_add_u32 s13, s13, s14
  s_sub_u32 s5, s2, 96
  s_add_u32 s92, s42, 0x13c0000
  s_addc_u32 s93, s43, 0
  s_mov_b32 s94, 0x10000
  s_mov_b32 s95, 0x20000
  s_add_u32 s28, s42, 0x780000
  s_addc_u32 s29, s43, 0
  s_mov_b32 s30, 0x3c0000
  s_mov_b32 s31, 0x20000
  s_lshr_b32 s32, s2, 5
  s_lshl_b32 s32, s32, 1
  s_and_b32 s33, s2, 1
  s_add_u32 s32, s32, s33
  s_mul_i32 s34, s32, 3
  s_lshr_b32 s34, s34, 1
  s_lshl_b32 s34, s34, 9
  s_lshl_b32 s32, s32, 2
  s_add_u32 s32, s32, s3
  s_mul_i32 s32, s32, 61440
  v_and_b32 v8, 7, v1
  v_lshlrev_b32 v8, 7, v8
  v_lshlrev_b32 v2, 4, v1
  s_waitcnt vmcnt(4)
  v_readfirstlane_b32 s90, v120
  v_readfirstlane_b32 s91, v121
  v_and_b32 v176, 0xffff0000, v124
  v_and_b32 v177, 0xffff0000, v125
  v_and_b32 v178, 0xffff0000, v128
  v_and_b32 v179, 0xffff0000, v129
  v_and_b32 v180, 0xffff0000, v136
  v_and_b32 v181, 0xffff0000, v137
  v_and_b32 v182, 0xffff0000, v140
  v_and_b32 v183, 0xffff0000, v141
  v_rcp_f32 v176, v176
  v_rcp_f32 v177, v177
  v_rcp_f32 v178, v178
  v_rcp_f32 v179, v179
  v_rcp_f32 v180, v180
  v_rcp_f32 v181, v181
  v_rcp_f32 v182, v182
  v_rcp_f32 v183, v183
  v_lshlrev_b32 v184, 16, v124
  v_lshlrev_b32 v185, 16, v125
  v_lshlrev_b32 v186, 16, v128
  v_lshlrev_b32 v187, 16, v129
  v_lshlrev_b32 v188, 16, v136
  v_lshlrev_b32 v189, 16, v137
  v_lshlrev_b32 v190, 16, v140
  v_lshlrev_b32 v191, 16, v141
  v_mul_f32 v184, -v184, v176
  v_mul_f32 v185, -v185, v177
  v_mul_f32 v186, -v186, v178
  v_mul_f32 v187, -v187, v179
  v_mul_f32 v188, -v188, v180
  v_mul_f32 v189, -v189, v181
  v_mul_f32 v190, -v190, v182
  v_mul_f32 v191, -v191, v183
  s_mov_b32 s70, 0
  s_mov_b32 s71, 0x80000000
  s_mov_b32 s72, 0
  s_mov_b32 s73, 0xc0000000
  s_mov_b32 s74, 0
  s_mov_b32 s75, 0xe0000000
  s_waitcnt vmcnt(2)
  v_lshlrev_b32 v192, 16, v152
  v_and_b32 v193, 0xffff0000, v152
  v_lshlrev_b32 v194, 16, v153
  v_and_b32 v195, 0xffff0000, v153
  v_lshlrev_b32 v196, 16, v154
  v_and_b32 v197, 0xffff0000, v154
  v_lshlrev_b32 v198, 16, v155
  v_and_b32 v199, 0xffff0000, v155
  v_lshlrev_b32 v200, 16, v156
  v_and_b32 v201, 0xffff0000, v156
  v_lshlrev_b32 v202, 16, v157
  v_and_b32 v203, 0xffff0000, v157
  v_lshlrev_b32 v204, 16, v158
  v_and_b32 v205, 0xffff0000, v158
  v_lshlrev_b32 v206, 16, v159
  v_and_b32 v207, 0xffff0000, v159
  v_pk_fma_f32 v[224:225], v[192:193], v[176:177], v[184:185]
  v_pk_fma_f32 v[226:227], v[194:195], v[178:179], v[186:187]
  v_pk_fma_f32 v[228:229], v[196:197], v[176:177], v[184:185]
  v_pk_fma_f32 v[230:231], v[198:199], v[178:179], v[186:187]
  v_pk_fma_f32 v[232:233], v[200:201], v[176:177], v[184:185]
  v_pk_fma_f32 v[234:235], v[202:203], v[178:179], v[186:187]
  v_pk_fma_f32 v[236:237], v[204:205], v[176:177], v[184:185]
  v_pk_fma_f32 v[238:239], v[206:207], v[178:179], v[186:187]
  v_cvt_pk_bf16_f32 v240, v224, v225
  v_cvt_pk_bf16_f32 v241, v226, v227
  v_cvt_pk_bf16_f32 v242, v228, v229
  v_cvt_pk_bf16_f32 v243, v230, v231
  ds_write_b128 v20, v[240:243] offset:0
  v_cvt_pk_bf16_f32 v244, v232, v233
  v_cvt_pk_bf16_f32 v245, v234, v235
  v_cvt_pk_bf16_f32 v246, v236, v237
  v_cvt_pk_bf16_f32 v247, v238, v239
  ds_write_b128 v21, v[244:247] offset:0
  v_pk_fma_f32 v[192:193], v[224:225], s[84:85], v[192:193] op_sel:[0,0,0] op_sel_hi:[1,0,1]
  v_pk_fma_f32 v[194:195], v[226:227], s[84:85], v[194:195] op_sel:[0,0,0] op_sel_hi:[1,0,1]
  v_pk_fma_f32 v[196:197], v[228:229], s[84:85], v[196:197] op_sel:[0,1,0] op_sel_hi:[1,1,1]
  v_pk_fma_f32 v[198:199], v[230:231], s[84:85], v[198:199] op_sel:[0,1,0] op_sel_hi:[1,1,1]
  v_pk_fma_f32 v[200:201], v[232:233], s[86:87], v[200:201] op_sel:[0,0,0] op_sel_hi:[1,0,1]
  v_pk_fma_f32 v[202:203], v[234:235], s[86:87], v[202:203] op_sel:[0,0,0] op_sel_hi:[1,0,1]
  v_pk_fma_f32 v[204:205], v[236:237], s[86:87], v[204:205] op_sel:[0,1,0] op_sel_hi:[1,1,1]
  v_pk_fma_f32 v[206:207], v[238:239], s[86:87], v[206:207] op_sel:[0,1,0] op_sel_hi:[1,1,1]
  s_waitcnt vmcnt(0)
  v_lshlrev_b32 v208, 16, v160
  v_and_b32 v209, 0xffff0000, v160
  v_lshlrev_b32 v210, 16, v161
  v_and_b32 v211, 0xffff0000, v161
  v_lshlrev_b32 v212, 16, v162
  v_and_b32 v213, 0xffff0000, v162
  v_lshlrev_b32 v214, 16, v163
  v_and_b32 v215, 0xffff0000, v163
  v_lshlrev_b32 v216, 16, v164
  v_and_b32 v217, 0xffff0000, v164
  v_lshlrev_b32 v218, 16, v165
  v_and_b32 v219, 0xffff0000, v165
  v_lshlrev_b32 v220, 16, v166
  v_and_b32 v221, 0xffff0000, v166
  v_lshlrev_b32 v222, 16, v167
  v_and_b32 v223, 0xffff0000, v167
  v_pk_fma_f32 v[224:225], v[208:209], v[180:181], v[188:189]
  v_pk_fma_f32 v[226:227], v[210:211], v[182:183], v[190:191]
  v_pk_fma_f32 v[228:229], v[212:213], v[180:181], v[188:189]
  v_pk_fma_f32 v[230:231], v[214:215], v[182:183], v[190:191]
  v_pk_fma_f32 v[232:233], v[216:217], v[180:181], v[188:189]
  v_pk_fma_f32 v[234:235], v[218:219], v[182:183], v[190:191]
  v_pk_fma_f32 v[236:237], v[220:221], v[180:181], v[188:189]
  v_pk_fma_f32 v[238:239], v[222:223], v[182:183], v[190:191]
  v_cvt_pk_bf16_f32 v240, v224, v225
  v_cvt_pk_bf16_f32 v241, v226, v227
  v_cvt_pk_bf16_f32 v242, v228, v229
  v_cvt_pk_bf16_f32 v243, v230, v231
  ds_write_b128 v20, v[240:243] offset:64
  v_cvt_pk_bf16_f32 v244, v232, v233
  v_cvt_pk_bf16_f32 v245, v234, v235
  v_cvt_pk_bf16_f32 v246, v236, v237
  v_cvt_pk_bf16_f32 v247, v238, v239
  ds_write_b128 v21, v[244:247] offset:64
  v_pk_fma_f32 v[208:209], v[224:225], s[84:85], v[208:209] op_sel:[0,0,0] op_sel_hi:[1,0,1]
  v_pk_fma_f32 v[210:211], v[226:227], s[84:85], v[210:211] op_sel:[0,0,0] op_sel_hi:[1,0,1]
  v_pk_fma_f32 v[212:213], v[228:229], s[84:85], v[212:213] op_sel:[0,1,0] op_sel_hi:[1,1,1]
  v_pk_fma_f32 v[214:215], v[230:231], s[84:85], v[214:215] op_sel:[0,1,0] op_sel_hi:[1,1,1]
  v_pk_fma_f32 v[216:217], v[232:233], s[86:87], v[216:217] op_sel:[0,0,0] op_sel_hi:[1,0,1]
  v_pk_fma_f32 v[218:219], v[234:235], s[86:87], v[218:219] op_sel:[0,0,0] op_sel_hi:[1,0,1]
  v_pk_fma_f32 v[220:221], v[236:237], s[86:87], v[220:221] op_sel:[0,1,0] op_sel_hi:[1,1,1]
  v_pk_fma_f32 v[222:223], v[238:239], s[86:87], v[222:223] op_sel:[0,1,0] op_sel_hi:[1,1,1]
  v_cvt_pk_bf16_f32 v152, v192, v194
  v_cvt_pk_bf16_f32 v153, v208, v210
  v_cvt_pk_bf16_f32 v154, v196, v198
  v_cvt_pk_bf16_f32 v155, v212, v214
  ds_write_b128 v22, v[152:155] offset:0
  v_cvt_pk_bf16_f32 v156, v200, v202
  v_cvt_pk_bf16_f32 v157, v216, v218
  v_cvt_pk_bf16_f32 v158, v204, v206
  v_cvt_pk_bf16_f32 v159, v220, v222
  ds_write_b128 v23, v[156:159] offset:0
  v_cvt_pk_bf16_f32 v160, v193, v195
  v_cvt_pk_bf16_f32 v161, v209, v211
  v_cvt_pk_bf16_f32 v162, v197, v199
  v_cvt_pk_bf16_f32 v163, v213, v215
  ds_write_b128 v22, v[160:163] offset:64
  v_cvt_pk_bf16_f32 v164, v201, v203
  v_cvt_pk_bf16_f32 v165, v217, v219
  v_cvt_pk_bf16_f32 v166, v205, v207
  v_cvt_pk_bf16_f32 v167, v221, v223
  ds_write_b128 v23, v[164:167] offset:64
  s_waitcnt lgkmcnt(0)
  s_barrier
  ds_read_b64_tr_b16 a[176:177], v17 offset:0
  ds_read_b64_tr_b16 a[178:179], v18 offset:0
  ds_read_b64_tr_b16 a[180:181], v17 offset:1024
  ds_read_b64_tr_b16 a[182:183], v18 offset:1024
  ds_read_b64_tr_b16 a[184:185], v17 offset:2048
  ds_read_b64_tr_b16 a[186:187], v18 offset:2048
  ds_read_b64_tr_b16 a[188:189], v17 offset:3072
  ds_read_b64_tr_b16 a[190:191], v18 offset:3072
  ds_read_b64_tr_b16 a[192:193], v17 offset:4096
  ds_read_b64_tr_b16 a[194:195], v18 offset:4096
  s_waitcnt lgkmcnt(8)
  v_mfma_f32_16x16x32_bf16 v[120:123], v[24:27], a[176:179], 0
  v_mfma_f32_16x16x32_bf16 v[128:131], v[28:31], a[176:179], 0
  v_mfma_f32_16x16x32_bf16 v[136:139], v[32:35], a[176:179], 0
  v_mfma_f32_16x16x32_bf16 v[144:147], v[36:39], a[176:179], 0
  v_mfma_f32_16x16x32_bf16 v[152:155], v[40:43], a[176:179], 0
  v_mfma_f32_16x16x32_bf16 v[160:163], v[44:47], a[176:179], 0
  v_mfma_f32_16x16x32_bf16 v[168:171], v[48:51], a[176:179], 0
  v_mfma_f32_16x16x32_bf16 v[176:179], v[52:55], a[176:179], 0
  ds_read_b64_tr_b16 a[196:197], v17 offset:5120
  ds_read_b64_tr_b16 a[198:199], v18 offset:5120
  ds_read_b64_tr_b16 a[200:201], v17 offset:6144
  ds_read_b64_tr_b16 a[202:203], v18 offset:6144
  s_waitcnt lgkmcnt(10)
  v_mfma_f32_16x16x32_bf16 v[124:127], v[24:27], a[180:183], 0
  v_mfma_f32_16x16x32_bf16 v[132:135], v[28:31], a[180:183], 0
  v_mfma_f32_16x16x32_bf16 v[140:143], v[32:35], a[180:183], 0
  v_mfma_f32_16x16x32_bf16 v[148:151], v[36:39], a[180:183], 0
  v_mfma_f32_16x16x32_bf16 v[156:159], v[40:43], a[180:183], 0
  v_mfma_f32_16x16x32_bf16 v[164:167], v[44:47], a[180:183], 0
  v_mfma_f32_16x16x32_bf16 v[172:175], v[48:51], a[180:183], 0
  v_mfma_f32_16x16x32_bf16 v[180:183], v[52:55], a[180:183], 0
  ds_read_b64_tr_b16 a[204:205], v17 offset:7168
  ds_read_b64_tr_b16 a[206:207], v18 offset:7168
  ds_read_b64_tr_b16 a[208:209], v17 offset:8192
  ds_read_b64_tr_b16 a[210:211], v18 offset:8192
  s_waitcnt lgkmcnt(12)
  v_mfma_f32_16x16x32_bf16 v[128:131], v[24:27], a[184:187], v[128:131]
  v_cndmask_b32 v251, v123, 0, s[74:75]
  v_cndmask_b32 v250, v122, 0, s[72:73]
  v_cndmask_b32 v249, v121, 0, s[70:71]
  v_mfma_f32_16x16x32_bf16 v[136:139], v[28:31], a[184:187], v[136:139]
  v_add_f32_dpp v250, v251, v250 wave_ror:1 row_mask:0xf bank_mask:0xf
  s_nop 1
  v_add_f32_dpp v249, v250, v249 wave_ror:1 row_mask:0xf bank_mask:0xf
  s_nop 1
  v_add_f32_dpp v248, v249, v120 wave_ror:1 row_mask:0xf bank_mask:0xf
  v_mfma_f32_16x16x32_bf16 v[144:147], v[32:35], a[184:187], v[144:147]
  v_cvt_pk_bf16_f32 v248, v248, v248
  ds_write_b16 v19, v248 offset:128
  v_mfma_f32_16x16x32_bf16 v[152:155], v[36:39], a[184:187], v[152:155]
  v_mfma_f32_16x16x32_bf16 v[160:163], v[40:43], a[184:187], v[160:163]
  v_mfma_f32_16x16x32_bf16 v[168:171], v[44:47], a[184:187], v[168:171]
  v_mfma_f32_16x16x32_bf16 v[176:179], v[48:51], a[184:187], v[176:179]
  ds_read_b64_tr_b16 a[212:213], v17 offset:9216
  ds_read_b64_tr_b16 a[214:215], v18 offset:9216
  ds_read_b64_tr_b16 a[216:217], v17 offset:10240
  ds_read_b64_tr_b16 a[218:219], v18 offset:10240
  s_waitcnt lgkmcnt(15)
  v_mfma_f32_16x16x32_bf16 v[132:135], v[24:27], a[188:191], v[132:135]
  v_cndmask_b32 v255, v127, v123, s[74:75]
  v_cndmask_b32 v254, v126, v122, s[72:73]
  v_cndmask_b32 v253, v125, v121, s[70:71]
  v_mfma_f32_16x16x32_bf16 v[140:143], v[28:31], a[188:191], v[140:143]
  v_add_f32_dpp v254, v255, v254 wave_ror:1 row_mask:0xf bank_mask:0xf
  s_nop 1
  v_add_f32_dpp v253, v254, v253 wave_ror:1 row_mask:0xf bank_mask:0xf
  s_nop 1
  v_add_f32_dpp v252, v253, v124 wave_ror:1 row_mask:0xf bank_mask:0xf
  v_mfma_f32_16x16x32_bf16 v[148:151], v[32:35], a[188:191], v[148:151]
  v_cvt_pk_bf16_f32 v252, v252, v252
  ds_write_b16 v19, v252 offset:192
  v_mfma_f32_16x16x32_bf16 v[156:159], v[36:39], a[188:191], v[156:159]
  v_mfma_f32_16x16x32_bf16 v[164:167], v[40:43], a[188:191], v[164:167]
  v_mfma_f32_16x16x32_bf16 v[172:175], v[44:47], a[188:191], v[172:175]
  v_mfma_f32_16x16x32_bf16 v[180:183], v[48:51], a[188:191], v[180:183]
  ds_read_b64_tr_b16 a[220:221], v17 offset:11264
  ds_read_b64_tr_b16 a[222:223], v18 offset:11264
  ds_read_b64_tr_b16 a[224:225], v17 offset:12288
  ds_read_b64_tr_b16 a[226:227], v18 offset:12288
  s_waitcnt lgkmcnt(15)
  v_mfma_f32_16x16x32_bf16 v[136:139], v[24:27], a[192:195], v[136:139]
  v_cndmask_b32 v251, v131, v127, s[74:75]
  v_cndmask_b32 v250, v130, v126, s[72:73]
  v_cndmask_b32 v249, v129, v125, s[70:71]
  v_mfma_f32_16x16x32_bf16 v[144:147], v[28:31], a[192:195], v[144:147]
  v_add_f32_dpp v250, v251, v250 wave_ror:1 row_mask:0xf bank_mask:0xf
  s_nop 1
  v_add_f32_dpp v249, v250, v249 wave_ror:1 row_mask:0xf bank_mask:0xf
  s_nop 1
  v_add_f32_dpp v248, v249, v128 wave_ror:1 row_mask:0xf bank_mask:0xf
  v_mfma_f32_16x16x32_bf16 v[152:155], v[32:35], a[192:195], v[152:155]
  v_cvt_pk_bf16_f32 v248, v248, v248
  ds_write_b16 v19, v248 offset:384
  v_mfma_f32_16x16x32_bf16 v[160:163], v[36:39], a[192:195], v[160:163]
  v_mfma_f32_16x16x32_bf16 v[168:171], v[40:43], a[192:195], v[168:171]
  v_mfma_f32_16x16x32_bf16 v[176:179], v[44:47], a[192:195], v[176:179]
  ds_read_b64_tr_b16 a[228:229], v17 offset:13312
  ds_read_b64_tr_b16 a[230:231], v18 offset:13312
  ds_read_b64_tr_b16 a[232:233], v17 offset:14336
  ds_read_b64_tr_b16 a[234:235], v18 offset:14336
  v_mfma_f32_16x16x32_bf16 v[140:143], v[24:27], a[196:199], v[140:143]
  v_cndmask_b32 v255, v135, v131, s[74:75]
  v_cndmask_b32 v254, v134, v130, s[72:73]
  v_cndmask_b32 v253, v133, v129, s[70:71]
  v_mfma_f32_16x16x32_bf16 v[148:151], v[28:31], a[196:199], v[148:151]
  v_add_f32_dpp v254, v255, v254 wave_ror:1 row_mask:0xf bank_mask:0xf
  s_nop 1
  v_add_f32_dpp v253, v254, v253 wave_ror:1 row_mask:0xf bank_mask:0xf
  s_nop 1
  v_add_f32_dpp v252, v253, v132 wave_ror:1 row_mask:0xf bank_mask:0xf
  v_mfma_f32_16x16x32_bf16 v[156:159], v[32:35], a[196:199], v[156:159]
  v_cvt_pk_bf16_f32 v252, v252, v252
  ds_write_b16 v19, v252 offset:448
  v_mfma_f32_16x16x32_bf16 v[164:167], v[36:39], a[196:199], v[164:167]
  v_mfma_f32_16x16x32_bf16 v[172:175], v[40:43], a[196:199], v[172:175]
  v_mfma_f32_16x16x32_bf16 v[180:183], v[44:47], a[196:199], v[180:183]
  ds_read_b64_tr_b16 a[236:237], v17 offset:15360
  ds_read_b64_tr_b16 a[238:239], v18 offset:15360
  s_waitcnt lgkmcnt(15)
  v_mfma_f32_16x16x32_bf16 v[144:147], v[24:27], a[200:203], v[144:147]
  v_cndmask_b32 v251, v139, v135, s[74:75]
  v_cndmask_b32 v250, v138, v134, s[72:73]
  v_cndmask_b32 v249, v137, v133, s[70:71]
  v_mfma_f32_16x16x32_bf16 v[152:155], v[28:31], a[200:203], v[152:155]
  v_add_f32_dpp v250, v251, v250 wave_ror:1 row_mask:0xf bank_mask:0xf
  s_nop 1
  v_add_f32_dpp v249, v250, v249 wave_ror:1 row_mask:0xf bank_mask:0xf
  s_nop 1
  v_add_f32_dpp v248, v249, v136 wave_ror:1 row_mask:0xf bank_mask:0xf
  v_mfma_f32_16x16x32_bf16 v[160:163], v[32:35], a[200:203], v[160:163]
  v_cvt_pk_bf16_f32 v248, v248, v248
  ds_write_b16 v19, v248 offset:640
  v_mfma_f32_16x16x32_bf16 v[168:171], v[36:39], a[200:203], v[168:171]
  v_mfma_f32_16x16x32_bf16 v[176:179], v[40:43], a[200:203], v[176:179]
  v_mfma_f32_16x16x32_bf16 v[148:151], v[24:27], a[204:207], v[148:151]
  v_cndmask_b32 v255, v143, v139, s[74:75]
  v_cndmask_b32 v254, v142, v138, s[72:73]
  v_cndmask_b32 v253, v141, v137, s[70:71]
  v_mfma_f32_16x16x32_bf16 v[156:159], v[28:31], a[204:207], v[156:159]
  v_add_f32_dpp v254, v255, v254 wave_ror:1 row_mask:0xf bank_mask:0xf
  s_nop 1
  v_add_f32_dpp v253, v254, v253 wave_ror:1 row_mask:0xf bank_mask:0xf
  s_nop 1
  v_add_f32_dpp v252, v253, v140 wave_ror:1 row_mask:0xf bank_mask:0xf
  v_mfma_f32_16x16x32_bf16 v[164:167], v[32:35], a[204:207], v[164:167]
  v_cvt_pk_bf16_f32 v252, v252, v252
  ds_write_b16 v19, v252 offset:704
  v_mfma_f32_16x16x32_bf16 v[172:175], v[36:39], a[204:207], v[172:175]
  v_mfma_f32_16x16x32_bf16 v[180:183], v[40:43], a[204:207], v[180:183]
  v_mfma_f32_16x16x32_bf16 v[152:155], v[24:27], a[208:211], v[152:155]
  v_cndmask_b32 v251, v147, v143, s[74:75]
  v_cndmask_b32 v250, v146, v142, s[72:73]
  v_cndmask_b32 v249, v145, v141, s[70:71]
  v_mfma_f32_16x16x32_bf16 v[160:163], v[28:31], a[208:211], v[160:163]
  v_add_f32_dpp v250, v251, v250 wave_ror:1 row_mask:0xf bank_mask:0xf
  s_nop 1
  v_add_f32_dpp v249, v250, v249 wave_ror:1 row_mask:0xf bank_mask:0xf
  s_nop 1
  v_add_f32_dpp v248, v249, v144 wave_ror:1 row_mask:0xf bank_mask:0xf
  v_mfma_f32_16x16x32_bf16 v[168:171], v[32:35], a[208:211], v[168:171]
  v_cvt_pk_bf16_f32 v248, v248, v248
  ds_write_b16 v19, v248 offset:896
  v_mfma_f32_16x16x32_bf16 v[176:179], v[36:39], a[208:211], v[176:179]
  v_mfma_f32_16x16x32_bf16 v[156:159], v[24:27], a[212:215], v[156:159]
  v_cndmask_b32 v255, v151, v147, s[74:75]
  v_cndmask_b32 v254, v150, v146, s[72:73]
  v_cndmask_b32 v253, v149, v145, s[70:71]
  v_mfma_f32_16x16x32_bf16 v[164:167], v[28:31], a[212:215], v[164:167]
  v_add_f32_dpp v254, v255, v254 wave_ror:1 row_mask:0xf bank_mask:0xf
  s_nop 1
  v_add_f32_dpp v253, v254, v253 wave_ror:1 row_mask:0xf bank_mask:0xf
  s_nop 1
  v_add_f32_dpp v252, v253, v148 wave_ror:1 row_mask:0xf bank_mask:0xf
  v_mfma_f32_16x16x32_bf16 v[172:175], v[32:35], a[212:215], v[172:175]
  v_cvt_pk_bf16_f32 v252, v252, v252
  ds_write_b16 v19, v252 offset:960
  v_mfma_f32_16x16x32_bf16 v[180:183], v[36:39], a[212:215], v[180:183]
  s_waitcnt lgkmcnt(15)
  v_mfma_f32_16x16x32_bf16 v[160:163], v[24:27], a[216:219], v[160:163]
  v_cndmask_b32 v251, v155, v151, s[74:75]
  v_cndmask_b32 v250, v154, v150, s[72:73]
  v_cndmask_b32 v249, v153, v149, s[70:71]
  v_mfma_f32_16x16x32_bf16 v[168:171], v[28:31], a[216:219], v[168:171]
  v_add_f32_dpp v250, v251, v250 wave_ror:1 row_mask:0xf bank_mask:0xf
  s_nop 1
  v_add_f32_dpp v249, v250, v249 wave_ror:1 row_mask:0xf bank_mask:0xf
  s_nop 1
  v_add_f32_dpp v248, v249, v152 wave_ror:1 row_mask:0xf bank_mask:0xf
  v_mfma_f32_16x16x32_bf16 v[176:179], v[32:35], a[216:219], v[176:179]
  v_cvt_pk_bf16_f32 v248, v248, v248
  ds_write_b16 v19, v248 offset:1152
  s_waitcnt lgkmcnt(15)
  v_mfma_f32_16x16x32_bf16 v[164:167], v[24:27], a[220:223], v[164:167]
  v_cndmask_b32 v255, v159, v155, s[74:75]
  v_cndmask_b32 v254, v158, v154, s[72:73]
  v_cndmask_b32 v253, v157, v153, s[70:71]
  v_mfma_f32_16x16x32_bf16 v[172:175], v[28:31], a[220:223], v[172:175]
  v_add_f32_dpp v254, v255, v254 wave_ror:1 row_mask:0xf bank_mask:0xf
  s_nop 1
  v_add_f32_dpp v253, v254, v253 wave_ror:1 row_mask:0xf bank_mask:0xf
  s_nop 1
  v_add_f32_dpp v252, v253, v156 wave_ror:1 row_mask:0xf bank_mask:0xf
  v_mfma_f32_16x16x32_bf16 v[180:183], v[32:35], a[220:223], v[180:183]
  v_cvt_pk_bf16_f32 v252, v252, v252
  ds_write_b16 v19, v252 offset:1216
  s_waitcnt lgkmcnt(14)
  v_mfma_f32_16x16x32_bf16 v[168:171], v[24:27], a[224:227], v[168:171]
  v_cndmask_b32 v251, v163, v159, s[74:75]
  v_cndmask_b32 v250, v162, v158, s[72:73]
  v_cndmask_b32 v249, v161, v157, s[70:71]
  v_mfma_f32_16x16x32_bf16 v[176:179], v[28:31], a[224:227], v[176:179]
  v_add_f32_dpp v250, v251, v250 wave_ror:1 row_mask:0xf bank_mask:0xf
  s_nop 1
  v_add_f32_dpp v249, v250, v249 wave_ror:1 row_mask:0xf bank_mask:0xf
  s_nop 1
  v_add_f32_dpp v248, v249, v160 wave_ror:1 row_mask:0xf bank_mask:0xf
  s_waitcnt lgkmcnt(11)
  v_mfma_f32_16x16x32_bf16 v[172:175], v[24:27], a[228:231], v[172:175]
  v_cvt_pk_bf16_f32 v248, v248, v248
  ds_write_b16 v19, v248 offset:1408
  v_cndmask_b32 v255, v167, v163, s[74:75]
  v_mfma_f32_16x16x32_bf16 v[180:183], v[28:31], a[228:231], v[180:183]
  v_cndmask_b32 v254, v166, v162, s[72:73]
  v_cndmask_b32 v253, v165, v161, s[70:71]
  s_nop 0
  v_add_f32_dpp v254, v255, v254 wave_ror:1 row_mask:0xf bank_mask:0xf
  s_waitcnt lgkmcnt(10)
  v_mfma_f32_16x16x32_bf16 v[176:179], v[24:27], a[232:235], v[176:179]
  v_add_f32_dpp v253, v254, v253 wave_ror:1 row_mask:0xf bank_mask:0xf
  s_nop 1
  v_add_f32_dpp v252, v253, v164 wave_ror:1 row_mask:0xf bank_mask:0xf
  v_cvt_pk_bf16_f32 v252, v252, v252
  s_waitcnt lgkmcnt(7)
  v_mfma_f32_16x16x32_bf16 v[180:183], v[24:27], a[236:239], v[180:183]
  ds_write_b16 v19, v252 offset:1472
  v_cndmask_b32 v251, v171, v167, s[74:75]
  v_cndmask_b32 v250, v170, v166, s[72:73]
  v_mfma_f32_16x16x32_bf16 v[184:187], v[56:59], a[176:179], 0
  v_cndmask_b32 v249, v169, v165, s[70:71]
  v_add_f32_dpp v250, v251, v250 wave_ror:1 row_mask:0xf bank_mask:0xf
  s_nop 1
  v_add_f32_dpp v249, v250, v249 wave_ror:1 row_mask:0xf bank_mask:0xf
  v_mfma_f32_16x16x32_bf16 v[192:195], v[60:63], a[176:179], 0
  s_nop 0
  v_add_f32_dpp v248, v249, v168 wave_ror:1 row_mask:0xf bank_mask:0xf
  v_cvt_pk_bf16_f32 v248, v248, v248
  ds_write_b16 v19, v248 offset:1664
  v_mfma_f32_16x16x32_bf16 v[200:203], v[64:67], a[176:179], 0
  v_cndmask_b32 v255, v175, v171, s[74:75]
  v_cndmask_b32 v254, v174, v170, s[72:73]
  v_cndmask_b32 v253, v173, v169, s[70:71]
  v_mfma_f32_16x16x32_bf16 v[208:211], v[68:71], a[176:179], 0
  v_add_f32_dpp v254, v255, v254 wave_ror:1 row_mask:0xf bank_mask:0xf
  s_nop 1
  v_add_f32_dpp v253, v254, v253 wave_ror:1 row_mask:0xf bank_mask:0xf
  s_nop 1
  v_add_f32_dpp v252, v253, v172 wave_ror:1 row_mask:0xf bank_mask:0xf
  v_mfma_f32_16x16x32_bf16 v[216:219], v[72:75], a[176:179], 0
  v_cvt_pk_bf16_f32 v252, v252, v252
  ds_write_b16 v19, v252 offset:1728
  v_cndmask_b32 v251, v179, v175, s[74:75]
  v_mfma_f32_16x16x32_bf16 v[224:227], v[76:79], a[176:179], 0
  v_cndmask_b32 v250, v178, v174, s[72:73]
  v_cndmask_b32 v249, v177, v173, s[70:71]
  s_nop 0
  v_add_f32_dpp v250, v251, v250 wave_ror:1 row_mask:0xf bank_mask:0xf
  v_mfma_f32_16x16x32_bf16 v[232:235], v[80:83], a[176:179], 0
  s_nop 0
  v_add_f32_dpp v249, v250, v249 wave_ror:1 row_mask:0xf bank_mask:0xf
  s_nop 1
  v_add_f32_dpp v248, v249, v176 wave_ror:1 row_mask:0xf bank_mask:0xf
  v_cvt_pk_bf16_f32 v248, v248, v248
  v_mfma_f32_16x16x32_bf16 v[240:243], v[84:87], a[176:179], 0
  ds_write_b16 v19, v248 offset:1920
  v_mfma_f32_16x16x32_bf16 v[188:191], v[56:59], a[180:183], 0
  v_cndmask_b32 v255, v183, v179, s[74:75]
  v_cndmask_b32 v254, v182, v178, s[72:73]
  v_cndmask_b32 v253, v181, v177, s[70:71]
  v_mfma_f32_16x16x32_bf16 v[196:199], v[60:63], a[180:183], 0
  v_add_f32_dpp v254, v255, v254 wave_ror:1 row_mask:0xf bank_mask:0xf
  s_nop 1
  v_add_f32_dpp v253, v254, v253 wave_ror:1 row_mask:0xf bank_mask:0xf
  s_nop 1
  v_add_f32_dpp v252, v253, v180 wave_ror:1 row_mask:0xf bank_mask:0xf
  v_mfma_f32_16x16x32_bf16 v[204:207], v[64:67], a[180:183], 0
  v_cvt_pk_bf16_f32 v252, v252, v252
  ds_write_b16 v19, v252 offset:1984
  v_mfma_f32_16x16x32_bf16 v[212:215], v[68:71], a[180:183], 0
  v_mfma_f32_16x16x32_bf16 v[220:223], v[72:75], a[180:183], 0
  v_mfma_f32_16x16x32_bf16 v[228:231], v[76:79], a[180:183], 0
  v_mfma_f32_16x16x32_bf16 v[236:239], v[80:83], a[180:183], 0
  v_mfma_f32_16x16x32_bf16 v[244:247], v[84:87], a[180:183], 0
  v_mfma_f32_16x16x32_bf16 v[184:187], v[52:55], a[184:187], v[184:187]
  v_mfma_f32_16x16x32_bf16 v[192:195], v[56:59], a[184:187], v[192:195]
  v_mfma_f32_16x16x32_bf16 v[200:203], v[60:63], a[184:187], v[200:203]
  v_mfma_f32_16x16x32_bf16 v[208:211], v[64:67], a[184:187], v[208:211]
  v_mfma_f32_16x16x32_bf16 v[216:219], v[68:71], a[184:187], v[216:219]
  v_mfma_f32_16x16x32_bf16 v[224:227], v[72:75], a[184:187], v[224:227]
  v_mfma_f32_16x16x32_bf16 v[232:235], v[76:79], a[184:187], v[232:235]
  v_mfma_f32_16x16x32_bf16 v[240:243], v[80:83], a[184:187], v[240:243]
  v_mfma_f32_16x16x32_bf16 v[188:191], v[52:55], a[188:191], v[188:191]
  v_mfma_f32_16x16x32_bf16 v[196:199], v[56:59], a[188:191], v[196:199]
  v_mfma_f32_16x16x32_bf16 v[204:207], v[60:63], a[188:191], v[204:207]
  v_mfma_f32_16x16x32_bf16 v[212:215], v[64:67], a[188:191], v[212:215]
  v_mfma_f32_16x16x32_bf16 v[220:223], v[68:71], a[188:191], v[220:223]
  v_mfma_f32_16x16x32_bf16 v[228:231], v[72:75], a[188:191], v[228:231]
  v_mfma_f32_16x16x32_bf16 v[236:239], v[76:79], a[188:191], v[236:239]
  v_mfma_f32_16x16x32_bf16 v[244:247], v[80:83], a[188:191], v[244:247]
  s_waitcnt lgkmcnt(0)
  s_barrier
  v_mfma_f32_16x16x32_bf16 v[184:187], v[48:51], a[192:195], v[184:187]
  ds_read_b64_tr_b16 v[120:121], v12 offset:128
  ds_read_b64_tr_b16 v[124:125], v13 offset:2048
  v_mfma_f32_16x16x32_bf16 v[192:195], v[52:55], a[192:195], v[192:195]
  ds_read_b64_tr_b16 v[122:123], v12 offset:256
  ds_read_b64_tr_b16 v[126:127], v13 offset:2112
  v_mfma_f32_16x16x32_bf16 v[200:203], v[56:59], a[192:195], v[200:203]
  ds_read_b64_tr_b16 v[128:129], v12 offset:1152
  ds_read_b64_tr_b16 v[132:133], v13 offset:10240
  v_mfma_f32_16x16x32_bf16 v[208:211], v[60:63], a[192:195], v[208:211]
  ds_read_b64_tr_b16 v[130:131], v12 offset:1280
  ds_read_b64_tr_b16 v[134:135], v13 offset:10304
  v_mfma_f32_16x16x32_bf16 v[216:219], v[64:67], a[192:195], v[216:219]
  s_waitcnt lgkmcnt(4)
  v_lshlrev_b32 v136, 16, v120
  v_mfma_f32_16x16x32_bf16 v[224:227], v[68:71], a[192:195], v[224:227]
  v_and_b32 v137, 0xffff0000, v120
  v_lshlrev_b32 v144, 16, v124
  v_mfma_f32_16x16x32_bf16 v[232:235], v[72:75], a[192:195], v[232:235]
  v_and_b32 v145, 0xffff0000, v124
  v_lshlrev_b32 v138, 16, v121
  v_mfma_f32_16x16x32_bf16 v[240:243], v[76:79], a[192:195], v[240:243]
  v_and_b32 v139, 0xffff0000, v121
  v_lshlrev_b32 v146, 16, v125
  v_mfma_f32_16x16x32_bf16 v[188:191], v[48:51], a[196:199], v[188:191]
  v_and_b32 v147, 0xffff0000, v125
  v_lshlrev_b32 v140, 16, v122
  v_mfma_f32_16x16x32_bf16 v[196:199], v[52:55], a[196:199], v[196:199]
  v_and_b32 v141, 0xffff0000, v122
  v_lshlrev_b32 v148, 16, v126
  v_mfma_f32_16x16x32_bf16 v[204:207], v[56:59], a[196:199], v[204:207]
  v_and_b32 v149, 0xffff0000, v126
  v_lshlrev_b32 v142, 16, v123
  v_mfma_f32_16x16x32_bf16 v[212:215], v[60:63], a[196:199], v[212:215]
  v_and_b32 v143, 0xffff0000, v123
  v_lshlrev_b32 v150, 16, v127
  v_mfma_f32_16x16x32_bf16 v[220:223], v[64:67], a[196:199], v[220:223]
  v_and_b32 v151, 0xffff0000, v127
  v_add_f32 v136, v136, v144
  v_mfma_f32_16x16x32_bf16 v[228:231], v[68:71], a[196:199], v[228:231]
  v_add_f32 v137, v137, v145
  v_add_f32 v138, v138, v146
  v_mfma_f32_16x16x32_bf16 v[236:239], v[72:75], a[196:199], v[236:239]
  v_add_f32 v139, v139, v147
  v_add_f32 v140, v140, v148
  v_mfma_f32_16x16x32_bf16 v[244:247], v[76:79], a[196:199], v[244:247]
  v_add_f32 v141, v141, v149
  v_add_f32 v142, v142, v150
  v_mfma_f32_16x16x32_bf16 v[184:187], v[44:47], a[200:203], v[184:187]
  v_add_f32 v143, v143, v151
  s_add_u32 s14, s13, 0
  v_mfma_f32_16x16x32_bf16 v[192:195], v[48:51], a[200:203], v[192:195]
  v_cvt_pk_bf16_f32 v120, v136, v137
  v_cvt_pk_bf16_f32 v121, v138, v139
  v_mfma_f32_16x16x32_bf16 v[200:203], v[52:55], a[200:203], v[200:203]
  v_cvt_pk_bf16_f32 v122, v140, v141
  v_cvt_pk_bf16_f32 v123, v142, v143
  v_mfma_f32_16x16x32_bf16 v[208:211], v[56:59], a[200:203], v[208:211]
  buffer_store_dwordx4 v[120:123], v14, s[56:59], s14 offen sc1
  s_waitcnt lgkmcnt(0)
  v_mfma_f32_16x16x32_bf16 v[216:219], v[60:63], a[200:203], v[216:219]
  v_lshlrev_b32 v152, 16, v128
  v_and_b32 v153, 0xffff0000, v128
  v_mfma_f32_16x16x32_bf16 v[224:227], v[64:67], a[200:203], v[224:227]
  v_lshlrev_b32 v160, 16, v132
  v_and_b32 v161, 0xffff0000, v132
  v_mfma_f32_16x16x32_bf16 v[232:235], v[68:71], a[200:203], v[232:235]
  v_lshlrev_b32 v154, 16, v129
  v_and_b32 v155, 0xffff0000, v129
  v_mfma_f32_16x16x32_bf16 v[240:243], v[72:75], a[200:203], v[240:243]
  v_lshlrev_b32 v162, 16, v133
  v_and_b32 v163, 0xffff0000, v133
  v_mfma_f32_16x16x32_bf16 v[188:191], v[44:47], a[204:207], v[188:191]
  v_lshlrev_b32 v156, 16, v130
  v_and_b32 v157, 0xffff0000, v130
  v_mfma_f32_16x16x32_bf16 v[196:199], v[48:51], a[204:207], v[196:199]
  v_lshlrev_b32 v164, 16, v134
  v_and_b32 v165, 0xffff0000, v134
  v_mfma_f32_16x16x32_bf16 v[204:207], v[52:55], a[204:207], v[204:207]
  v_lshlrev_b32 v158, 16, v131
  v_and_b32 v159, 0xffff0000, v131
  v_mfma_f32_16x16x32_bf16 v[212:215], v[56:59], a[204:207], v[212:215]
  v_lshlrev_b32 v166, 16, v135
  v_and_b32 v167, 0xffff0000, v135
  v_mfma_f32_16x16x32_bf16 v[220:223], v[60:63], a[204:207], v[220:223]
  v_add_f32 v152, v152, v160
  v_add_f32 v153, v153, v161
  v_mfma_f32_16x16x32_bf16 v[228:231], v[64:67], a[204:207], v[228:231]
  v_add_f32 v154, v154, v162
  v_add_f32 v155, v155, v163
  v_mfma_f32_16x16x32_bf16 v[236:239], v[68:71], a[204:207], v[236:239]
  v_add_f32 v156, v156, v164
  v_add_f32 v157, v157, v165
  v_mfma_f32_16x16x32_bf16 v[244:247], v[72:75], a[204:207], v[244:247]
  v_add_f32 v158, v158, v166
  v_add_f32 v159, v159, v167
  s_add_u32 s14, s13, 1310720
  v_cvt_pk_bf16_f32 v128, v152, v153
  v_cvt_pk_bf16_f32 v129, v154, v155
  v_cvt_pk_bf16_f32 v130, v156, v157
  v_cvt_pk_bf16_f32 v131, v158, v159
  buffer_store_dwordx4 v[128:131], v14, s[56:59], s14 offen sc1
  buffer_load_dwordx2 v[10:11], v8, s[92:95], s34 offen sc1
  v_mfma_f32_16x16x32_bf16 v[184:187], v[40:43], a[208:211], v[184:187]
  v_mfma_f32_16x16x32_bf16 v[192:195], v[44:47], a[208:211], v[192:195]
  v_mfma_f32_16x16x32_bf16 v[200:203], v[48:51], a[208:211], v[200:203]
  v_mfma_f32_16x16x32_bf16 v[208:211], v[52:55], a[208:211], v[208:211]
  v_mfma_f32_16x16x32_bf16 v[216:219], v[56:59], a[208:211], v[216:219]
  v_mfma_f32_16x16x32_bf16 v[224:227], v[60:63], a[208:211], v[224:227]
  v_mfma_f32_16x16x32_bf16 v[232:235], v[64:67], a[208:211], v[232:235]
  v_mfma_f32_16x16x32_bf16 v[240:243], v[68:71], a[208:211], v[240:243]
  v_mfma_f32_16x16x32_bf16 v[188:191], v[40:43], a[212:215], v[188:191]
  v_mfma_f32_16x16x32_bf16 v[196:199], v[44:47], a[212:215], v[196:199]
  v_mfma_f32_16x16x32_bf16 v[204:207], v[48:51], a[212:215], v[204:207]
  v_mfma_f32_16x16x32_bf16 v[212:215], v[52:55], a[212:215], v[212:215]
  v_mfma_f32_16x16x32_bf16 v[220:223], v[56:59], a[212:215], v[220:223]
  v_mfma_f32_16x16x32_bf16 v[228:231], v[60:63], a[212:215], v[228:231]
  v_mfma_f32_16x16x32_bf16 v[236:239], v[64:67], a[212:215], v[236:239]
  v_mfma_f32_16x16x32_bf16 v[244:247], v[68:71], a[212:215], v[244:247]
  v_mfma_f32_16x16x32_bf16 v[184:187], v[36:39], a[216:219], v[184:187]
  v_mfma_f32_16x16x32_bf16 v[192:195], v[40:43], a[216:219], v[192:195]
  v_mfma_f32_16x16x32_bf16 v[200:203], v[44:47], a[216:219], v[200:203]
  v_mfma_f32_16x16x32_bf16 v[208:211], v[48:51], a[216:219], v[208:211]
  v_mfma_f32_16x16x32_bf16 v[216:219], v[52:55], a[216:219], v[216:219]
  v_mfma_f32_16x16x32_bf16 v[224:227], v[56:59], a[216:219], v[224:227]
  v_mfma_f32_16x16x32_bf16 v[232:235], v[60:63], a[216:219], v[232:235]
  v_mfma_f32_16x16x32_bf16 v[240:243], v[64:67], a[216:219], v[240:243]
  ds_read_b64_tr_b16 v[88:89], v17 offset:16384
  ds_read_b64_tr_b16 v[90:91], v18 offset:16384
  v_mfma_f32_16x16x32_bf16 v[188:191], v[36:39], a[220:223], v[188:191]
  v_mfma_f32_16x16x32_bf16 v[196:199], v[40:43], a[220:223], v[196:199]
  v_mfma_f32_16x16x32_bf16 v[204:207], v[44:47], a[220:223], v[204:207]
  v_mfma_f32_16x16x32_bf16 v[212:215], v[48:51], a[220:223], v[212:215]
  v_mfma_f32_16x16x32_bf16 v[220:223], v[52:55], a[220:223], v[220:223]
  v_mfma_f32_16x16x32_bf16 v[228:231], v[56:59], a[220:223], v[228:231]
  v_mfma_f32_16x16x32_bf16 v[236:239], v[60:63], a[220:223], v[236:239]
  v_mfma_f32_16x16x32_bf16 v[244:247], v[64:67], a[220:223], v[244:247]
  ds_read_b64_tr_b16 v[92:93], v17 offset:17408
  ds_read_b64_tr_b16 v[94:95], v18 offset:17408
  s_waitcnt vmcnt(0)
  s_barrier
  s_cmp_lg_u32 s3, 0
  s_nop 2
  s_cbranch_scc1 FLG_HA
  s_add_u32 s92, s42, 0x13c0000
  s_addc_u32 s93, s43, 0
  s_mov_b32 s94, 0x10000
  s_mov_b32 s95, 0x20000
  s_lshl_b32 s35, s5, 7
  v_mov_b32 v20, s90
  v_mov_b32 v21, s91
  v_mov_b32 v22, 24576
  s_mov_b64 exec, 1
  buffer_store_dwordx2 v[20:21], v22, s[92:95], s35 offen sc1
  s_mov_b64 exec, -1
FLG_HA:
  v_cmp_ne_u64 vcc, s[90:91], v[10:11]
  s_nop 4
  s_cbranch_vccnz F_NOW13
  s_mov_b32 s33, 1
  v_mfma_f32_16x16x32_bf16 v[184:187], v[32:35], a[224:227], v[184:187]
  v_mfma_f32_16x16x32_bf16 v[192:195], v[36:39], a[224:227], v[192:195]
  v_mfma_f32_16x16x32_bf16 v[200:203], v[40:43], a[224:227], v[200:203]
  v_mfma_f32_16x16x32_bf16 v[208:211], v[44:47], a[224:227], v[208:211]
  s_add_u32 s35, s32, 0
  buffer_load_dwordx4 a[0:3], v2, s[28:31], s35 offen offset:0 sc1
  v_mfma_f32_16x16x32_bf16 v[216:219], v[48:51], a[224:227], v[216:219]
  v_mfma_f32_16x16x32_bf16 v[224:227], v[52:55], a[224:227], v[224:227]
  v_mfma_f32_16x16x32_bf16 v[232:235], v[56:59], a[224:227], v[232:235]
  v_mfma_f32_16x16x32_bf16 v[240:243], v[60:63], a[224:227], v[240:243]
  buffer_load_dwordx4 a[4:7], v2, s[28:31], s35 offen offset:1024 sc1
  ds_read_b64_tr_b16 v[96:97], v17 offset:18432
  ds_read_b64_tr_b16 v[98:99], v18 offset:18432
  v_mfma_f32_16x16x32_bf16 v[188:191], v[32:35], a[228:231], v[188:191]
  v_mfma_f32_16x16x32_bf16 v[196:199], v[36:39], a[228:231], v[196:199]
  v_mfma_f32_16x16x32_bf16 v[204:207], v[40:43], a[228:231], v[204:207]
  v_mfma_f32_16x16x32_bf16 v[212:215], v[44:47], a[228:231], v[212:215]
  buffer_load_dwordx4 a[8:11], v2, s[28:31], s35 offen offset:2048 sc1
  v_mfma_f32_16x16x32_bf16 v[220:223], v[48:51], a[228:231], v[220:223]
  v_mfma_f32_16x16x32_bf16 v[228:231], v[52:55], a[228:231], v[228:231]
  v_mfma_f32_16x16x32_bf16 v[236:239], v[56:59], a[228:231], v[236:239]
  v_mfma_f32_16x16x32_bf16 v[244:247], v[60:63], a[228:231], v[244:247]
  buffer_load_dwordx4 a[12:15], v2, s[28:31], s35 offen offset:3072 sc1
  ds_read_b64_tr_b16 v[100:101], v17 offset:19456
  ds_read_b64_tr_b16 v[102:103], v18 offset:19456
  v_mfma_f32_16x16x32_bf16 v[184:187], v[28:31], a[232:235], v[184:187]
  v_mfma_f32_16x16x32_bf16 v[192:195], v[32:35], a[232:235], v[192:195]
  v_mfma_f32_16x16x32_bf16 v[200:203], v[36:39], a[232:235], v[200:203]
  v_mfma_f32_16x16x32_bf16 v[208:211], v[40:43], a[232:235], v[208:211]
  s_add_u32 s35, s32, 4096
  buffer_load_dwordx4 a[16:19], v2, s[28:31], s35 offen offset:0 sc1
  v_mfma_f32_16x16x32_bf16 v[216:219], v[44:47], a[232:235], v[216:219]
  v_mfma_f32_16x16x32_bf16 v[224:227], v[48:51], a[232:235], v[224:227]
  v_mfma_f32_16x16x32_bf16 v[232:235], v[52:55], a[232:235], v[232:235]
  v_mfma_f32_16x16x32_bf16 v[240:243], v[56:59], a[232:235], v[240:243]
  buffer_load_dwordx4 a[20:23], v2, s[28:31], s35 offen offset:1024 sc1
  ds_read_b64_tr_b16 v[104:105], v17 offset:20480
  ds_read_b64_tr_b16 v[106:107], v18 offset:20480
  v_mfma_f32_16x16x32_bf16 v[188:191], v[28:31], a[236:239], v[188:191]
  v_mfma_f32_16x16x32_bf16 v[196:199], v[32:35], a[236:239], v[196:199]
  v_mfma_f32_16x16x32_bf16 v[204:207], v[36:39], a[236:239], v[204:207]
  v_mfma_f32_16x16x32_bf16 v[212:215], v[40:43], a[236:239], v[212:215]
  buffer_load_dwordx4 a[24:27], v2, s[28:31], s35 offen offset:2048 sc1
  v_mfma_f32_16x16x32_bf16 v[220:223], v[44:47], a[236:239], v[220:223]
  v_mfma_f32_16x16x32_bf16 v[228:231], v[48:51], a[236:239], v[228:231]
  v_mfma_f32_16x16x32_bf16 v[236:239], v[52:55], a[236:239], v[236:239]
  v_mfma_f32_16x16x32_bf16 v[244:247], v[56:59], a[236:239], v[244:247]
  buffer_load_dwordx4 a[28:31], v2, s[28:31], s35 offen offset:3072 sc1
  ds_read_b64_tr_b16 v[108:109], v17 offset:21504
  ds_read_b64_tr_b16 v[110:111], v18 offset:21504
  s_waitcnt lgkmcnt(10)
  v_mfma_f32_16x16x32_bf16 v[184:187], v[24:27], v[88:91], v[184:187]
  v_mfma_f32_16x16x32_bf16 v[192:195], v[28:31], v[88:91], v[192:195]
  v_mfma_f32_16x16x32_bf16 v[200:203], v[32:35], v[88:91], v[200:203]
  v_mfma_f32_16x16x32_bf16 v[208:211], v[36:39], v[88:91], v[208:211]
  s_add_u32 s35, s32, 8192
  buffer_load_dwordx4 a[32:35], v2, s[28:31], s35 offen offset:0 sc1
  v_mfma_f32_16x16x32_bf16 v[216:219], v[40:43], v[88:91], v[216:219]
  v_mfma_f32_16x16x32_bf16 v[224:227], v[44:47], v[88:91], v[224:227]
  v_mfma_f32_16x16x32_bf16 v[232:235], v[48:51], v[88:91], v[232:235]
  v_mfma_f32_16x16x32_bf16 v[240:243], v[52:55], v[88:91], v[240:243]
  buffer_load_dwordx4 a[36:39], v2, s[28:31], s35 offen offset:1024 sc1
  ds_read_b64_tr_b16 v[112:113], v17 offset:22528
  ds_read_b64_tr_b16 v[114:115], v18 offset:22528
  s_waitcnt lgkmcnt(10)
  v_mfma_f32_16x16x32_bf16 v[188:191], v[24:27], v[92:95], v[188:191]
  v_mfma_f32_16x16x32_bf16 v[196:199], v[28:31], v[92:95], v[196:199]
  v_mfma_f32_16x16x32_bf16 v[204:207], v[32:35], v[92:95], v[204:207]
  v_mfma_f32_16x16x32_bf16 v[212:215], v[36:39], v[92:95], v[212:215]
  buffer_load_dwordx4 a[40:43], v2, s[28:31], s35 offen offset:2048 sc1
  v_mfma_f32_16x16x32_bf16 v[220:223], v[40:43], v[92:95], v[220:223]
  v_mfma_f32_16x16x32_bf16 v[228:231], v[44:47], v[92:95], v[228:231]
  v_mfma_f32_16x16x32_bf16 v[236:239], v[48:51], v[92:95], v[236:239]
  v_mfma_f32_16x16x32_bf16 v[244:247], v[52:55], v[92:95], v[244:247]
  buffer_load_dwordx4 a[44:47], v2, s[28:31], s35 offen offset:3072 sc1
  ds_read_b64_tr_b16 v[116:117], v17 offset:23552
  ds_read_b64_tr_b16 v[118:119], v18 offset:23552
  s_waitcnt lgkmcnt(10)
  v_mfma_f32_16x16x32_bf16 v[192:195], v[24:27], v[96:99], v[192:195]
  v_cndmask_b32 v251, v187, v183, s[74:75]
  v_cndmask_b32 v250, v186, v182, s[72:73]
  v_mfma_f32_16x16x32_bf16 v[200:203], v[28:31], v[96:99], v[200:203]
  v_cndmask_b32 v249, v185, v181, s[70:71]
  v_add_f32_dpp v250, v251, v250 wave_ror:1 row_mask:0xf bank_mask:0xf
  v_mfma_f32_16x16x32_bf16 v[208:211], v[32:35], v[96:99], v[208:211]
  s_nop 0
  v_add_f32_dpp v249, v250, v249 wave_ror:1 row_mask:0xf bank_mask:0xf
  s_nop 1
  v_add_f32_dpp v248, v249, v184 wave_ror:1 row_mask:0xf bank_mask:0xf
  v_mfma_f32_16x16x32_bf16 v[216:219], v[36:39], v[96:99], v[216:219]
  s_add_u32 s35, s32, 12288
  buffer_load_dwordx4 a[48:51], v2, s[28:31], s35 offen offset:0 sc1
  v_mfma_f32_16x16x32_bf16 v[224:227], v[40:43], v[96:99], v[224:227]
  v_cvt_pk_bf16_f32 v248, v248, v248
  ds_write_b16 v19, v248 offset:2176
  v_mfma_f32_16x16x32_bf16 v[232:235], v[44:47], v[96:99], v[232:235]
  v_mfma_f32_16x16x32_bf16 v[240:243], v[48:51], v[96:99], v[240:243]
  ds_read_b64_tr_b16 v[88:89], v17 offset:24576
  ds_read_b64_tr_b16 v[90:91], v18 offset:24576
  s_waitcnt lgkmcnt(11)
  v_mfma_f32_16x16x32_bf16 v[196:199], v[24:27], v[100:103], v[196:199]
  buffer_load_dwordx4 a[52:55], v2, s[28:31], s35 offen offset:1024 sc1
  v_mfma_f32_16x16x32_bf16 v[204:207], v[28:31], v[100:103], v[204:207]
  v_cndmask_b32 v255, v191, v187, s[74:75]
  v_cndmask_b32 v254, v190, v186, s[72:73]
  v_mfma_f32_16x16x32_bf16 v[212:215], v[32:35], v[100:103], v[212:215]
  v_cndmask_b32 v253, v189, v185, s[70:71]
  v_add_f32_dpp v254, v255, v254 wave_ror:1 row_mask:0xf bank_mask:0xf
  v_mfma_f32_16x16x32_bf16 v[220:223], v[36:39], v[100:103], v[220:223]
  s_nop 0
  v_add_f32_dpp v253, v254, v253 wave_ror:1 row_mask:0xf bank_mask:0xf
  s_nop 1
  v_add_f32_dpp v252, v253, v188 wave_ror:1 row_mask:0xf bank_mask:0xf
  v_mfma_f32_16x16x32_bf16 v[228:231], v[40:43], v[100:103], v[228:231]
  buffer_load_dwordx4 a[56:59], v2, s[28:31], s35 offen offset:2048 sc1
  v_mfma_f32_16x16x32_bf16 v[236:239], v[44:47], v[100:103], v[236:239]
  v_cvt_pk_bf16_f32 v252, v252, v252
  ds_write_b16 v19, v252 offset:2240
  v_mfma_f32_16x16x32_bf16 v[244:247], v[48:51], v[100:103], v[244:247]
  ds_read_b64_tr_b16 v[92:93], v17 offset:25600
  ds_read_b64_tr_b16 v[94:95], v18 offset:25600
  s_waitcnt lgkmcnt(12)
  v_mfma_f32_16x16x32_bf16 v[200:203], v[24:27], v[104:107], v[200:203]
  v_cndmask_b32 v251, v195, v191, s[74:75]
  v_cndmask_b32 v250, v194, v190, s[72:73]
  v_mfma_f32_16x16x32_bf16 v[208:211], v[28:31], v[104:107], v[208:211]
  buffer_load_dwordx4 a[60:63], v2, s[28:31], s35 offen offset:3072 sc1
  v_mfma_f32_16x16x32_bf16 v[216:219], v[32:35], v[104:107], v[216:219]
  v_cndmask_b32 v249, v193, v189, s[70:71]
  v_add_f32_dpp v250, v251, v250 wave_ror:1 row_mask:0xf bank_mask:0xf
  v_mfma_f32_16x16x32_bf16 v[224:227], v[36:39], v[104:107], v[224:227]
  s_nop 0
  v_add_f32_dpp v249, v250, v249 wave_ror:1 row_mask:0xf bank_mask:0xf
  s_nop 1
  v_add_f32_dpp v248, v249, v192 wave_ror:1 row_mask:0xf bank_mask:0xf
  v_mfma_f32_16x16x32_bf16 v[232:235], v[40:43], v[104:107], v[232:235]
  v_cvt_pk_bf16_f32 v248, v248, v248
  ds_write_b16 v19, v248 offset:2432
  v_mfma_f32_16x16x32_bf16 v[240:243], v[44:47], v[104:107], v[240:243]
  s_add_u32 s35, s32, 16384
  buffer_load_dwordx4 a[64:67], v2, s[28:31], s35 offen offset:0 sc1
  ds_read_b64_tr_b16 v[96:97], v17 offset:26624
  ds_read_b64_tr_b16 v[98:99], v18 offset:26624
  s_waitcnt lgkmcnt(13)
  v_mfma_f32_16x16x32_bf16 v[204:207], v[24:27], v[108:111], v[204:207]
  v_cndmask_b32 v255, v199, v195, s[74:75]
  v_cndmask_b32 v254, v198, v194, s[72:73]
  v_mfma_f32_16x16x32_bf16 v[212:215], v[28:31], v[108:111], v[212:215]
  v_cndmask_b32 v253, v197, v193, s[70:71]
  v_add_f32_dpp v254, v255, v254 wave_ror:1 row_mask:0xf bank_mask:0xf
  v_mfma_f32_16x16x32_bf16 v[220:223], v[32:35], v[108:111], v[220:223]
  s_nop 0
  v_add_f32_dpp v253, v254, v253 wave_ror:1 row_mask:0xf bank_mask:0xf
  s_nop 1
  v_add_f32_dpp v252, v253, v196 wave_ror:1 row_mask:0xf bank_mask:0xf
  v_mfma_f32_16x16x32_bf16 v[228:231], v[36:39], v[108:111], v[228:231]
  buffer_load_dwordx4 a[68:71], v2, s[28:31], s35 offen offset:1024 sc1
  v_mfma_f32_16x16x32_bf16 v[236:239], v[40:43], v[108:111], v[236:239]
  v_cvt_pk_bf16_f32 v252, v252, v252
  ds_write_b16 v19, v252 offset:2496
  v_mfma_f32_16x16x32_bf16 v[244:247], v[44:47], v[108:111], v[244:247]
  ds_read_b64_tr_b16 v[100:101], v17 offset:27648
  ds_read_b64_tr_b16 v[102:103], v18 offset:27648
  s_waitcnt lgkmcnt(14)
  v_mfma_f32_16x16x32_bf16 v[208:211], v[24:27], v[112:115], v[208:211]
  v_cndmask_b32 v251, v203, v199, s[74:75]
  v_cndmask_b32 v250, v202, v198, s[72:73]
  v_mfma_f32_16x16x32_bf16 v[216:219], v[28:31], v[112:115], v[216:219]
  buffer_load_dwordx4 a[72:75], v2, s[28:31], s35 offen offset:2048 sc1
  v_mfma_f32_16x16x32_bf16 v[224:227], v[32:35], v[112:115], v[224:227]
  v_cndmask_b32 v249, v201, v197, s[70:71]
  v_add_f32_dpp v250, v251, v250 wave_ror:1 row_mask:0xf bank_mask:0xf
  v_mfma_f32_16x16x32_bf16 v[232:235], v[36:39], v[112:115], v[232:235]
  s_nop 0
  v_add_f32_dpp v249, v250, v249 wave_ror:1 row_mask:0xf bank_mask:0xf
  s_nop 1
  v_add_f32_dpp v248, v249, v200 wave_ror:1 row_mask:0xf bank_mask:0xf
  v_mfma_f32_16x16x32_bf16 v[240:243], v[40:43], v[112:115], v[240:243]
  v_cvt_pk_bf16_f32 v248, v248, v248
  ds_write_b16 v19, v248 offset:2688
  ds_read_b64_tr_b16 v[104:105], v17 offset:28672
  ds_read_b64_tr_b16 v[106:107], v18 offset:28672
  s_waitcnt lgkmcnt(15)
  v_mfma_f32_16x16x32_bf16 v[212:215], v[24:27], v[116:119], v[212:215]
  buffer_load_dwordx4 a[76:79], v2, s[28:31], s35 offen offset:3072 sc1
  v_mfma_f32_16x16x32_bf16 v[220:223], v[28:31], v[116:119], v[220:223]
  v_cndmask_b32 v255, v207, v203, s[74:75]
  v_cndmask_b32 v254, v206, v202, s[72:73]
  v_mfma_f32_16x16x32_bf16 v[228:231], v[32:35], v[116:119], v[228:231]
  v_cndmask_b32 v253, v205, v201, s[70:71]
  v_add_f32_dpp v254, v255, v254 wave_ror:1 row_mask:0xf bank_mask:0xf
  v_mfma_f32_16x16x32_bf16 v[236:239], v[36:39], v[116:119], v[236:239]
  s_nop 0
  v_add_f32_dpp v253, v254, v253 wave_ror:1 row_mask:0xf bank_mask:0xf
  s_nop 1
  v_add_f32_dpp v252, v253, v204 wave_ror:1 row_mask:0xf bank_mask:0xf
  v_mfma_f32_16x16x32_bf16 v[244:247], v[40:43], v[116:119], v[244:247]
  s_add_u32 s35, s32, 20480
  buffer_load_dwordx4 a[80:83], v2, s[28:31], s35 offen offset:0 sc1
  ds_read_b64_tr_b16 v[108:109], v17 offset:29696
  ds_read_b64_tr_b16 v[110:111], v18 offset:29696
  s_waitcnt lgkmcnt(14)
  v_mfma_f32_16x16x32_bf16 v[216:219], v[24:27], v[88:91], v[216:219]
  v_cvt_pk_bf16_f32 v252, v252, v252
  ds_write_b16 v19, v252 offset:2752
  v_mfma_f32_16x16x32_bf16 v[224:227], v[28:31], v[88:91], v[224:227]
  v_cndmask_b32 v251, v211, v207, s[74:75]
  v_cndmask_b32 v250, v210, v206, s[72:73]
  v_mfma_f32_16x16x32_bf16 v[232:235], v[32:35], v[88:91], v[232:235]
  v_cndmask_b32 v249, v209, v205, s[70:71]
  v_add_f32_dpp v250, v251, v250 wave_ror:1 row_mask:0xf bank_mask:0xf
  v_mfma_f32_16x16x32_bf16 v[240:243], v[36:39], v[88:91], v[240:243]
  buffer_load_dwordx4 a[84:87], v2, s[28:31], s35 offen offset:1024 sc1
  ds_read_b64_tr_b16 v[112:113], v17 offset:30720
  ds_read_b64_tr_b16 v[114:115], v18 offset:30720
  s_waitcnt lgkmcnt(14)
  v_mfma_f32_16x16x32_bf16 v[220:223], v[24:27], v[92:95], v[220:223]
  v_add_f32_dpp v249, v250, v249 wave_ror:1 row_mask:0xf bank_mask:0xf
  s_nop 1
  v_add_f32_dpp v248, v249, v208 wave_ror:1 row_mask:0xf bank_mask:0xf
  v_mfma_f32_16x16x32_bf16 v[228:231], v[28:31], v[92:95], v[228:231]
  v_cvt_pk_bf16_f32 v248, v248, v248
  ds_write_b16 v19, v248 offset:2944
  v_mfma_f32_16x16x32_bf16 v[236:239], v[32:35], v[92:95], v[236:239]
  v_cndmask_b32 v255, v215, v211, s[74:75]
  v_cndmask_b32 v254, v214, v210, s[72:73]
  v_mfma_f32_16x16x32_bf16 v[244:247], v[36:39], v[92:95], v[244:247]
  buffer_load_dwordx4 a[88:91], v2, s[28:31], s35 offen offset:2048 sc1
  ds_read_b64_tr_b16 v[116:117], v17 offset:31744
  ds_read_b64_tr_b16 v[118:119], v18 offset:31744
  s_waitcnt lgkmcnt(14)
  v_mfma_f32_16x16x32_bf16 v[224:227], v[24:27], v[96:99], v[224:227]
  v_cndmask_b32 v253, v213, v209, s[70:71]
  v_add_f32_dpp v254, v255, v254 wave_ror:1 row_mask:0xf bank_mask:0xf
  v_mfma_f32_16x16x32_bf16 v[232:235], v[28:31], v[96:99], v[232:235]
  s_nop 0
  v_add_f32_dpp v253, v254, v253 wave_ror:1 row_mask:0xf bank_mask:0xf
  s_nop 1
  v_add_f32_dpp v252, v253, v212 wave_ror:1 row_mask:0xf bank_mask:0xf
  v_mfma_f32_16x16x32_bf16 v[240:243], v[32:35], v[96:99], v[240:243]
  v_cvt_pk_bf16_f32 v252, v252, v252
  ds_write_b16 v19, v252 offset:3008
  s_waitcnt lgkmcnt(12)
  v_mfma_f32_16x16x32_bf16 v[228:231], v[24:27], v[100:103], v[228:231]
  buffer_load_dwordx4 a[92:95], v2, s[28:31], s35 offen offset:3072 sc1
  v_mfma_f32_16x16x32_bf16 v[236:239], v[28:31], v[100:103], v[236:239]
  v_cndmask_b32 v251, v219, v215, s[74:75]
  v_cndmask_b32 v250, v218, v214, s[72:73]
  v_mfma_f32_16x16x32_bf16 v[244:247], v[32:35], v[100:103], v[244:247]
  v_cndmask_b32 v249, v217, v213, s[70:71]
  v_add_f32_dpp v250, v251, v250 wave_ror:1 row_mask:0xf bank_mask:0xf
  s_waitcnt lgkmcnt(9)
  v_mfma_f32_16x16x32_bf16 v[232:235], v[24:27], v[104:107], v[232:235]
  v_add_f32_dpp v249, v250, v249 wave_ror:1 row_mask:0xf bank_mask:0xf
  s_nop 1
  v_add_f32_dpp v248, v249, v216 wave_ror:1 row_mask:0xf bank_mask:0xf
  v_mfma_f32_16x16x32_bf16 v[240:243], v[28:31], v[104:107], v[240:243]
  s_add_u32 s35, s32, 24576
  buffer_load_dwordx4 a[96:99], v2, s[28:31], s35 offen offset:0 sc1
  s_waitcnt lgkmcnt(7)
  v_mfma_f32_16x16x32_bf16 v[236:239], v[24:27], v[108:111], v[236:239]
  v_cvt_pk_bf16_f32 v248, v248, v248
  ds_write_b16 v19, v248 offset:3200
  v_mfma_f32_16x16x32_bf16 v[244:247], v[28:31], v[108:111], v[244:247]
  v_cndmask_b32 v255, v223, v219, s[74:75]
  v_cndmask_b32 v254, v222, v218, s[72:73]
  s_waitcnt lgkmcnt(5)
  v_mfma_f32_16x16x32_bf16 v[240:243], v[24:27], v[112:115], v[240:243]
  v_cndmask_b32 v253, v221, v217, s[70:71]
  v_add_f32_dpp v254, v255, v254 wave_ror:1 row_mask:0xf bank_mask:0xf
  s_waitcnt lgkmcnt(2)
  v_mfma_f32_16x16x32_bf16 v[244:247], v[24:27], v[116:119], v[244:247]
  buffer_load_dwordx4 a[100:103], v2, s[28:31], s35 offen offset:1024 sc1
  v_add_f32_dpp v253, v254, v253 wave_ror:1 row_mask:0xf bank_mask:0xf
  s_nop 1
  v_add_f32_dpp v252, v253, v220 wave_ror:1 row_mask:0xf bank_mask:0xf
  v_cvt_pk_bf16_f32 v252, v252, v252
  ds_write_b16 v19, v252 offset:3264
  v_cndmask_b32 v251, v227, v223, s[74:75]
  v_cndmask_b32 v250, v226, v222, s[72:73]
  v_cndmask_b32 v249, v225, v221, s[70:71]
  s_nop 0
  v_add_f32_dpp v250, v251, v250 wave_ror:1 row_mask:0xf bank_mask:0xf
  s_nop 1
  v_add_f32_dpp v249, v250, v249 wave_ror:1 row_mask:0xf bank_mask:0xf
  s_nop 1
  v_add_f32_dpp v248, v249, v224 wave_ror:1 row_mask:0xf bank_mask:0xf
  v_cvt_pk_bf16_f32 v248, v248, v248
  ds_write_b16 v19, v248 offset:3456
  v_cndmask_b32 v255, v231, v227, s[74:75]
  v_cndmask_b32 v254, v230, v226, s[72:73]
  v_cndmask_b32 v253, v229, v225, s[70:71]
  s_nop 0
  v_add_f32_dpp v254, v255, v254 wave_ror:1 row_mask:0xf bank_mask:0xf
  s_nop 1
  v_add_f32_dpp v253, v254, v253 wave_ror:1 row_mask:0xf bank_mask:0xf
  s_nop 1
  v_add_f32_dpp v252, v253, v228 wave_ror:1 row_mask:0xf bank_mask:0xf
  v_cvt_pk_bf16_f32 v252, v252, v252
  ds_write_b16 v19, v252 offset:3520
  v_cndmask_b32 v251, v235, v231, s[74:75]
  v_cndmask_b32 v250, v234, v230, s[72:73]
  v_cndmask_b32 v249, v233, v229, s[70:71]
  s_nop 0
  v_add_f32_dpp v250, v251, v250 wave_ror:1 row_mask:0xf bank_mask:0xf
  s_nop 1
  v_add_f32_dpp v249, v250, v249 wave_ror:1 row_mask:0xf bank_mask:0xf
  s_nop 1
  v_add_f32_dpp v248, v249, v232 wave_ror:1 row_mask:0xf bank_mask:0xf
  v_cvt_pk_bf16_f32 v248, v248, v248
  ds_write_b16 v19, v248 offset:3712
  v_cndmask_b32 v255, v239, v235, s[74:75]
  v_cndmask_b32 v254, v238, v234, s[72:73]
  v_cndmask_b32 v253, v237, v233, s[70:71]
  s_nop 0
  v_add_f32_dpp v254, v255, v254 wave_ror:1 row_mask:0xf bank_mask:0xf
  s_nop 1
  v_add_f32_dpp v253, v254, v253 wave_ror:1 row_mask:0xf bank_mask:0xf
  s_nop 1
  v_add_f32_dpp v252, v253, v236 wave_ror:1 row_mask:0xf bank_mask:0xf
  v_cvt_pk_bf16_f32 v252, v252, v252
  ds_write_b16 v19, v252 offset:3776
  v_cndmask_b32 v251, v243, v239, s[74:75]
  v_cndmask_b32 v250, v242, v238, s[72:73]
  v_cndmask_b32 v249, v241, v237, s[70:71]
  s_nop 0
  v_add_f32_dpp v250, v251, v250 wave_ror:1 row_mask:0xf bank_mask:0xf
  s_nop 1
  v_add_f32_dpp v249, v250, v249 wave_ror:1 row_mask:0xf bank_mask:0xf
  s_nop 1
  v_add_f32_dpp v248, v249, v240 wave_ror:1 row_mask:0xf bank_mask:0xf
  v_cvt_pk_bf16_f32 v248, v248, v248
  ds_write_b16 v19, v248 offset:3968
  v_cndmask_b32 v255, v247, v243, s[74:75]
  v_cndmask_b32 v254, v246, v242, s[72:73]
  v_cndmask_b32 v253, v245, v241, s[70:71]
  s_nop 0
  v_add_f32_dpp v254, v255, v254 wave_ror:1 row_mask:0xf bank_mask:0xf
  s_nop 1
  v_add_f32_dpp v253, v254, v253 wave_ror:1 row_mask:0xf bank_mask:0xf
  s_nop 1
  v_add_f32_dpp v252, v253, v244 wave_ror:1 row_mask:0xf bank_mask:0xf
  v_cvt_pk_bf16_f32 v252, v252, v252
  ds_write_b16 v19, v252 offset:4032
  s_nop 0
  s_branch F_CONVDONE
F_NOW13:
  s_mov_b32 s33, 0
  v_mfma_f32_16x16x32_bf16 v[184:187], v[32:35], a[224:227], v[184:187]
  v_mfma_f32_16x16x32_bf16 v[192:195], v[36:39], a[224:227], v[192:195]
  v_mfma_f32_16x16x32_bf16 v[200:203], v[40:43], a[224:227], v[200:203]
  v_mfma_f32_16x16x32_bf16 v[208:211], v[44:47], a[224:227], v[208:211]
  v_mfma_f32_16x16x32_bf16 v[216:219], v[48:51], a[224:227], v[216:219]
  v_mfma_f32_16x16x32_bf16 v[224:227], v[52:55], a[224:227], v[224:227]
  v_mfma_f32_16x16x32_bf16 v[232:235], v[56:59], a[224:227], v[232:235]
  v_mfma_f32_16x16x32_bf16 v[240:243], v[60:63], a[224:227], v[240:243]
  ds_read_b64_tr_b16 v[96:97], v17 offset:18432
  ds_read_b64_tr_b16 v[98:99], v18 offset:18432
  v_mfma_f32_16x16x32_bf16 v[188:191], v[32:35], a[228:231], v[188:191]
  v_mfma_f32_16x16x32_bf16 v[196:199], v[36:39], a[228:231], v[196:199]
  v_mfma_f32_16x16x32_bf16 v[204:207], v[40:43], a[228:231], v[204:207]
  v_mfma_f32_16x16x32_bf16 v[212:215], v[44:47], a[228:231], v[212:215]
  v_mfma_f32_16x16x32_bf16 v[220:223], v[48:51], a[228:231], v[220:223]
  v_mfma_f32_16x16x32_bf16 v[228:231], v[52:55], a[228:231], v[228:231]
  v_mfma_f32_16x16x32_bf16 v[236:239], v[56:59], a[228:231], v[236:239]
  v_mfma_f32_16x16x32_bf16 v[244:247], v[60:63], a[228:231], v[244:247]
  ds_read_b64_tr_b16 v[100:101], v17 offset:19456
  ds_read_b64_tr_b16 v[102:103], v18 offset:19456
  v_mfma_f32_16x16x32_bf16 v[184:187], v[28:31], a[232:235], v[184:187]
  v_mfma_f32_16x16x32_bf16 v[192:195], v[32:35], a[232:235], v[192:195]
  v_mfma_f32_16x16x32_bf16 v[200:203], v[36:39], a[232:235], v[200:203]
  v_mfma_f32_16x16x32_bf16 v[208:211], v[40:43], a[232:235], v[208:211]
  v_mfma_f32_16x16x32_bf16 v[216:219], v[44:47], a[232:235], v[216:219]
  v_mfma_f32_16x16x32_bf16 v[224:227], v[48:51], a[232:235], v[224:227]
  v_mfma_f32_16x16x32_bf16 v[232:235], v[52:55], a[232:235], v[232:235]
  v_mfma_f32_16x16x32_bf16 v[240:243], v[56:59], a[232:235], v[240:243]
  ds_read_b64_tr_b16 v[104:105], v17 offset:20480
  ds_read_b64_tr_b16 v[106:107], v18 offset:20480
  v_mfma_f32_16x16x32_bf16 v[188:191], v[28:31], a[236:239], v[188:191]
  v_mfma_f32_16x16x32_bf16 v[196:199], v[32:35], a[236:239], v[196:199]
  v_mfma_f32_16x16x32_bf16 v[204:207], v[36:39], a[236:239], v[204:207]
  v_mfma_f32_16x16x32_bf16 v[212:215], v[40:43], a[236:239], v[212:215]
  v_mfma_f32_16x16x32_bf16 v[220:223], v[44:47], a[236:239], v[220:223]
  v_mfma_f32_16x16x32_bf16 v[228:231], v[48:51], a[236:239], v[228:231]
  v_mfma_f32_16x16x32_bf16 v[236:239], v[52:55], a[236:239], v[236:239]
  v_mfma_f32_16x16x32_bf16 v[244:247], v[56:59], a[236:239], v[244:247]
  ds_read_b64_tr_b16 v[108:109], v17 offset:21504
  ds_read_b64_tr_b16 v[110:111], v18 offset:21504
  s_waitcnt lgkmcnt(10)
  v_mfma_f32_16x16x32_bf16 v[184:187], v[24:27], v[88:91], v[184:187]
  v_mfma_f32_16x16x32_bf16 v[192:195], v[28:31], v[88:91], v[192:195]
  v_mfma_f32_16x16x32_bf16 v[200:203], v[32:35], v[88:91], v[200:203]
  v_mfma_f32_16x16x32_bf16 v[208:211], v[36:39], v[88:91], v[208:211]
  v_mfma_f32_16x16x32_bf16 v[216:219], v[40:43], v[88:91], v[216:219]
  v_mfma_f32_16x16x32_bf16 v[224:227], v[44:47], v[88:91], v[224:227]
  v_mfma_f32_16x16x32_bf16 v[232:235], v[48:51], v[88:91], v[232:235]
  v_mfma_f32_16x16x32_bf16 v[240:243], v[52:55], v[88:91], v[240:243]
  ds_read_b64_tr_b16 v[112:113], v17 offset:22528
  ds_read_b64_tr_b16 v[114:115], v18 offset:22528
  s_waitcnt lgkmcnt(10)
  v_mfma_f32_16x16x32_bf16 v[188:191], v[24:27], v[92:95], v[188:191]
  v_mfma_f32_16x16x32_bf16 v[196:199], v[28:31], v[92:95], v[196:199]
  v_mfma_f32_16x16x32_bf16 v[204:207], v[32:35], v[92:95], v[204:207]
  v_mfma_f32_16x16x32_bf16 v[212:215], v[36:39], v[92:95], v[212:215]
  v_mfma_f32_16x16x32_bf16 v[220:223], v[40:43], v[92:95], v[220:223]
  v_mfma_f32_16x16x32_bf16 v[228:231], v[44:47], v[92:95], v[228:231]
  v_mfma_f32_16x16x32_bf16 v[236:239], v[48:51], v[92:95], v[236:239]
  v_mfma_f32_16x16x32_bf16 v[244:247], v[52:55], v[92:95], v[244:247]
  ds_read_b64_tr_b16 v[116:117], v17 offset:23552
  ds_read_b64_tr_b16 v[118:119], v18 offset:23552
  s_waitcnt lgkmcnt(10)
  v_mfma_f32_16x16x32_bf16 v[192:195], v[24:27], v[96:99], v[192:195]
  v_cndmask_b32 v251, v187, v183, s[74:75]
  v_cndmask_b32 v250, v186, v182, s[72:73]
  v_mfma_f32_16x16x32_bf16 v[200:203], v[28:31], v[96:99], v[200:203]
  v_cndmask_b32 v249, v185, v181, s[70:71]
  v_add_f32_dpp v250, v251, v250 wave_ror:1 row_mask:0xf bank_mask:0xf
  v_mfma_f32_16x16x32_bf16 v[208:211], v[32:35], v[96:99], v[208:211]
  s_nop 0
  v_add_f32_dpp v249, v250, v249 wave_ror:1 row_mask:0xf bank_mask:0xf
  s_nop 1
  v_add_f32_dpp v248, v249, v184 wave_ror:1 row_mask:0xf bank_mask:0xf
  v_mfma_f32_16x16x32_bf16 v[216:219], v[36:39], v[96:99], v[216:219]
  v_cvt_pk_bf16_f32 v248, v248, v248
  ds_write_b16 v19, v248 offset:2176
  v_mfma_f32_16x16x32_bf16 v[224:227], v[40:43], v[96:99], v[224:227]
  v_mfma_f32_16x16x32_bf16 v[232:235], v[44:47], v[96:99], v[232:235]
  v_mfma_f32_16x16x32_bf16 v[240:243], v[48:51], v[96:99], v[240:243]
  ds_read_b64_tr_b16 v[88:89], v17 offset:24576
  ds_read_b64_tr_b16 v[90:91], v18 offset:24576
  s_waitcnt lgkmcnt(11)
  v_mfma_f32_16x16x32_bf16 v[196:199], v[24:27], v[100:103], v[196:199]
  v_cndmask_b32 v255, v191, v187, s[74:75]
  v_cndmask_b32 v254, v190, v186, s[72:73]
  v_mfma_f32_16x16x32_bf16 v[204:207], v[28:31], v[100:103], v[204:207]
  v_cndmask_b32 v253, v189, v185, s[70:71]
  v_add_f32_dpp v254, v255, v254 wave_ror:1 row_mask:0xf bank_mask:0xf
  v_mfma_f32_16x16x32_bf16 v[212:215], v[32:35], v[100:103], v[212:215]
  s_nop 0
  v_add_f32_dpp v253, v254, v253 wave_ror:1 row_mask:0xf bank_mask:0xf
  s_nop 1
  v_add_f32_dpp v252, v253, v188 wave_ror:1 row_mask:0xf bank_mask:0xf
  v_mfma_f32_16x16x32_bf16 v[220:223], v[36:39], v[100:103], v[220:223]
  v_cvt_pk_bf16_f32 v252, v252, v252
  ds_write_b16 v19, v252 offset:2240
  v_mfma_f32_16x16x32_bf16 v[228:231], v[40:43], v[100:103], v[228:231]
  v_mfma_f32_16x16x32_bf16 v[236:239], v[44:47], v[100:103], v[236:239]
  v_mfma_f32_16x16x32_bf16 v[244:247], v[48:51], v[100:103], v[244:247]
  ds_read_b64_tr_b16 v[92:93], v17 offset:25600
  ds_read_b64_tr_b16 v[94:95], v18 offset:25600
  s_waitcnt lgkmcnt(12)
  v_mfma_f32_16x16x32_bf16 v[200:203], v[24:27], v[104:107], v[200:203]
  v_cndmask_b32 v251, v195, v191, s[74:75]
  v_cndmask_b32 v250, v194, v190, s[72:73]
  v_mfma_f32_16x16x32_bf16 v[208:211], v[28:31], v[104:107], v[208:211]
  v_cndmask_b32 v249, v193, v189, s[70:71]
  v_add_f32_dpp v250, v251, v250 wave_ror:1 row_mask:0xf bank_mask:0xf
  v_mfma_f32_16x16x32_bf16 v[216:219], v[32:35], v[104:107], v[216:219]
  s_nop 0
  v_add_f32_dpp v249, v250, v249 wave_ror:1 row_mask:0xf bank_mask:0xf
  s_nop 1
  v_add_f32_dpp v248, v249, v192 wave_ror:1 row_mask:0xf bank_mask:0xf
  v_mfma_f32_16x16x32_bf16 v[224:227], v[36:39], v[104:107], v[224:227]
  v_cvt_pk_bf16_f32 v248, v248, v248
  ds_write_b16 v19, v248 offset:2432
  v_mfma_f32_16x16x32_bf16 v[232:235], v[40:43], v[104:107], v[232:235]
  v_mfma_f32_16x16x32_bf16 v[240:243], v[44:47], v[104:107], v[240:243]
  ds_read_b64_tr_b16 v[96:97], v17 offset:26624
  ds_read_b64_tr_b16 v[98:99], v18 offset:26624
  s_waitcnt lgkmcnt(13)
  v_mfma_f32_16x16x32_bf16 v[204:207], v[24:27], v[108:111], v[204:207]
  v_cndmask_b32 v255, v199, v195, s[74:75]
  v_cndmask_b32 v254, v198, v194, s[72:73]
  v_mfma_f32_16x16x32_bf16 v[212:215], v[28:31], v[108:111], v[212:215]
  v_cndmask_b32 v253, v197, v193, s[70:71]
  v_add_f32_dpp v254, v255, v254 wave_ror:1 row_mask:0xf bank_mask:0xf
  v_mfma_f32_16x16x32_bf16 v[220:223], v[32:35], v[108:111], v[220:223]
  s_nop 0
  v_add_f32_dpp v253, v254, v253 wave_ror:1 row_mask:0xf bank_mask:0xf
  s_nop 1
  v_add_f32_dpp v252, v253, v196 wave_ror:1 row_mask:0xf bank_mask:0xf
  v_mfma_f32_16x16x32_bf16 v[228:231], v[36:39], v[108:111], v[228:231]
  v_cvt_pk_bf16_f32 v252, v252, v252
  ds_write_b16 v19, v252 offset:2496
  v_mfma_f32_16x16x32_bf16 v[236:239], v[40:43], v[108:111], v[236:239]
  v_mfma_f32_16x16x32_bf16 v[244:247], v[44:47], v[108:111], v[244:247]
  ds_read_b64_tr_b16 v[100:101], v17 offset:27648
  ds_read_b64_tr_b16 v[102:103], v18 offset:27648
  s_waitcnt lgkmcnt(14)
  v_mfma_f32_16x16x32_bf16 v[208:211], v[24:27], v[112:115], v[208:211]
  v_cndmask_b32 v251, v203, v199, s[74:75]
  v_cndmask_b32 v250, v202, v198, s[72:73]
  v_mfma_f32_16x16x32_bf16 v[216:219], v[28:31], v[112:115], v[216:219]
  v_cndmask_b32 v249, v201, v197, s[70:71]
  v_add_f32_dpp v250, v251, v250 wave_ror:1 row_mask:0xf bank_mask:0xf
  v_mfma_f32_16x16x32_bf16 v[224:227], v[32:35], v[112:115], v[224:227]
  s_nop 0
  v_add_f32_dpp v249, v250, v249 wave_ror:1 row_mask:0xf bank_mask:0xf
  s_nop 1
  v_add_f32_dpp v248, v249, v200 wave_ror:1 row_mask:0xf bank_mask:0xf
  v_mfma_f32_16x16x32_bf16 v[232:235], v[36:39], v[112:115], v[232:235]
  v_cvt_pk_bf16_f32 v248, v248, v248
  ds_write_b16 v19, v248 offset:2688
  v_mfma_f32_16x16x32_bf16 v[240:243], v[40:43], v[112:115], v[240:243]
  ds_read_b64_tr_b16 v[104:105], v17 offset:28672
  ds_read_b64_tr_b16 v[106:107], v18 offset:28672
  s_waitcnt lgkmcnt(15)
  v_mfma_f32_16x16x32_bf16 v[212:215], v[24:27], v[116:119], v[212:215]
  v_cndmask_b32 v255, v207, v203, s[74:75]
  v_cndmask_b32 v254, v206, v202, s[72:73]
  v_mfma_f32_16x16x32_bf16 v[220:223], v[28:31], v[116:119], v[220:223]
  v_cndmask_b32 v253, v205, v201, s[70:71]
  v_add_f32_dpp v254, v255, v254 wave_ror:1 row_mask:0xf bank_mask:0xf
  v_mfma_f32_16x16x32_bf16 v[228:231], v[32:35], v[116:119], v[228:231]
  s_nop 0
  v_add_f32_dpp v253, v254, v253 wave_ror:1 row_mask:0xf bank_mask:0xf
  s_nop 1
  v_add_f32_dpp v252, v253, v204 wave_ror:1 row_mask:0xf bank_mask:0xf
  v_mfma_f32_16x16x32_bf16 v[236:239], v[36:39], v[116:119], v[236:239]
  v_cvt_pk_bf16_f32 v252, v252, v252
  ds_write_b16 v19, v252 offset:2752
  v_mfma_f32_16x16x32_bf16 v[244:247], v[40:43], v[116:119], v[244:247]
  ds_read_b64_tr_b16 v[108:109], v17 offset:29696
  ds_read_b64_tr_b16 v[110:111], v18 offset:29696
  s_waitcnt lgkmcnt(15)
  v_mfma_f32_16x16x32_bf16 v[216:219], v[24:27], v[88:91], v[216:219]
  v_cndmask_b32 v251, v211, v207, s[74:75]
  v_cndmask_b32 v250, v210, v206, s[72:73]
  v_mfma_f32_16x16x32_bf16 v[224:227], v[28:31], v[88:91], v[224:227]
  v_cndmask_b32 v249, v209, v205, s[70:71]
  v_add_f32_dpp v250, v251, v250 wave_ror:1 row_mask:0xf bank_mask:0xf
  v_mfma_f32_16x16x32_bf16 v[232:235], v[32:35], v[88:91], v[232:235]
  s_nop 0
  v_add_f32_dpp v249, v250, v249 wave_ror:1 row_mask:0xf bank_mask:0xf
  s_nop 1
  v_add_f32_dpp v248, v249, v208 wave_ror:1 row_mask:0xf bank_mask:0xf
  v_mfma_f32_16x16x32_bf16 v[240:243], v[36:39], v[88:91], v[240:243]
  v_cvt_pk_bf16_f32 v248, v248, v248
  ds_write_b16 v19, v248 offset:2944
  ds_read_b64_tr_b16 v[112:113], v17 offset:30720
  ds_read_b64_tr_b16 v[114:115], v18 offset:30720
  s_waitcnt lgkmcnt(15)
  v_mfma_f32_16x16x32_bf16 v[220:223], v[24:27], v[92:95], v[220:223]
  v_cndmask_b32 v255, v215, v211, s[74:75]
  v_cndmask_b32 v254, v214, v210, s[72:73]
  v_mfma_f32_16x16x32_bf16 v[228:231], v[28:31], v[92:95], v[228:231]
  v_cndmask_b32 v253, v213, v209, s[70:71]
  v_add_f32_dpp v254, v255, v254 wave_ror:1 row_mask:0xf bank_mask:0xf
  v_mfma_f32_16x16x32_bf16 v[236:239], v[32:35], v[92:95], v[236:239]
  s_nop 0
  v_add_f32_dpp v253, v254, v253 wave_ror:1 row_mask:0xf bank_mask:0xf
  s_nop 1
  v_add_f32_dpp v252, v253, v212 wave_ror:1 row_mask:0xf bank_mask:0xf
  v_mfma_f32_16x16x32_bf16 v[244:247], v[36:39], v[92:95], v[244:247]
  v_cvt_pk_bf16_f32 v252, v252, v252
  ds_write_b16 v19, v252 offset:3008
  ds_read_b64_tr_b16 v[116:117], v17 offset:31744
  ds_read_b64_tr_b16 v[118:119], v18 offset:31744
  s_waitcnt lgkmcnt(15)
  v_mfma_f32_16x16x32_bf16 v[224:227], v[24:27], v[96:99], v[224:227]
  v_cndmask_b32 v251, v219, v215, s[74:75]
  v_cndmask_b32 v250, v218, v214, s[72:73]
  v_mfma_f32_16x16x32_bf16 v[232:235], v[28:31], v[96:99], v[232:235]
  v_cndmask_b32 v249, v217, v213, s[70:71]
  v_add_f32_dpp v250, v251, v250 wave_ror:1 row_mask:0xf bank_mask:0xf
  v_mfma_f32_16x16x32_bf16 v[240:243], v[32:35], v[96:99], v[240:243]
  s_nop 0
  v_add_f32_dpp v249, v250, v249 wave_ror:1 row_mask:0xf bank_mask:0xf
  s_nop 1
  v_add_f32_dpp v248, v249, v216 wave_ror:1 row_mask:0xf bank_mask:0xf
  s_waitcnt lgkmcnt(12)
  v_mfma_f32_16x16x32_bf16 v[228:231], v[24:27], v[100:103], v[228:231]
  v_cvt_pk_bf16_f32 v248, v248, v248
  ds_write_b16 v19, v248 offset:3200
  v_mfma_f32_16x16x32_bf16 v[236:239], v[28:31], v[100:103], v[236:239]
  v_cndmask_b32 v255, v223, v219, s[74:75]
  v_cndmask_b32 v254, v222, v218, s[72:73]
  v_mfma_f32_16x16x32_bf16 v[244:247], v[32:35], v[100:103], v[244:247]
  v_cndmask_b32 v253, v221, v217, s[70:71]
  v_add_f32_dpp v254, v255, v254 wave_ror:1 row_mask:0xf bank_mask:0xf
  s_waitcnt lgkmcnt(10)
  v_mfma_f32_16x16x32_bf16 v[232:235], v[24:27], v[104:107], v[232:235]
  v_add_f32_dpp v253, v254, v253 wave_ror:1 row_mask:0xf bank_mask:0xf
  s_nop 1
  v_add_f32_dpp v252, v253, v220 wave_ror:1 row_mask:0xf bank_mask:0xf
  v_mfma_f32_16x16x32_bf16 v[240:243], v[28:31], v[104:107], v[240:243]
  v_cvt_pk_bf16_f32 v252, v252, v252
  ds_write_b16 v19, v252 offset:3264
  s_waitcnt lgkmcnt(8)
  v_mfma_f32_16x16x32_bf16 v[236:239], v[24:27], v[108:111], v[236:239]
  v_cndmask_b32 v251, v227, v223, s[74:75]
  v_cndmask_b32 v250, v226, v222, s[72:73]
  v_mfma_f32_16x16x32_bf16 v[244:247], v[28:31], v[108:111], v[244:247]
  v_cndmask_b32 v249, v225, v221, s[70:71]
  v_add_f32_dpp v250, v251, v250 wave_ror:1 row_mask:0xf bank_mask:0xf
  s_waitcnt lgkmcnt(5)
  v_mfma_f32_16x16x32_bf16 v[240:243], v[24:27], v[112:115], v[240:243]
  v_add_f32_dpp v249, v250, v249 wave_ror:1 row_mask:0xf bank_mask:0xf
  s_nop 1
  v_add_f32_dpp v248, v249, v224 wave_ror:1 row_mask:0xf bank_mask:0xf
  s_waitcnt lgkmcnt(2)
  v_mfma_f32_16x16x32_bf16 v[244:247], v[24:27], v[116:119], v[244:247]
  v_cvt_pk_bf16_f32 v248, v248, v248
  ds_write_b16 v19, v248 offset:3456
  v_cndmask_b32 v255, v231, v227, s[74:75]
  v_cndmask_b32 v254, v230, v226, s[72:73]
  v_cndmask_b32 v253, v229, v225, s[70:71]
  s_nop 0
  v_add_f32_dpp v254, v255, v254 wave_ror:1 row_mask:0xf bank_mask:0xf
  s_nop 1
  v_add_f32_dpp v253, v254, v253 wave_ror:1 row_mask:0xf bank_mask:0xf
  s_nop 1
  v_add_f32_dpp v252, v253, v228 wave_ror:1 row_mask:0xf bank_mask:0xf
  v_cvt_pk_bf16_f32 v252, v252, v252
  ds_write_b16 v19, v252 offset:3520
  v_cndmask_b32 v251, v235, v231, s[74:75]
  v_cndmask_b32 v250, v234, v230, s[72:73]
  v_cndmask_b32 v249, v233, v229, s[70:71]
  s_nop 0
  v_add_f32_dpp v250, v251, v250 wave_ror:1 row_mask:0xf bank_mask:0xf
  s_nop 1
  v_add_f32_dpp v249, v250, v249 wave_ror:1 row_mask:0xf bank_mask:0xf
  s_nop 1
  v_add_f32_dpp v248, v249, v232 wave_ror:1 row_mask:0xf bank_mask:0xf
  v_cvt_pk_bf16_f32 v248, v248, v248
  ds_write_b16 v19, v248 offset:3712
  v_cndmask_b32 v255, v239, v235, s[74:75]
  v_cndmask_b32 v254, v238, v234, s[72:73]
  v_cndmask_b32 v253, v237, v233, s[70:71]
  s_nop 0
  v_add_f32_dpp v254, v255, v254 wave_ror:1 row_mask:0xf bank_mask:0xf
  s_nop 1
  v_add_f32_dpp v253, v254, v253 wave_ror:1 row_mask:0xf bank_mask:0xf
  s_nop 1
  v_add_f32_dpp v252, v253, v236 wave_ror:1 row_mask:0xf bank_mask:0xf
  v_cvt_pk_bf16_f32 v252, v252, v252
  ds_write_b16 v19, v252 offset:3776
  v_cndmask_b32 v251, v243, v239, s[74:75]
  v_cndmask_b32 v250, v242, v238, s[72:73]
  v_cndmask_b32 v249, v241, v237, s[70:71]
  s_nop 0
  v_add_f32_dpp v250, v251, v250 wave_ror:1 row_mask:0xf bank_mask:0xf
  s_nop 1
  v_add_f32_dpp v249, v250, v249 wave_ror:1 row_mask:0xf bank_mask:0xf
  s_nop 1
  v_add_f32_dpp v248, v249, v240 wave_ror:1 row_mask:0xf bank_mask:0xf
  v_cvt_pk_bf16_f32 v248, v248, v248
  ds_write_b16 v19, v248 offset:3968
  v_cndmask_b32 v255, v247, v243, s[74:75]
  v_cndmask_b32 v254, v246, v242, s[72:73]
  v_cndmask_b32 v253, v245, v241, s[70:71]
  s_nop 0
  v_add_f32_dpp v254, v255, v254 wave_ror:1 row_mask:0xf bank_mask:0xf
  s_nop 1
  v_add_f32_dpp v253, v254, v253 wave_ror:1 row_mask:0xf bank_mask:0xf
  s_nop 1
  v_add_f32_dpp v252, v253, v244 wave_ror:1 row_mask:0xf bank_mask:0xf
  v_cvt_pk_bf16_f32 v252, v252, v252
  ds_write_b16 v19, v252 offset:4032
  s_nop 0
F_CONVDONE:
  s_waitcnt lgkmcnt(0)
  s_barrier
  ds_read_b64_tr_b16 v[24:25], v12 offset:2176
  ds_read_b64_tr_b16 v[28:29], v13 offset:18432
  ds_read_b64_tr_b16 v[26:27], v12 offset:2304
  ds_read_b64_tr_b16 v[30:31], v13 offset:18496
  ds_read_b64_tr_b16 v[32:33], v12 offset:3200
  ds_read_b64_tr_b16 v[36:37], v13 offset:26624
  ds_read_b64_tr_b16 v[34:35], v12 offset:3328
  ds_read_b64_tr_b16 v[38:39], v13 offset:26688
  s_waitcnt lgkmcnt(4)
  v_lshlrev_b32 v64, 16, v24
  v_and_b32 v65, 0xffff0000, v24
  v_lshlrev_b32 v72, 16, v28
  v_and_b32 v73, 0xffff0000, v28
  v_lshlrev_b32 v66, 16, v25
  v_and_b32 v67, 0xffff0000, v25
  v_lshlrev_b32 v74, 16, v29
  v_and_b32 v75, 0xffff0000, v29
  v_lshlrev_b32 v68, 16, v26
  v_and_b32 v69, 0xffff0000, v26
  v_lshlrev_b32 v76, 16, v30
  v_and_b32 v77, 0xffff0000, v30
  v_lshlrev_b32 v70, 16, v27
  v_and_b32 v71, 0xffff0000, v27
  v_lshlrev_b32 v78, 16, v31
  v_and_b32 v79, 0xffff0000, v31
  v_add_f32 v64, v64, v72
  v_add_f32 v65, v65, v73
  v_add_f32 v66, v66, v74
  v_add_f32 v67, v67, v75
  v_add_f32 v68, v68, v76
  v_add_f32 v69, v69, v77
  v_add_f32 v70, v70, v78
  v_add_f32 v71, v71, v79
  s_add_u32 s14, s13, 81920
  v_cvt_pk_bf16_f32 v24, v64, v65
  v_cvt_pk_bf16_f32 v25, v66, v67
  v_cvt_pk_bf16_f32 v26, v68, v69
  v_cvt_pk_bf16_f32 v27, v70, v71
  buffer_store_dwordx4 v[24:27], v14, s[56:59], s14 offen sc1
  s_waitcnt lgkmcnt(0)
  v_lshlrev_b32 v80, 16, v32
  v_and_b32 v81, 0xffff0000, v32
  v_lshlrev_b32 v88, 16, v36
  v_and_b32 v89, 0xffff0000, v36
  v_lshlrev_b32 v82, 16, v33
  v_and_b32 v83, 0xffff0000, v33
  v_lshlrev_b32 v90, 16, v37
  v_and_b32 v91, 0xffff0000, v37
  v_lshlrev_b32 v84, 16, v34
  v_and_b32 v85, 0xffff0000, v34
  v_lshlrev_b32 v92, 16, v38
  v_and_b32 v93, 0xffff0000, v38
  v_lshlrev_b32 v86, 16, v35
  v_and_b32 v87, 0xffff0000, v35
  v_lshlrev_b32 v94, 16, v39
  v_and_b32 v95, 0xffff0000, v39
  v_add_f32 v80, v80, v88
  v_add_f32 v81, v81, v89
  v_add_f32 v82, v82, v90
  v_add_f32 v83, v83, v91
  v_add_f32 v84, v84, v92
  v_add_f32 v85, v85, v93
  v_add_f32 v86, v86, v94
  v_add_f32 v87, v87, v95
  s_add_u32 s14, s13, 1392640
  v_cvt_pk_bf16_f32 v32, v80, v81
  v_cvt_pk_bf16_f32 v33, v82, v83
  v_cvt_pk_bf16_f32 v34, v84, v85
  v_cvt_pk_bf16_f32 v35, v86, v87
  buffer_store_dwordx4 v[32:35], v14, s[56:59], s14 offen sc1
  v_min_u32 v189, 39, v1
  v_lshlrev_b32 v189, 7, v189
  s_mul_i32 s37, s3, 5120
  s_add_u32 s37, s37, 24576
  buffer_load_dwordx2 v[190:191], v189, s[92:95], s37 offen sc1
  s_mov_b32 s36, 2
  s_load_dwordx2 s[38:39], s[0:1], 88
  s_load_dwordx2 s[40:41], s[0:1], 104
  s_cmp_eq_u32 s33, 0
  s_cbranch_scc1 C_ALL
  s_add_u32 s35, s32, 24576
  buffer_load_dwordx4 a[104:107], v2, s[28:31], s35 offen offset:2048 sc1
  buffer_load_dwordx4 a[108:111], v2, s[28:31], s35 offen offset:3072 sc1
  s_add_u32 s35, s32, 28672
  buffer_load_dwordx4 a[112:115], v2, s[28:31], s35 offen offset:0 sc1
  buffer_load_dwordx4 a[116:119], v2, s[28:31], s35 offen offset:1024 sc1
  buffer_load_dwordx4 a[120:123], v2, s[28:31], s35 offen offset:2048 sc1
  buffer_load_dwordx4 a[124:127], v2, s[28:31], s35 offen offset:3072 sc1
  v_lshlrev_b32 v2, 4, v1
  s_bfe_u32 s4, s2, 0x20001
  s_lshl_b32 s4, s4, 2
  s_bfe_u32 s5, s2, 0x20003
  s_add_u32 s4, s4, s5
  s_lshr_b32 s18, s2, 5
  s_and_b32 s19, s2, 1
  s_lshl_b32 s5, s18, 1
  s_add_u32 s5, s5, s19
  s_mul_i32 s6, s3, 20480
  s_mul_i32 s20, s4, 163840
  s_add_u32 s7, s20, s6
  s_lshl_b32 s8, s5, 2
  s_add_u32 s8, s8, s3
  s_mul_i32 s9, s8, 61440
  s_and_b32 s21, s18, 3
  s_mul_i32 s21, s21, 20480
  s_add_u32 s21, s21, s20
  s_mul_i32 s10, s3, 5120
  s_add_u32 s21, s21, s10
  s_mul_i32 s22, s18, 245760
  s_mul_i32 s10, s3, 61440
  s_add_u32 s22, s22, s10
  s_waitcnt lgkmcnt(0)
  s_add_u32 s44, s40, 0x500000
  s_addc_u32 s45, s41, 0
  s_mov_b32 s46, 0x280000
  s_mov_b32 s47, 0x20000
  s_add_u32 s48, s40, 0x780000
  s_addc_u32 s49, s41, 0
  s_mov_b32 s50, 0x3c0000
  s_mov_b32 s51, 0x20000
  s_add_u32 s52, s40, 0x1360000
  s_addc_u32 s53, s41, 0
  s_mov_b32 s54, 0x10000
  s_mov_b32 s55, 0x20000
  s_add_u32 s56, s40, 0xd20000
  s_addc_u32 s57, s41, 0
  s_mov_b32 s58, 0x600000
  s_mov_b32 s59, 0x20000
  s_add_u32 s68, s40, 0xb40000
  s_addc_u32 s69, s41, 0
  s_mov_b32 s70, 0x1e0000
  s_mov_b32 s71, 0x20000
  s_add_u32 s72, s40, 0x1324000
  s_addc_u32 s73, s41, 0
  s_mov_b32 s74, 0x8000
  s_mov_b32 s75, 0x20000
  v_and_b32 v6, 15, v1
  v_lshrrev_b32 v7, 4, v1
  v_lshrrev_b32 v3, 1, v7
  v_lshlrev_b32 v3, 5, v3
  v_and_b32 v4, 1, v7
  v_lshl_add_u32 v3, v4, 3, v3
  v_lshlrev_b32 v186, 3, v1
  s_cmp_lt_u32 s18, 3
  s_cselect_b32 s26, 10240, 0
  s_cselect_b32 s27, 4096, 0
  s_add_u32 s15, s27, s6
  v_add_u32 v185, s15, v2
  v_add_u32 v183, s15, v186
  s_add_u32 s13, s26, s6
  v_add_u32 v31, s13, v2
  s_lshl_b32 s17, s8, 10
  v_lshlrev_b32 v5, 3, v6
  s_lshl_b32 s24, s4, 10
  v_add_u32 v3, s15, v3
  v_add_u32 v187, 5120, v3
  v_add_u32 v184, s15, v5
  v_add_u32 v30, s26, v186
  s_add_u32 s13, s3, 0
  s_and_b32 s13, s13, 3
  s_mul_i32 s14, s13, 20480
  v_add_u32 v8, s14, v186
  s_add_u32 s13, s3, 1
  s_and_b32 s13, s13, 3
  s_mul_i32 s14, s13, 20480
  v_add_u32 v9, s14, v186
  s_add_u32 s13, s3, 2
  s_and_b32 s13, s13, 3
  s_mul_i32 s14, s13, 20480
  v_add_u32 v10, s14, v186
  s_add_u32 s13, s3, 3
  s_and_b32 s13, s13, 3
  s_mul_i32 s14, s13, 20480
  v_add_u32 v11, s14, v186
  s_add_u32 s13, s3, 4
  s_and_b32 s13, s13, 3
  s_add_u32 s13, s13, 4
  s_mul_i32 s14, s13, 20480
  v_add_u32 v12, s14, v186
  s_add_u32 s13, s3, 5
  s_and_b32 s13, s13, 3
  s_add_u32 s13, s13, 4
  s_mul_i32 s14, s13, 20480
  v_add_u32 v13, s14, v186
  s_add_u32 s13, s3, 6
  s_and_b32 s13, s13, 3
  s_add_u32 s13, s13, 4
  s_mul_i32 s14, s13, 20480
  v_add_u32 v14, s14, v186
  s_add_u32 s13, s3, 7
  s_and_b32 s13, s13, 3
  s_add_u32 s13, s13, 4
  s_mul_i32 s14, s13, 20480
  v_add_u32 v15, s14, v186
  s_waitcnt vmcnt(6)
  s_barrier
  s_sub_u32 s13, s2, 96
  s_cmp_lg_u32 s3, 0
  s_cbranch_scc1 FLG_H1
  s_add_u32 s92, s42, 0x13c0000
  s_addc_u32 s93, s43, 0
  s_mov_b32 s94, 0x10000
  s_mov_b32 s95, 0x20000
  s_lshl_b32 s35, s13, 7
  v_mov_b32 v248, s90
  v_mov_b32 v249, s91
  v_mov_b32 v250, 45056
  s_mov_b64 exec, 1
  buffer_store_dwordx2 v[248:249], v250, s[92:95], s35 offen sc1
  s_mov_b64 exec, -1
FLG_H1:
  s_add_u32 s35, s32, 32768
  buffer_load_dwordx4 a[128:131], v2, s[28:31], s35 offen offset:0 sc1
  buffer_load_dwordx4 a[132:135], v2, s[28:31], s35 offen offset:1024 sc1
  buffer_load_dwordx4 a[136:139], v2, s[28:31], s35 offen offset:2048 sc1
  buffer_load_dwordx4 a[140:143], v2, s[28:31], s35 offen offset:3072 sc1
  s_branch M_BODY
C_ALL:
  s_waitcnt vmcnt(0)
  s_barrier
  s_cmp_lg_u32 s3, 0
  s_cbranch_scc1 FLG_H2
  s_add_u32 s92, s42, 0x13c0000
  s_addc_u32 s93, s43, 0
  s_mov_b32 s94, 0x10000
  s_mov_b32 s95, 0x20000
  s_lshl_b32 s35, s5, 7
  v_mov_b32 v12, s90
  v_mov_b32 v13, s91
  v_mov_b32 v14, 45056
  s_mov_b64 exec, 1
  buffer_store_dwordx2 v[12:13], v14, s[92:95], s35 offen sc1
  s_mov_b64 exec, -1
FLG_H2:
  s_branch M_LOADALL
F_LN:
  s_memrealtime s[60:61]
  v_mov_b32 v6, 0
  s_waitcnt lgkmcnt(0)
  s_mov_b32 s48, s40
  s_mov_b32 s49, s41
  s_mov_b32 s50, 0x8
  s_mov_b32 s51, 0x20000
  s_cmp_ge_u32 s2, 64
  s_cbranch_scc1 F_SPARE
  s_lshl_b32 s4, s2, 3
  s_lshl_b32 s5, s3, 1
  s_add_u32 s4, s4, s5
  s_mul_i32 s5, s4, 5120
  v_lshlrev_b32 v4, 2, v1
  v_add_u32 v5, 2560, v4
  s_mov_b32 s44, s16
  s_mov_b32 s45, s17
  s_mov_b32 s46, 0x280000
  s_mov_b32 s47, 0x20000
  s_add_u32 s7, s5, 5120
  buffer_load_dword v8, v4, s[44:47], s5 offen offset:0
  buffer_load_dword v9, v4, s[44:47], s5 offen offset:256
  buffer_load_dword v10, v4, s[44:47], s5 offen offset:512
  buffer_load_dword v11, v4, s[44:47], s5 offen offset:768
  buffer_load_dword v12, v4, s[44:47], s5 offen offset:1024
  buffer_load_dword v13, v4, s[44:47], s5 offen offset:1280
  buffer_load_dword v14, v4, s[44:47], s5 offen offset:1536
  buffer_load_dword v15, v4, s[44:47], s5 offen offset:1792
  buffer_load_dword v16, v4, s[44:47], s5 offen offset:2048
  buffer_load_dword v17, v4, s[44:47], s5 offen offset:2304
  buffer_load_dword v18, v5, s[44:47], s5 offen offset:0
  buffer_load_dword v19, v5, s[44:47], s5 offen offset:256
  buffer_load_dword v20, v5, s[44:47], s5 offen offset:512
  buffer_load_dword v21, v5, s[44:47], s5 offen offset:768
  buffer_load_dword v22, v5, s[44:47], s5 offen offset:1024
  buffer_load_dword v23, v5, s[44:47], s5 offen offset:1280
  buffer_load_dword v24, v5, s[44:47], s5 offen offset:1536
  buffer_load_dword v25, v5, s[44:47], s5 offen offset:1792
  buffer_load_dword v26, v5, s[44:47], s5 offen offset:2048
  buffer_load_dword v27, v5, s[44:47], s5 offen offset:2304
  buffer_load_dword v28, v4, s[44:47], s7 offen offset:0
  buffer_load_dword v29, v4, s[44:47], s7 offen offset:256
  buffer_load_dword v30, v4, s[44:47], s7 offen offset:512
  buffer_load_dword v31, v4, s[44:47], s7 offen offset:768
  buffer_load_dword v32, v4, s[44:47], s7 offen offset:1024
  buffer_load_dword v33, v4, s[44:47], s7 offen offset:1280
  buffer_load_dword v34, v4, s[44:47], s7 offen offset:1536
  buffer_load_dword v35, v4, s[44:47], s7 offen offset:1792
  buffer_load_dword v36, v4, s[44:47], s7 offen offset:2048
  buffer_load_dword v37, v4, s[44:47], s7 offen offset:2304
  buffer_load_dword v38, v5, s[44:47], s7 offen offset:0
  buffer_load_dword v39, v5, s[44:47], s7 offen offset:256
  buffer_load_dword v40, v5, s[44:47], s7 offen offset:512
  buffer_load_dword v41, v5, s[44:47], s7 offen offset:768
  buffer_load_dword v42, v5, s[44:47], s7 offen offset:1024
  buffer_load_dword v43, v5, s[44:47], s7 offen offset:1280
  buffer_load_dword v44, v5, s[44:47], s7 offen offset:1536
  buffer_load_dword v45, v5, s[44:47], s7 offen offset:1792
  buffer_load_dword v46, v5, s[44:47], s7 offen offset:2048
  buffer_load_dword v47, v5, s[44:47], s7 offen offset:2304
  s_lshl_b32 s9, s2, 2
  s_add_u32 s9, s9, s3
  s_cmp_lg_u32 s9, 0
  s_cbranch_scc1 F_NOEP
  s_or_b32 s60, s60, 1
  v_mov_b32 v50, s60
  v_mov_b32 v51, s61
  v_mov_b32 v52, 0
  v_mov_b32 v53, 0
  v_lshlrev_b32 v48, 3, v1
  buffer_atomic_cmpswap_x2 v[50:53], v48, s[48:51], 0 offen sc1
  s_nop 1
F_NOEP:
  s_add_u32 s52, s42, 0x1324000
  s_addc_u32 s53, s43, 0
  s_mov_b32 s54, 0x8000
  s_mov_b32 s55, 0x20000
  s_lshl_b32 s9, s9, 7
  s_mov_b64 exec, 0xffffffff
  buffer_store_dword v6, v4, s[52:55], s9 offen sc1
  s_mov_b64 exec, -1
  s_add_u32 s52, s42, 0x1350000
  s_addc_u32 s53, s43, 0
  s_mov_b32 s54, 0x4000
  s_mov_b32 s55, 0x20000
  s_add_u32 s56, s42, 0x1400000
  s_addc_u32 s57, s43, 0
  s_mov_b32 s58, 0x280000
  s_mov_b32 s59, 0x20000
  s_mov_b32 s10, 0x05040100
  s_mov_b32 s11, 0x07060302
  v_lshrrev_b32 v54, 1, v1
  v_mul_u32_u24 v54, 272, v54
  v_and_b32 v55, 1, v1
  v_lshl_add_u32 v54, v55, 4, v54
  s_lshl_b32 s9, s3, 6
  s_add_u32 s9, s9, 65536
  v_add_u32 v54, s9, v54
  v_lshrrev_b32 v57, 4, v0
  v_and_b32 v58, 15, v0
  v_mul_u32_u24 v55, 272, v57
  v_lshl_add_u32 v55, v58, 4, v55
  v_add_u32 v55, 65536, v55
  v_lshlrev_b32 v56, 14, v57
  v_lshl_add_u32 v56, v58, 4, v56
  s_lshl_b32 s68, s2, 8
  s_lshl_b32 s6, s4, 5
  v_mov_b32 v7, 0x3acccccd
  s_waitcnt vmcnt(0)
  buffer_load_dwordx2 v[50:51], v6, s[48:51], 0 offen sc1
  v_perm_b32 v60, v13, v8, s10
  v_perm_b32 v61, v23, v18, s10
  v_perm_b32 v62, v13, v8, s11
  v_perm_b32 v63, v23, v18, s11
  ds_write_b128 v54, v[60:63] offset:0
  v_perm_b32 v64, v14, v9, s10
  v_perm_b32 v65, v24, v19, s10
  v_perm_b32 v66, v14, v9, s11
  v_perm_b32 v67, v24, v19, s11
  ds_write_b128 v54, v[64:67] offset:8704
  v_perm_b32 v68, v15, v10, s10
  v_perm_b32 v69, v25, v20, s10
  v_perm_b32 v70, v15, v10, s11
  v_perm_b32 v71, v25, v20, s11
  ds_write_b128 v54, v[68:71] offset:17408
  v_perm_b32 v72, v16, v11, s10
  v_perm_b32 v73, v26, v21, s10
  v_perm_b32 v74, v16, v11, s11
  v_perm_b32 v75, v26, v21, s11
  ds_write_b128 v54, v[72:75] offset:26112
  v_perm_b32 v76, v17, v12, s10
  v_perm_b32 v77, v27, v22, s10
  v_perm_b32 v78, v17, v12, s11
  v_perm_b32 v79, v27, v22, s11
  ds_write_b128 v54, v[76:79] offset:34816
  v_perm_b32 v80, v33, v28, s10
  v_perm_b32 v81, v43, v38, s10
  v_perm_b32 v82, v33, v28, s11
  v_perm_b32 v83, v43, v38, s11
  ds_write_b128 v54, v[80:83] offset:32
  v_perm_b32 v84, v34, v29, s10
  v_perm_b32 v85, v44, v39, s10
  v_perm_b32 v86, v34, v29, s11
  v_perm_b32 v87, v44, v39, s11
  ds_write_b128 v54, v[84:87] offset:8736
  v_perm_b32 v88, v35, v30, s10
  v_perm_b32 v89, v45, v40, s10
  v_perm_b32 v90, v35, v30, s11
  v_perm_b32 v91, v45, v40, s11
  ds_write_b128 v54, v[88:91] offset:17440
  v_perm_b32 v92, v36, v31, s10
  v_perm_b32 v93, v46, v41, s10
  v_perm_b32 v94, v36, v31, s11
  v_perm_b32 v95, v46, v41, s11
  ds_write_b128 v54, v[92:95] offset:26144
  v_perm_b32 v96, v37, v32, s10
  v_perm_b32 v97, v47, v42, s10
  v_perm_b32 v98, v37, v32, s11
  v_perm_b32 v99, v47, v42, s11
  ds_write_b128 v54, v[96:99] offset:34848
  s_waitcnt lgkmcnt(0)
  s_barrier
  ds_read_b128 v[60:63], v55 offset:0
  ds_read_b128 v[64:67], v55 offset:4352
  ds_read_b128 v[68:71], v55 offset:8704
  ds_read_b128 v[72:75], v55 offset:13056
  ds_read_b128 v[76:79], v55 offset:17408
  ds_read_b128 v[80:83], v55 offset:21760
  ds_read_b128 v[84:87], v55 offset:26112
  ds_read_b128 v[88:91], v55 offset:30464
  ds_read_b128 v[92:95], v55 offset:34816
  ds_read_b128 v[96:99], v55 offset:39168
  s_add_u32 s69, s68, 0
  s_waitcnt lgkmcnt(9)
  buffer_store_dwordx4 v[60:63], v56, s[56:59], s69 offen sc1
  s_add_u32 s69, s68, 262144
  s_waitcnt lgkmcnt(8)
  buffer_store_dwordx4 v[64:67], v56, s[56:59], s69 offen sc1
  s_add_u32 s69, s68, 524288
  s_waitcnt lgkmcnt(7)
  buffer_store_dwordx4 v[68:71], v56, s[56:59], s69 offen sc1
  s_add_u32 s69, s68, 786432
  s_waitcnt lgkmcnt(6)
  buffer_store_dwordx4 v[72:75], v56, s[56:59], s69 offen sc1
  s_add_u32 s69, s68, 1048576
  s_waitcnt lgkmcnt(5)
  buffer_store_dwordx4 v[76:79], v56, s[56:59], s69 offen sc1
  s_add_u32 s69, s68, 1310720
  s_waitcnt lgkmcnt(4)
  buffer_store_dwordx4 v[80:83], v56, s[56:59], s69 offen sc1
  s_add_u32 s69, s68, 1572864
  s_waitcnt lgkmcnt(3)
  buffer_store_dwordx4 v[84:87], v56, s[56:59], s69 offen sc1
  s_add_u32 s69, s68, 1835008
  s_waitcnt lgkmcnt(2)
  buffer_store_dwordx4 v[88:91], v56, s[56:59], s69 offen sc1
  s_add_u32 s69, s68, 2097152
  s_waitcnt lgkmcnt(1)
  buffer_store_dwordx4 v[92:95], v56, s[56:59], s69 offen sc1
  s_add_u32 s69, s68, 2359296
  s_waitcnt lgkmcnt(0)
  buffer_store_dwordx4 v[96:99], v56, s[56:59], s69 offen sc1
  v_lshlrev_b32 v104, 16, v8
  v_and_b32 v105, 0xffff0000, v8
  v_lshlrev_b32 v106, 16, v9
  v_and_b32 v107, 0xffff0000, v9
  v_lshlrev_b32 v108, 16, v10
  v_and_b32 v109, 0xffff0000, v10
  v_lshlrev_b32 v110, 16, v11
  v_and_b32 v111, 0xffff0000, v11
  v_lshlrev_b32 v112, 16, v12
  v_and_b32 v113, 0xffff0000, v12
  v_lshlrev_b32 v114, 16, v13
  v_and_b32 v115, 0xffff0000, v13
  v_lshlrev_b32 v116, 16, v14
  v_and_b32 v117, 0xffff0000, v14
  v_lshlrev_b32 v118, 16, v15
  v_and_b32 v119, 0xffff0000, v15
  v_lshlrev_b32 v120, 16, v16
  v_and_b32 v121, 0xffff0000, v16
  v_lshlrev_b32 v122, 16, v17
  v_and_b32 v123, 0xffff0000, v17
  v_lshlrev_b32 v124, 16, v18
  v_and_b32 v125, 0xffff0000, v18
  v_lshlrev_b32 v126, 16, v19
  v_and_b32 v127, 0xffff0000, v19
  v_lshlrev_b32 v128, 16, v20
  v_and_b32 v129, 0xffff0000, v20
  v_lshlrev_b32 v130, 16, v21
  v_and_b32 v131, 0xffff0000, v21
  v_lshlrev_b32 v132, 16, v22
  v_and_b32 v133, 0xffff0000, v22
  v_lshlrev_b32 v134, 16, v23
  v_and_b32 v135, 0xffff0000, v23
  v_lshlrev_b32 v136, 16, v24
  v_and_b32 v137, 0xffff0000, v24
  v_lshlrev_b32 v138, 16, v25
  v_and_b32 v139, 0xffff0000, v25
  v_lshlrev_b32 v140, 16, v26
  v_and_b32 v141, 0xffff0000, v26
  v_lshlrev_b32 v142, 16, v27
  v_and_b32 v143, 0xffff0000, v27
  v_lshlrev_b32 v144, 16, v28
  v_and_b32 v145, 0xffff0000, v28
  v_lshlrev_b32 v146, 16, v29
  v_and_b32 v147, 0xffff0000, v29
  v_lshlrev_b32 v148, 16, v30
  v_and_b32 v149, 0xffff0000, v30
  v_lshlrev_b32 v150, 16, v31
  v_and_b32 v151, 0xffff0000, v31
  v_lshlrev_b32 v152, 16, v32
  v_and_b32 v153, 0xffff0000, v32
  v_lshlrev_b32 v154, 16, v33
  v_and_b32 v155, 0xffff0000, v33
  v_lshlrev_b32 v156, 16, v34
  v_and_b32 v157, 0xffff0000, v34
  v_lshlrev_b32 v158, 16, v35
  v_and_b32 v159, 0xffff0000, v35
  v_lshlrev_b32 v160, 16, v36
  v_and_b32 v161, 0xffff0000, v36
  v_lshlrev_b32 v162, 16, v37
  v_and_b32 v163, 0xffff0000, v37
  v_lshlrev_b32 v164, 16, v38
  v_and_b32 v165, 0xffff0000, v38
  v_lshlrev_b32 v166, 16, v39
  v_and_b32 v167, 0xffff0000, v39
  v_lshlrev_b32 v168, 16, v40
  v_and_b32 v169, 0xffff0000, v40
  v_lshlrev_b32 v170, 16, v41
  v_and_b32 v171, 0xffff0000, v41
  v_lshlrev_b32 v172, 16, v42
  v_and_b32 v173, 0xffff0000, v42
  v_lshlrev_b32 v174, 16, v43
  v_and_b32 v175, 0xffff0000, v43
  v_lshlrev_b32 v176, 16, v44
  v_and_b32 v177, 0xffff0000, v44
  v_lshlrev_b32 v178, 16, v45
  v_and_b32 v179, 0xffff0000, v45
  v_lshlrev_b32 v180, 16, v46
  v_and_b32 v181, 0xffff0000, v46
  v_lshlrev_b32 v182, 16, v47
  v_and_b32 v183, 0xffff0000, v47
  v_pk_add_f32 v[184:185], v[104:105], v[106:107]
  v_pk_add_f32 v[186:187], v[114:115], v[116:117]
  v_pk_add_f32 v[188:189], v[124:125], v[126:127]
  v_pk_add_f32 v[190:191], v[134:135], v[136:137]
  v_pk_add_f32 v[192:193], v[144:145], v[146:147]
  v_pk_add_f32 v[194:195], v[154:155], v[156:157]
  v_pk_add_f32 v[196:197], v[164:165], v[166:167]
  v_pk_add_f32 v[198:199], v[174:175], v[176:177]
  v_pk_add_f32 v[184:185], v[184:185], v[108:109]
  v_pk_add_f32 v[186:187], v[186:187], v[118:119]
  v_pk_add_f32 v[188:189], v[188:189], v[128:129]
  v_pk_add_f32 v[190:191], v[190:191], v[138:139]
  v_pk_add_f32 v[192:193], v[192:193], v[148:149]
  v_pk_add_f32 v[194:195], v[194:195], v[158:159]
  v_pk_add_f32 v[196:197], v[196:197], v[168:169]
  v_pk_add_f32 v[198:199], v[198:199], v[178:179]
  v_pk_add_f32 v[184:185], v[184:185], v[110:111]
  v_pk_add_f32 v[186:187], v[186:187], v[120:121]
  v_pk_add_f32 v[188:189], v[188:189], v[130:131]
  v_pk_add_f32 v[190:191], v[190:191], v[140:141]
  v_pk_add_f32 v[192:193], v[192:193], v[150:151]
  v_pk_add_f32 v[194:195], v[194:195], v[160:161]
  v_pk_add_f32 v[196:197], v[196:197], v[170:171]
  v_pk_add_f32 v[198:199], v[198:199], v[180:181]
  v_pk_add_f32 v[184:185], v[184:185], v[112:113]
  v_pk_add_f32 v[186:187], v[186:187], v[122:123]
  v_pk_add_f32 v[188:189], v[188:189], v[132:133]
  v_pk_add_f32 v[190:191], v[190:191], v[142:143]
  v_pk_add_f32 v[192:193], v[192:193], v[152:153]
  v_pk_add_f32 v[194:195], v[194:195], v[162:163]
  v_pk_add_f32 v[196:197], v[196:197], v[172:173]
  v_pk_add_f32 v[198:199], v[198:199], v[182:183]
  v_add_f32 v184, v184, v185
  v_add_f32 v186, v186, v187
  v_add_f32 v188, v188, v189
  v_add_f32 v190, v190, v191
  v_add_f32 v192, v192, v193
  v_add_f32 v194, v194, v195
  v_add_f32 v196, v196, v197
  v_add_f32 v198, v198, v199
  v_add_f32_dpp v184, v184, v184 row_shr:1 row_mask:0xf bank_mask:0xf bound_ctrl:0
  v_add_f32_dpp v186, v186, v186 row_shr:1 row_mask:0xf bank_mask:0xf bound_ctrl:0
  v_add_f32_dpp v188, v188, v188 row_shr:1 row_mask:0xf bank_mask:0xf bound_ctrl:0
  v_add_f32_dpp v190, v190, v190 row_shr:1 row_mask:0xf bank_mask:0xf bound_ctrl:0
  v_add_f32_dpp v192, v192, v192 row_shr:1 row_mask:0xf bank_mask:0xf bound_ctrl:0
  v_add_f32_dpp v194, v194, v194 row_shr:1 row_mask:0xf bank_mask:0xf bound_ctrl:0
  v_add_f32_dpp v196, v196, v196 row_shr:1 row_mask:0xf bank_mask:0xf bound_ctrl:0
  v_add_f32_dpp v198, v198, v198 row_shr:1 row_mask:0xf bank_mask:0xf bound_ctrl:0
  v_add_f32_dpp v184, v184, v184 row_shr:2 row_mask:0xf bank_mask:0xf bound_ctrl:0
  v_add_f32_dpp v186, v186, v186 row_shr:2 row_mask:0xf bank_mask:0xf bound_ctrl:0
  v_add_f32_dpp v188, v188, v188 row_shr:2 row_mask:0xf bank_mask:0xf bound_ctrl:0
  v_add_f32_dpp v190, v190, v190 row_shr:2 row_mask:0xf bank_mask:0xf bound_ctrl:0
  v_add_f32_dpp v192, v192, v192 row_shr:2 row_mask:0xf bank_mask:0xf bound_ctrl:0
  v_add_f32_dpp v194, v194, v194 row_shr:2 row_mask:0xf bank_mask:0xf bound_ctrl:0
  v_add_f32_dpp v196, v196, v196 row_shr:2 row_mask:0xf bank_mask:0xf bound_ctrl:0
  v_add_f32_dpp v198, v198, v198 row_shr:2 row_mask:0xf bank_mask:0xf bound_ctrl:0
  v_add_f32_dpp v184, v184, v184 row_shr:4 row_mask:0xf bank_mask:0xf bound_ctrl:0
  v_add_f32_dpp v186, v186, v186 row_shr:4 row_mask:0xf bank_mask:0xf bound_ctrl:0
  v_add_f32_dpp v188, v188, v188 row_shr:4 row_mask:0xf bank_mask:0xf bound_ctrl:0
  v_add_f32_dpp v190, v190, v190 row_shr:4 row_mask:0xf bank_mask:0xf bound_ctrl:0
  v_add_f32_dpp v192, v192, v192 row_shr:4 row_mask:0xf bank_mask:0xf bound_ctrl:0
  v_add_f32_dpp v194, v194, v194 row_shr:4 row_mask:0xf bank_mask:0xf bound_ctrl:0
  v_add_f32_dpp v196, v196, v196 row_shr:4 row_mask:0xf bank_mask:0xf bound_ctrl:0
  v_add_f32_dpp v198, v198, v198 row_shr:4 row_mask:0xf bank_mask:0xf bound_ctrl:0
  v_add_f32_dpp v184, v184, v184 row_shr:8 row_mask:0xf bank_mask:0xf bound_ctrl:0
  v_add_f32_dpp v186, v186, v186 row_shr:8 row_mask:0xf bank_mask:0xf bound_ctrl:0
  v_add_f32_dpp v188, v188, v188 row_shr:8 row_mask:0xf bank_mask:0xf bound_ctrl:0
  v_add_f32_dpp v190, v190, v190 row_shr:8 row_mask:0xf bank_mask:0xf bound_ctrl:0
  v_add_f32_dpp v192, v192, v192 row_shr:8 row_mask:0xf bank_mask:0xf bound_ctrl:0
  v_add_f32_dpp v194, v194, v194 row_shr:8 row_mask:0xf bank_mask:0xf bound_ctrl:0
  v_add_f32_dpp v196, v196, v196 row_shr:8 row_mask:0xf bank_mask:0xf bound_ctrl:0
  v_add_f32_dpp v198, v198, v198 row_shr:8 row_mask:0xf bank_mask:0xf bound_ctrl:0
  v_add_f32_dpp v184, v184, v184 row_bcast:15 row_mask:0xa bank_mask:0xf
  v_add_f32_dpp v186, v186, v186 row_bcast:15 row_mask:0xa bank_mask:0xf
  v_add_f32_dpp v188, v188, v188 row_bcast:15 row_mask:0xa bank_mask:0xf
  v_add_f32_dpp v190, v190, v190 row_bcast:15 row_mask:0xa bank_mask:0xf
  v_add_f32_dpp v192, v192, v192 row_bcast:15 row_mask:0xa bank_mask:0xf
  v_add_f32_dpp v194, v194, v194 row_bcast:15 row_mask:0xa bank_mask:0xf
  v_add_f32_dpp v196, v196, v196 row_bcast:15 row_mask:0xa bank_mask:0xf
  v_add_f32_dpp v198, v198, v198 row_bcast:15 row_mask:0xa bank_mask:0xf
  v_add_f32_dpp v184, v184, v184 row_bcast:31 row_mask:0xc bank_mask:0xf
  v_add_f32_dpp v186, v186, v186 row_bcast:31 row_mask:0xc bank_mask:0xf
  v_add_f32_dpp v188, v188, v188 row_bcast:31 row_mask:0xc bank_mask:0xf
  v_add_f32_dpp v190, v190, v190 row_bcast:31 row_mask:0xc bank_mask:0xf
  v_add_f32_dpp v192, v192, v192 row_bcast:31 row_mask:0xc bank_mask:0xf
  v_add_f32_dpp v194, v194, v194 row_bcast:31 row_mask:0xc bank_mask:0xf
  v_add_f32_dpp v196, v196, v196 row_bcast:31 row_mask:0xc bank_mask:0xf
  v_add_f32_dpp v198, v198, v198 row_bcast:31 row_mask:0xc bank_mask:0xf
  v_readlane_b32 s60, v184, 63
  v_readlane_b32 s61, v186, 63
  v_readlane_b32 s62, v188, 63
  v_readlane_b32 s63, v190, 63
  v_readlane_b32 s64, v192, 63
  v_readlane_b32 s65, v194, 63
  v_readlane_b32 s66, v196, 63
  v_readlane_b32 s67, v198, 63
  v_mul_f32 v200, s60, v7
  v_mul_f32 v202, s61, v7
  v_mul_f32 v204, s62, v7
  v_mul_f32 v206, s63, v7
  v_mul_f32 v208, s64, v7
  v_mul_f32 v210, s65, v7
  v_mul_f32 v212, s66, v7
  v_mul_f32 v214, s67, v7
  v_pk_add_f32 v[104:105], v[104:105], v[200:201] op_sel_hi:[1,0] neg_lo:[0,1] neg_hi:[0,1]
  v_pk_add_f32 v[114:115], v[114:115], v[202:203] op_sel_hi:[1,0] neg_lo:[0,1] neg_hi:[0,1]
  v_pk_add_f32 v[124:125], v[124:125], v[204:205] op_sel_hi:[1,0] neg_lo:[0,1] neg_hi:[0,1]
  v_pk_add_f32 v[134:135], v[134:135], v[206:207] op_sel_hi:[1,0] neg_lo:[0,1] neg_hi:[0,1]
  v_pk_add_f32 v[144:145], v[144:145], v[208:209] op_sel_hi:[1,0] neg_lo:[0,1] neg_hi:[0,1]
  v_pk_add_f32 v[154:155], v[154:155], v[210:211] op_sel_hi:[1,0] neg_lo:[0,1] neg_hi:[0,1]
  v_pk_add_f32 v[164:165], v[164:165], v[212:213] op_sel_hi:[1,0] neg_lo:[0,1] neg_hi:[0,1]
  v_pk_add_f32 v[174:175], v[174:175], v[214:215] op_sel_hi:[1,0] neg_lo:[0,1] neg_hi:[0,1]
  v_pk_add_f32 v[106:107], v[106:107], v[200:201] op_sel_hi:[1,0] neg_lo:[0,1] neg_hi:[0,1]
  v_pk_add_f32 v[116:117], v[116:117], v[202:203] op_sel_hi:[1,0] neg_lo:[0,1] neg_hi:[0,1]
  v_pk_add_f32 v[126:127], v[126:127], v[204:205] op_sel_hi:[1,0] neg_lo:[0,1] neg_hi:[0,1]
  v_pk_add_f32 v[136:137], v[136:137], v[206:207] op_sel_hi:[1,0] neg_lo:[0,1] neg_hi:[0,1]
  v_pk_add_f32 v[146:147], v[146:147], v[208:209] op_sel_hi:[1,0] neg_lo:[0,1] neg_hi:[0,1]
  v_pk_add_f32 v[156:157], v[156:157], v[210:211] op_sel_hi:[1,0] neg_lo:[0,1] neg_hi:[0,1]
  v_pk_add_f32 v[166:167], v[166:167], v[212:213] op_sel_hi:[1,0] neg_lo:[0,1] neg_hi:[0,1]
  v_pk_add_f32 v[176:177], v[176:177], v[214:215] op_sel_hi:[1,0] neg_lo:[0,1] neg_hi:[0,1]
  v_pk_add_f32 v[108:109], v[108:109], v[200:201] op_sel_hi:[1,0] neg_lo:[0,1] neg_hi:[0,1]
  v_pk_add_f32 v[118:119], v[118:119], v[202:203] op_sel_hi:[1,0] neg_lo:[0,1] neg_hi:[0,1]
  v_pk_add_f32 v[128:129], v[128:129], v[204:205] op_sel_hi:[1,0] neg_lo:[0,1] neg_hi:[0,1]
  v_pk_add_f32 v[138:139], v[138:139], v[206:207] op_sel_hi:[1,0] neg_lo:[0,1] neg_hi:[0,1]
  v_pk_add_f32 v[148:149], v[148:149], v[208:209] op_sel_hi:[1,0] neg_lo:[0,1] neg_hi:[0,1]
  v_pk_add_f32 v[158:159], v[158:159], v[210:211] op_sel_hi:[1,0] neg_lo:[0,1] neg_hi:[0,1]
  v_pk_add_f32 v[168:169], v[168:169], v[212:213] op_sel_hi:[1,0] neg_lo:[0,1] neg_hi:[0,1]
  v_pk_add_f32 v[178:179], v[178:179], v[214:215] op_sel_hi:[1,0] neg_lo:[0,1] neg_hi:[0,1]
  v_pk_add_f32 v[110:111], v[110:111], v[200:201] op_sel_hi:[1,0] neg_lo:[0,1] neg_hi:[0,1]
  v_pk_add_f32 v[120:121], v[120:121], v[202:203] op_sel_hi:[1,0] neg_lo:[0,1] neg_hi:[0,1]
  v_pk_add_f32 v[130:131], v[130:131], v[204:205] op_sel_hi:[1,0] neg_lo:[0,1] neg_hi:[0,1]
  v_pk_add_f32 v[140:141], v[140:141], v[206:207] op_sel_hi:[1,0] neg_lo:[0,1] neg_hi:[0,1]
  v_pk_add_f32 v[150:151], v[150:151], v[208:209] op_sel_hi:[1,0] neg_lo:[0,1] neg_hi:[0,1]
  v_pk_add_f32 v[160:161], v[160:161], v[210:211] op_sel_hi:[1,0] neg_lo:[0,1] neg_hi:[0,1]
  v_pk_add_f32 v[170:171], v[170:171], v[212:213] op_sel_hi:[1,0] neg_lo:[0,1] neg_hi:[0,1]
  v_pk_add_f32 v[180:181], v[180:181], v[214:215] op_sel_hi:[1,0] neg_lo:[0,1] neg_hi:[0,1]
  v_pk_add_f32 v[112:113], v[112:113], v[200:201] op_sel_hi:[1,0] neg_lo:[0,1] neg_hi:[0,1]
  v_pk_add_f32 v[122:123], v[122:123], v[202:203] op_sel_hi:[1,0] neg_lo:[0,1] neg_hi:[0,1]
  v_pk_add_f32 v[132:133], v[132:133], v[204:205] op_sel_hi:[1,0] neg_lo:[0,1] neg_hi:[0,1]
  v_pk_add_f32 v[142:143], v[142:143], v[206:207] op_sel_hi:[1,0] neg_lo:[0,1] neg_hi:[0,1]
  v_pk_add_f32 v[152:153], v[152:153], v[208:209] op_sel_hi:[1,0] neg_lo:[0,1] neg_hi:[0,1]
  v_pk_add_f32 v[162:163], v[162:163], v[210:211] op_sel_hi:[1,0] neg_lo:[0,1] neg_hi:[0,1]
  v_pk_add_f32 v[172:173], v[172:173], v[212:213] op_sel_hi:[1,0] neg_lo:[0,1] neg_hi:[0,1]
  v_pk_add_f32 v[182:183], v[182:183], v[214:215] op_sel_hi:[1,0] neg_lo:[0,1] neg_hi:[0,1]
  v_pk_mul_f32 v[184:185], v[104:105], v[104:105]
  v_pk_mul_f32 v[186:187], v[114:115], v[114:115]
  v_pk_mul_f32 v[188:189], v[124:125], v[124:125]
  v_pk_mul_f32 v[190:191], v[134:135], v[134:135]
  v_pk_mul_f32 v[192:193], v[144:145], v[144:145]
  v_pk_mul_f32 v[194:195], v[154:155], v[154:155]
  v_pk_mul_f32 v[196:197], v[164:165], v[164:165]
  v_pk_mul_f32 v[198:199], v[174:175], v[174:175]
  v_pk_fma_f32 v[184:185], v[106:107], v[106:107], v[184:185]
  v_pk_fma_f32 v[186:187], v[116:117], v[116:117], v[186:187]
  v_pk_fma_f32 v[188:189], v[126:127], v[126:127], v[188:189]
  v_pk_fma_f32 v[190:191], v[136:137], v[136:137], v[190:191]
  v_pk_fma_f32 v[192:193], v[146:147], v[146:147], v[192:193]
  v_pk_fma_f32 v[194:195], v[156:157], v[156:157], v[194:195]
  v_pk_fma_f32 v[196:197], v[166:167], v[166:167], v[196:197]
  v_pk_fma_f32 v[198:199], v[176:177], v[176:177], v[198:199]
  v_pk_fma_f32 v[184:185], v[108:109], v[108:109], v[184:185]
  v_pk_fma_f32 v[186:187], v[118:119], v[118:119], v[186:187]
  v_pk_fma_f32 v[188:189], v[128:129], v[128:129], v[188:189]
  v_pk_fma_f32 v[190:191], v[138:139], v[138:139], v[190:191]
  v_pk_fma_f32 v[192:193], v[148:149], v[148:149], v[192:193]
  v_pk_fma_f32 v[194:195], v[158:159], v[158:159], v[194:195]
  v_pk_fma_f32 v[196:197], v[168:169], v[168:169], v[196:197]
  v_pk_fma_f32 v[198:199], v[178:179], v[178:179], v[198:199]
  v_pk_fma_f32 v[184:185], v[110:111], v[110:111], v[184:185]
  v_pk_fma_f32 v[186:187], v[120:121], v[120:121], v[186:187]
  v_pk_fma_f32 v[188:189], v[130:131], v[130:131], v[188:189]
  v_pk_fma_f32 v[190:191], v[140:141], v[140:141], v[190:191]
  v_pk_fma_f32 v[192:193], v[150:151], v[150:151], v[192:193]
  v_pk_fma_f32 v[194:195], v[160:161], v[160:161], v[194:195]
  v_pk_fma_f32 v[196:197], v[170:171], v[170:171], v[196:197]
  v_pk_fma_f32 v[198:199], v[180:181], v[180:181], v[198:199]
  v_pk_fma_f32 v[184:185], v[112:113], v[112:113], v[184:185]
  v_pk_fma_f32 v[186:187], v[122:123], v[122:123], v[186:187]
  v_pk_fma_f32 v[188:189], v[132:133], v[132:133], v[188:189]
  v_pk_fma_f32 v[190:191], v[142:143], v[142:143], v[190:191]
  v_pk_fma_f32 v[192:193], v[152:153], v[152:153], v[192:193]
  v_pk_fma_f32 v[194:195], v[162:163], v[162:163], v[194:195]
  v_pk_fma_f32 v[196:197], v[172:173], v[172:173], v[196:197]
  v_pk_fma_f32 v[198:199], v[182:183], v[182:183], v[198:199]
  v_add_f32 v184, v184, v185
  v_add_f32 v186, v186, v187
  v_add_f32 v188, v188, v189
  v_add_f32 v190, v190, v191
  v_add_f32 v192, v192, v193
  v_add_f32 v194, v194, v195
  v_add_f32 v196, v196, v197
  v_add_f32 v198, v198, v199
  v_add_f32_dpp v184, v184, v184 row_shr:1 row_mask:0xf bank_mask:0xf bound_ctrl:0
  v_add_f32_dpp v186, v186, v186 row_shr:1 row_mask:0xf bank_mask:0xf bound_ctrl:0
  v_add_f32_dpp v188, v188, v188 row_shr:1 row_mask:0xf bank_mask:0xf bound_ctrl:0
  v_add_f32_dpp v190, v190, v190 row_shr:1 row_mask:0xf bank_mask:0xf bound_ctrl:0
  v_add_f32_dpp v192, v192, v192 row_shr:1 row_mask:0xf bank_mask:0xf bound_ctrl:0
  v_add_f32_dpp v194, v194, v194 row_shr:1 row_mask:0xf bank_mask:0xf bound_ctrl:0
  v_add_f32_dpp v196, v196, v196 row_shr:1 row_mask:0xf bank_mask:0xf bound_ctrl:0
  v_add_f32_dpp v198, v198, v198 row_shr:1 row_mask:0xf bank_mask:0xf bound_ctrl:0
  v_add_f32_dpp v184, v184, v184 row_shr:2 row_mask:0xf bank_mask:0xf bound_ctrl:0
  v_add_f32_dpp v186, v186, v186 row_shr:2 row_mask:0xf bank_mask:0xf bound_ctrl:0
  v_add_f32_dpp v188, v188, v188 row_shr:2 row_mask:0xf bank_mask:0xf bound_ctrl:0
  v_add_f32_dpp v190, v190, v190 row_shr:2 row_mask:0xf bank_mask:0xf bound_ctrl:0
  v_add_f32_dpp v192, v192, v192 row_shr:2 row_mask:0xf bank_mask:0xf bound_ctrl:0
  v_add_f32_dpp v194, v194, v194 row_shr:2 row_mask:0xf bank_mask:0xf bound_ctrl:0
  v_add_f32_dpp v196, v196, v196 row_shr:2 row_mask:0xf bank_mask:0xf bound_ctrl:0
  v_add_f32_dpp v198, v198, v198 row_shr:2 row_mask:0xf bank_mask:0xf bound_ctrl:0
  v_add_f32_dpp v184, v184, v184 row_shr:4 row_mask:0xf bank_mask:0xf bound_ctrl:0
  v_add_f32_dpp v186, v186, v186 row_shr:4 row_mask:0xf bank_mask:0xf bound_ctrl:0
  v_add_f32_dpp v188, v188, v188 row_shr:4 row_mask:0xf bank_mask:0xf bound_ctrl:0
  v_add_f32_dpp v190, v190, v190 row_shr:4 row_mask:0xf bank_mask:0xf bound_ctrl:0
  v_add_f32_dpp v192, v192, v192 row_shr:4 row_mask:0xf bank_mask:0xf bound_ctrl:0
  v_add_f32_dpp v194, v194, v194 row_shr:4 row_mask:0xf bank_mask:0xf bound_ctrl:0
  v_add_f32_dpp v196, v196, v196 row_shr:4 row_mask:0xf bank_mask:0xf bound_ctrl:0
  v_add_f32_dpp v198, v198, v198 row_shr:4 row_mask:0xf bank_mask:0xf bound_ctrl:0
  v_add_f32_dpp v184, v184, v184 row_shr:8 row_mask:0xf bank_mask:0xf bound_ctrl:0
  v_add_f32_dpp v186, v186, v186 row_shr:8 row_mask:0xf bank_mask:0xf bound_ctrl:0
  v_add_f32_dpp v188, v188, v188 row_shr:8 row_mask:0xf bank_mask:0xf bound_ctrl:0
  v_add_f32_dpp v190, v190, v190 row_shr:8 row_mask:0xf bank_mask:0xf bound_ctrl:0
  v_add_f32_dpp v192, v192, v192 row_shr:8 row_mask:0xf bank_mask:0xf bound_ctrl:0
  v_add_f32_dpp v194, v194, v194 row_shr:8 row_mask:0xf bank_mask:0xf bound_ctrl:0
  v_add_f32_dpp v196, v196, v196 row_shr:8 row_mask:0xf bank_mask:0xf bound_ctrl:0
  v_add_f32_dpp v198, v198, v198 row_shr:8 row_mask:0xf bank_mask:0xf bound_ctrl:0
  v_add_f32_dpp v184, v184, v184 row_bcast:15 row_mask:0xa bank_mask:0xf
  v_add_f32_dpp v186, v186, v186 row_bcast:15 row_mask:0xa bank_mask:0xf
  v_add_f32_dpp v188, v188, v188 row_bcast:15 row_mask:0xa bank_mask:0xf
  v_add_f32_dpp v190, v190, v190 row_bcast:15 row_mask:0xa bank_mask:0xf
  v_add_f32_dpp v192, v192, v192 row_bcast:15 row_mask:0xa bank_mask:0xf
  v_add_f32_dpp v194, v194, v194 row_bcast:15 row_mask:0xa bank_mask:0xf
  v_add_f32_dpp v196, v196, v196 row_bcast:15 row_mask:0xa bank_mask:0xf
  v_add_f32_dpp v198, v198, v198 row_bcast:15 row_mask:0xa bank_mask:0xf
  v_add_f32_dpp v184, v184, v184 row_bcast:31 row_mask:0xc bank_mask:0xf
  v_add_f32_dpp v186, v186, v186 row_bcast:31 row_mask:0xc bank_mask:0xf
  v_add_f32_dpp v188, v188, v188 row_bcast:31 row_mask:0xc bank_mask:0xf
  v_add_f32_dpp v190, v190, v190 row_bcast:31 row_mask:0xc bank_mask:0xf
  v_add_f32_dpp v192, v192, v192 row_bcast:31 row_mask:0xc bank_mask:0xf
  v_add_f32_dpp v194, v194, v194 row_bcast:31 row_mask:0xc bank_mask:0xf
  v_add_f32_dpp v196, v196, v196 row_bcast:31 row_mask:0xc bank_mask:0xf
  v_add_f32_dpp v198, v198, v198 row_bcast:31 row_mask:0xc bank_mask:0xf
  v_readlane_b32 s60, v184, 63
  v_readlane_b32 s61, v186, 63
  v_readlane_b32 s62, v188, 63
  v_readlane_b32 s63, v190, 63
  v_readlane_b32 s64, v192, 63
  v_readlane_b32 s65, v194, 63
  v_readlane_b32 s66, v196, 63
  v_readlane_b32 s67, v198, 63
  v_mul_f32 v16, s60, v7
  v_mul_f32 v17, s61, v7
  v_mul_f32 v18, s62, v7
  v_mul_f32 v19, s63, v7
  v_mul_f32 v20, s64, v7
  v_mul_f32 v21, s65, v7
  v_mul_f32 v22, s66, v7
  v_mul_f32 v23, s67, v7
  v_cvt_pk_bf16_f32 v16, v16, v16
  v_cvt_pk_bf16_f32 v17, v17, v17
  v_cvt_pk_bf16_f32 v18, v18, v18
  v_cvt_pk_bf16_f32 v19, v19, v19
  v_cvt_pk_bf16_f32 v20, v20, v20
  v_cvt_pk_bf16_f32 v21, v21, v21
  v_cvt_pk_bf16_f32 v22, v22, v22
  v_cvt_pk_bf16_f32 v23, v23, v23
  v_lshlrev_b32 v16, 16, v16
  v_lshlrev_b32 v17, 16, v17
  v_lshlrev_b32 v18, 16, v18
  v_lshlrev_b32 v19, 16, v19
  v_lshlrev_b32 v20, 16, v20
  v_lshlrev_b32 v21, 16, v21
  v_lshlrev_b32 v22, 16, v22
  v_lshlrev_b32 v23, 16, v23
  v_add_f32 v16, 0x3727c5ac, v16
  v_add_f32 v17, 0x3727c5ac, v17
  v_add_f32 v18, 0x3727c5ac, v18
  v_add_f32 v19, 0x3727c5ac, v19
  v_add_f32 v20, 0x3727c5ac, v20
  v_add_f32 v21, 0x3727c5ac, v21
  v_add_f32 v22, 0x3727c5ac, v22
  v_add_f32 v23, 0x3727c5ac, v23
  v_cvt_pk_bf16_f32 v16, v16, v16
  v_cvt_pk_bf16_f32 v17, v17, v17
  v_cvt_pk_bf16_f32 v18, v18, v18
  v_cvt_pk_bf16_f32 v19, v19, v19
  v_cvt_pk_bf16_f32 v20, v20, v20
  v_cvt_pk_bf16_f32 v21, v21, v21
  v_cvt_pk_bf16_f32 v22, v22, v22
  v_cvt_pk_bf16_f32 v23, v23, v23
  v_lshlrev_b32 v16, 16, v16
  v_lshlrev_b32 v17, 16, v17
  v_lshlrev_b32 v18, 16, v18
  v_lshlrev_b32 v19, 16, v19
  v_lshlrev_b32 v20, 16, v20
  v_lshlrev_b32 v21, 16, v21
  v_lshlrev_b32 v22, 16, v22
  v_lshlrev_b32 v23, 16, v23
  v_sqrt_f32 v16, v16
  v_sqrt_f32 v17, v17
  v_sqrt_f32 v18, v18
  v_sqrt_f32 v19, v19
  v_sqrt_f32 v20, v20
  v_sqrt_f32 v21, v21
  v_sqrt_f32 v22, v22
  v_sqrt_f32 v23, v23
  v_cvt_pk_bf16_f32 v24, v200, v16
  v_cvt_pk_bf16_f32 v25, v202, v17
  v_cvt_pk_bf16_f32 v28, v204, v18
  v_cvt_pk_bf16_f32 v29, v206, v19
  v_cvt_pk_bf16_f32 v32, v208, v20
  v_cvt_pk_bf16_f32 v33, v210, v21
  v_cvt_pk_bf16_f32 v36, v212, v22
  v_cvt_pk_bf16_f32 v37, v214, v23
  s_waitcnt vmcnt(10)
  s_mov_b32 s8, 0
EPWL:
  v_readfirstlane_b32 s9, v50
  s_nop 0
  s_cmp_lg_u32 s9, 0
  s_nop 2
  s_cbranch_scc1 EPOKL
  s_add_u32 s8, s8, 1
  s_cmp_ge_u32 s8, 0x8000
  s_cbranch_scc1 EPOKL
  buffer_load_dwordx2 v[50:51], v6, s[48:51], 0 offen sc1
  s_waitcnt vmcnt(0)
  s_branch EPWL
EPOKL:
  v_mov_b32 v26, v50
  v_mov_b32 v27, v51
  v_mov_b32 v30, v50
  v_mov_b32 v31, v51
  v_mov_b32 v34, v50
  v_mov_b32 v35, v51
  v_mov_b32 v38, v50
  v_mov_b32 v39, v51
  s_lshl_b32 s9, s3, 6
  s_add_u32 s9, s9, 64512
  v_mov_b32 v40, s9
  ds_write_b128 v40, v[24:27] offset:0
  ds_write_b128 v40, v[28:31] offset:16
  ds_write_b128 v40, v[32:35] offset:32
  ds_write_b128 v40, v[36:39] offset:48
  v_lshlrev_b32 v41, 4, v1
  v_add_u32 v42, 64512, v41
  s_lshl_b32 s6, s2, 8
  s_waitcnt vmcnt(0) lgkmcnt(0)
  s_barrier
  s_cmp_lg_u32 s3, 0
  s_cbranch_scc1 F_W2
  ds_read_b128 v[44:47], v42
  s_mov_b64 exec, 0xffff
  s_waitcnt lgkmcnt(0)
  buffer_store_dwordx4 v[44:47], v41, s[52:55], s6 offen sc1
  s_mov_b64 exec, -1
  s_nop 0
  s_branch F_W2
F_SPARE:
  v_mov_b32 v50, 0
  s_mov_b32 s8, 0
  s_nop 0
EPWS0:
  v_readfirstlane_b32 s9, v50
  s_nop 0
  s_cmp_lg_u32 s9, 0
  s_nop 2
  s_cbranch_scc1 EPOKS0
  s_add_u32 s8, s8, 1
  s_cmp_ge_u32 s8, 0x8000
  s_cbranch_scc1 EPOKS0
  buffer_load_dwordx2 v[50:51], v6, s[48:51], 0 offen sc1
  s_waitcnt vmcnt(0)
  s_branch EPWS0
EPOKS0:
F_W2:
  s_lshr_b32 s14, s2, 2
  s_and_b32 s15, s2, 3
  v_lshrrev_b32 v216, 3, v1
  v_mul_u32_u24 v216, 3072, v216
  v_and_b32 v3, 7, v1
  v_lshl_add_u32 v216, v3, 4, v216
  s_mul_i32 s70, s15, 491520
  s_lshl_b32 s71, s14, 7
  s_add_u32 s70, s70, s71
  s_and_b32 s71, s3, 1
  s_mul_i32 s71, s71, 49152
  s_add_u32 s70, s70, s71
  s_cmp_lt_u32 s3, 2
  s_cselect_b32 s72, s32, s34
  s_cselect_b32 s73, s33, s35
  s_mov_b32 s74, 1966080
  s_mov_b32 s75, 0x20000
  s_lshl_b32 s69, s3, 11
  s_add_u32 m0, s69, 0
  s_add_u32 s71, s70, 0
  buffer_load_dwordx4 v216, s[72:75], s71 offen lds
  s_add_u32 m0, s69, 1024
  s_add_u32 s71, s70, 24576
  buffer_load_dwordx4 v216, s[72:75], s71 offen lds
  s_add_u32 m0, s69, 8192
  s_add_u32 s71, s70, 98304
  buffer_load_dwordx4 v216, s[72:75], s71 offen lds
  s_add_u32 m0, s69, 9216
  s_add_u32 s71, s70, 122880
  buffer_load_dwordx4 v216, s[72:75], s71 offen lds
  s_add_u32 m0, s69, 16384
  s_add_u32 s71, s70, 196608
  buffer_load_dwordx4 v216, s[72:75], s71 offen lds
  s_add_u32 m0, s69, 17408
  s_add_u32 s71, s70, 221184
  buffer_load_dwordx4 v216, s[72:75], s71 offen lds
  s_add_u32 m0, s69, 24576
  s_add_u32 s71, s70, 294912
  buffer_load_dwordx4 v216, s[72:75], s71 offen lds
  s_add_u32 m0, s69, 25600
  s_add_u32 s71, s70, 319488
  buffer_load_dwordx4 v216, s[72:75], s71 offen lds
  s_add_u32 m0, s69, 32768
  s_add_u32 s71, s70, 393216
  buffer_load_dwordx4 v216, s[72:75], s71 offen lds
  s_add_u32 m0, s69, 33792
  s_add_u32 s71, s70, 417792
  buffer_load_dwordx4 v216, s[72:75], s71 offen lds
  s_lshr_b32 s62, s2, 2
  s_and_b32 s63, s2, 3
  s_mul_i32 s9, s2, 3
  s_add_u32 s9, s9, s3
  s_cmp_eq_u32 s3, 3
  s_cselect_b32 s9, 240, s9
  s_min_u32 s9, s9, 240
  s_mov_b32 s28, s48
  s_mov_b32 s29, s49
  s_mov_b32 s40, s42
  s_mov_b32 s41, s43
  s_mul_i32 s65, s9, 13108
  s_lshr_b32 s65, s65, 16
  s_mul_i32 s66, s65, 5
  s_sub_u32 s66, s9, s66
  s_mul_i32 s67, s65, 21846
  s_lshr_b32 s67, s67, 16
  s_mul_i32 s68, s67, 3
  s_sub_u32 s68, s65, s68
  v_lshrrev_b32 v126, 4, v1
  v_and_b32 v127, 1, v126
  v_lshrrev_b32 v126, 1, v126
  v_lshl_add_u32 v124, v126, 3, v127
  s_mul_i32 s69, s68, 24
  s_lshl_b32 s70, s68, 3
  s_add_u32 s70, s70, 72
  s_add_u32 s71, s69, 16
  v_cmp_eq_u32 vcc, 0, v126
  v_mov_b32 v125, s71
  v_mov_b32 v126, s70
  v_add_u32 v124, s69, v124
  v_cndmask_b32 v125, v126, v125, vcc
  v_add_u32 v125, v125, v127
  v_and_b32 v126, 15, v1
  v_lshlrev_b32 v126, 4, v126
  v_mul_u32_u24 v124, 1280, v124
  v_mul_u32_u24 v125, 1280, v125
  v_add_u32 v124, v124, v126
  v_add_u32 v125, v125, v126
  s_mul_i32 s69, s67, 122880
  s_lshl_b32 s70, s66, 8
  s_add_u32 s69, s69, s70
  s_mov_b32 s48, s36
  s_mov_b32 s49, s37
  s_mov_b32 s50, 0x1e0000
  s_mov_b32 s51, 0x20000
  s_cmp_eq_u32 s9, 240
  s_cselect_b32 s50, 0, s50
  s_lshl_b32 s8, s3, 13
  s_add_u32 s8, s8, 40960
  s_add_u32 m0, s8, 0
  s_add_u32 s70, s69, 0
  buffer_load_dwordx4 v124, s[48:51], s70 offen lds
  s_add_u32 m0, s8, 1024
  s_add_u32 s70, s69, 0
  buffer_load_dwordx4 v125, s[48:51], s70 offen lds
  s_add_u32 m0, s8, 2048
  s_add_u32 s70, s69, 2560
  buffer_load_dwordx4 v124, s[48:51], s70 offen lds
  s_add_u32 m0, s8, 3072
  s_add_u32 s70, s69, 2560
  buffer_load_dwordx4 v125, s[48:51], s70 offen lds
  s_add_u32 m0, s8, 4096
  s_add_u32 s70, s69, 5120
  buffer_load_dwordx4 v124, s[48:51], s70 offen lds
  s_add_u32 m0, s8, 5120
  s_add_u32 s70, s69, 5120
  buffer_load_dwordx4 v125, s[48:51], s70 offen lds
  s_add_u32 m0, s8, 6144
  s_add_u32 s70, s69, 7680
  buffer_load_dwordx4 v124, s[48:51], s70 offen lds
  s_add_u32 m0, s8, 7168
  s_add_u32 s70, s69, 7680
  buffer_load_dwordx4 v125, s[48:51], s70 offen lds
  s_mov_b32 s30, s65
  s_mov_b32 s31, s66
  s_mov_b32 s48, s28
  s_mov_b32 s49, s29
  s_mov_b32 s50, 0x8
  s_mov_b32 s51, 0x20000
  s_lshl_b32 s12, s62, 2
  s_add_u32 s12, s12, s3
  s_lshl_b32 s12, s12, 1
  s_mul_i32 s6, s12, 21846
  s_lshr_b32 s6, s6, 16
  s_mul_i32 s64, s6, 58368
  s_lshl_b32 s55, s12, 10
  s_add_u32 s64, s64, s55
  s_mul_i32 s55, s63, 15360
  s_add_u32 s64, s64, s55
  s_mul_i32 s66, s6, 832
  s_lshl_b32 s55, s12, 6
  s_add_u32 s66, s66, s55
  s_lshl_b32 s55, s63, 8
  s_add_u32 s66, s66, s55
  s_lshl_b32 s12, s62, 2
  s_add_u32 s12, s12, s3
  s_lshl_b32 s12, s12, 1
  s_add_u32 s12, s12, 1
  s_mul_i32 s6, s12, 21846
  s_lshr_b32 s6, s6, 16
  s_mul_i32 s65, s6, 58368
  s_lshl_b32 s55, s12, 10
  s_add_u32 s65, s65, s55
  s_mul_i32 s55, s63, 15360
  s_add_u32 s65, s65, s55
  s_mul_i32 s67, s6, 832
  s_lshl_b32 s55, s12, 6
  s_add_u32 s67, s67, s55
  s_lshl_b32 s55, s63, 8
  s_add_u32 s67, s67, s55
  v_lshrrev_b32 v217, 4, v1
  v_bfe_u32 v3, v1, 2, 2
  v_lshl_add_u32 v217, v217, 3, v3
  v_lshlrev_b32 v217, 7, v217
  v_and_b32 v3, 1, v1
  v_lshl_add_u32 v217, v3, 12, v217
  v_bfe_u32 v3, v1, 1, 1
  v_lshl_add_u32 v217, v3, 3, v217
  s_lshl_b32 s14, s3, 5
  v_add_u32 v217, s14, v217
  v_bfe_u32 v218, v1, 3, 1
  v_lshlrev_b32 v218, 3, v218
  v_bfe_u32 v3, v1, 1, 1
  v_lshl_add_u32 v218, v3, 2, v218
  v_and_b32 v3, 1, v1
  v_add_u32 v218, v218, v3
  v_bfe_u32 v3, v1, 2, 1
  v_lshl_add_u32 v218, v3, 1, v218
  v_lshrrev_b32 v3, 4, v1
  v_lshlrev_b32 v219, 4, v3
  v_lshlrev_b32 v3, 8, v3
  v_lshl_add_u32 v218, v218, 4, v3
  s_add_u32 s44, s42, 0x780000
  s_addc_u32 s45, s43, 0
  s_mov_b32 s46, 0x3c0000
  s_mov_b32 s47, 0x20000
  s_add_u32 s52, s42, 0x1360000
  s_addc_u32 s53, s43, 0
  s_mov_b32 s54, 0x10000
  s_mov_b32 s55, 0x20000
  v_mov_b32 v8, 0x3f803f80
  v_mov_b32 v9, 0x3f803f80
  v_mov_b32 v10, 0x3f803f80
  v_mov_b32 v11, 0x3f803f80
  s_mov_b32 s12, 0x00010001
  s_mov_b32 s13, 0x00010001
  s_waitcnt vmcnt(8)
  s_barrier
  ds_read_b64_tr_b16 v[64:65], v217 offset:0
  ds_read_b64_tr_b16 v[66:67], v217 offset:512
  ds_read_b64_tr_b16 v[68:69], v217 offset:16
  ds_read_b64_tr_b16 v[70:71], v217 offset:528
  ds_read_b64_tr_b16 v[72:73], v217 offset:8192
  ds_read_b64_tr_b16 v[74:75], v217 offset:8704
  ds_read_b64_tr_b16 v[76:77], v217 offset:8208
  ds_read_b64_tr_b16 v[78:79], v217 offset:8720
  ds_read_b64_tr_b16 v[80:81], v217 offset:16384
  ds_read_b64_tr_b16 v[82:83], v217 offset:16896
  ds_read_b64_tr_b16 v[84:85], v217 offset:16400
  ds_read_b64_tr_b16 v[86:87], v217 offset:16912
  ds_read_b64_tr_b16 v[88:89], v217 offset:24576
  ds_read_b64_tr_b16 v[90:91], v217 offset:25088
  ds_read_b64_tr_b16 v[92:93], v217 offset:24592
  ds_read_b64_tr_b16 v[94:95], v217 offset:25104
  ds_read_b64_tr_b16 v[96:97], v217 offset:32768
  ds_read_b64_tr_b16 v[98:99], v217 offset:33280
  ds_read_b64_tr_b16 v[100:101], v217 offset:32784
  ds_read_b64_tr_b16 v[102:103], v217 offset:33296
  s_waitcnt lgkmcnt(15)
  buffer_store_dwordx4 v[64:67], v218, s[44:47], s64 offen sc1
  v_mfma_f32_16x16x32_bf16 v[12:15], v[64:67], v[8:11], 0
  s_add_u32 s64, s64, 3072
  s_waitcnt lgkmcnt(15)
  buffer_store_dwordx4 v[68:71], v218, s[44:47], s65 offen sc1
  v_mfma_f32_16x16x32_bf16 v[16:19], v[68:71], v[8:11], 0
  s_add_u32 s65, s65, 3072
  s_waitcnt lgkmcnt(14)
  buffer_store_dwordx4 v[72:75], v218, s[44:47], s64 offen sc1
  v_mfma_f32_16x16x32_bf16 v[12:15], v[72:75], v[8:11], v[12:15]
  s_add_u32 s64, s64, 3072
  s_waitcnt lgkmcnt(12)
  buffer_store_dwordx4 v[76:79], v218, s[44:47], s65 offen sc1
  v_mfma_f32_16x16x32_bf16 v[16:19], v[76:79], v[8:11], v[16:19]
  s_add_u32 s65, s65, 3072
  s_waitcnt lgkmcnt(10)
  buffer_store_dwordx4 v[80:83], v218, s[44:47], s64 offen sc1
  v_mfma_f32_16x16x32_bf16 v[12:15], v[80:83], v[8:11], v[12:15]
  s_add_u32 s64, s64, 3072
  s_waitcnt lgkmcnt(8)
  buffer_store_dwordx4 v[84:87], v218, s[44:47], s65 offen sc1
  v_mfma_f32_16x16x32_bf16 v[16:19], v[84:87], v[8:11], v[16:19]
  s_add_u32 s65, s65, 3072
  s_waitcnt lgkmcnt(6)
  buffer_store_dwordx4 v[88:91], v218, s[44:47], s64 offen sc1
  v_mfma_f32_16x16x32_bf16 v[12:15], v[88:91], v[8:11], v[12:15]
  s_add_u32 s64, s64, 3072
  s_waitcnt lgkmcnt(4)
  buffer_store_dwordx4 v[92:95], v218, s[44:47], s65 offen sc1
  v_mfma_f32_16x16x32_bf16 v[16:19], v[92:95], v[8:11], v[16:19]
  s_add_u32 s65, s65, 3072
  s_waitcnt lgkmcnt(2)
  buffer_store_dwordx4 v[96:99], v218, s[44:47], s64 offen sc1
  v_mfma_f32_16x16x32_bf16 v[12:15], v[96:99], v[8:11], v[12:15]
  s_waitcnt lgkmcnt(0)
  buffer_store_dwordx4 v[100:103], v218, s[44:47], s65 offen sc1
  v_mfma_f32_16x16x32_bf16 v[16:19], v[100:103], v[8:11], v[16:19]
  s_mov_b64 exec, s[12:13]
  s_nop 3
  buffer_store_dwordx4 v[12:15], v219, s[52:55], s66 offen sc1
  s_nop 1
  buffer_store_dwordx4 v[16:19], v219, s[52:55], s67 offen sc1
  s_mov_b64 exec, -1
  s_mov_b32 s65, s30
  s_mov_b32 s66, s31
  v_mov_b32 v7, 0
  s_mov_b32 s8, 0
  s_nop 0
EPWS:
  v_readfirstlane_b32 s9, v50
  s_nop 0
  s_cmp_lg_u32 s9, 0
  s_nop 2
  s_cbranch_scc1 EPOKS
  s_add_u32 s8, s8, 1
  s_cmp_ge_u32 s8, 0x8000
  s_cbranch_scc1 EPOKS
  buffer_load_dwordx2 v[50:51], v7, s[48:51], 0 offen sc1
  s_waitcnt vmcnt(0)
  s_branch EPWS
EPOKS:
  v_readfirstlane_b32 s90, v50
  v_readfirstlane_b32 s91, v51
  s_mul_i32 s9, s2, 3
  s_add_u32 s9, s9, s3
  s_cmp_eq_u32 s3, 3
  s_cselect_b32 s9, 240, s9
  s_min_u32 s9, s9, 240
  v_lshrrev_b32 v6, 4, v1
  v_bfe_u32 v7, v1, 2, 2
  v_lshl_add_u32 v6, v6, 3, v7
  v_lshlrev_b32 v6, 8, v6
  v_and_b32 v7, 3, v1
  v_lshl_add_u32 v6, v7, 3, v6
  v_lshlrev_b32 v8, 4, v1
  s_lshl_b32 s11, s66, 3
  s_mul_i32 s14, s65, 5120
  s_add_u32 s12, s11, 0
  s_mul_i32 s13, s12, 13108
  s_lshr_b32 s13, s13, 16
  s_mul_i32 s13, s13, 240640
  s_lshl_b32 s12, s12, 10
  s_add_u32 s13, s13, s12
  s_add_u32 s56, s13, s14
  s_add_u32 s12, s11, 1
  s_mul_i32 s13, s12, 13108
  s_lshr_b32 s13, s13, 16
  s_mul_i32 s13, s13, 240640
  s_lshl_b32 s12, s12, 10
  s_add_u32 s13, s13, s12
  s_add_u32 s57, s13, s14
  s_add_u32 s12, s11, 2
  s_mul_i32 s13, s12, 13108
  s_lshr_b32 s13, s13, 16
  s_mul_i32 s13, s13, 240640
  s_lshl_b32 s12, s12, 10
  s_add_u32 s13, s13, s12
  s_add_u32 s58, s13, s14
  s_add_u32 s12, s11, 3
  s_mul_i32 s13, s12, 13108
  s_lshr_b32 s13, s13, 16
  s_mul_i32 s13, s13, 240640
  s_lshl_b32 s12, s12, 10
  s_add_u32 s13, s13, s12
  s_add_u32 s59, s13, s14
  s_add_u32 s12, s11, 4
  s_mul_i32 s13, s12, 13108
  s_lshr_b32 s13, s13, 16
  s_mul_i32 s13, s13, 240640
  s_lshl_b32 s12, s12, 10
  s_add_u32 s13, s13, s12
  s_add_u32 s60, s13, s14
  s_add_u32 s12, s11, 5
  s_mul_i32 s13, s12, 13108
  s_lshr_b32 s13, s13, 16
  s_mul_i32 s13, s13, 240640
  s_lshl_b32 s12, s12, 10
  s_add_u32 s13, s13, s12
  s_add_u32 s61, s13, s14
  s_add_u32 s12, s11, 6
  s_mul_i32 s13, s12, 13108
  s_lshr_b32 s13, s13, 16
  s_mul_i32 s13, s13, 240640
  s_lshl_b32 s12, s12, 10
  s_add_u32 s13, s13, s12
  s_add_u32 s62, s13, s14
  s_add_u32 s12, s11, 7
  s_mul_i32 s13, s12, 13108
  s_lshr_b32 s13, s13, 16
  s_mul_i32 s13, s13, 240640
  s_lshl_b32 s12, s12, 10
  s_add_u32 s13, s13, s12
  s_add_u32 s63, s13, s14
  s_add_u32 s52, s40, 0xb40000
  s_addc_u32 s53, s41, 0
  s_mov_b32 s54, 0x1e0000
  s_mov_b32 s55, 0x20000
  s_cmp_eq_u32 s9, 240
  s_cselect_b32 s54, 0, s54
  s_lshl_b32 s8, s3, 13
  s_add_u32 s8, s8, 40960
  v_add_u32 v6, s8, v6
  s_waitcnt vmcnt(0)
  ds_read_b64_tr_b16 v[24:25], v6 offset:0
  ds_read_b64_tr_b16 v[26:27], v6 offset:1024
  ds_read_b64_tr_b16 v[28:29], v6 offset:32
  ds_read_b64_tr_b16 v[30:31], v6 offset:1056
  ds_read_b64_tr_b16 v[32:33], v6 offset:64
  ds_read_b64_tr_b16 v[34:35], v6 offset:1088
  ds_read_b64_tr_b16 v[36:37], v6 offset:96
  ds_read_b64_tr_b16 v[38:39], v6 offset:1120
  ds_read_b64_tr_b16 v[40:41], v6 offset:128
  ds_read_b64_tr_b16 v[42:43], v6 offset:1152
  ds_read_b64_tr_b16 v[44:45], v6 offset:160
  ds_read_b64_tr_b16 v[46:47], v6 offset:1184
  ds_read_b64_tr_b16 v[48:49], v6 offset:192
  ds_read_b64_tr_b16 v[50:51], v6 offset:1216
  ds_read_b64_tr_b16 v[52:53], v6 offset:224
  ds_read_b64_tr_b16 v[54:55], v6 offset:1248
  s_barrier
  s_cmp_lg_u32 s3, 0
  s_cbranch_scc1 FLG_W
  s_add_u32 s92, s42, 0x13c0000
  s_addc_u32 s93, s43, 0
  s_mov_b32 s94, 0x10000
  s_mov_b32 s95, 0x20000
  s_lshl_b32 s35, s2, 7
  v_mov_b32 v20, s90
  v_mov_b32 v21, s91
  v_mov_b32 v22, 0
  s_mov_b64 exec, 1
  buffer_store_dwordx2 v[20:21], v22, s[92:95], s35 offen sc1
  s_mov_b64 exec, -1
FLG_W:
  s_waitcnt lgkmcnt(14)
  buffer_store_dwordx4 v[24:27], v8, s[52:55], s56 offen sc1
  s_waitcnt lgkmcnt(12)
  buffer_store_dwordx4 v[28:31], v8, s[52:55], s57 offen sc1
  s_waitcnt lgkmcnt(10)
  buffer_store_dwordx4 v[32:35], v8, s[52:55], s58 offen sc1
  s_waitcnt lgkmcnt(8)
  buffer_store_dwordx4 v[36:39], v8, s[52:55], s59 offen sc1
  s_waitcnt lgkmcnt(6)
  buffer_store_dwordx4 v[40:43], v8, s[52:55], s60 offen sc1
  s_waitcnt lgkmcnt(4)
  buffer_store_dwordx4 v[44:47], v8, s[52:55], s61 offen sc1
  s_waitcnt lgkmcnt(2)
  buffer_store_dwordx4 v[48:51], v8, s[52:55], s62 offen sc1
  s_waitcnt lgkmcnt(0)
  buffer_store_dwordx4 v[52:55], v8, s[52:55], s63 offen sc1
  s_add_u32 s92, s42, 0x13c0000
  s_addc_u32 s93, s43, 0
  s_mov_b32 s94, 0x10000
  s_mov_b32 s95, 0x20000
  s_add_u32 s28, s42, 0x780000
  s_addc_u32 s29, s43, 0
  s_mov_b32 s30, 0x3c0000
  s_mov_b32 s31, 0x20000
  s_lshr_b32 s32, s2, 5
  s_lshl_b32 s32, s32, 1
  s_and_b32 s33, s2, 1
  s_add_u32 s32, s32, s33
  s_mul_i32 s34, s32, 3
  s_lshr_b32 s34, s34, 1
  s_lshl_b32 s34, s34, 9
  s_lshl_b32 s32, s32, 2
  s_add_u32 s32, s32, s3
  s_mul_i32 s32, s32, 61440
  v_and_b32 v8, 7, v1
  v_lshlrev_b32 v8, 7, v8
  v_lshlrev_b32 v2, 4, v1
  s_mov_b32 s36, 0
  v_mov_b32 v190, 0
  s_nop 1
M_LOADALL:
  s_mov_b32 s35, 0
W13W_C:
  buffer_load_dwordx2 v[10:11], v8, s[92:95], s34 offen sc1
  s_waitcnt vmcnt(0)
  v_cmp_ne_u64 vcc, s[90:91], v[10:11]
  s_nop 4
  s_cbranch_vccz W13K_C
  s_sleep 4
  s_add_u32 s35, s35, 1
  s_cmp_lt_u32 s35, 0x8000
  s_cbranch_scc1 W13W_C
W13K_C:
  s_add_u32 s35, s32, 0
  buffer_load_dwordx4 a[0:3], v2, s[28:31], s35 offen offset:0 sc1
  buffer_load_dwordx4 a[4:7], v2, s[28:31], s35 offen offset:1024 sc1
  buffer_load_dwordx4 a[8:11], v2, s[28:31], s35 offen offset:2048 sc1
  buffer_load_dwordx4 a[12:15], v2, s[28:31], s35 offen offset:3072 sc1
  s_add_u32 s35, s32, 4096
  buffer_load_dwordx4 a[16:19], v2, s[28:31], s35 offen offset:0 sc1
  buffer_load_dwordx4 a[20:23], v2, s[28:31], s35 offen offset:1024 sc1
  buffer_load_dwordx4 a[24:27], v2, s[28:31], s35 offen offset:2048 sc1
  buffer_load_dwordx4 a[28:31], v2, s[28:31], s35 offen offset:3072 sc1
  s_add_u32 s35, s32, 8192
  buffer_load_dwordx4 a[32:35], v2, s[28:31], s35 offen offset:0 sc1
  buffer_load_dwordx4 a[36:39], v2, s[28:31], s35 offen offset:1024 sc1
  buffer_load_dwordx4 a[40:43], v2, s[28:31], s35 offen offset:2048 sc1
  buffer_load_dwordx4 a[44:47], v2, s[28:31], s35 offen offset:3072 sc1
  s_add_u32 s35, s32, 12288
  buffer_load_dwordx4 a[48:51], v2, s[28:31], s35 offen offset:0 sc1
  buffer_load_dwordx4 a[52:55], v2, s[28:31], s35 offen offset:1024 sc1
  buffer_load_dwordx4 a[56:59], v2, s[28:31], s35 offen offset:2048 sc1
  buffer_load_dwordx4 a[60:63], v2, s[28:31], s35 offen offset:3072 sc1
  s_add_u32 s35, s32, 16384
  buffer_load_dwordx4 a[64:67], v2, s[28:31], s35 offen offset:0 sc1
  buffer_load_dwordx4 a[68:71], v2, s[28:31], s35 offen offset:1024 sc1
  buffer_load_dwordx4 a[72:75], v2, s[28:31], s35 offen offset:2048 sc1
  buffer_load_dwordx4 a[76:79], v2, s[28:31], s35 offen offset:3072 sc1
  s_add_u32 s35, s32, 20480
  buffer_load_dwordx4 a[80:83], v2, s[28:31], s35 offen offset:0 sc1
  buffer_load_dwordx4 a[84:87], v2, s[28:31], s35 offen offset:1024 sc1
  buffer_load_dwordx4 a[88:91], v2, s[28:31], s35 offen offset:2048 sc1
  buffer_load_dwordx4 a[92:95], v2, s[28:31], s35 offen offset:3072 sc1
  s_add_u32 s35, s32, 24576
  buffer_load_dwordx4 a[96:99], v2, s[28:31], s35 offen offset:0 sc1
  buffer_load_dwordx4 a[100:103], v2, s[28:31], s35 offen offset:1024 sc1
  buffer_load_dwordx4 a[104:107], v2, s[28:31], s35 offen offset:2048 sc1
  buffer_load_dwordx4 a[108:111], v2, s[28:31], s35 offen offset:3072 sc1
  s_add_u32 s35, s32, 28672
  buffer_load_dwordx4 a[112:115], v2, s[28:31], s35 offen offset:0 sc1
  buffer_load_dwordx4 a[116:119], v2, s[28:31], s35 offen offset:1024 sc1
  buffer_load_dwordx4 a[120:123], v2, s[28:31], s35 offen offset:2048 sc1
  buffer_load_dwordx4 a[124:127], v2, s[28:31], s35 offen offset:3072 sc1
  s_add_u32 s35, s32, 32768
  buffer_load_dwordx4 a[128:131], v2, s[28:31], s35 offen offset:0 sc1
  buffer_load_dwordx4 a[132:135], v2, s[28:31], s35 offen offset:1024 sc1
  buffer_load_dwordx4 a[136:139], v2, s[28:31], s35 offen offset:2048 sc1
  buffer_load_dwordx4 a[140:143], v2, s[28:31], s35 offen offset:3072 sc1
M_START:
  s_load_dwordx2 s[38:39], s[0:1], 88
  s_load_dwordx2 s[40:41], s[0:1], 104
  v_lshlrev_b32 v2, 4, v1
  s_bfe_u32 s4, s2, 0x20001
  s_lshl_b32 s4, s4, 2
  s_bfe_u32 s5, s2, 0x20003
  s_add_u32 s4, s4, s5
  s_lshr_b32 s18, s2, 5
  s_and_b32 s19, s2, 1
  s_lshl_b32 s5, s18, 1
  s_add_u32 s5, s5, s19
  s_mul_i32 s6, s3, 20480
  s_mul_i32 s20, s4, 163840
  s_add_u32 s7, s20, s6
  s_lshl_b32 s8, s5, 2
  s_add_u32 s8, s8, s3
  s_mul_i32 s9, s8, 61440
  s_and_b32 s21, s18, 3
  s_mul_i32 s21, s21, 20480
  s_add_u32 s21, s21, s20
  s_mul_i32 s10, s3, 5120
  s_add_u32 s21, s21, s10
  s_mul_i32 s22, s18, 245760
  s_mul_i32 s10, s3, 61440
  s_add_u32 s22, s22, s10
  s_waitcnt lgkmcnt(0)
  s_add_u32 s44, s40, 0x500000
  s_addc_u32 s45, s41, 0
  s_mov_b32 s46, 0x280000
  s_mov_b32 s47, 0x20000
  s_add_u32 s48, s40, 0x780000
  s_addc_u32 s49, s41, 0
  s_mov_b32 s50, 0x3c0000
  s_mov_b32 s51, 0x20000
  s_add_u32 s52, s40, 0x1360000
  s_addc_u32 s53, s41, 0
  s_mov_b32 s54, 0x10000
  s_mov_b32 s55, 0x20000
  s_add_u32 s56, s40, 0xd20000
  s_addc_u32 s57, s41, 0
  s_mov_b32 s58, 0x600000
  s_mov_b32 s59, 0x20000
  s_add_u32 s68, s40, 0xb40000
  s_addc_u32 s69, s41, 0
  s_mov_b32 s70, 0x1e0000
  s_mov_b32 s71, 0x20000
  s_add_u32 s72, s40, 0x1324000
  s_addc_u32 s73, s41, 0
  s_mov_b32 s74, 0x8000
  s_mov_b32 s75, 0x20000
  v_and_b32 v6, 15, v1
  v_lshrrev_b32 v7, 4, v1
  v_lshrrev_b32 v3, 1, v7
  v_lshlrev_b32 v3, 5, v3
  v_and_b32 v4, 1, v7
  v_lshl_add_u32 v3, v4, 3, v3
  v_lshlrev_b32 v186, 3, v1
  s_cmp_lt_u32 s18, 3
  s_cselect_b32 s26, 10240, 0
  s_cselect_b32 s27, 4096, 0
  s_add_u32 s15, s27, s6
  v_add_u32 v185, s15, v2
  v_add_u32 v183, s15, v186
  s_add_u32 s13, s26, s6
  v_add_u32 v31, s13, v2
  s_lshl_b32 s17, s8, 10
  v_lshlrev_b32 v5, 3, v6
  s_lshl_b32 s24, s4, 10
  v_add_u32 v3, s15, v3
  v_add_u32 v187, 5120, v3
  v_add_u32 v184, s15, v5
  v_add_u32 v30, s26, v186
  s_add_u32 s13, s3, 0
  s_and_b32 s13, s13, 3
  s_mul_i32 s14, s13, 20480
  v_add_u32 v8, s14, v186
  s_add_u32 s13, s3, 1
  s_and_b32 s13, s13, 3
  s_mul_i32 s14, s13, 20480
  v_add_u32 v9, s14, v186
  s_add_u32 s13, s3, 2
  s_and_b32 s13, s13, 3
  s_mul_i32 s14, s13, 20480
  v_add_u32 v10, s14, v186
  s_add_u32 s13, s3, 3
  s_and_b32 s13, s13, 3
  s_mul_i32 s14, s13, 20480
  v_add_u32 v11, s14, v186
  s_add_u32 s13, s3, 4
  s_and_b32 s13, s13, 3
  s_add_u32 s13, s13, 4
  s_mul_i32 s14, s13, 20480
  v_add_u32 v12, s14, v186
  s_add_u32 s13, s3, 5
  s_and_b32 s13, s13, 3
  s_add_u32 s13, s13, 4
  s_mul_i32 s14, s13, 20480
  v_add_u32 v13, s14, v186
  s_add_u32 s13, s3, 6
  s_and_b32 s13, s13, 3
  s_add_u32 s13, s13, 4
  s_mul_i32 s14, s13, 20480
  v_add_u32 v14, s14, v186
  s_add_u32 s13, s3, 7
  s_and_b32 s13, s13, 3
  s_add_u32 s13, s13, 4
  s_mul_i32 s14, s13, 20480
  v_add_u32 v15, s14, v186
  s_nop 1
M_BODY:
  v_min_u32 v189, 39, v1
  v_lshlrev_b32 v189, 7, v189
  v_min_u32 v188, 23, v1
  v_lshlrev_b32 v188, 7, v188
  s_mov_b32 s35, 0
  s_mul_i32 s14, s3, 5120
  s_add_u32 s14, s14, 24576
  s_add_u32 s12, s14, 20480
  s_cmp_eq_u32 s36, 0
  s_cbranch_scc1 HW
  s_waitcnt vmcnt(63)
  v_cmp_ne_u64 vcc, s[90:91], v[190:191]
  s_nop 4
  s_cbranch_vccz HOK
HW:
  buffer_load_dwordx2 v[190:191], v189, s[92:95], s14 offen sc1
  s_waitcnt vmcnt(0)
  v_cmp_ne_u64 vcc, s[90:91], v[190:191]
  s_nop 4
  s_cbranch_vccz HOK
  s_sleep 4
  s_add_u32 s35, s35, 1
  s_cmp_lt_u32 s35, 0x8000
  s_cbranch_scc1 HW
HOK:
  s_mul_i32 s37, s3, 3072
  s_add_u32 s37, s37, 12288
  s_waitcnt lgkmcnt(0)
  s_barrier
  s_cmp_lg_u32 s36, 0
  s_cbranch_scc1 FB_SKIP
  s_cmp_lg_u32 s3, 0
  s_cbranch_scc1 FLG_W2
  s_add_u32 s92, s42, 0x13c0000
  s_addc_u32 s93, s43, 0
  s_mov_b32 s94, 0x10000
  s_mov_b32 s95, 0x20000
  s_lshl_b32 s35, s2, 7
  v_mov_b32 v248, s90
  v_mov_b32 v249, s91
  v_mov_b32 v250, 12288
  s_mov_b64 exec, 1
  buffer_store_dwordx2 v[248:249], v250, s[92:95], s35 offen sc1
  s_mov_b64 exec, -1
FLG_W2:
FB_SKIP:
  buffer_load_dwordx4 v[160:163], v2, s[44:47], s21 offen offset:0 sc1
  buffer_load_dwordx4 v[164:167], v2, s[44:47], s21 offen offset:1024 sc1
  buffer_load_dwordx4 v[168:171], v2, s[44:47], s21 offen offset:2048 sc1
  buffer_load_dwordx4 v[172:175], v2, s[44:47], s21 offen offset:3072 sc1
  s_add_u32 s21, s21, 4096
  buffer_load_dwordx4 v[176:179], v2, s[44:47], s21 offen offset:0 sc1
  s_add_u32 m0, s6, 0
  s_add_u32 s10, s7, 0
  buffer_load_dwordx4 v2, s[44:47], s10 offen offset:0 sc1 lds
  buffer_load_dwordx4 v2, s[44:47], s10 offen offset:1024 sc1 lds
  buffer_load_dwordx4 v2, s[44:47], s10 offen offset:2048 sc1 lds
  buffer_load_dwordx4 v2, s[44:47], s10 offen offset:3072 sc1 lds
  s_add_u32 m0, s6, 4096
  s_add_u32 s10, s7, 4096
  buffer_load_dwordx4 v2, s[44:47], s10 offen offset:0 sc1 lds
  buffer_load_dwordx4 v2, s[44:47], s10 offen offset:1024 sc1 lds
  buffer_load_dwordx4 v2, s[44:47], s10 offen offset:2048 sc1 lds
  buffer_load_dwordx4 v2, s[44:47], s10 offen offset:3072 sc1 lds
  s_add_u32 m0, s6, 8192
  s_add_u32 s10, s7, 8192
  buffer_load_dwordx4 v2, s[44:47], s10 offen offset:0 sc1 lds
  buffer_load_dwordx4 v2, s[44:47], s10 offen offset:1024 sc1 lds
  buffer_load_dwordx4 v2, s[44:47], s10 offen offset:2048 sc1 lds
  buffer_load_dwordx4 v2, s[44:47], s10 offen offset:3072 sc1 lds
  s_mov_b32 s16, 0x3f803f80
  s_lshl_b32 s13, s3, 7
  v_and_b32 v182, 7, v1
  v_lshlrev_b32 v182, 4, v182
  v_add_u32 v182, s13, v182
  s_waitcnt vmcnt(12)
  v_dot2_f32_bf16 v252, v160, s16, 0
  v_dot2_f32_bf16 v253, v160, v160, 0
  v_dot2_f32_bf16 v252, v161, s16, v252
  v_dot2_f32_bf16 v253, v161, v161, v253
  s_add_u32 m0, s6, 12288
  s_add_u32 s10, s7, 12288
  buffer_load_dwordx4 v2, s[44:47], s10 offen offset:0 sc1 lds
  v_dot2_f32_bf16 v254, v162, s16, 0
  v_dot2_f32_bf16 v255, v162, v162, 0
  v_dot2_f32_bf16 v254, v163, s16, v254
  v_dot2_f32_bf16 v255, v163, v163, v255
  s_add_u32 s11, s9, 36864
  buffer_load_dwordx4 a[144:147], v2, s[48:51], s11 offen offset:0 sc1
  v_dot2_f32_bf16 v252, v164, s16, v252
  v_dot2_f32_bf16 v253, v164, v164, v253
  v_dot2_f32_bf16 v252, v165, s16, v252
  v_dot2_f32_bf16 v253, v165, v165, v253
  buffer_load_dwordx4 a[148:151], v2, s[48:51], s11 offen offset:1024 sc1
  v_dot2_f32_bf16 v254, v166, s16, v254
  v_dot2_f32_bf16 v255, v166, v166, v255
  v_dot2_f32_bf16 v254, v167, s16, v254
  v_dot2_f32_bf16 v255, v167, v167, v255
  buffer_load_dwordx4 a[152:155], v2, s[48:51], s11 offen offset:2048 sc1
  v_dot2_f32_bf16 v252, v168, s16, v252
  v_dot2_f32_bf16 v253, v168, v168, v253
  v_dot2_f32_bf16 v252, v169, s16, v252
  v_dot2_f32_bf16 v253, v169, v169, v253
  buffer_load_dwordx4 v2, s[44:47], s10 offen offset:1024 sc1 lds
  v_dot2_f32_bf16 v254, v170, s16, v254
  v_dot2_f32_bf16 v255, v170, v170, v255
  v_dot2_f32_bf16 v254, v171, s16, v254
  v_dot2_f32_bf16 v255, v171, v171, v255
  buffer_load_dwordx4 a[156:159], v2, s[48:51], s11 offen offset:3072 sc1
  v_dot2_f32_bf16 v252, v172, s16, v252
  v_dot2_f32_bf16 v253, v172, v172, v253
  v_dot2_f32_bf16 v252, v173, s16, v252
  v_dot2_f32_bf16 v253, v173, v173, v253
  s_add_u32 s11, s9, 40960
  buffer_load_dwordx4 a[160:163], v2, s[48:51], s11 offen offset:0 sc1
  v_dot2_f32_bf16 v254, v174, s16, v254
  v_dot2_f32_bf16 v255, v174, v174, v255
  v_dot2_f32_bf16 v254, v175, s16, v254
  v_dot2_f32_bf16 v255, v175, v175, v255
  buffer_load_dwordx4 a[164:167], v2, s[48:51], s11 offen offset:1024 sc1
  v_dot2_f32_bf16 v252, v176, s16, v252
  v_dot2_f32_bf16 v253, v176, v176, v253
  v_dot2_f32_bf16 v252, v177, s16, v252
  v_dot2_f32_bf16 v253, v177, v177, v253
  buffer_load_dwordx4 v2, s[44:47], s10 offen offset:2048 sc1 lds
  v_dot2_f32_bf16 v254, v178, s16, v254
  v_dot2_f32_bf16 v255, v178, v178, v255
  v_dot2_f32_bf16 v254, v179, s16, v254
  v_dot2_f32_bf16 v255, v179, v179, v255
  buffer_load_dwordx4 a[168:171], v2, s[48:51], s11 offen offset:2048 sc1
  v_mov_b32 v160, v252
  v_mov_b32 v161, v253
  v_mov_b32 v162, v254
  v_mov_b32 v163, v255
  v_permlane32_swap_b32 v252, v160
  v_permlane32_swap_b32 v253, v161
  v_permlane32_swap_b32 v254, v162
  v_permlane32_swap_b32 v255, v163
  v_pk_add_f32 v[252:253], v[252:253], v[160:161]
  v_pk_add_f32 v[254:255], v[254:255], v[162:163]
  v_mov_b32 v160, v252
  v_mov_b32 v161, v253
  v_mov_b32 v162, v254
  v_mov_b32 v163, v255
  v_permlane16_swap_b32 v252, v160
  v_permlane16_swap_b32 v253, v161
  v_permlane16_swap_b32 v254, v162
  v_permlane16_swap_b32 v255, v163
  v_pk_add_f32 v[252:253], v[252:253], v[160:161]
  v_pk_add_f32 v[254:255], v[254:255], v[162:163]
  s_nop 0
  v_add_f32_dpp v252, v252, v252 row_ror:8 row_mask:0xf bank_mask:0xf
  v_add_f32_dpp v253, v253, v253 row_ror:8 row_mask:0xf bank_mask:0xf
  v_add_f32_dpp v254, v254, v254 row_ror:8 row_mask:0xf bank_mask:0xf
  v_add_f32_dpp v255, v255, v255 row_ror:8 row_mask:0xf bank_mask:0xf
  v_add_u32 v6, 162816, v182
  ds_write_b128 v6, v[252:255]
  s_waitcnt lgkmcnt(0)
  s_waitcnt vmcnt(21)
  s_barrier
  ds_read2st64_b64 v[128:131], v8 offset0:0 offset1:1
  ds_read2st64_b64 v[132:135], v9 offset0:0 offset1:1
  ds_read2st64_b64 v[136:139], v10 offset0:0 offset1:1
  ds_read2st64_b64 v[140:143], v11 offset0:0 offset1:1
  s_cmp_eq_u32 s3, 1
  s_cbranch_scc1 K3_VAR1
  s_cmp_eq_u32 s3, 2
  s_cbranch_scc1 K3_VAR2
  s_cmp_eq_u32 s3, 3
  s_cbranch_scc1 K3_VAR3
  s_waitcnt vmcnt(20)
  s_barrier
  s_waitcnt lgkmcnt(0)
  v_mfma_f32_16x16x32_bf16 v[32:35], a[0:3], v[128:131], 0
  ds_read2st64_b64 v[144:147], v8 offset0:2 offset1:3
  buffer_load_dwordx4 a[172:175], v2, s[48:51], s11 offen offset:3072 sc1
  v_mfma_f32_16x16x32_bf16 v[36:39], a[4:7], v[128:131], 0
  s_add_u32 s11, s9, 45056
  buffer_load_dwordx4 a[176:179], v2, s[48:51], s11 offen offset:0 sc1
  buffer_load_dwordx4 v2, s[44:47], s10 offen offset:3072 sc1 lds
  v_mfma_f32_16x16x32_bf16 v[40:43], a[8:11], v[128:131], 0
  v_mfma_f32_16x16x32_bf16 v[44:47], a[0:3], v[132:135], 0
  ds_read2st64_b64 v[148:151], v9 offset0:2 offset1:3
  v_mfma_f32_16x16x32_bf16 v[48:51], a[4:7], v[132:135], 0
  v_add_u32 v7, 162816, v5
  ds_read_b64 v[240:241], v7 offset:0
  v_mfma_f32_16x16x32_bf16 v[52:55], a[8:11], v[132:135], 0
  ds_read_b64 v[242:243], v7 offset:128
  ds_read_b64 v[244:245], v7 offset:256
  v_mfma_f32_16x16x32_bf16 v[56:59], a[0:3], v[136:139], 0
  ds_read2st64_b64 v[152:155], v10 offset0:2 offset1:3
  v_mfma_f32_16x16x32_bf16 v[60:63], a[4:7], v[136:139], 0
  ds_read_b64 v[246:247], v7 offset:384
  v_mov_b32 v248, 0x3acccccd
  v_mfma_f32_16x16x32_bf16 v[64:67], a[8:11], v[136:139], 0
  s_lshr_b32 s13, s18, 2
  s_lshl_b32 s13, s13, 1
  v_mfma_f32_16x16x32_bf16 v[68:71], a[0:3], v[140:143], 0
  ds_read2st64_b64 v[156:159], v11 offset0:2 offset1:3
  v_mfma_f32_16x16x32_bf16 v[72:75], a[4:7], v[140:143], 0
  s_add_u32 s13, s13, s19
  s_lshl_b32 s13, s13, 2
  v_mfma_f32_16x16x32_bf16 v[76:79], a[8:11], v[140:143], 0
  s_lshl_b64 s[32:33], 15, s13
  s_lshl_b32 s13, s4, 3
  s_waitcnt vmcnt(22)
  s_barrier
  s_waitcnt lgkmcnt(0)
  v_mfma_f32_16x16x32_bf16 v[32:35], a[12:15], v[144:147], v[32:35]
  ds_read2st64_b64 v[128:131], v8 offset0:4 offset1:5
  buffer_load_dwordx4 a[180:183], v2, s[48:51], s11 offen offset:1024 sc1
  v_mfma_f32_16x16x32_bf16 v[36:39], a[16:19], v[144:147], v[36:39]
  buffer_load_dwordx4 a[184:187], v2, s[48:51], s11 offen offset:2048 sc1
  buffer_load_dwordx4 a[188:191], v2, s[48:51], s11 offen offset:3072 sc1
  v_mfma_f32_16x16x32_bf16 v[40:43], a[20:23], v[144:147], v[40:43]
  v_mfma_f32_16x16x32_bf16 v[44:47], a[12:15], v[148:151], v[44:47]
  ds_read2st64_b64 v[132:135], v9 offset0:4 offset1:5
  v_mfma_f32_16x16x32_bf16 v[48:51], a[16:19], v[148:151], v[48:51]
  s_and_b32 s14, s18, 3
  s_add_u32 s13, s13, s14
  v_mfma_f32_16x16x32_bf16 v[52:55], a[20:23], v[148:151], v[52:55]
  s_add_u32 s13, s13, 0
  s_lshl_b32 s34, s13, 7
  v_mfma_f32_16x16x32_bf16 v[56:59], a[12:15], v[152:155], v[56:59]
  ds_read2st64_b64 v[136:139], v10 offset0:4 offset1:5
  v_mfma_f32_16x16x32_bf16 v[60:63], a[16:19], v[152:155], v[60:63]
  v_add_f32 v240, v240, v242
  v_mfma_f32_16x16x32_bf16 v[64:67], a[20:23], v[152:155], v[64:67]
  v_add_f32 v241, v241, v243
  v_add_f32 v244, v244, v246
  v_mfma_f32_16x16x32_bf16 v[68:71], a[12:15], v[156:159], v[68:71]
  ds_read2st64_b64 v[140:143], v11 offset0:4 offset1:5
  v_mfma_f32_16x16x32_bf16 v[72:75], a[16:19], v[156:159], v[72:75]
  v_add_f32 v245, v245, v247
  v_add_f32 v240, v240, v244
  v_mfma_f32_16x16x32_bf16 v[76:79], a[20:23], v[156:159], v[76:79]
  v_add_f32 v241, v241, v245
  v_mul_f32 v240, v240, v248
  s_waitcnt vmcnt(24)
  s_barrier
  s_waitcnt lgkmcnt(0)
  v_mfma_f32_16x16x32_bf16 v[32:35], a[24:27], v[128:131], v[32:35]
  ds_read2st64_b64 v[144:147], v8 offset0:6 offset1:7
  s_add_u32 m0, s6, 16384
  s_add_u32 s10, s7, 16384
  buffer_load_dwordx4 v2, s[44:47], s10 offen offset:0 sc1 lds
  v_mfma_f32_16x16x32_bf16 v[36:39], a[28:31], v[128:131], v[36:39]
  s_add_u32 s11, s9, 49152
  buffer_load_dwordx4 a[192:195], v2, s[48:51], s11 offen offset:0 sc1
  buffer_load_dwordx4 a[196:199], v2, s[48:51], s11 offen offset:1024 sc1
  v_mfma_f32_16x16x32_bf16 v[40:43], a[32:35], v[128:131], v[40:43]
  v_mfma_f32_16x16x32_bf16 v[44:47], a[24:27], v[132:135], v[44:47]
  ds_read2st64_b64 v[148:151], v9 offset0:6 offset1:7
  v_mfma_f32_16x16x32_bf16 v[48:51], a[28:31], v[132:135], v[48:51]
  v_mul_f32 v241, v241, v248
  v_fma_f32 v241, -v240, v240, v241
  v_mfma_f32_16x16x32_bf16 v[52:55], a[32:35], v[132:135], v[52:55]
  v_max_f32 v241, 0, v241
  v_cvt_pk_bf16_f32 v242, v240, v241
  v_mfma_f32_16x16x32_bf16 v[56:59], a[24:27], v[136:139], v[56:59]
  ds_read2st64_b64 v[152:155], v10 offset0:6 offset1:7
  v_mfma_f32_16x16x32_bf16 v[60:63], a[28:31], v[136:139], v[60:63]
  v_lshlrev_b32 v240, 16, v242
  v_and_b32 v241, 0xffff0000, v242
  v_mfma_f32_16x16x32_bf16 v[64:67], a[32:35], v[136:139], v[64:67]
  v_add_f32 v241, 0x3727c5ac, v241
  v_cvt_pk_bf16_f32 v241, v241, v241
  v_mfma_f32_16x16x32_bf16 v[68:71], a[24:27], v[140:143], v[68:71]
  ds_read2st64_b64 v[156:159], v11 offset0:6 offset1:7
  v_mfma_f32_16x16x32_bf16 v[72:75], a[28:31], v[140:143], v[72:75]
  v_lshlrev_b32 v241, 16, v241
  v_sqrt_f32 v241, v241
  v_mfma_f32_16x16x32_bf16 v[76:79], a[32:35], v[140:143], v[76:79]
  v_cvt_pk_bf16_f32 v241, v241, v241
  v_lshlrev_b32 v241, 16, v241
  s_waitcnt vmcnt(26)
  s_barrier
  s_waitcnt lgkmcnt(0)
  v_mfma_f32_16x16x32_bf16 v[32:35], a[36:39], v[144:147], v[32:35]
  ds_read2st64_b64 v[128:131], v8 offset0:8 offset1:9
  buffer_load_dwordx4 a[200:203], v2, s[48:51], s11 offen offset:2048 sc1
  v_mfma_f32_16x16x32_bf16 v[36:39], a[40:43], v[144:147], v[36:39]
  buffer_load_dwordx4 v2, s[44:47], s10 offen offset:1024 sc1 lds
  buffer_load_dwordx4 a[204:207], v2, s[48:51], s11 offen offset:3072 sc1
  v_mfma_f32_16x16x32_bf16 v[40:43], a[44:47], v[144:147], v[40:43]
  v_mfma_f32_16x16x32_bf16 v[44:47], a[36:39], v[148:151], v[44:47]
  ds_read2st64_b64 v[132:135], v9 offset0:8 offset1:9
  v_mfma_f32_16x16x32_bf16 v[48:51], a[40:43], v[148:151], v[48:51]
  s_mov_b64 exec, s[32:33]
  buffer_store_dwordx2 v[240:241], v5, s[72:75], s34 offen sc1
  s_mov_b64 exec, -1
  s_lshl_b32 s13, s4, 3
  v_mfma_f32_16x16x32_bf16 v[52:55], a[44:47], v[148:151], v[52:55]
  s_add_u32 s13, s13, s3
  s_mul_i32 s13, s13, 49152
  v_mfma_f32_16x16x32_bf16 v[56:59], a[36:39], v[152:155], v[56:59]
  ds_read2st64_b64 v[136:139], v10 offset0:8 offset1:9
  v_mfma_f32_16x16x32_bf16 v[60:63], a[40:43], v[152:155], v[60:63]
  s_mul_i32 s14, s5, 3072
  s_add_u32 s60, s13, s14
  v_mfma_f32_16x16x32_bf16 v[64:67], a[44:47], v[152:155], v[64:67]
  s_add_u32 s61, s60, 196608
  s_lshl_b32 s13, s4, 2
  v_mfma_f32_16x16x32_bf16 v[68:71], a[36:39], v[156:159], v[68:71]
  ds_read2st64_b64 v[140:143], v11 offset0:8 offset1:9
  v_mfma_f32_16x16x32_bf16 v[72:75], a[40:43], v[156:159], v[72:75]
  s_lshr_b32 s14, s5, 2
  s_add_u32 s14, s14, s13
  v_mfma_f32_16x16x32_bf16 v[76:79], a[44:47], v[156:159], v[76:79]
  s_lshl_b32 s14, s14, 8
  s_add_u32 s62, s14, 0x4000
  s_waitcnt vmcnt(29)
  s_barrier
  s_waitcnt lgkmcnt(0)
  v_mfma_f32_16x16x32_bf16 v[32:35], a[48:51], v[128:131], v[32:35]
  ds_read2st64_b64 v[144:147], v8 offset0:10 offset1:11
  s_add_u32 s11, s9, 53248
  buffer_load_dwordx4 a[208:211], v2, s[48:51], s11 offen offset:0 sc1
  v_mfma_f32_16x16x32_bf16 v[36:39], a[52:55], v[128:131], v[36:39]
  buffer_load_dwordx4 a[212:215], v2, s[48:51], s11 offen offset:1024 sc1
  buffer_load_dwordx4 v2, s[44:47], s10 offen offset:2048 sc1 lds
  v_mfma_f32_16x16x32_bf16 v[40:43], a[56:59], v[128:131], v[40:43]
  v_mfma_f32_16x16x32_bf16 v[44:47], a[48:51], v[132:135], v[44:47]
  ds_read2st64_b64 v[148:151], v9 offset0:10 offset1:11
  v_mfma_f32_16x16x32_bf16 v[48:51], a[52:55], v[132:135], v[48:51]
  s_add_u32 s13, s13, s3
  s_lshl_b32 s13, s13, 8
  v_mfma_f32_16x16x32_bf16 v[52:55], a[56:59], v[132:135], v[52:55]
  s_add_u32 s63, s13, 0x4000
  s_lshl_b32 s13, s4, 3
  v_mfma_f32_16x16x32_bf16 v[56:59], a[48:51], v[136:139], v[56:59]
  ds_read2st64_b64 v[152:155], v10 offset0:10 offset1:11
  v_mfma_f32_16x16x32_bf16 v[60:63], a[52:55], v[136:139], v[60:63]
  s_lshl_b32 s14, s19, 1
  s_add_u32 s23, s13, s14
  v_mfma_f32_16x16x32_bf16 v[64:67], a[56:59], v[136:139], v[64:67]
  s_mul_i32 s13, s23, 49152
  s_mul_i32 s14, s3, 12288
  v_mfma_f32_16x16x32_bf16 v[68:71], a[48:51], v[140:143], v[68:71]
  ds_read2st64_b64 v[156:159], v11 offset0:10 offset1:11
  v_mfma_f32_16x16x32_bf16 v[72:75], a[52:55], v[140:143], v[72:75]
  s_add_u32 s64, s13, s14
  s_add_u32 s65, s64, 49152
  v_mfma_f32_16x16x32_bf16 v[76:79], a[56:59], v[140:143], v[76:79]
  s_add_u32 s66, s64, 196608
  s_add_u32 s67, s64, 245760
  s_waitcnt vmcnt(31)
  s_barrier
  s_waitcnt lgkmcnt(0)
  v_mfma_f32_16x16x32_bf16 v[32:35], a[60:63], v[144:147], v[32:35]
  ds_read2st64_b64 v[128:131], v8 offset0:12 offset1:13
  buffer_load_dwordx4 a[216:219], v2, s[48:51], s11 offen offset:2048 sc1
  v_mfma_f32_16x16x32_bf16 v[36:39], a[64:67], v[144:147], v[36:39]
  buffer_load_dwordx4 a[220:223], v2, s[48:51], s11 offen offset:3072 sc1
  s_add_u32 s11, s9, 57344
  buffer_load_dwordx4 a[224:227], v2, s[48:51], s11 offen offset:0 sc1
  v_mfma_f32_16x16x32_bf16 v[40:43], a[68:71], v[144:147], v[40:43]
  v_mfma_f32_16x16x32_bf16 v[44:47], a[60:63], v[148:151], v[44:47]
  ds_read2st64_b64 v[132:135], v9 offset0:12 offset1:13
  v_mfma_f32_16x16x32_bf16 v[48:51], a[64:67], v[148:151], v[48:51]
  v_mfma_f32_16x16x32_bf16 v[52:55], a[68:71], v[148:151], v[52:55]
  v_mfma_f32_16x16x32_bf16 v[56:59], a[60:63], v[152:155], v[56:59]
  ds_read2st64_b64 v[136:139], v10 offset0:12 offset1:13
  v_mfma_f32_16x16x32_bf16 v[60:63], a[64:67], v[152:155], v[60:63]
  v_mfma_f32_16x16x32_bf16 v[64:67], a[68:71], v[152:155], v[64:67]
  v_mfma_f32_16x16x32_bf16 v[68:71], a[60:63], v[156:159], v[68:71]
  ds_read2st64_b64 v[140:143], v11 offset0:12 offset1:13
  v_mfma_f32_16x16x32_bf16 v[72:75], a[64:67], v[156:159], v[72:75]
  v_mfma_f32_16x16x32_bf16 v[76:79], a[68:71], v[156:159], v[76:79]
  s_waitcnt vmcnt(33)
  s_barrier
  s_waitcnt lgkmcnt(0)
  v_mfma_f32_16x16x32_bf16 v[32:35], a[72:75], v[128:131], v[32:35]
  ds_read2st64_b64 v[144:147], v8 offset0:14 offset1:15
  buffer_load_dwordx4 v2, s[44:47], s10 offen offset:3072 sc1 lds
  v_mfma_f32_16x16x32_bf16 v[36:39], a[76:79], v[128:131], v[36:39]
  buffer_load_dwordx4 a[228:231], v2, s[48:51], s11 offen offset:1024 sc1
  buffer_load_dwordx4 a[232:235], v2, s[48:51], s11 offen offset:2048 sc1
  v_mfma_f32_16x16x32_bf16 v[40:43], a[80:83], v[128:131], v[40:43]
  v_mfma_f32_16x16x32_bf16 v[44:47], a[72:75], v[132:135], v[44:47]
  ds_read2st64_b64 v[148:151], v9 offset0:14 offset1:15
  v_mfma_f32_16x16x32_bf16 v[48:51], a[76:79], v[132:135], v[48:51]
  v_mfma_f32_16x16x32_bf16 v[52:55], a[80:83], v[132:135], v[52:55]
  v_mfma_f32_16x16x32_bf16 v[56:59], a[72:75], v[136:139], v[56:59]
  ds_read2st64_b64 v[152:155], v10 offset0:14 offset1:15
  v_mfma_f32_16x16x32_bf16 v[60:63], a[76:79], v[136:139], v[60:63]
  v_mfma_f32_16x16x32_bf16 v[64:67], a[80:83], v[136:139], v[64:67]
  v_mfma_f32_16x16x32_bf16 v[68:71], a[72:75], v[140:143], v[68:71]
  ds_read2st64_b64 v[156:159], v11 offset0:14 offset1:15
  v_mfma_f32_16x16x32_bf16 v[72:75], a[76:79], v[140:143], v[72:75]
  v_mfma_f32_16x16x32_bf16 v[76:79], a[80:83], v[140:143], v[76:79]
  buffer_load_dwordx2 v[180:181], v189, s[92:95], s12 offen sc1
  s_waitcnt vmcnt(36)
  s_barrier
  s_waitcnt lgkmcnt(0)
  v_mfma_f32_16x16x32_bf16 v[32:35], a[84:87], v[144:147], v[32:35]
  ds_read2st64_b64 v[128:131], v8 offset0:16 offset1:17
  buffer_load_dwordx4 a[236:239], v2, s[48:51], s11 offen offset:3072 sc1
  v_mfma_f32_16x16x32_bf16 v[36:39], a[88:91], v[144:147], v[36:39]
  buffer_load_dwordx4 v[228:231], v2, s[52:55], s17 offen sc1
  v_mfma_f32_16x16x32_bf16 v[40:43], a[92:95], v[144:147], v[40:43]
  v_mfma_f32_16x16x32_bf16 v[44:47], a[84:87], v[148:151], v[44:47]
  ds_read2st64_b64 v[132:135], v9 offset0:16 offset1:17
  v_mfma_f32_16x16x32_bf16 v[48:51], a[88:91], v[148:151], v[48:51]
  v_mfma_f32_16x16x32_bf16 v[52:55], a[92:95], v[148:151], v[52:55]
  v_mfma_f32_16x16x32_bf16 v[56:59], a[84:87], v[152:155], v[56:59]
  ds_read2st64_b64 v[136:139], v10 offset0:16 offset1:17
  v_mfma_f32_16x16x32_bf16 v[60:63], a[88:91], v[152:155], v[60:63]
  v_mfma_f32_16x16x32_bf16 v[64:67], a[92:95], v[152:155], v[64:67]
  v_mfma_f32_16x16x32_bf16 v[68:71], a[84:87], v[156:159], v[68:71]
  ds_read2st64_b64 v[140:143], v11 offset0:16 offset1:17
  v_mfma_f32_16x16x32_bf16 v[72:75], a[88:91], v[156:159], v[72:75]
  v_mfma_f32_16x16x32_bf16 v[76:79], a[92:95], v[156:159], v[76:79]
  s_waitcnt vmcnt(37)
  s_barrier
  s_waitcnt lgkmcnt(0)
  v_mfma_f32_16x16x32_bf16 v[32:35], a[96:99], v[128:131], v[32:35]
  ds_read2st64_b64 v[144:147], v8 offset0:18 offset1:19
  v_mfma_f32_16x16x32_bf16 v[36:39], a[100:103], v[128:131], v[36:39]
  v_mfma_f32_16x16x32_bf16 v[40:43], a[104:107], v[128:131], v[40:43]
  v_mfma_f32_16x16x32_bf16 v[44:47], a[96:99], v[132:135], v[44:47]
  ds_read2st64_b64 v[148:151], v9 offset0:18 offset1:19
  v_mfma_f32_16x16x32_bf16 v[48:51], a[100:103], v[132:135], v[48:51]
  v_mfma_f32_16x16x32_bf16 v[52:55], a[104:107], v[132:135], v[52:55]
  v_mfma_f32_16x16x32_bf16 v[56:59], a[96:99], v[136:139], v[56:59]
  ds_read2st64_b64 v[152:155], v10 offset0:18 offset1:19
  v_mfma_f32_16x16x32_bf16 v[60:63], a[100:103], v[136:139], v[60:63]
  v_mfma_f32_16x16x32_bf16 v[64:67], a[104:107], v[136:139], v[64:67]
  v_mfma_f32_16x16x32_bf16 v[68:71], a[96:99], v[140:143], v[68:71]
  ds_read2st64_b64 v[156:159], v11 offset0:18 offset1:19
  v_mfma_f32_16x16x32_bf16 v[72:75], a[100:103], v[140:143], v[72:75]
  v_mfma_f32_16x16x32_bf16 v[76:79], a[104:107], v[140:143], v[76:79]
  s_waitcnt vmcnt(36)
  s_barrier
  s_waitcnt lgkmcnt(0)
  v_mfma_f32_16x16x32_bf16 v[32:35], a[108:111], v[144:147], v[32:35]
  ds_read2st64_b64 v[128:131], v8 offset0:20 offset1:21
  v_mfma_f32_16x16x32_bf16 v[36:39], a[112:115], v[144:147], v[36:39]
  v_mfma_f32_16x16x32_bf16 v[40:43], a[116:119], v[144:147], v[40:43]
  v_mfma_f32_16x16x32_bf16 v[44:47], a[108:111], v[148:151], v[44:47]
  ds_read2st64_b64 v[132:135], v9 offset0:20 offset1:21
  v_mfma_f32_16x16x32_bf16 v[48:51], a[112:115], v[148:151], v[48:51]
  v_mfma_f32_16x16x32_bf16 v[52:55], a[116:119], v[148:151], v[52:55]
  v_mfma_f32_16x16x32_bf16 v[56:59], a[108:111], v[152:155], v[56:59]
  ds_read2st64_b64 v[136:139], v10 offset0:20 offset1:21
  v_mfma_f32_16x16x32_bf16 v[60:63], a[112:115], v[152:155], v[60:63]
  v_mfma_f32_16x16x32_bf16 v[64:67], a[116:119], v[152:155], v[64:67]
  v_mfma_f32_16x16x32_bf16 v[68:71], a[108:111], v[156:159], v[68:71]
  ds_read2st64_b64 v[140:143], v11 offset0:20 offset1:21
  v_mfma_f32_16x16x32_bf16 v[72:75], a[112:115], v[156:159], v[72:75]
  v_mfma_f32_16x16x32_bf16 v[76:79], a[116:119], v[156:159], v[76:79]
  s_waitcnt vmcnt(35)
  s_barrier
  s_waitcnt lgkmcnt(0)
  v_mfma_f32_16x16x32_bf16 v[32:35], a[120:123], v[128:131], v[32:35]
  ds_read2st64_b64 v[144:147], v8 offset0:22 offset1:23
  v_mfma_f32_16x16x32_bf16 v[36:39], a[124:127], v[128:131], v[36:39]
  v_mfma_f32_16x16x32_bf16 v[40:43], a[128:131], v[128:131], v[40:43]
  v_mfma_f32_16x16x32_bf16 v[44:47], a[120:123], v[132:135], v[44:47]
  ds_read2st64_b64 v[148:151], v9 offset0:22 offset1:23
  v_mfma_f32_16x16x32_bf16 v[48:51], a[124:127], v[132:135], v[48:51]
  v_mfma_f32_16x16x32_bf16 v[52:55], a[128:131], v[132:135], v[52:55]
  v_mfma_f32_16x16x32_bf16 v[56:59], a[120:123], v[136:139], v[56:59]
  ds_read2st64_b64 v[152:155], v10 offset0:22 offset1:23
  v_mfma_f32_16x16x32_bf16 v[60:63], a[124:127], v[136:139], v[60:63]
  v_mfma_f32_16x16x32_bf16 v[64:67], a[128:131], v[136:139], v[64:67]
  v_mfma_f32_16x16x32_bf16 v[68:71], a[120:123], v[140:143], v[68:71]
  ds_read2st64_b64 v[156:159], v11 offset0:22 offset1:23
  v_mfma_f32_16x16x32_bf16 v[72:75], a[124:127], v[140:143], v[72:75]
  v_mfma_f32_16x16x32_bf16 v[76:79], a[128:131], v[140:143], v[76:79]
  s_waitcnt vmcnt(2)
  s_mov_b32 s35, 0
  s_nop 5
HBW0:
  v_cmp_ne_u64 vcc, s[90:91], v[180:181]
  s_nop 4
  s_cbranch_vccz HBK0
  s_add_u32 s35, s35, 1
  s_cmp_ge_u32 s35, 0x8000
  s_cbranch_scc1 HBK0
  s_sleep 1
  buffer_load_dwordx2 v[180:181], v189, s[92:95], s12 offen sc1
  s_waitcnt vmcnt(0)
  s_branch HBW0
HBK0:
  s_barrier
  s_waitcnt lgkmcnt(0)
  v_mfma_f32_16x16x32_bf16 v[32:35], a[132:135], v[144:147], v[32:35]
  ds_read2st64_b64 v[128:131], v8 offset0:24 offset1:25
  s_add_u32 s21, s21, 77824
  buffer_load_dwordx4 v[192:195], v2, s[44:47], s21 offen offset:0 sc1
  buffer_load_dwordx4 v[196:199], v2, s[44:47], s21 offen offset:1024 sc1
  buffer_load_dwordx4 v[200:203], v2, s[44:47], s21 offen offset:2048 sc1
  buffer_load_dwordx4 v[204:207], v2, s[44:47], s21 offen offset:3072 sc1
  s_add_u32 s21, s21, 4096
  buffer_load_dwordx4 v[208:211], v2, s[44:47], s21 offen offset:0 sc1
  v_mfma_f32_16x16x32_bf16 v[36:39], a[136:139], v[144:147], v[36:39]
  s_add_u32 m0, s6, 81920
  s_add_u32 s10, s7, 81920
  buffer_load_dwordx4 v2, s[44:47], s10 offen offset:0 sc1 lds
  buffer_load_dwordx4 v2, s[44:47], s10 offen offset:1024 sc1 lds
  v_mfma_f32_16x16x32_bf16 v[40:43], a[140:143], v[144:147], v[40:43]
  v_mfma_f32_16x16x32_bf16 v[44:47], a[132:135], v[148:151], v[44:47]
  ds_read2st64_b64 v[132:135], v9 offset0:24 offset1:25
  v_mfma_f32_16x16x32_bf16 v[48:51], a[136:139], v[148:151], v[48:51]
  v_mfma_f32_16x16x32_bf16 v[52:55], a[140:143], v[148:151], v[52:55]
  v_mfma_f32_16x16x32_bf16 v[56:59], a[132:135], v[152:155], v[56:59]
  ds_read2st64_b64 v[136:139], v10 offset0:24 offset1:25
  v_mfma_f32_16x16x32_bf16 v[60:63], a[136:139], v[152:155], v[60:63]
  v_mfma_f32_16x16x32_bf16 v[64:67], a[140:143], v[152:155], v[64:67]
  v_mfma_f32_16x16x32_bf16 v[68:71], a[132:135], v[156:159], v[68:71]
  ds_read2st64_b64 v[140:143], v11 offset0:24 offset1:25
  v_mfma_f32_16x16x32_bf16 v[72:75], a[136:139], v[156:159], v[72:75]
  v_mfma_f32_16x16x32_bf16 v[76:79], a[140:143], v[156:159], v[76:79]
  s_barrier
  s_waitcnt lgkmcnt(0)
  v_mfma_f32_16x16x32_bf16 v[32:35], a[144:147], v[128:131], v[32:35]
  ds_read2st64_b64 v[144:147], v8 offset0:26 offset1:27
  buffer_load_dwordx4 v2, s[44:47], s10 offen offset:2048 sc1 lds
  v_mfma_f32_16x16x32_bf16 v[36:39], a[148:151], v[128:131], v[36:39]
  buffer_load_dwordx4 v2, s[44:47], s10 offen offset:3072 sc1 lds
  s_add_u32 m0, s6, 86016
  s_add_u32 s10, s7, 86016
  buffer_load_dwordx4 v2, s[44:47], s10 offen offset:0 sc1 lds
  v_mfma_f32_16x16x32_bf16 v[40:43], a[152:155], v[128:131], v[40:43]
  v_mfma_f32_16x16x32_bf16 v[44:47], a[144:147], v[132:135], v[44:47]
  ds_read2st64_b64 v[148:151], v9 offset0:26 offset1:27
  v_mfma_f32_16x16x32_bf16 v[48:51], a[148:151], v[132:135], v[48:51]
  v_mfma_f32_16x16x32_bf16 v[52:55], a[152:155], v[132:135], v[52:55]
  v_mfma_f32_16x16x32_bf16 v[56:59], a[144:147], v[136:139], v[56:59]
  ds_read2st64_b64 v[152:155], v10 offset0:26 offset1:27
  v_mfma_f32_16x16x32_bf16 v[60:63], a[148:151], v[136:139], v[60:63]
  v_mfma_f32_16x16x32_bf16 v[64:67], a[152:155], v[136:139], v[64:67]
  v_mfma_f32_16x16x32_bf16 v[68:71], a[144:147], v[140:143], v[68:71]
  ds_read2st64_b64 v[156:159], v11 offset0:26 offset1:27
  v_mfma_f32_16x16x32_bf16 v[72:75], a[148:151], v[140:143], v[72:75]
  v_mfma_f32_16x16x32_bf16 v[76:79], a[152:155], v[140:143], v[76:79]
  buffer_load_dwordx2 v[190:191], v188, s[92:95], s37 offen sc1
  s_barrier
  s_waitcnt lgkmcnt(0)
  v_mfma_f32_16x16x32_bf16 v[32:35], a[156:159], v[144:147], v[32:35]
  ds_read2st64_b64 v[128:131], v8 offset0:28 offset1:29
  buffer_load_dwordx4 v2, s[44:47], s10 offen offset:1024 sc1 lds
  v_mfma_f32_16x16x32_bf16 v[36:39], a[160:163], v[144:147], v[36:39]
  buffer_load_dwordx4 v2, s[44:47], s10 offen offset:2048 sc1 lds
  buffer_load_dwordx4 v2, s[44:47], s10 offen offset:3072 sc1 lds
  v_mfma_f32_16x16x32_bf16 v[40:43], a[164:167], v[144:147], v[40:43]
  v_mfma_f32_16x16x32_bf16 v[44:47], a[156:159], v[148:151], v[44:47]
  ds_read2st64_b64 v[132:135], v9 offset0:28 offset1:29
  v_mfma_f32_16x16x32_bf16 v[48:51], a[160:163], v[148:151], v[48:51]
  v_mfma_f32_16x16x32_bf16 v[52:55], a[164:167], v[148:151], v[52:55]
  v_mfma_f32_16x16x32_bf16 v[56:59], a[156:159], v[152:155], v[56:59]
  ds_read2st64_b64 v[136:139], v10 offset0:28 offset1:29
  v_mfma_f32_16x16x32_bf16 v[60:63], a[160:163], v[152:155], v[60:63]
  v_mfma_f32_16x16x32_bf16 v[64:67], a[164:167], v[152:155], v[64:67]
  v_mfma_f32_16x16x32_bf16 v[68:71], a[156:159], v[156:159], v[68:71]
  ds_read2st64_b64 v[140:143], v11 offset0:28 offset1:29
  v_mfma_f32_16x16x32_bf16 v[72:75], a[160:163], v[156:159], v[72:75]
  v_mfma_f32_16x16x32_bf16 v[76:79], a[164:167], v[156:159], v[76:79]
  s_barrier
  s_waitcnt lgkmcnt(0)
  v_mfma_f32_16x16x32_bf16 v[32:35], a[168:171], v[128:131], v[32:35]
  ds_read2st64_b64 v[144:147], v8 offset0:30 offset1:31
  v_mfma_f32_16x16x32_bf16 v[36:39], a[172:175], v[128:131], v[36:39]
  v_mfma_f32_16x16x32_bf16 v[40:43], a[176:179], v[128:131], v[40:43]
  v_mfma_f32_16x16x32_bf16 v[44:47], a[168:171], v[132:135], v[44:47]
  ds_read2st64_b64 v[148:151], v9 offset0:30 offset1:31
  v_mfma_f32_16x16x32_bf16 v[48:51], a[172:175], v[132:135], v[48:51]
  v_mfma_f32_16x16x32_bf16 v[52:55], a[176:179], v[132:135], v[52:55]
  v_mfma_f32_16x16x32_bf16 v[56:59], a[168:171], v[136:139], v[56:59]
  ds_read2st64_b64 v[152:155], v10 offset0:30 offset1:31
  v_mfma_f32_16x16x32_bf16 v[60:63], a[172:175], v[136:139], v[60:63]
  v_mfma_f32_16x16x32_bf16 v[64:67], a[176:179], v[136:139], v[64:67]
  v_mfma_f32_16x16x32_bf16 v[68:71], a[168:171], v[140:143], v[68:71]
  ds_read2st64_b64 v[156:159], v11 offset0:30 offset1:31
  v_mfma_f32_16x16x32_bf16 v[72:75], a[172:175], v[140:143], v[72:75]
  v_mfma_f32_16x16x32_bf16 v[76:79], a[176:179], v[140:143], v[76:79]
  s_barrier
  s_waitcnt lgkmcnt(0)
  v_mfma_f32_16x16x32_bf16 v[32:35], a[180:183], v[144:147], v[32:35]
  ds_read2st64_b64 v[128:131], v8 offset0:32 offset1:33
  v_mfma_f32_16x16x32_bf16 v[36:39], a[184:187], v[144:147], v[36:39]
  v_mfma_f32_16x16x32_bf16 v[40:43], a[188:191], v[144:147], v[40:43]
  v_mfma_f32_16x16x32_bf16 v[44:47], a[180:183], v[148:151], v[44:47]
  ds_read2st64_b64 v[132:135], v9 offset0:32 offset1:33
  v_mfma_f32_16x16x32_bf16 v[48:51], a[184:187], v[148:151], v[48:51]
  v_mfma_f32_16x16x32_bf16 v[52:55], a[188:191], v[148:151], v[52:55]
  v_mfma_f32_16x16x32_bf16 v[56:59], a[180:183], v[152:155], v[56:59]
  ds_read2st64_b64 v[136:139], v10 offset0:32 offset1:33
  v_mfma_f32_16x16x32_bf16 v[60:63], a[184:187], v[152:155], v[60:63]
  v_mfma_f32_16x16x32_bf16 v[64:67], a[188:191], v[152:155], v[64:67]
  v_mfma_f32_16x16x32_bf16 v[68:71], a[180:183], v[156:159], v[68:71]
  ds_read2st64_b64 v[140:143], v11 offset0:32 offset1:33
  v_mfma_f32_16x16x32_bf16 v[72:75], a[184:187], v[156:159], v[72:75]
  v_mfma_f32_16x16x32_bf16 v[76:79], a[188:191], v[156:159], v[76:79]
  s_barrier
  s_waitcnt lgkmcnt(0)
  v_mfma_f32_16x16x32_bf16 v[32:35], a[192:195], v[128:131], v[32:35]
  ds_read2st64_b64 v[144:147], v8 offset0:34 offset1:35
  v_mfma_f32_16x16x32_bf16 v[36:39], a[196:199], v[128:131], v[36:39]
  v_mfma_f32_16x16x32_bf16 v[40:43], a[200:203], v[128:131], v[40:43]
  v_mfma_f32_16x16x32_bf16 v[44:47], a[192:195], v[132:135], v[44:47]
  ds_read2st64_b64 v[148:151], v9 offset0:34 offset1:35
  v_mfma_f32_16x16x32_bf16 v[48:51], a[196:199], v[132:135], v[48:51]
  v_mfma_f32_16x16x32_bf16 v[52:55], a[200:203], v[132:135], v[52:55]
  v_mfma_f32_16x16x32_bf16 v[56:59], a[192:195], v[136:139], v[56:59]
  ds_read2st64_b64 v[152:155], v10 offset0:34 offset1:35
  v_mfma_f32_16x16x32_bf16 v[60:63], a[196:199], v[136:139], v[60:63]
  v_mfma_f32_16x16x32_bf16 v[64:67], a[200:203], v[136:139], v[64:67]
  v_mfma_f32_16x16x32_bf16 v[68:71], a[192:195], v[140:143], v[68:71]
  ds_read2st64_b64 v[156:159], v11 offset0:34 offset1:35
  v_mfma_f32_16x16x32_bf16 v[72:75], a[196:199], v[140:143], v[72:75]
  v_mfma_f32_16x16x32_bf16 v[76:79], a[200:203], v[140:143], v[76:79]
  s_waitcnt vmcnt(9)
  v_dot2_f32_bf16 v252, v192, s16, 0
  v_dot2_f32_bf16 v253, v192, v192, 0
  v_dot2_f32_bf16 v252, v193, s16, v252
  v_dot2_f32_bf16 v253, v193, v193, v253
  v_dot2_f32_bf16 v254, v194, s16, 0
  v_dot2_f32_bf16 v255, v194, v194, 0
  v_dot2_f32_bf16 v254, v195, s16, v254
  v_dot2_f32_bf16 v255, v195, v195, v255
  v_dot2_f32_bf16 v252, v196, s16, v252
  v_dot2_f32_bf16 v253, v196, v196, v253
  v_dot2_f32_bf16 v252, v197, s16, v252
  v_dot2_f32_bf16 v253, v197, v197, v253
  v_dot2_f32_bf16 v254, v198, s16, v254
  v_dot2_f32_bf16 v255, v198, v198, v255
  v_dot2_f32_bf16 v254, v199, s16, v254
  v_dot2_f32_bf16 v255, v199, v199, v255
  v_dot2_f32_bf16 v252, v200, s16, v252
  v_dot2_f32_bf16 v253, v200, v200, v253
  v_dot2_f32_bf16 v252, v201, s16, v252
  v_dot2_f32_bf16 v253, v201, v201, v253
  v_dot2_f32_bf16 v254, v202, s16, v254
  v_dot2_f32_bf16 v255, v202, v202, v255
  v_dot2_f32_bf16 v254, v203, s16, v254
  v_dot2_f32_bf16 v255, v203, v203, v255
  v_dot2_f32_bf16 v252, v204, s16, v252
  v_dot2_f32_bf16 v253, v204, v204, v253
  v_dot2_f32_bf16 v252, v205, s16, v252
  v_dot2_f32_bf16 v253, v205, v205, v253
  v_dot2_f32_bf16 v254, v206, s16, v254
  v_dot2_f32_bf16 v255, v206, v206, v255
  v_dot2_f32_bf16 v254, v207, s16, v254
  v_dot2_f32_bf16 v255, v207, v207, v255
  v_dot2_f32_bf16 v252, v208, s16, v252
  v_dot2_f32_bf16 v253, v208, v208, v253
  v_dot2_f32_bf16 v252, v209, s16, v252
  v_dot2_f32_bf16 v253, v209, v209, v253
  v_dot2_f32_bf16 v254, v210, s16, v254
  v_dot2_f32_bf16 v255, v210, v210, v255
  v_dot2_f32_bf16 v254, v211, s16, v254
  v_dot2_f32_bf16 v255, v211, v211, v255
  v_mov_b32 v192, v252
  v_mov_b32 v193, v253
  v_mov_b32 v194, v254
  v_mov_b32 v195, v255
  v_permlane32_swap_b32 v252, v192
  v_permlane32_swap_b32 v253, v193
  v_permlane32_swap_b32 v254, v194
  v_permlane32_swap_b32 v255, v195
  v_pk_add_f32 v[252:253], v[252:253], v[192:193]
  v_pk_add_f32 v[254:255], v[254:255], v[194:195]
  v_mov_b32 v192, v252
  v_mov_b32 v193, v253
  v_mov_b32 v194, v254
  v_mov_b32 v195, v255
  v_permlane16_swap_b32 v252, v192
  v_permlane16_swap_b32 v253, v193
  v_permlane16_swap_b32 v254, v194
  v_permlane16_swap_b32 v255, v195
  v_pk_add_f32 v[252:253], v[252:253], v[192:193]
  v_pk_add_f32 v[254:255], v[254:255], v[194:195]
  s_nop 0
  v_add_f32_dpp v252, v252, v252 row_ror:8 row_mask:0xf bank_mask:0xf
  v_add_f32_dpp v253, v253, v253 row_ror:8 row_mask:0xf bank_mask:0xf
  v_add_f32_dpp v254, v254, v254 row_ror:8 row_mask:0xf bank_mask:0xf
  v_add_f32_dpp v255, v255, v255 row_ror:8 row_mask:0xf bank_mask:0xf
  v_add_u32 v6, 6144, v182
  v_add_u32 v6, s27, v6
  ds_write_b128 v6, v[252:255]
  s_waitcnt lgkmcnt(0)
  s_barrier
  v_mfma_f32_16x16x32_bf16 v[32:35], a[204:207], v[144:147], v[32:35]
  ds_read2st64_b64 v[128:131], v8 offset0:36 offset1:37
  v_mfma_f32_16x16x32_bf16 v[36:39], a[208:211], v[144:147], v[36:39]
  v_mfma_f32_16x16x32_bf16 v[40:43], a[212:215], v[144:147], v[40:43]
  v_mfma_f32_16x16x32_bf16 v[44:47], a[204:207], v[148:151], v[44:47]
  ds_read2st64_b64 v[132:135], v9 offset0:36 offset1:37
  v_mfma_f32_16x16x32_bf16 v[48:51], a[208:211], v[148:151], v[48:51]
  v_mfma_f32_16x16x32_bf16 v[52:55], a[212:215], v[148:151], v[52:55]
  v_mfma_f32_16x16x32_bf16 v[56:59], a[204:207], v[152:155], v[56:59]
  ds_read2st64_b64 v[136:139], v10 offset0:36 offset1:37
  v_mfma_f32_16x16x32_bf16 v[60:63], a[208:211], v[152:155], v[60:63]
  v_mfma_f32_16x16x32_bf16 v[64:67], a[212:215], v[152:155], v[64:67]
  v_mfma_f32_16x16x32_bf16 v[68:71], a[204:207], v[156:159], v[68:71]
  ds_read2st64_b64 v[140:143], v11 offset0:36 offset1:37
  v_mfma_f32_16x16x32_bf16 v[72:75], a[208:211], v[156:159], v[72:75]
  v_mfma_f32_16x16x32_bf16 v[76:79], a[212:215], v[156:159], v[76:79]
  s_barrier
  s_waitcnt lgkmcnt(0)
  v_mfma_f32_16x16x32_bf16 v[32:35], a[216:219], v[128:131], v[32:35]
  ds_read2st64_b64 v[144:147], v8 offset0:38 offset1:39
  buffer_load_dwordx2 v[176:177], v186, s[72:75], s24 offen offset:0 sc1
  v_mfma_f32_16x16x32_bf16 v[36:39], a[220:223], v[128:131], v[36:39]
  s_add_u32 m0, s6, 90112
  s_add_u32 s10, s7, 90112
  buffer_load_dwordx4 v2, s[44:47], s10 offen offset:0 sc1 lds
  v_mfma_f32_16x16x32_bf16 v[40:43], a[224:227], v[128:131], v[40:43]
  v_mfma_f32_16x16x32_bf16 v[44:47], a[216:219], v[132:135], v[44:47]
  ds_read2st64_b64 v[148:151], v9 offset0:38 offset1:39
  v_mfma_f32_16x16x32_bf16 v[48:51], a[220:223], v[132:135], v[48:51]
  v_add_u32 v7, 6144, v5
  v_add_u32 v7, s27, v7
  v_mfma_f32_16x16x32_bf16 v[52:55], a[224:227], v[132:135], v[52:55]
  ds_read_b64 v[240:241], v7 offset:0
  ds_read_b64 v[242:243], v7 offset:128
  v_mfma_f32_16x16x32_bf16 v[56:59], a[216:219], v[136:139], v[56:59]
  ds_read2st64_b64 v[152:155], v10 offset0:38 offset1:39
  v_mfma_f32_16x16x32_bf16 v[60:63], a[220:223], v[136:139], v[60:63]
  ds_read_b64 v[244:245], v7 offset:256
  ds_read_b64 v[246:247], v7 offset:384
  v_mfma_f32_16x16x32_bf16 v[64:67], a[224:227], v[136:139], v[64:67]
  v_mov_b32 v248, 0x3acccccd
  s_lshr_b32 s13, s18, 2
  v_mfma_f32_16x16x32_bf16 v[68:71], a[216:219], v[140:143], v[68:71]
  ds_read2st64_b64 v[156:159], v11 offset0:38 offset1:39
  v_mfma_f32_16x16x32_bf16 v[72:75], a[220:223], v[140:143], v[72:75]
  s_lshl_b32 s13, s13, 1
  s_add_u32 s13, s13, s19
  v_mfma_f32_16x16x32_bf16 v[76:79], a[224:227], v[140:143], v[76:79]
  s_lshl_b32 s13, s13, 2
  s_lshl_b64 s[32:33], 15, s13
  s_waitcnt vmcnt(5)
  s_mov_b32 s35, 0
  s_nop 3
W2W0:
  v_cmp_ne_u64 vcc, s[90:91], v[190:191]
  s_nop 4
  s_cbranch_vccz W2K0
  s_add_u32 s35, s35, 1
  s_cmp_ge_u32 s35, 0x8000
  s_cbranch_scc1 W2K0
  s_sleep 2
  buffer_load_dwordx2 v[190:191], v188, s[92:95], s37 offen sc1
  s_waitcnt vmcnt(0)
  s_branch W2W0
W2K0:
  s_barrier
  s_waitcnt lgkmcnt(0)
  v_mfma_f32_16x16x32_bf16 v[32:35], a[228:231], v[144:147], v[32:35]
  ds_read2st64_b64 v[128:131], v12 offset0:0 offset1:1
  v_mfma_f32_16x16x32_bf16 v[36:39], a[232:235], v[144:147], v[36:39]
  v_mfma_f32_16x16x32_bf16 v[40:43], a[236:239], v[144:147], v[40:43]
  v_mfma_f32_16x16x32_bf16 v[44:47], a[228:231], v[148:151], v[44:47]
  ds_read2st64_b64 v[132:135], v13 offset0:0 offset1:1
  v_mfma_f32_16x16x32_bf16 v[48:51], a[232:235], v[148:151], v[48:51]
  s_lshl_b32 s13, s4, 3
  s_and_b32 s14, s18, 3
  v_mfma_f32_16x16x32_bf16 v[52:55], a[236:239], v[148:151], v[52:55]
  s_add_u32 s13, s13, s14
  s_add_u32 s13, s13, 4
  v_mfma_f32_16x16x32_bf16 v[56:59], a[228:231], v[152:155], v[56:59]
  ds_read2st64_b64 v[136:139], v14 offset0:0 offset1:1
  v_mfma_f32_16x16x32_bf16 v[60:63], a[232:235], v[152:155], v[60:63]
  s_lshl_b32 s34, s13, 7
  v_mfma_f32_16x16x32_bf16 v[64:67], a[236:239], v[152:155], v[64:67]
  v_add_f32 v240, v240, v242
  v_add_f32 v241, v241, v243
  v_mfma_f32_16x16x32_bf16 v[68:71], a[228:231], v[156:159], v[68:71]
  ds_read2st64_b64 v[140:143], v15 offset0:0 offset1:1
  v_mfma_f32_16x16x32_bf16 v[72:75], a[232:235], v[156:159], v[72:75]
  v_add_f32 v244, v244, v246
  v_add_f32 v245, v245, v247
  v_mfma_f32_16x16x32_bf16 v[76:79], a[236:239], v[156:159], v[76:79]
  v_add_f32 v240, v240, v244
  v_add_f32 v241, v241, v245
  v_mul_f32 v240, v240, v248
  v_mul_f32 v241, v241, v248
  v_fma_f32 v241, -v240, v240, v241
  v_max_f32 v241, 0, v241
  v_cvt_pk_bf16_f32 v242, v240, v241
  v_lshlrev_b32 v240, 16, v242
  v_and_b32 v241, 0xffff0000, v242
  v_add_f32 v241, 0x3727c5ac, v241
  v_cvt_pk_bf16_f32 v241, v241, v241
  v_lshlrev_b32 v241, 16, v241
  v_sqrt_f32 v241, v241
  s_nop 0
  v_cvt_pk_bf16_f32 v241, v241, v241
  v_lshlrev_b32 v241, 16, v241
  s_mov_b64 exec, s[32:33]
  buffer_store_dwordx2 v[240:241], v5, s[72:75], s34 offen sc1
  s_mov_b64 exec, -1
  s_barrier
  s_waitcnt lgkmcnt(0)
  v_mfma_f32_16x16x32_bf16 v[80:83], a[0:3], v[128:131], 0
  ds_read2st64_b64 v[144:147], v12 offset0:2 offset1:3
  v_mfma_f32_16x16x32_bf16 v[84:87], a[4:7], v[128:131], 0
  v_mfma_f32_16x16x32_bf16 v[88:91], a[8:11], v[128:131], 0
  v_mfma_f32_16x16x32_bf16 v[92:95], a[0:3], v[132:135], 0
  ds_read2st64_b64 v[148:151], v13 offset0:2 offset1:3
  v_mfma_f32_16x16x32_bf16 v[96:99], a[4:7], v[132:135], 0
  v_mfma_f32_16x16x32_bf16 v[100:103], a[8:11], v[132:135], 0
  v_mfma_f32_16x16x32_bf16 v[104:107], a[0:3], v[136:139], 0
  ds_read2st64_b64 v[152:155], v14 offset0:2 offset1:3
  v_mfma_f32_16x16x32_bf16 v[108:111], a[4:7], v[136:139], 0
  v_mfma_f32_16x16x32_bf16 v[112:115], a[8:11], v[136:139], 0
  v_mfma_f32_16x16x32_bf16 v[116:119], a[0:3], v[140:143], 0
  ds_read2st64_b64 v[156:159], v15 offset0:2 offset1:3
  v_mfma_f32_16x16x32_bf16 v[120:123], a[4:7], v[140:143], 0
  v_mfma_f32_16x16x32_bf16 v[124:127], a[8:11], v[140:143], 0
  s_barrier
  s_waitcnt lgkmcnt(0)
  v_mfma_f32_16x16x32_bf16 v[80:83], a[12:15], v[144:147], v[80:83]
  ds_read2st64_b64 v[128:131], v12 offset0:4 offset1:5
  s_add_u32 s11, s22, 0
  buffer_load_dwordx4 a[0:3], v2, s[68:71], s11 offen offset:0 sc1
  v_mfma_f32_16x16x32_bf16 v[84:87], a[16:19], v[144:147], v[84:87]
  buffer_load_dwordx4 a[4:7], v2, s[68:71], s11 offen offset:1024 sc1
  v_mfma_f32_16x16x32_bf16 v[88:91], a[20:23], v[144:147], v[88:91]
  buffer_load_dwordx4 a[8:11], v2, s[68:71], s11 offen offset:2048 sc1
  buffer_load_dwordx4 v2, s[44:47], s10 offen offset:1024 sc1 lds
  v_mfma_f32_16x16x32_bf16 v[92:95], a[12:15], v[148:151], v[92:95]
  ds_read2st64_b64 v[132:135], v13 offset0:4 offset1:5
  v_mfma_f32_16x16x32_bf16 v[96:99], a[16:19], v[148:151], v[96:99]
  v_mfma_f32_16x16x32_bf16 v[100:103], a[20:23], v[148:151], v[100:103]
  v_mfma_f32_16x16x32_bf16 v[104:107], a[12:15], v[152:155], v[104:107]
  ds_read2st64_b64 v[136:139], v14 offset0:4 offset1:5
  v_mfma_f32_16x16x32_bf16 v[108:111], a[16:19], v[152:155], v[108:111]
  v_mfma_f32_16x16x32_bf16 v[112:115], a[20:23], v[152:155], v[112:115]
  v_mfma_f32_16x16x32_bf16 v[116:119], a[12:15], v[156:159], v[116:119]
  ds_read2st64_b64 v[140:143], v15 offset0:4 offset1:5
  v_mfma_f32_16x16x32_bf16 v[120:123], a[16:19], v[156:159], v[120:123]
  v_mfma_f32_16x16x32_bf16 v[124:127], a[20:23], v[156:159], v[124:127]
  s_mov_b32 s35, 0
  s_nop 6
K3_STCHK00:
  s_waitcnt vmcnt(6)
  v_cmp_eq_u32 vcc, 0, v177
  s_nop 4
  s_cbranch_vccz K3_STOK00
  s_add_u32 s35, s35, 1
  s_cmp_ge_u32 s35, 0x4000
  s_cbranch_scc1 K3_STOK00
  s_sleep 2
  buffer_load_dwordx2 v[176:177], v186, s[72:75], s24 offen offset:0 sc1
  s_waitcnt vmcnt(0)
  s_branch K3_STCHK00
K3_STOK00:
  s_barrier
  s_waitcnt lgkmcnt(0)
  v_mfma_f32_16x16x32_bf16 v[80:83], a[24:27], v[128:131], v[80:83]
  ds_read2st64_b64 v[144:147], v12 offset0:6 offset1:7
  buffer_load_dwordx4 a[12:15], v2, s[68:71], s11 offen offset:3072 sc1
  v_mfma_f32_16x16x32_bf16 v[84:87], a[28:31], v[128:131], v[84:87]
  s_add_u32 s11, s22, 4096
  buffer_load_dwordx4 a[16:19], v2, s[68:71], s11 offen offset:0 sc1
  v_mfma_f32_16x16x32_bf16 v[88:91], a[32:35], v[128:131], v[88:91]
  buffer_load_dwordx4 a[20:23], v2, s[68:71], s11 offen offset:1024 sc1
  buffer_load_dwordx4 v2, s[44:47], s10 offen offset:2048 sc1 lds
  v_mfma_f32_16x16x32_bf16 v[92:95], a[24:27], v[132:135], v[92:95]
  ds_read2st64_b64 v[148:151], v13 offset0:6 offset1:7
  ds_write_b64 v183, v[176:177] offset:4096
  v_mov_b32 v232, v228
  v_mfma_f32_16x16x32_bf16 v[96:99], a[28:31], v[132:135], v[96:99]
  v_mov_b32 v233, v229
  v_mov_b32 v234, v230
  v_mov_b32 v235, v231
  v_mfma_f32_16x16x32_bf16 v[100:103], a[32:35], v[132:135], v[100:103]
  v_permlane32_swap_b32 v228, v232
  v_permlane32_swap_b32 v229, v233
  v_permlane32_swap_b32 v230, v234
  v_mfma_f32_16x16x32_bf16 v[104:107], a[24:27], v[136:139], v[104:107]
  ds_read2st64_b64 v[152:155], v14 offset0:6 offset1:7
  v_permlane32_swap_b32 v231, v235
  v_add_f32 v228, v228, v232
  v_mfma_f32_16x16x32_bf16 v[108:111], a[28:31], v[136:139], v[108:111]
  v_add_f32 v229, v229, v233
  v_add_f32 v230, v230, v234
  v_add_f32 v231, v231, v235
  v_mfma_f32_16x16x32_bf16 v[112:115], a[32:35], v[136:139], v[112:115]
  v_mov_b32 v232, v228
  v_mov_b32 v233, v229
  v_mov_b32 v234, v230
  v_mfma_f32_16x16x32_bf16 v[116:119], a[24:27], v[140:143], v[116:119]
  ds_read2st64_b64 v[156:159], v15 offset0:6 offset1:7
  v_mov_b32 v235, v231
  v_permlane16_swap_b32 v228, v232
  v_mfma_f32_16x16x32_bf16 v[120:123], a[28:31], v[140:143], v[120:123]
  v_permlane16_swap_b32 v229, v233
  v_permlane16_swap_b32 v230, v234
  v_permlane16_swap_b32 v231, v235
  v_mfma_f32_16x16x32_bf16 v[124:127], a[32:35], v[140:143], v[124:127]
  v_add_f32 v228, v228, v232
  v_add_f32 v229, v229, v233
  v_add_f32 v230, v230, v234
  s_barrier
  s_waitcnt lgkmcnt(0)
  v_mfma_f32_16x16x32_bf16 v[80:83], a[36:39], v[144:147], v[80:83]
  ds_read2st64_b64 v[128:131], v12 offset0:8 offset1:9
  buffer_load_dwordx4 a[24:27], v2, s[68:71], s11 offen offset:2048 sc1
  v_mfma_f32_16x16x32_bf16 v[84:87], a[40:43], v[144:147], v[84:87]
  buffer_load_dwordx4 a[28:31], v2, s[68:71], s11 offen offset:3072 sc1
  v_mfma_f32_16x16x32_bf16 v[88:91], a[44:47], v[144:147], v[88:91]
  s_add_u32 s11, s22, 8192
  buffer_load_dwordx4 a[32:35], v2, s[68:71], s11 offen offset:0 sc1
  buffer_load_dwordx4 v2, s[44:47], s10 offen offset:3072 sc1 lds
  v_mfma_f32_16x16x32_bf16 v[92:95], a[36:39], v[148:151], v[92:95]
  ds_read2st64_b64 v[132:135], v13 offset0:8 offset1:9
  v_add_f32 v231, v231, v235
  ds_write_b128 v185, v[228:231] offset:5120
  v_mfma_f32_16x16x32_bf16 v[96:99], a[40:43], v[148:151], v[96:99]
  ds_read_b64 v[192:193], v184 offset:4096
  ds_read_b64 v[196:197], v184 offset:4224
  ds_read_b64 v[200:201], v184 offset:4352
  v_mfma_f32_16x16x32_bf16 v[100:103], a[44:47], v[148:151], v[100:103]
  ds_read_b64 v[204:205], v184 offset:4480
  ds_read2_b64 v[16:19], v187 offset0:0 offset1:2
  ds_read2_b64 v[20:23], v187 offset0:8 offset1:10
  v_mfma_f32_16x16x32_bf16 v[104:107], a[36:39], v[152:155], v[104:107]
  ds_read2st64_b64 v[136:139], v14 offset0:8 offset1:9
  ds_read2_b64 v[24:27], v187 offset0:16 offset1:18
  v_mov_b32 v181, v30
  v_mfma_f32_16x16x32_bf16 v[108:111], a[40:43], v[152:155], v[108:111]
  v_mov_b32 v28, 1
  v_mov_b32 v29, 0
  v_mov_b32 v4, 0xbfb8aa3b
  v_mfma_f32_16x16x32_bf16 v[112:115], a[44:47], v[152:155], v[112:115]
  s_waitcnt lgkmcnt(0)
  v_rcp_f32 v194, v193
  v_rcp_f32 v198, v197
  v_mfma_f32_16x16x32_bf16 v[116:119], a[36:39], v[156:159], v[116:119]
  ds_read2st64_b64 v[140:143], v15 offset0:8 offset1:9
  v_rcp_f32 v202, v201
  v_rcp_f32 v206, v205
  v_mfma_f32_16x16x32_bf16 v[120:123], a[40:43], v[156:159], v[120:123]
  v_mul_f32 v193, v193, v193
  v_mul_f32 v197, v197, v197
  v_mul_f32 v201, v201, v201
  v_mfma_f32_16x16x32_bf16 v[124:127], a[44:47], v[156:159], v[124:127]
  v_mul_f32 v205, v205, v205
  v_mul_f32 v194, v194, v4
  v_mul_f32 v198, v198, v4
  s_barrier
  s_waitcnt lgkmcnt(0)
  v_mfma_f32_16x16x32_bf16 v[80:83], a[48:51], v[128:131], v[80:83]
  ds_read2st64_b64 v[144:147], v12 offset0:10 offset1:11
  buffer_load_dwordx4 a[36:39], v2, s[68:71], s11 offen offset:1024 sc1
  v_mfma_f32_16x16x32_bf16 v[84:87], a[52:55], v[128:131], v[84:87]
  buffer_load_dwordx4 a[40:43], v2, s[68:71], s11 offen offset:2048 sc1
  v_mfma_f32_16x16x32_bf16 v[88:91], a[56:59], v[128:131], v[88:91]
  buffer_load_dwordx4 a[44:47], v2, s[68:71], s11 offen offset:3072 sc1
  s_add_u32 m0, s6, 94208
  s_add_u32 s10, s7, 94208
  buffer_load_dwordx4 v2, s[44:47], s10 offen offset:0 sc1 lds
  v_mfma_f32_16x16x32_bf16 v[92:95], a[48:51], v[132:135], v[92:95]
  ds_read2st64_b64 v[148:151], v13 offset0:10 offset1:11
  v_mul_f32 v202, v202, v4
  v_mul_f32 v206, v206, v4
  v_mfma_f32_16x16x32_bf16 v[96:99], a[52:55], v[132:135], v[96:99]
  v_fma_f32 v32, -v192, v16, v32
  v_fma_f32 v36, -v192, v20, v36
  v_fma_f32 v40, -v192, v24, v40
  v_mfma_f32_16x16x32_bf16 v[100:103], a[56:59], v[132:135], v[100:103]
  v_fma_f32 v33, -v192, v17, v33
  v_fma_f32 v37, -v192, v21, v37
  v_fma_f32 v41, -v192, v25, v41
  v_mfma_f32_16x16x32_bf16 v[104:107], a[48:51], v[136:139], v[104:107]
  ds_read2st64_b64 v[152:155], v14 offset0:10 offset1:11
  v_mul_f32 v232, v32, v194
  v_mul_f32 v234, v36, v194
  v_mfma_f32_16x16x32_bf16 v[108:111], a[52:55], v[136:139], v[108:111]
  v_mul_f32 v236, v40, v194
  v_mul_f32 v233, v33, v194
  v_mul_f32 v235, v37, v194
  v_mfma_f32_16x16x32_bf16 v[112:115], a[56:59], v[136:139], v[112:115]
  v_mul_f32 v237, v41, v194
  v_exp_f32 v232, v232
  v_mfma_f32_16x16x32_bf16 v[116:119], a[48:51], v[140:143], v[116:119]
  ds_read2st64_b64 v[156:159], v15 offset0:10 offset1:11
  v_exp_f32 v234, v234
  v_mfma_f32_16x16x32_bf16 v[120:123], a[52:55], v[140:143], v[120:123]
  v_exp_f32 v236, v236
  v_fma_f32 v34, -v192, v18, v34
  v_mfma_f32_16x16x32_bf16 v[124:127], a[56:59], v[140:143], v[124:127]
  v_fma_f32 v38, -v192, v22, v38
  v_fma_f32 v42, -v192, v26, v42
  v_exp_f32 v233, v233
  s_barrier
  s_waitcnt lgkmcnt(0)
  v_mfma_f32_16x16x32_bf16 v[80:83], a[60:63], v[144:147], v[80:83]
  ds_read2st64_b64 v[128:131], v12 offset0:12 offset1:13
  s_add_u32 s11, s22, 12288
  buffer_load_dwordx4 a[48:51], v2, s[68:71], s11 offen offset:0 sc1
  v_mfma_f32_16x16x32_bf16 v[84:87], a[64:67], v[144:147], v[84:87]
  buffer_load_dwordx4 a[52:55], v2, s[68:71], s11 offen offset:1024 sc1
  v_mfma_f32_16x16x32_bf16 v[88:91], a[68:71], v[144:147], v[88:91]
  buffer_load_dwordx4 a[56:59], v2, s[68:71], s11 offen offset:2048 sc1
  buffer_load_dwordx4 v2, s[44:47], s10 offen offset:1024 sc1 lds
  v_mfma_f32_16x16x32_bf16 v[92:95], a[60:63], v[148:151], v[92:95]
  ds_read2st64_b64 v[132:135], v13 offset0:12 offset1:13
  v_exp_f32 v235, v235
  v_mfma_f32_16x16x32_bf16 v[96:99], a[64:67], v[148:151], v[96:99]
  v_exp_f32 v237, v237
  v_fma_f32 v35, -v192, v19, v35
  v_mfma_f32_16x16x32_bf16 v[100:103], a[68:71], v[148:151], v[100:103]
  v_fma_f32 v39, -v192, v23, v39
  v_fma_f32 v43, -v192, v27, v43
  v_mul_f32 v32, v32, v34
  v_mfma_f32_16x16x32_bf16 v[104:107], a[60:63], v[152:155], v[104:107]
  ds_read2st64_b64 v[136:139], v14 offset0:12 offset1:13
  v_mul_f32 v36, v36, v38
  v_mul_f32 v40, v40, v42
  v_mfma_f32_16x16x32_bf16 v[108:111], a[64:67], v[152:155], v[108:111]
  v_mul_f32 v33, v33, v35
  v_mul_f32 v37, v37, v39
  v_mul_f32 v41, v41, v43
  v_mfma_f32_16x16x32_bf16 v[112:115], a[68:71], v[152:155], v[112:115]
  v_fma_f32 v232, v232, v193, v193
  v_fma_f32 v234, v234, v193, v193
  v_fma_f32 v236, v236, v193, v193
  v_mfma_f32_16x16x32_bf16 v[116:119], a[60:63], v[156:159], v[116:119]
  ds_read2st64_b64 v[140:143], v15 offset0:12 offset1:13
  v_fma_f32 v233, v233, v193, v193
  v_fma_f32 v235, v235, v193, v193
  v_mfma_f32_16x16x32_bf16 v[120:123], a[64:67], v[156:159], v[120:123]
  v_fma_f32 v237, v237, v193, v193
  v_rcp_f32 v232, v232
  v_mfma_f32_16x16x32_bf16 v[124:127], a[68:71], v[156:159], v[124:127]
  v_rcp_f32 v234, v234
  v_rcp_f32 v236, v236
  s_barrier
  s_waitcnt lgkmcnt(0)
  v_mfma_f32_16x16x32_bf16 v[80:83], a[72:75], v[128:131], v[80:83]
  ds_read2st64_b64 v[144:147], v12 offset0:14 offset1:15
  buffer_load_dwordx4 a[60:63], v2, s[68:71], s11 offen offset:3072 sc1
  v_mfma_f32_16x16x32_bf16 v[84:87], a[76:79], v[128:131], v[84:87]
  s_add_u32 s11, s22, 16384
  buffer_load_dwordx4 a[64:67], v2, s[68:71], s11 offen offset:0 sc1
  v_mfma_f32_16x16x32_bf16 v[88:91], a[80:83], v[128:131], v[88:91]
  buffer_load_dwordx4 a[68:71], v2, s[68:71], s11 offen offset:1024 sc1
  buffer_load_dwordx4 v2, s[44:47], s10 offen offset:2048 sc1 lds
  v_mfma_f32_16x16x32_bf16 v[92:95], a[72:75], v[132:135], v[92:95]
  ds_read2st64_b64 v[148:151], v13 offset0:14 offset1:15
  v_rcp_f32 v233, v233
  v_mfma_f32_16x16x32_bf16 v[96:99], a[76:79], v[132:135], v[96:99]
  v_rcp_f32 v235, v235
  v_rcp_f32 v237, v237
  v_mfma_f32_16x16x32_bf16 v[100:103], a[80:83], v[132:135], v[100:103]
  v_mul_f32 v32, v32, v232
  v_mul_f32 v36, v36, v234
  v_mul_f32 v40, v40, v236
  v_mfma_f32_16x16x32_bf16 v[104:107], a[72:75], v[136:139], v[104:107]
  ds_read2st64_b64 v[152:155], v14 offset0:14 offset1:15
  v_mul_f32 v33, v33, v233
  v_mul_f32 v37, v37, v235
  v_mfma_f32_16x16x32_bf16 v[108:111], a[76:79], v[136:139], v[108:111]
  v_mul_f32 v41, v41, v237
  v_cvt_pk_bf16_f32 v224, v32, v33
  v_cvt_pk_bf16_f32 v225, v36, v37
  v_mfma_f32_16x16x32_bf16 v[112:115], a[80:83], v[136:139], v[112:115]
  v_cvt_pk_bf16_f32 v226, v40, v41
  v_add_u32 v6, v8, v181
  ds_write_b96 v6, v[224:226] offset:0
  v_mfma_f32_16x16x32_bf16 v[116:119], a[72:75], v[140:143], v[116:119]
  ds_read2st64_b64 v[156:159], v15 offset0:14 offset1:15
  v_fma_f32 v44, -v196, v16, v44
  v_fma_f32 v48, -v196, v20, v48
  v_mfma_f32_16x16x32_bf16 v[120:123], a[76:79], v[140:143], v[120:123]
  v_fma_f32 v52, -v196, v24, v52
  v_fma_f32 v45, -v196, v17, v45
  v_fma_f32 v49, -v196, v21, v49
  v_mfma_f32_16x16x32_bf16 v[124:127], a[80:83], v[140:143], v[124:127]
  v_fma_f32 v53, -v196, v25, v53
  v_mul_f32 v232, v44, v198
  v_mul_f32 v234, v48, v198
  s_waitcnt vmcnt(25)
  s_barrier
  s_waitcnt lgkmcnt(0)
  v_mfma_f32_16x16x32_bf16 v[80:83], a[84:87], v[144:147], v[80:83]
  ds_read2st64_b64 v[128:131], v12 offset0:16 offset1:17
  buffer_load_dwordx4 a[72:75], v2, s[68:71], s11 offen offset:2048 sc1
  v_mfma_f32_16x16x32_bf16 v[84:87], a[88:91], v[144:147], v[84:87]
  buffer_load_dwordx4 a[76:79], v2, s[68:71], s11 offen offset:3072 sc1
  v_mfma_f32_16x16x32_bf16 v[88:91], a[92:95], v[144:147], v[88:91]
  s_add_u32 s11, s22, 20480
  buffer_load_dwordx4 a[80:83], v2, s[68:71], s11 offen offset:0 sc1
  buffer_load_dwordx4 v2, s[44:47], s10 offen offset:3072 sc1 lds
  v_mfma_f32_16x16x32_bf16 v[92:95], a[84:87], v[148:151], v[92:95]
  ds_read2st64_b64 v[132:135], v13 offset0:16 offset1:17
  v_mul_f32 v236, v52, v198
  v_mul_f32 v233, v45, v198
  v_mfma_f32_16x16x32_bf16 v[96:99], a[88:91], v[148:151], v[96:99]
  v_mul_f32 v235, v49, v198
  v_mul_f32 v237, v53, v198
  v_exp_f32 v232, v232
  v_mfma_f32_16x16x32_bf16 v[100:103], a[92:95], v[148:151], v[100:103]
  v_exp_f32 v234, v234
  v_exp_f32 v236, v236
  v_mfma_f32_16x16x32_bf16 v[104:107], a[84:87], v[152:155], v[104:107]
  ds_read2st64_b64 v[136:139], v14 offset0:16 offset1:17
  v_fma_f32 v46, -v196, v18, v46
  v_fma_f32 v50, -v196, v22, v50
  v_mfma_f32_16x16x32_bf16 v[108:111], a[88:91], v[152:155], v[108:111]
  v_fma_f32 v54, -v196, v26, v54
  v_exp_f32 v233, v233
  v_mfma_f32_16x16x32_bf16 v[112:115], a[92:95], v[152:155], v[112:115]
  v_exp_f32 v235, v235
  v_exp_f32 v237, v237
  v_mfma_f32_16x16x32_bf16 v[116:119], a[84:87], v[156:159], v[116:119]
  ds_read2st64_b64 v[140:143], v15 offset0:16 offset1:17
  v_fma_f32 v47, -v196, v19, v47
  v_fma_f32 v51, -v196, v23, v51
  v_mfma_f32_16x16x32_bf16 v[120:123], a[88:91], v[156:159], v[120:123]
  v_fma_f32 v55, -v196, v27, v55
  v_mul_f32 v44, v44, v46
  v_mul_f32 v48, v48, v50
  v_mfma_f32_16x16x32_bf16 v[124:127], a[92:95], v[156:159], v[124:127]
  v_mul_f32 v52, v52, v54
  v_mul_f32 v45, v45, v47
  v_mul_f32 v49, v49, v51
  s_waitcnt vmcnt(24)
  s_barrier
  s_waitcnt lgkmcnt(0)
  v_mfma_f32_16x16x32_bf16 v[80:83], a[96:99], v[128:131], v[80:83]
  ds_read2st64_b64 v[144:147], v12 offset0:18 offset1:19
  buffer_load_dwordx4 a[84:87], v2, s[68:71], s11 offen offset:1024 sc1
  v_mfma_f32_16x16x32_bf16 v[84:87], a[100:103], v[128:131], v[84:87]
  buffer_load_dwordx4 a[88:91], v2, s[68:71], s11 offen offset:2048 sc1
  v_mfma_f32_16x16x32_bf16 v[88:91], a[104:107], v[128:131], v[88:91]
  buffer_load_dwordx4 a[92:95], v2, s[68:71], s11 offen offset:3072 sc1
  s_add_u32 m0, s6, 98304
  s_add_u32 s10, s7, 98304
  buffer_load_dwordx4 v2, s[44:47], s10 offen offset:0 sc1 lds
  v_mfma_f32_16x16x32_bf16 v[92:95], a[96:99], v[132:135], v[92:95]
  ds_read2st64_b64 v[148:151], v13 offset0:18 offset1:19
  v_mul_f32 v53, v53, v55
  v_fma_f32 v232, v232, v197, v197
  v_mfma_f32_16x16x32_bf16 v[96:99], a[100:103], v[132:135], v[96:99]
  v_fma_f32 v234, v234, v197, v197
  v_fma_f32 v236, v236, v197, v197
  v_fma_f32 v233, v233, v197, v197
  v_mfma_f32_16x16x32_bf16 v[100:103], a[104:107], v[132:135], v[100:103]
  v_fma_f32 v235, v235, v197, v197
  v_fma_f32 v237, v237, v197, v197
  v_rcp_f32 v232, v232
  v_mfma_f32_16x16x32_bf16 v[104:107], a[96:99], v[136:139], v[104:107]
  ds_read2st64_b64 v[152:155], v14 offset0:18 offset1:19
  v_rcp_f32 v234, v234
  v_mfma_f32_16x16x32_bf16 v[108:111], a[100:103], v[136:139], v[108:111]
  v_rcp_f32 v236, v236
  v_rcp_f32 v233, v233
  v_mfma_f32_16x16x32_bf16 v[112:115], a[104:107], v[136:139], v[112:115]
  v_rcp_f32 v235, v235
  v_rcp_f32 v237, v237
  v_mfma_f32_16x16x32_bf16 v[116:119], a[96:99], v[140:143], v[116:119]
  ds_read2st64_b64 v[156:159], v15 offset0:18 offset1:19
  v_mul_f32 v44, v44, v232
  v_mul_f32 v48, v48, v234
  v_mfma_f32_16x16x32_bf16 v[120:123], a[100:103], v[140:143], v[120:123]
  v_mul_f32 v52, v52, v236
  v_mul_f32 v45, v45, v233
  v_mul_f32 v49, v49, v235
  v_mfma_f32_16x16x32_bf16 v[124:127], a[104:107], v[140:143], v[124:127]
  v_mul_f32 v53, v53, v237
  v_cvt_pk_bf16_f32 v228, v44, v45
  v_cvt_pk_bf16_f32 v229, v48, v49
  s_waitcnt vmcnt(24)
  s_barrier
  s_waitcnt lgkmcnt(0)
  v_mfma_f32_16x16x32_bf16 v[80:83], a[108:111], v[144:147], v[80:83]
  ds_read2st64_b64 v[128:131], v12 offset0:20 offset1:21
  s_add_u32 s11, s22, 24576
  buffer_load_dwordx4 a[96:99], v2, s[68:71], s11 offen offset:0 sc1
  v_mfma_f32_16x16x32_bf16 v[84:87], a[112:115], v[144:147], v[84:87]
  buffer_load_dwordx4 a[100:103], v2, s[68:71], s11 offen offset:1024 sc1
  v_mfma_f32_16x16x32_bf16 v[88:91], a[116:119], v[144:147], v[88:91]
  buffer_load_dwordx4 a[104:107], v2, s[68:71], s11 offen offset:2048 sc1
  buffer_load_dwordx4 v2, s[44:47], s10 offen offset:1024 sc1 lds
  v_mfma_f32_16x16x32_bf16 v[92:95], a[108:111], v[148:151], v[92:95]
  ds_read2st64_b64 v[132:135], v13 offset0:20 offset1:21
  v_cvt_pk_bf16_f32 v230, v52, v53
  v_add_u32 v6, v9, v181
  v_mfma_f32_16x16x32_bf16 v[96:99], a[112:115], v[148:151], v[96:99]
  ds_write_b96 v6, v[228:230] offset:0
  v_fma_f32 v56, -v200, v16, v56
  v_fma_f32 v60, -v200, v20, v60
  v_mfma_f32_16x16x32_bf16 v[100:103], a[116:119], v[148:151], v[100:103]
  v_fma_f32 v64, -v200, v24, v64
  v_fma_f32 v57, -v200, v17, v57
  v_fma_f32 v61, -v200, v21, v61
  v_mfma_f32_16x16x32_bf16 v[104:107], a[108:111], v[152:155], v[104:107]
  ds_read2st64_b64 v[136:139], v14 offset0:20 offset1:21
  v_fma_f32 v65, -v200, v25, v65
  v_mul_f32 v232, v56, v202
  v_mfma_f32_16x16x32_bf16 v[108:111], a[112:115], v[152:155], v[108:111]
  v_mul_f32 v234, v60, v202
  v_mul_f32 v236, v64, v202
  v_mul_f32 v233, v57, v202
  v_mfma_f32_16x16x32_bf16 v[112:115], a[116:119], v[152:155], v[112:115]
  v_mul_f32 v235, v61, v202
  v_mul_f32 v237, v65, v202
  v_exp_f32 v232, v232
  v_mfma_f32_16x16x32_bf16 v[116:119], a[108:111], v[156:159], v[116:119]
  ds_read2st64_b64 v[140:143], v15 offset0:20 offset1:21
  v_exp_f32 v234, v234
  v_mfma_f32_16x16x32_bf16 v[120:123], a[112:115], v[156:159], v[120:123]
  v_exp_f32 v236, v236
  v_fma_f32 v58, -v200, v18, v58
  v_mfma_f32_16x16x32_bf16 v[124:127], a[116:119], v[156:159], v[124:127]
  v_fma_f32 v62, -v200, v22, v62
  v_fma_f32 v66, -v200, v26, v66
  v_exp_f32 v233, v233
  s_waitcnt vmcnt(24)
  s_barrier
  s_waitcnt lgkmcnt(0)
  v_mfma_f32_16x16x32_bf16 v[80:83], a[120:123], v[128:131], v[80:83]
  ds_read2st64_b64 v[144:147], v12 offset0:22 offset1:23
  buffer_load_dwordx4 a[108:111], v2, s[68:71], s11 offen offset:3072 sc1
  v_mfma_f32_16x16x32_bf16 v[84:87], a[124:127], v[128:131], v[84:87]
  s_add_u32 s11, s22, 28672
  buffer_load_dwordx4 a[112:115], v2, s[68:71], s11 offen offset:0 sc1
  v_mfma_f32_16x16x32_bf16 v[88:91], a[128:131], v[128:131], v[88:91]
  buffer_load_dwordx4 a[116:119], v2, s[68:71], s11 offen offset:1024 sc1
  buffer_load_dwordx4 v2, s[44:47], s10 offen offset:2048 sc1 lds
  v_mfma_f32_16x16x32_bf16 v[92:95], a[120:123], v[132:135], v[92:95]
  ds_read2st64_b64 v[148:151], v13 offset0:22 offset1:23
  v_exp_f32 v235, v235
  v_mfma_f32_16x16x32_bf16 v[96:99], a[124:127], v[132:135], v[96:99]
  v_exp_f32 v237, v237
  v_fma_f32 v59, -v200, v19, v59
  v_mfma_f32_16x16x32_bf16 v[100:103], a[128:131], v[132:135], v[100:103]
  v_fma_f32 v63, -v200, v23, v63
  v_fma_f32 v67, -v200, v27, v67
  v_mul_f32 v56, v56, v58
  v_mfma_f32_16x16x32_bf16 v[104:107], a[120:123], v[136:139], v[104:107]
  ds_read2st64_b64 v[152:155], v14 offset0:22 offset1:23
  v_mul_f32 v60, v60, v62
  v_mul_f32 v64, v64, v66
  v_mfma_f32_16x16x32_bf16 v[108:111], a[124:127], v[136:139], v[108:111]
  v_mul_f32 v57, v57, v59
  v_mul_f32 v61, v61, v63
  v_mul_f32 v65, v65, v67
  v_mfma_f32_16x16x32_bf16 v[112:115], a[128:131], v[136:139], v[112:115]
  v_fma_f32 v232, v232, v201, v201
  v_fma_f32 v234, v234, v201, v201
  v_fma_f32 v236, v236, v201, v201
  v_mfma_f32_16x16x32_bf16 v[116:119], a[120:123], v[140:143], v[116:119]
  ds_read2st64_b64 v[156:159], v15 offset0:22 offset1:23
  v_fma_f32 v233, v233, v201, v201
  v_fma_f32 v235, v235, v201, v201
  v_mfma_f32_16x16x32_bf16 v[120:123], a[124:127], v[140:143], v[120:123]
  v_fma_f32 v237, v237, v201, v201
  v_rcp_f32 v232, v232
  v_mfma_f32_16x16x32_bf16 v[124:127], a[128:131], v[140:143], v[124:127]
  v_rcp_f32 v234, v234
  v_rcp_f32 v236, v236
  s_waitcnt vmcnt(24)
  v_rcp_f32 v233, v233
  v_rcp_f32 v235, v235
  v_rcp_f32 v237, v237
  v_mul_f32 v56, v56, v232
  v_mul_f32 v60, v60, v234
  v_mul_f32 v64, v64, v236
  v_mul_f32 v57, v57, v233
  v_mul_f32 v61, v61, v235
  v_mul_f32 v65, v65, v237
  v_cvt_pk_bf16_f32 v224, v56, v57
  v_cvt_pk_bf16_f32 v225, v60, v61
  v_cvt_pk_bf16_f32 v226, v64, v65
  v_add_u32 v6, v10, v181
  ds_write_b96 v6, v[224:226] offset:0
  v_fma_f32 v68, -v204, v16, v68
  v_fma_f32 v72, -v204, v20, v72
  v_fma_f32 v76, -v204, v24, v76
  v_fma_f32 v69, -v204, v17, v69
  v_fma_f32 v73, -v204, v21, v73
  v_fma_f32 v77, -v204, v25, v77
  v_mul_f32 v232, v68, v206
  v_mul_f32 v234, v72, v206
  v_mul_f32 v236, v76, v206
  v_mul_f32 v233, v69, v206
  v_mul_f32 v235, v73, v206
  v_mul_f32 v237, v77, v206
  v_exp_f32 v232, v232
  v_exp_f32 v234, v234
  v_exp_f32 v236, v236
  v_fma_f32 v70, -v204, v18, v70
  v_fma_f32 v74, -v204, v22, v74
  v_fma_f32 v78, -v204, v26, v78
  v_exp_f32 v233, v233
  v_exp_f32 v235, v235
  v_exp_f32 v237, v237
  v_fma_f32 v71, -v204, v19, v71
  v_fma_f32 v75, -v204, v23, v75
  v_fma_f32 v79, -v204, v27, v79
  v_mul_f32 v68, v68, v70
  v_mul_f32 v72, v72, v74
  v_mul_f32 v76, v76, v78
  v_mul_f32 v69, v69, v71
  v_mul_f32 v73, v73, v75
  v_mul_f32 v77, v77, v79
  v_fma_f32 v232, v232, v205, v205
  v_fma_f32 v234, v234, v205, v205
  v_fma_f32 v236, v236, v205, v205
  v_fma_f32 v233, v233, v205, v205
  v_fma_f32 v235, v235, v205, v205
  v_fma_f32 v237, v237, v205, v205
  v_rcp_f32 v232, v232
  v_rcp_f32 v234, v234
  v_rcp_f32 v236, v236
  v_rcp_f32 v233, v233
  v_rcp_f32 v235, v235
  v_rcp_f32 v237, v237
  v_mul_f32 v68, v68, v232
  v_mul_f32 v72, v72, v234
  v_mul_f32 v76, v76, v236
  v_mul_f32 v69, v69, v233
  v_mul_f32 v73, v73, v235
  v_mul_f32 v77, v77, v237
  v_cvt_pk_bf16_f32 v228, v68, v69
  v_cvt_pk_bf16_f32 v229, v72, v73
  v_cvt_pk_bf16_f32 v230, v76, v77
  v_add_u32 v6, v11, v181
  ds_write_b96 v6, v[228:230] offset:0
  s_waitcnt lgkmcnt(0)
  s_barrier
  ds_read_b128 v[160:163], v31 offset:0
  ds_read_b128 v[164:167], v31 offset:1024
  ds_read_b128 v[168:171], v31 offset:2048
  v_mfma_f32_16x16x32_bf16 v[80:83], a[132:135], v[144:147], v[80:83]
  ds_read2st64_b64 v[128:131], v12 offset0:24 offset1:25
  buffer_load_dwordx4 a[120:123], v2, s[68:71], s11 offen offset:2048 sc1
  v_mfma_f32_16x16x32_bf16 v[84:87], a[136:139], v[144:147], v[84:87]
  buffer_load_dwordx4 a[124:127], v2, s[68:71], s11 offen offset:3072 sc1
  v_mfma_f32_16x16x32_bf16 v[88:91], a[140:143], v[144:147], v[88:91]
  s_add_u32 s11, s22, 32768
  buffer_load_dwordx4 a[128:131], v2, s[68:71], s11 offen offset:0 sc1
  buffer_load_dwordx4 v2, s[44:47], s10 offen offset:3072 sc1 lds
  v_mfma_f32_16x16x32_bf16 v[92:95], a[132:135], v[148:151], v[92:95]
  ds_read2st64_b64 v[132:135], v13 offset0:24 offset1:25
  v_mfma_f32_16x16x32_bf16 v[96:99], a[136:139], v[148:151], v[96:99]
  v_mfma_f32_16x16x32_bf16 v[100:103], a[140:143], v[148:151], v[100:103]
  v_mfma_f32_16x16x32_bf16 v[104:107], a[132:135], v[152:155], v[104:107]
  ds_read2st64_b64 v[136:139], v14 offset0:24 offset1:25
  v_mfma_f32_16x16x32_bf16 v[108:111], a[136:139], v[152:155], v[108:111]
  v_mfma_f32_16x16x32_bf16 v[112:115], a[140:143], v[152:155], v[112:115]
  v_mfma_f32_16x16x32_bf16 v[116:119], a[132:135], v[156:159], v[116:119]
  ds_read2st64_b64 v[140:143], v15 offset0:24 offset1:25
  v_mfma_f32_16x16x32_bf16 v[120:123], a[136:139], v[156:159], v[120:123]
  v_mfma_f32_16x16x32_bf16 v[124:127], a[140:143], v[156:159], v[124:127]
  s_waitcnt vmcnt(24)
  s_barrier
  s_waitcnt lgkmcnt(4)
  buffer_store_dwordx4 v[160:163], v2, s[56:59], s60 offen offset:0 sc1
  buffer_store_dwordx4 v[164:167], v2, s[56:59], s60 offen offset:1024 sc1
  buffer_store_dwordx4 v[168:171], v2, s[56:59], s60 offen offset:2048 sc1
  s_waitcnt lgkmcnt(0)
  v_mfma_f32_16x16x32_bf16 v[80:83], a[144:147], v[128:131], v[80:83]
  ds_read2st64_b64 v[144:147], v12 offset0:26 offset1:27
  buffer_load_dwordx4 a[132:135], v2, s[68:71], s11 offen offset:1024 sc1
  v_mfma_f32_16x16x32_bf16 v[84:87], a[148:151], v[128:131], v[84:87]
  buffer_load_dwordx4 a[136:139], v2, s[68:71], s11 offen offset:2048 sc1
  v_mfma_f32_16x16x32_bf16 v[88:91], a[152:155], v[128:131], v[88:91]
  buffer_load_dwordx4 a[140:143], v2, s[68:71], s11 offen offset:3072 sc1
  v_mfma_f32_16x16x32_bf16 v[92:95], a[144:147], v[132:135], v[92:95]
  ds_read2st64_b64 v[148:151], v13 offset0:26 offset1:27
  v_mfma_f32_16x16x32_bf16 v[96:99], a[148:151], v[132:135], v[96:99]
  v_mfma_f32_16x16x32_bf16 v[100:103], a[152:155], v[132:135], v[100:103]
  v_mfma_f32_16x16x32_bf16 v[104:107], a[144:147], v[136:139], v[104:107]
  ds_read2st64_b64 v[152:155], v14 offset0:26 offset1:27
  v_mfma_f32_16x16x32_bf16 v[108:111], a[148:151], v[136:139], v[108:111]
  v_mfma_f32_16x16x32_bf16 v[112:115], a[152:155], v[136:139], v[112:115]
  v_mfma_f32_16x16x32_bf16 v[116:119], a[144:147], v[140:143], v[116:119]
  ds_read2st64_b64 v[156:159], v15 offset0:26 offset1:27
  v_mfma_f32_16x16x32_bf16 v[120:123], a[148:151], v[140:143], v[120:123]
  v_mfma_f32_16x16x32_bf16 v[124:127], a[152:155], v[140:143], v[124:127]
  s_waitcnt vmcnt(26)
  s_barrier
  s_waitcnt lgkmcnt(0)
  v_mfma_f32_16x16x32_bf16 v[80:83], a[156:159], v[144:147], v[80:83]
  ds_read2st64_b64 v[128:131], v12 offset0:28 offset1:29
  s_add_u32 s11, s22, 36864
  buffer_load_dwordx4 a[144:147], v2, s[68:71], s11 offen offset:0 sc1
  v_mfma_f32_16x16x32_bf16 v[84:87], a[160:163], v[144:147], v[84:87]
  buffer_load_dwordx4 a[148:151], v2, s[68:71], s11 offen offset:1024 sc1
  v_mfma_f32_16x16x32_bf16 v[88:91], a[164:167], v[144:147], v[88:91]
  buffer_load_dwordx4 a[152:155], v2, s[68:71], s11 offen offset:2048 sc1
  v_mfma_f32_16x16x32_bf16 v[92:95], a[156:159], v[148:151], v[92:95]
  ds_read2st64_b64 v[132:135], v13 offset0:28 offset1:29
  v_mfma_f32_16x16x32_bf16 v[96:99], a[160:163], v[148:151], v[96:99]
  v_mfma_f32_16x16x32_bf16 v[100:103], a[164:167], v[148:151], v[100:103]
  v_mfma_f32_16x16x32_bf16 v[104:107], a[156:159], v[152:155], v[104:107]
  ds_read2st64_b64 v[136:139], v14 offset0:28 offset1:29
  v_mfma_f32_16x16x32_bf16 v[108:111], a[160:163], v[152:155], v[108:111]
  v_mfma_f32_16x16x32_bf16 v[112:115], a[164:167], v[152:155], v[112:115]
  v_mfma_f32_16x16x32_bf16 v[116:119], a[156:159], v[156:159], v[116:119]
  ds_read2st64_b64 v[140:143], v15 offset0:28 offset1:29
  v_mfma_f32_16x16x32_bf16 v[120:123], a[160:163], v[156:159], v[120:123]
  v_mfma_f32_16x16x32_bf16 v[124:127], a[164:167], v[156:159], v[124:127]
  buffer_load_dwordx2 v[176:177], v186, s[72:75], s24 offen offset:512 sc1
  s_waitcnt vmcnt(26)
  s_barrier
  s_waitcnt lgkmcnt(0)
  v_mfma_f32_16x16x32_bf16 v[80:83], a[168:171], v[128:131], v[80:83]
  ds_read2st64_b64 v[144:147], v12 offset0:30 offset1:31
  buffer_load_dwordx4 a[156:159], v2, s[68:71], s11 offen offset:3072 sc1
  v_mfma_f32_16x16x32_bf16 v[84:87], a[172:175], v[128:131], v[84:87]
  s_add_u32 s11, s22, 40960
  buffer_load_dwordx4 a[160:163], v2, s[68:71], s11 offen offset:0 sc1
  v_mfma_f32_16x16x32_bf16 v[88:91], a[176:179], v[128:131], v[88:91]
  buffer_load_dwordx4 a[164:167], v2, s[68:71], s11 offen offset:1024 sc1
  v_mfma_f32_16x16x32_bf16 v[92:95], a[168:171], v[132:135], v[92:95]
  ds_read2st64_b64 v[148:151], v13 offset0:30 offset1:31
  v_mfma_f32_16x16x32_bf16 v[96:99], a[172:175], v[132:135], v[96:99]
  v_mfma_f32_16x16x32_bf16 v[100:103], a[176:179], v[132:135], v[100:103]
  v_mfma_f32_16x16x32_bf16 v[104:107], a[168:171], v[136:139], v[104:107]
  ds_read2st64_b64 v[152:155], v14 offset0:30 offset1:31
  v_mfma_f32_16x16x32_bf16 v[108:111], a[172:175], v[136:139], v[108:111]
  v_mfma_f32_16x16x32_bf16 v[112:115], a[176:179], v[136:139], v[112:115]
  v_mfma_f32_16x16x32_bf16 v[116:119], a[168:171], v[140:143], v[116:119]
  ds_read2st64_b64 v[156:159], v15 offset0:30 offset1:31
  v_mfma_f32_16x16x32_bf16 v[120:123], a[172:175], v[140:143], v[120:123]
  v_mfma_f32_16x16x32_bf16 v[124:127], a[176:179], v[140:143], v[124:127]
  s_waitcnt vmcnt(25)
  s_barrier
  s_waitcnt lgkmcnt(0)
  v_mfma_f32_16x16x32_bf16 v[80:83], a[180:183], v[144:147], v[80:83]
  ds_read2st64_b64 v[128:131], v12 offset0:32 offset1:33
  buffer_load_dwordx4 a[168:171], v2, s[68:71], s11 offen offset:2048 sc1
  v_mfma_f32_16x16x32_bf16 v[84:87], a[184:187], v[144:147], v[84:87]
  buffer_load_dwordx4 a[172:175], v2, s[68:71], s11 offen offset:3072 sc1
  v_mfma_f32_16x16x32_bf16 v[88:91], a[188:191], v[144:147], v[88:91]
  s_add_u32 s11, s22, 45056
  buffer_load_dwordx4 a[176:179], v2, s[68:71], s11 offen offset:0 sc1
  v_mfma_f32_16x16x32_bf16 v[92:95], a[180:183], v[148:151], v[92:95]
  ds_read2st64_b64 v[132:135], v13 offset0:32 offset1:33
  v_mfma_f32_16x16x32_bf16 v[96:99], a[184:187], v[148:151], v[96:99]
  v_mfma_f32_16x16x32_bf16 v[100:103], a[188:191], v[148:151], v[100:103]
  v_mfma_f32_16x16x32_bf16 v[104:107], a[180:183], v[152:155], v[104:107]
  ds_read2st64_b64 v[136:139], v14 offset0:32 offset1:33
  v_mfma_f32_16x16x32_bf16 v[108:111], a[184:187], v[152:155], v[108:111]
  v_mfma_f32_16x16x32_bf16 v[112:115], a[188:191], v[152:155], v[112:115]
  v_mfma_f32_16x16x32_bf16 v[116:119], a[180:183], v[156:159], v[116:119]
  ds_read2st64_b64 v[140:143], v15 offset0:32 offset1:33
  v_mfma_f32_16x16x32_bf16 v[120:123], a[184:187], v[156:159], v[120:123]
  v_mfma_f32_16x16x32_bf16 v[124:127], a[188:191], v[156:159], v[124:127]
  s_waitcnt vmcnt(24)
  s_waitcnt vmcnt(13)
  s_barrier
  s_mov_b64 exec, 1
  buffer_atomic_add v28, v29, s[72:75], s62 offen offset:0 sc1
  s_mov_b64 exec, -1
  s_waitcnt lgkmcnt(0)
  v_mfma_f32_16x16x32_bf16 v[80:83], a[192:195], v[128:131], v[80:83]
  ds_read2st64_b64 v[144:147], v12 offset0:34 offset1:35
  buffer_load_dwordx4 a[180:183], v2, s[68:71], s11 offen offset:1024 sc1
  v_mfma_f32_16x16x32_bf16 v[84:87], a[196:199], v[128:131], v[84:87]
  buffer_load_dwordx4 a[184:187], v2, s[68:71], s11 offen offset:2048 sc1
  v_mfma_f32_16x16x32_bf16 v[88:91], a[200:203], v[128:131], v[88:91]
  buffer_load_dwordx4 a[188:191], v2, s[68:71], s11 offen offset:3072 sc1
  v_mfma_f32_16x16x32_bf16 v[92:95], a[192:195], v[132:135], v[92:95]
  ds_read2st64_b64 v[148:151], v13 offset0:34 offset1:35
  v_mfma_f32_16x16x32_bf16 v[96:99], a[196:199], v[132:135], v[96:99]
  v_mfma_f32_16x16x32_bf16 v[100:103], a[200:203], v[132:135], v[100:103]
  v_mfma_f32_16x16x32_bf16 v[104:107], a[192:195], v[136:139], v[104:107]
  ds_read2st64_b64 v[152:155], v14 offset0:34 offset1:35
  v_mfma_f32_16x16x32_bf16 v[108:111], a[196:199], v[136:139], v[108:111]
  v_mfma_f32_16x16x32_bf16 v[112:115], a[200:203], v[136:139], v[112:115]
  v_mfma_f32_16x16x32_bf16 v[116:119], a[192:195], v[140:143], v[116:119]
  ds_read2st64_b64 v[156:159], v15 offset0:34 offset1:35
  v_mfma_f32_16x16x32_bf16 v[120:123], a[196:199], v[140:143], v[120:123]
  v_mfma_f32_16x16x32_bf16 v[124:127], a[200:203], v[140:143], v[124:127]
  s_barrier
  s_waitcnt lgkmcnt(0)
  v_mfma_f32_16x16x32_bf16 v[80:83], a[204:207], v[144:147], v[80:83]
  ds_read2st64_b64 v[128:131], v12 offset0:36 offset1:37
  s_add_u32 s11, s22, 49152
  buffer_load_dwordx4 a[192:195], v2, s[68:71], s11 offen offset:0 sc1
  v_mfma_f32_16x16x32_bf16 v[84:87], a[208:211], v[144:147], v[84:87]
  buffer_load_dwordx4 a[196:199], v2, s[68:71], s11 offen offset:1024 sc1
  v_mfma_f32_16x16x32_bf16 v[88:91], a[212:215], v[144:147], v[88:91]
  buffer_load_dwordx4 a[200:203], v2, s[68:71], s11 offen offset:2048 sc1
  v_mfma_f32_16x16x32_bf16 v[92:95], a[204:207], v[148:151], v[92:95]
  ds_read2st64_b64 v[132:135], v13 offset0:36 offset1:37
  v_mfma_f32_16x16x32_bf16 v[96:99], a[208:211], v[148:151], v[96:99]
  v_mfma_f32_16x16x32_bf16 v[100:103], a[212:215], v[148:151], v[100:103]
  v_mfma_f32_16x16x32_bf16 v[104:107], a[204:207], v[152:155], v[104:107]
  ds_read2st64_b64 v[136:139], v14 offset0:36 offset1:37
  v_mfma_f32_16x16x32_bf16 v[108:111], a[208:211], v[152:155], v[108:111]
  v_mfma_f32_16x16x32_bf16 v[112:115], a[212:215], v[152:155], v[112:115]
  v_mfma_f32_16x16x32_bf16 v[116:119], a[204:207], v[156:159], v[116:119]
  ds_read2st64_b64 v[140:143], v15 offset0:36 offset1:37
  v_mfma_f32_16x16x32_bf16 v[120:123], a[208:211], v[156:159], v[120:123]
  v_mfma_f32_16x16x32_bf16 v[124:127], a[212:215], v[156:159], v[124:127]
  s_mov_b32 s35, 0
  s_nop 6
K3_STCHK10:
  s_waitcnt vmcnt(13)
  v_cmp_eq_u32 vcc, 0, v177
  s_nop 4
  s_cbranch_vccz K3_STOK10
  s_add_u32 s35, s35, 1
  s_cmp_ge_u32 s35, 0x4000
  s_cbranch_scc1 K3_STOK10
  s_sleep 2
  buffer_load_dwordx2 v[176:177], v186, s[72:75], s24 offen offset:512 sc1
  s_waitcnt vmcnt(0)
  s_branch K3_STCHK10
K3_STOK10:
  s_barrier
  s_waitcnt lgkmcnt(0)
  v_mfma_f32_16x16x32_bf16 v[80:83], a[216:219], v[128:131], v[80:83]
  ds_read2st64_b64 v[144:147], v12 offset0:38 offset1:39
  buffer_load_dwordx4 a[204:207], v2, s[68:71], s11 offen offset:3072 sc1
  v_mfma_f32_16x16x32_bf16 v[84:87], a[220:223], v[128:131], v[84:87]
  s_add_u32 s11, s22, 53248
  buffer_load_dwordx4 a[208:211], v2, s[68:71], s11 offen offset:0 sc1
  v_mfma_f32_16x16x32_bf16 v[88:91], a[224:227], v[128:131], v[88:91]
  buffer_load_dwordx4 a[212:215], v2, s[68:71], s11 offen offset:1024 sc1
  v_mfma_f32_16x16x32_bf16 v[92:95], a[216:219], v[132:135], v[92:95]
  ds_read2st64_b64 v[148:151], v13 offset0:38 offset1:39
  ds_write_b64 v183, v[176:177] offset:4608
  ds_read_b64 v[208:209], v184 offset:4608
  v_mfma_f32_16x16x32_bf16 v[96:99], a[220:223], v[132:135], v[96:99]
  ds_read_b64 v[212:213], v184 offset:4736
  ds_read_b64 v[216:217], v184 offset:4864
  ds_read_b64 v[220:221], v184 offset:4992
  v_mfma_f32_16x16x32_bf16 v[100:103], a[224:227], v[132:135], v[100:103]
  s_waitcnt lgkmcnt(0)
  v_rcp_f32 v210, v209
  v_rcp_f32 v214, v213
  v_mfma_f32_16x16x32_bf16 v[104:107], a[216:219], v[136:139], v[104:107]
  ds_read2st64_b64 v[152:155], v14 offset0:38 offset1:39
  v_rcp_f32 v218, v217
  v_rcp_f32 v222, v221
  v_mfma_f32_16x16x32_bf16 v[108:111], a[220:223], v[136:139], v[108:111]
  v_mul_f32 v209, v209, v209
  v_mul_f32 v213, v213, v213
  v_mul_f32 v217, v217, v217
  v_mfma_f32_16x16x32_bf16 v[112:115], a[224:227], v[136:139], v[112:115]
  v_mul_f32 v221, v221, v221
  v_mul_f32 v210, v210, v4
  v_mul_f32 v214, v214, v4
  v_mfma_f32_16x16x32_bf16 v[116:119], a[216:219], v[140:143], v[116:119]
  ds_read2st64_b64 v[156:159], v15 offset0:38 offset1:39
  v_mul_f32 v218, v218, v4
  v_mul_f32 v222, v222, v4
  v_mfma_f32_16x16x32_bf16 v[120:123], a[220:223], v[140:143], v[120:123]
  v_mfma_f32_16x16x32_bf16 v[124:127], a[224:227], v[140:143], v[124:127]
  buffer_load_dword v30, v29, s[72:75], s63 offen sc1
  s_waitcnt lgkmcnt(0)
  v_mfma_f32_16x16x32_bf16 v[80:83], a[228:231], v[144:147], v[80:83]
  buffer_load_dwordx4 a[216:219], v2, s[68:71], s11 offen offset:2048 sc1
  v_mfma_f32_16x16x32_bf16 v[84:87], a[232:235], v[144:147], v[84:87]
  buffer_load_dwordx4 a[220:223], v2, s[68:71], s11 offen offset:3072 sc1
  v_mfma_f32_16x16x32_bf16 v[88:91], a[236:239], v[144:147], v[88:91]
  s_add_u32 s11, s22, 57344
  buffer_load_dwordx4 a[224:227], v2, s[68:71], s11 offen offset:0 sc1
  v_mfma_f32_16x16x32_bf16 v[92:95], a[228:231], v[148:151], v[92:95]
  v_mfma_f32_16x16x32_bf16 v[96:99], a[232:235], v[148:151], v[96:99]
  v_mfma_f32_16x16x32_bf16 v[100:103], a[236:239], v[148:151], v[100:103]
  v_mfma_f32_16x16x32_bf16 v[104:107], a[228:231], v[152:155], v[104:107]
  v_mfma_f32_16x16x32_bf16 v[108:111], a[232:235], v[152:155], v[108:111]
  v_mfma_f32_16x16x32_bf16 v[112:115], a[236:239], v[152:155], v[112:115]
  v_mfma_f32_16x16x32_bf16 v[116:119], a[228:231], v[156:159], v[116:119]
  v_mfma_f32_16x16x32_bf16 v[120:123], a[232:235], v[156:159], v[120:123]
  v_mfma_f32_16x16x32_bf16 v[124:127], a[236:239], v[156:159], v[124:127]
  v_pk_fma_f32 v[80:81], v[16:17], v[208:209], v[80:81] op_sel_hi:[1,0,1] neg_lo:[0,1,0] neg_hi:[0,1,0]
  v_pk_fma_f32 v[84:85], v[20:21], v[208:209], v[84:85] op_sel_hi:[1,0,1] neg_lo:[0,1,0] neg_hi:[0,1,0]
  v_pk_fma_f32 v[88:89], v[24:25], v[208:209], v[88:89] op_sel_hi:[1,0,1] neg_lo:[0,1,0] neg_hi:[0,1,0]
  v_pk_fma_f32 v[82:83], v[18:19], v[208:209], v[82:83] op_sel_hi:[1,0,1] neg_lo:[0,1,0] neg_hi:[0,1,0]
  v_pk_fma_f32 v[86:87], v[22:23], v[208:209], v[86:87] op_sel_hi:[1,0,1] neg_lo:[0,1,0] neg_hi:[0,1,0]
  v_pk_fma_f32 v[90:91], v[26:27], v[208:209], v[90:91] op_sel_hi:[1,0,1] neg_lo:[0,1,0] neg_hi:[0,1,0]
  v_pk_mul_f32 v[232:233], v[80:81], v[210:211] op_sel_hi:[1,0]
  v_pk_mul_f32 v[234:235], v[84:85], v[210:211] op_sel_hi:[1,0]
  v_pk_mul_f32 v[236:237], v[88:89], v[210:211] op_sel_hi:[1,0]
  v_exp_f32 v232, v232
  v_exp_f32 v234, v234
  v_exp_f32 v236, v236
  v_exp_f32 v233, v233
  v_exp_f32 v235, v235
  v_exp_f32 v237, v237
  v_pk_mul_f32 v[80:81], v[80:81], v[82:83]
  v_pk_mul_f32 v[84:85], v[84:85], v[86:87]
  v_pk_mul_f32 v[88:89], v[88:89], v[90:91]
  v_pk_fma_f32 v[232:233], v[232:233], v[208:209], v[208:209] op_sel:[0,1,1] op_sel_hi:[1,1,1]
  v_pk_fma_f32 v[234:235], v[234:235], v[208:209], v[208:209] op_sel:[0,1,1] op_sel_hi:[1,1,1]
  v_pk_fma_f32 v[236:237], v[236:237], v[208:209], v[208:209] op_sel:[0,1,1] op_sel_hi:[1,1,1]
  v_rcp_f32 v232, v232
  v_rcp_f32 v234, v234
  v_rcp_f32 v236, v236
  v_rcp_f32 v233, v233
  v_rcp_f32 v235, v235
  v_rcp_f32 v237, v237
  v_pk_mul_f32 v[80:81], v[80:81], v[232:233]
  v_pk_mul_f32 v[84:85], v[84:85], v[234:235]
  v_pk_mul_f32 v[88:89], v[88:89], v[236:237]
  v_cvt_pk_bf16_f32 v224, v80, v81
  v_cvt_pk_bf16_f32 v225, v84, v85
  v_cvt_pk_bf16_f32 v226, v88, v89
  v_add_u32 v6, v12, v181
  ds_write_b96 v6, v[224:226] offset:0
  v_pk_fma_f32 v[92:93], v[16:17], v[212:213], v[92:93] op_sel_hi:[1,0,1] neg_lo:[0,1,0] neg_hi:[0,1,0]
  v_pk_fma_f32 v[96:97], v[20:21], v[212:213], v[96:97] op_sel_hi:[1,0,1] neg_lo:[0,1,0] neg_hi:[0,1,0]
  v_pk_fma_f32 v[100:101], v[24:25], v[212:213], v[100:101] op_sel_hi:[1,0,1] neg_lo:[0,1,0] neg_hi:[0,1,0]
  buffer_load_dwordx4 a[228:231], v2, s[68:71], s11 offen offset:1024 sc1
  v_pk_fma_f32 v[94:95], v[18:19], v[212:213], v[94:95] op_sel_hi:[1,0,1] neg_lo:[0,1,0] neg_hi:[0,1,0]
  v_pk_fma_f32 v[98:99], v[22:23], v[212:213], v[98:99] op_sel_hi:[1,0,1] neg_lo:[0,1,0] neg_hi:[0,1,0]
  v_pk_fma_f32 v[102:103], v[26:27], v[212:213], v[102:103] op_sel_hi:[1,0,1] neg_lo:[0,1,0] neg_hi:[0,1,0]
  v_pk_mul_f32 v[232:233], v[92:93], v[214:215] op_sel_hi:[1,0]
  v_pk_mul_f32 v[234:235], v[96:97], v[214:215] op_sel_hi:[1,0]
  v_pk_mul_f32 v[236:237], v[100:101], v[214:215] op_sel_hi:[1,0]
  v_exp_f32 v232, v232
  v_exp_f32 v234, v234
  v_exp_f32 v236, v236
  v_exp_f32 v233, v233
  v_exp_f32 v235, v235
  v_exp_f32 v237, v237
  v_pk_mul_f32 v[92:93], v[92:93], v[94:95]
  v_pk_mul_f32 v[96:97], v[96:97], v[98:99]
  v_pk_mul_f32 v[100:101], v[100:101], v[102:103]
  v_pk_fma_f32 v[232:233], v[232:233], v[212:213], v[212:213] op_sel:[0,1,1] op_sel_hi:[1,1,1]
  v_pk_fma_f32 v[234:235], v[234:235], v[212:213], v[212:213] op_sel:[0,1,1] op_sel_hi:[1,1,1]
  v_pk_fma_f32 v[236:237], v[236:237], v[212:213], v[212:213] op_sel:[0,1,1] op_sel_hi:[1,1,1]
  v_rcp_f32 v232, v232
  v_rcp_f32 v234, v234
  v_rcp_f32 v236, v236
  v_rcp_f32 v233, v233
  v_rcp_f32 v235, v235
  v_rcp_f32 v237, v237
  v_pk_mul_f32 v[92:93], v[92:93], v[232:233]
  v_pk_mul_f32 v[96:97], v[96:97], v[234:235]
  v_pk_mul_f32 v[100:101], v[100:101], v[236:237]
  v_cvt_pk_bf16_f32 v228, v92, v93
  v_cvt_pk_bf16_f32 v229, v96, v97
  v_cvt_pk_bf16_f32 v230, v100, v101
  v_add_u32 v6, v13, v181
  ds_write_b96 v6, v[228:230] offset:0
  v_pk_fma_f32 v[104:105], v[16:17], v[216:217], v[104:105] op_sel_hi:[1,0,1] neg_lo:[0,1,0] neg_hi:[0,1,0]
  v_pk_fma_f32 v[108:109], v[20:21], v[216:217], v[108:109] op_sel_hi:[1,0,1] neg_lo:[0,1,0] neg_hi:[0,1,0]
  v_pk_fma_f32 v[112:113], v[24:25], v[216:217], v[112:113] op_sel_hi:[1,0,1] neg_lo:[0,1,0] neg_hi:[0,1,0]
  v_pk_fma_f32 v[106:107], v[18:19], v[216:217], v[106:107] op_sel_hi:[1,0,1] neg_lo:[0,1,0] neg_hi:[0,1,0]
  v_pk_fma_f32 v[110:111], v[22:23], v[216:217], v[110:111] op_sel_hi:[1,0,1] neg_lo:[0,1,0] neg_hi:[0,1,0]
  v_pk_fma_f32 v[114:115], v[26:27], v[216:217], v[114:115] op_sel_hi:[1,0,1] neg_lo:[0,1,0] neg_hi:[0,1,0]
  buffer_load_dwordx4 a[232:235], v2, s[68:71], s11 offen offset:2048 sc1
  v_pk_mul_f32 v[232:233], v[104:105], v[218:219] op_sel_hi:[1,0]
  v_pk_mul_f32 v[234:235], v[108:109], v[218:219] op_sel_hi:[1,0]
  v_pk_mul_f32 v[236:237], v[112:113], v[218:219] op_sel_hi:[1,0]
  v_exp_f32 v232, v232
  v_exp_f32 v234, v234
  v_exp_f32 v236, v236
  v_exp_f32 v233, v233
  v_exp_f32 v235, v235
  v_exp_f32 v237, v237
  v_pk_mul_f32 v[104:105], v[104:105], v[106:107]
  v_pk_mul_f32 v[108:109], v[108:109], v[110:111]
  v_pk_mul_f32 v[112:113], v[112:113], v[114:115]
  v_pk_fma_f32 v[232:233], v[232:233], v[216:217], v[216:217] op_sel:[0,1,1] op_sel_hi:[1,1,1]
  v_pk_fma_f32 v[234:235], v[234:235], v[216:217], v[216:217] op_sel:[0,1,1] op_sel_hi:[1,1,1]
  v_pk_fma_f32 v[236:237], v[236:237], v[216:217], v[216:217] op_sel:[0,1,1] op_sel_hi:[1,1,1]
  v_rcp_f32 v232, v232
  v_rcp_f32 v234, v234
  v_rcp_f32 v236, v236
  v_rcp_f32 v233, v233
  v_rcp_f32 v235, v235
  v_rcp_f32 v237, v237
  v_pk_mul_f32 v[104:105], v[104:105], v[232:233]
  v_pk_mul_f32 v[108:109], v[108:109], v[234:235]
  v_pk_mul_f32 v[112:113], v[112:113], v[236:237]
  v_cvt_pk_bf16_f32 v224, v104, v105
  v_cvt_pk_bf16_f32 v225, v108, v109
  v_cvt_pk_bf16_f32 v226, v112, v113
  v_add_u32 v6, v14, v181
  ds_write_b96 v6, v[224:226] offset:0
  v_pk_fma_f32 v[116:117], v[16:17], v[220:221], v[116:117] op_sel_hi:[1,0,1] neg_lo:[0,1,0] neg_hi:[0,1,0]
  v_pk_fma_f32 v[120:121], v[20:21], v[220:221], v[120:121] op_sel_hi:[1,0,1] neg_lo:[0,1,0] neg_hi:[0,1,0]
  v_pk_fma_f32 v[124:125], v[24:25], v[220:221], v[124:125] op_sel_hi:[1,0,1] neg_lo:[0,1,0] neg_hi:[0,1,0]
  v_pk_fma_f32 v[118:119], v[18:19], v[220:221], v[118:119] op_sel_hi:[1,0,1] neg_lo:[0,1,0] neg_hi:[0,1,0]
  v_pk_fma_f32 v[122:123], v[22:23], v[220:221], v[122:123] op_sel_hi:[1,0,1] neg_lo:[0,1,0] neg_hi:[0,1,0]
  v_pk_fma_f32 v[126:127], v[26:27], v[220:221], v[126:127] op_sel_hi:[1,0,1] neg_lo:[0,1,0] neg_hi:[0,1,0]
  v_pk_mul_f32 v[232:233], v[116:117], v[222:223] op_sel_hi:[1,0]
  v_pk_mul_f32 v[234:235], v[120:121], v[222:223] op_sel_hi:[1,0]
  v_pk_mul_f32 v[236:237], v[124:125], v[222:223] op_sel_hi:[1,0]
  buffer_load_dwordx4 a[236:239], v2, s[68:71], s11 offen offset:3072 sc1
  v_exp_f32 v232, v232
  v_exp_f32 v234, v234
  v_exp_f32 v236, v236
  v_exp_f32 v233, v233
  v_exp_f32 v235, v235
  v_exp_f32 v237, v237
  v_pk_mul_f32 v[116:117], v[116:117], v[118:119]
  v_pk_mul_f32 v[120:121], v[120:121], v[122:123]
  v_pk_mul_f32 v[124:125], v[124:125], v[126:127]
  v_pk_fma_f32 v[232:233], v[232:233], v[220:221], v[220:221] op_sel:[0,1,1] op_sel_hi:[1,1,1]
  v_pk_fma_f32 v[234:235], v[234:235], v[220:221], v[220:221] op_sel:[0,1,1] op_sel_hi:[1,1,1]
  v_pk_fma_f32 v[236:237], v[236:237], v[220:221], v[220:221] op_sel:[0,1,1] op_sel_hi:[1,1,1]
  v_rcp_f32 v232, v232
  v_rcp_f32 v234, v234
  v_rcp_f32 v236, v236
  v_rcp_f32 v233, v233
  v_rcp_f32 v235, v235
  v_rcp_f32 v237, v237
  v_pk_mul_f32 v[116:117], v[116:117], v[232:233]
  v_pk_mul_f32 v[120:121], v[120:121], v[234:235]
  v_pk_mul_f32 v[124:125], v[124:125], v[236:237]
  v_cvt_pk_bf16_f32 v228, v116, v117
  v_cvt_pk_bf16_f32 v229, v120, v121
  v_cvt_pk_bf16_f32 v230, v124, v125
  v_add_u32 v6, v15, v181
  ds_write_b96 v6, v[228:230] offset:0
  s_nop 0
  s_branch K3_EPIDONE
K3_VAR1:
  s_waitcnt vmcnt(20)
  s_barrier
  s_waitcnt lgkmcnt(0)
  v_mfma_f32_16x16x32_bf16 v[32:35], a[0:3], v[128:131], 0
  ds_read2st64_b64 v[144:147], v8 offset0:2 offset1:3
  v_mfma_f32_16x16x32_bf16 v[36:39], a[4:7], v[128:131], 0
  s_lshl_b32 s13, s4, 3
  s_add_u32 s13, s13, s3
  v_mfma_f32_16x16x32_bf16 v[40:43], a[8:11], v[128:131], 0
  s_mul_i32 s13, s13, 49152
  s_mul_i32 s14, s5, 3072
  v_mfma_f32_16x16x32_bf16 v[44:47], a[0:3], v[132:135], 0
  ds_read2st64_b64 v[148:151], v9 offset0:2 offset1:3
  buffer_load_dwordx4 a[172:175], v2, s[48:51], s11 offen offset:3072 sc1
  v_mfma_f32_16x16x32_bf16 v[48:51], a[4:7], v[132:135], 0
  s_add_u32 s11, s9, 45056
  buffer_load_dwordx4 a[176:179], v2, s[48:51], s11 offen offset:0 sc1
  buffer_load_dwordx4 v2, s[44:47], s10 offen offset:3072 sc1 lds
  v_mfma_f32_16x16x32_bf16 v[52:55], a[8:11], v[132:135], 0
  v_mfma_f32_16x16x32_bf16 v[56:59], a[0:3], v[136:139], 0
  ds_read2st64_b64 v[152:155], v10 offset0:2 offset1:3
  v_mfma_f32_16x16x32_bf16 v[60:63], a[4:7], v[136:139], 0
  s_add_u32 s60, s13, s14
  s_add_u32 s61, s60, 196608
  v_mfma_f32_16x16x32_bf16 v[64:67], a[8:11], v[136:139], 0
  s_lshl_b32 s13, s4, 2
  s_lshr_b32 s14, s5, 2
  v_mfma_f32_16x16x32_bf16 v[68:71], a[0:3], v[140:143], 0
  ds_read2st64_b64 v[156:159], v11 offset0:2 offset1:3
  v_mfma_f32_16x16x32_bf16 v[72:75], a[4:7], v[140:143], 0
  s_add_u32 s14, s14, s13
  s_lshl_b32 s14, s14, 8
  v_mfma_f32_16x16x32_bf16 v[76:79], a[8:11], v[140:143], 0
  s_add_u32 s62, s14, 0x4000
  s_add_u32 s13, s13, s3
  s_waitcnt vmcnt(22)
  s_barrier
  s_waitcnt lgkmcnt(0)
  v_mfma_f32_16x16x32_bf16 v[32:35], a[12:15], v[144:147], v[32:35]
  ds_read2st64_b64 v[128:131], v8 offset0:4 offset1:5
  v_mfma_f32_16x16x32_bf16 v[36:39], a[16:19], v[144:147], v[36:39]
  s_lshl_b32 s13, s13, 8
  s_add_u32 s63, s13, 0x4000
  v_mfma_f32_16x16x32_bf16 v[40:43], a[20:23], v[144:147], v[40:43]
  s_lshl_b32 s13, s4, 3
  s_lshl_b32 s14, s19, 1
  v_mfma_f32_16x16x32_bf16 v[44:47], a[12:15], v[148:151], v[44:47]
  ds_read2st64_b64 v[132:135], v9 offset0:4 offset1:5
  buffer_load_dwordx4 a[180:183], v2, s[48:51], s11 offen offset:1024 sc1
  v_mfma_f32_16x16x32_bf16 v[48:51], a[16:19], v[148:151], v[48:51]
  buffer_load_dwordx4 a[184:187], v2, s[48:51], s11 offen offset:2048 sc1
  buffer_load_dwordx4 a[188:191], v2, s[48:51], s11 offen offset:3072 sc1
  v_mfma_f32_16x16x32_bf16 v[52:55], a[20:23], v[148:151], v[52:55]
  v_mfma_f32_16x16x32_bf16 v[56:59], a[12:15], v[152:155], v[56:59]
  ds_read2st64_b64 v[136:139], v10 offset0:4 offset1:5
  v_mfma_f32_16x16x32_bf16 v[60:63], a[16:19], v[152:155], v[60:63]
  s_add_u32 s23, s13, s14
  s_mul_i32 s13, s23, 49152
  v_mfma_f32_16x16x32_bf16 v[64:67], a[20:23], v[152:155], v[64:67]
  s_mul_i32 s14, s3, 12288
  s_add_u32 s64, s13, s14
  v_mfma_f32_16x16x32_bf16 v[68:71], a[12:15], v[156:159], v[68:71]
  ds_read2st64_b64 v[140:143], v11 offset0:4 offset1:5
  v_mfma_f32_16x16x32_bf16 v[72:75], a[16:19], v[156:159], v[72:75]
  s_add_u32 s65, s64, 49152
  s_add_u32 s66, s64, 196608
  v_mfma_f32_16x16x32_bf16 v[76:79], a[20:23], v[156:159], v[76:79]
  s_add_u32 s67, s64, 245760
  s_waitcnt vmcnt(24)
  s_barrier
  s_waitcnt lgkmcnt(0)
  v_mfma_f32_16x16x32_bf16 v[32:35], a[24:27], v[128:131], v[32:35]
  ds_read2st64_b64 v[144:147], v8 offset0:6 offset1:7
  v_mfma_f32_16x16x32_bf16 v[36:39], a[28:31], v[128:131], v[36:39]
  v_mfma_f32_16x16x32_bf16 v[40:43], a[32:35], v[128:131], v[40:43]
  v_mfma_f32_16x16x32_bf16 v[44:47], a[24:27], v[132:135], v[44:47]
  ds_read2st64_b64 v[148:151], v9 offset0:6 offset1:7
  s_add_u32 m0, s6, 16384
  s_add_u32 s10, s7, 16384
  buffer_load_dwordx4 v2, s[44:47], s10 offen offset:0 sc1 lds
  v_mfma_f32_16x16x32_bf16 v[48:51], a[28:31], v[132:135], v[48:51]
  s_add_u32 s11, s9, 49152
  buffer_load_dwordx4 a[192:195], v2, s[48:51], s11 offen offset:0 sc1
  buffer_load_dwordx4 a[196:199], v2, s[48:51], s11 offen offset:1024 sc1
  v_mfma_f32_16x16x32_bf16 v[52:55], a[32:35], v[132:135], v[52:55]
  v_mfma_f32_16x16x32_bf16 v[56:59], a[24:27], v[136:139], v[56:59]
  ds_read2st64_b64 v[152:155], v10 offset0:6 offset1:7
  v_mfma_f32_16x16x32_bf16 v[60:63], a[28:31], v[136:139], v[60:63]
  v_mfma_f32_16x16x32_bf16 v[64:67], a[32:35], v[136:139], v[64:67]
  v_mfma_f32_16x16x32_bf16 v[68:71], a[24:27], v[140:143], v[68:71]
  ds_read2st64_b64 v[156:159], v11 offset0:6 offset1:7
  v_mfma_f32_16x16x32_bf16 v[72:75], a[28:31], v[140:143], v[72:75]
  v_mfma_f32_16x16x32_bf16 v[76:79], a[32:35], v[140:143], v[76:79]
  s_waitcnt vmcnt(26)
  s_barrier
  s_waitcnt lgkmcnt(0)
  v_mfma_f32_16x16x32_bf16 v[32:35], a[36:39], v[144:147], v[32:35]
  ds_read2st64_b64 v[128:131], v8 offset0:8 offset1:9
  v_mfma_f32_16x16x32_bf16 v[36:39], a[40:43], v[144:147], v[36:39]
  v_mfma_f32_16x16x32_bf16 v[40:43], a[44:47], v[144:147], v[40:43]
  v_mfma_f32_16x16x32_bf16 v[44:47], a[36:39], v[148:151], v[44:47]
  ds_read2st64_b64 v[132:135], v9 offset0:8 offset1:9
  buffer_load_dwordx4 a[200:203], v2, s[48:51], s11 offen offset:2048 sc1
  v_mfma_f32_16x16x32_bf16 v[48:51], a[40:43], v[148:151], v[48:51]
  buffer_load_dwordx4 v2, s[44:47], s10 offen offset:1024 sc1 lds
  buffer_load_dwordx4 a[204:207], v2, s[48:51], s11 offen offset:3072 sc1
  v_mfma_f32_16x16x32_bf16 v[52:55], a[44:47], v[148:151], v[52:55]
  v_mfma_f32_16x16x32_bf16 v[56:59], a[36:39], v[152:155], v[56:59]
  ds_read2st64_b64 v[136:139], v10 offset0:8 offset1:9
  v_mfma_f32_16x16x32_bf16 v[60:63], a[40:43], v[152:155], v[60:63]
  v_mfma_f32_16x16x32_bf16 v[64:67], a[44:47], v[152:155], v[64:67]
  v_mfma_f32_16x16x32_bf16 v[68:71], a[36:39], v[156:159], v[68:71]
  ds_read2st64_b64 v[140:143], v11 offset0:8 offset1:9
  v_mfma_f32_16x16x32_bf16 v[72:75], a[40:43], v[156:159], v[72:75]
  v_mfma_f32_16x16x32_bf16 v[76:79], a[44:47], v[156:159], v[76:79]
  s_waitcnt vmcnt(28)
  s_barrier
  s_waitcnt lgkmcnt(0)
  v_mfma_f32_16x16x32_bf16 v[32:35], a[48:51], v[128:131], v[32:35]
  ds_read2st64_b64 v[144:147], v8 offset0:10 offset1:11
  v_mfma_f32_16x16x32_bf16 v[36:39], a[52:55], v[128:131], v[36:39]
  v_mfma_f32_16x16x32_bf16 v[40:43], a[56:59], v[128:131], v[40:43]
  v_mfma_f32_16x16x32_bf16 v[44:47], a[48:51], v[132:135], v[44:47]
  ds_read2st64_b64 v[148:151], v9 offset0:10 offset1:11
  s_add_u32 s11, s9, 53248
  buffer_load_dwordx4 a[208:211], v2, s[48:51], s11 offen offset:0 sc1
  v_mfma_f32_16x16x32_bf16 v[48:51], a[52:55], v[132:135], v[48:51]
  buffer_load_dwordx4 a[212:215], v2, s[48:51], s11 offen offset:1024 sc1
  buffer_load_dwordx4 v2, s[44:47], s10 offen offset:2048 sc1 lds
  v_mfma_f32_16x16x32_bf16 v[52:55], a[56:59], v[132:135], v[52:55]
  v_mfma_f32_16x16x32_bf16 v[56:59], a[48:51], v[136:139], v[56:59]
  ds_read2st64_b64 v[152:155], v10 offset0:10 offset1:11
  v_mfma_f32_16x16x32_bf16 v[60:63], a[52:55], v[136:139], v[60:63]
  v_mfma_f32_16x16x32_bf16 v[64:67], a[56:59], v[136:139], v[64:67]
  v_mfma_f32_16x16x32_bf16 v[68:71], a[48:51], v[140:143], v[68:71]
  ds_read2st64_b64 v[156:159], v11 offset0:10 offset1:11
  v_mfma_f32_16x16x32_bf16 v[72:75], a[52:55], v[140:143], v[72:75]
  v_mfma_f32_16x16x32_bf16 v[76:79], a[56:59], v[140:143], v[76:79]
  s_waitcnt vmcnt(30)
  s_barrier
  s_waitcnt lgkmcnt(0)
  v_mfma_f32_16x16x32_bf16 v[32:35], a[60:63], v[144:147], v[32:35]
  ds_read2st64_b64 v[128:131], v8 offset0:12 offset1:13
  v_mfma_f32_16x16x32_bf16 v[36:39], a[64:67], v[144:147], v[36:39]
  v_mfma_f32_16x16x32_bf16 v[40:43], a[68:71], v[144:147], v[40:43]
  v_mfma_f32_16x16x32_bf16 v[44:47], a[60:63], v[148:151], v[44:47]
  ds_read2st64_b64 v[132:135], v9 offset0:12 offset1:13
  buffer_load_dwordx4 a[216:219], v2, s[48:51], s11 offen offset:2048 sc1
  v_mfma_f32_16x16x32_bf16 v[48:51], a[64:67], v[148:151], v[48:51]
  buffer_load_dwordx4 a[220:223], v2, s[48:51], s11 offen offset:3072 sc1
  s_add_u32 s11, s9, 57344
  buffer_load_dwordx4 a[224:227], v2, s[48:51], s11 offen offset:0 sc1
  v_mfma_f32_16x16x32_bf16 v[52:55], a[68:71], v[148:151], v[52:55]
  v_mfma_f32_16x16x32_bf16 v[56:59], a[60:63], v[152:155], v[56:59]
  ds_read2st64_b64 v[136:139], v10 offset0:12 offset1:13
  v_mfma_f32_16x16x32_bf16 v[60:63], a[64:67], v[152:155], v[60:63]
  v_mfma_f32_16x16x32_bf16 v[64:67], a[68:71], v[152:155], v[64:67]
  v_mfma_f32_16x16x32_bf16 v[68:71], a[60:63], v[156:159], v[68:71]
  ds_read2st64_b64 v[140:143], v11 offset0:12 offset1:13
  v_mfma_f32_16x16x32_bf16 v[72:75], a[64:67], v[156:159], v[72:75]
  v_mfma_f32_16x16x32_bf16 v[76:79], a[68:71], v[156:159], v[76:79]
  s_waitcnt vmcnt(32)
  s_barrier
  s_waitcnt lgkmcnt(0)
  v_mfma_f32_16x16x32_bf16 v[32:35], a[72:75], v[128:131], v[32:35]
  ds_read2st64_b64 v[144:147], v8 offset0:14 offset1:15
  v_mfma_f32_16x16x32_bf16 v[36:39], a[76:79], v[128:131], v[36:39]
  v_mfma_f32_16x16x32_bf16 v[40:43], a[80:83], v[128:131], v[40:43]
  v_mfma_f32_16x16x32_bf16 v[44:47], a[72:75], v[132:135], v[44:47]
  ds_read2st64_b64 v[148:151], v9 offset0:14 offset1:15
  buffer_load_dwordx4 v2, s[44:47], s10 offen offset:3072 sc1 lds
  v_mfma_f32_16x16x32_bf16 v[48:51], a[76:79], v[132:135], v[48:51]
  buffer_load_dwordx4 a[228:231], v2, s[48:51], s11 offen offset:1024 sc1
  buffer_load_dwordx4 a[232:235], v2, s[48:51], s11 offen offset:2048 sc1
  v_mfma_f32_16x16x32_bf16 v[52:55], a[80:83], v[132:135], v[52:55]
  v_mfma_f32_16x16x32_bf16 v[56:59], a[72:75], v[136:139], v[56:59]
  ds_read2st64_b64 v[152:155], v10 offset0:14 offset1:15
  v_mfma_f32_16x16x32_bf16 v[60:63], a[76:79], v[136:139], v[60:63]
  v_mfma_f32_16x16x32_bf16 v[64:67], a[80:83], v[136:139], v[64:67]
  v_mfma_f32_16x16x32_bf16 v[68:71], a[72:75], v[140:143], v[68:71]
  ds_read2st64_b64 v[156:159], v11 offset0:14 offset1:15
  v_mfma_f32_16x16x32_bf16 v[72:75], a[76:79], v[140:143], v[72:75]
  v_mfma_f32_16x16x32_bf16 v[76:79], a[80:83], v[140:143], v[76:79]
  buffer_load_dwordx2 v[180:181], v189, s[92:95], s12 offen sc1
  s_waitcnt vmcnt(35)
  s_barrier
  s_waitcnt lgkmcnt(0)
  v_mfma_f32_16x16x32_bf16 v[32:35], a[84:87], v[144:147], v[32:35]
  ds_read2st64_b64 v[128:131], v8 offset0:16 offset1:17
  v_mfma_f32_16x16x32_bf16 v[36:39], a[88:91], v[144:147], v[36:39]
  v_mfma_f32_16x16x32_bf16 v[40:43], a[92:95], v[144:147], v[40:43]
  v_mfma_f32_16x16x32_bf16 v[44:47], a[84:87], v[148:151], v[44:47]
  ds_read2st64_b64 v[132:135], v9 offset0:16 offset1:17
  buffer_load_dwordx4 a[236:239], v2, s[48:51], s11 offen offset:3072 sc1
  v_mfma_f32_16x16x32_bf16 v[48:51], a[88:91], v[148:151], v[48:51]
  buffer_load_dwordx4 v[228:231], v2, s[52:55], s17 offen sc1
  v_mfma_f32_16x16x32_bf16 v[52:55], a[92:95], v[148:151], v[52:55]
  v_mfma_f32_16x16x32_bf16 v[56:59], a[84:87], v[152:155], v[56:59]
  ds_read2st64_b64 v[136:139], v10 offset0:16 offset1:17
  v_mfma_f32_16x16x32_bf16 v[60:63], a[88:91], v[152:155], v[60:63]
  v_mfma_f32_16x16x32_bf16 v[64:67], a[92:95], v[152:155], v[64:67]
  v_mfma_f32_16x16x32_bf16 v[68:71], a[84:87], v[156:159], v[68:71]
  ds_read2st64_b64 v[140:143], v11 offset0:16 offset1:17
  v_mfma_f32_16x16x32_bf16 v[72:75], a[88:91], v[156:159], v[72:75]
  v_mfma_f32_16x16x32_bf16 v[76:79], a[92:95], v[156:159], v[76:79]
  s_waitcnt vmcnt(36)
  s_barrier
  s_waitcnt lgkmcnt(0)
  v_mfma_f32_16x16x32_bf16 v[32:35], a[96:99], v[128:131], v[32:35]
  ds_read2st64_b64 v[144:147], v8 offset0:18 offset1:19
  v_mfma_f32_16x16x32_bf16 v[36:39], a[100:103], v[128:131], v[36:39]
  v_mfma_f32_16x16x32_bf16 v[40:43], a[104:107], v[128:131], v[40:43]
  v_mfma_f32_16x16x32_bf16 v[44:47], a[96:99], v[132:135], v[44:47]
  ds_read2st64_b64 v[148:151], v9 offset0:18 offset1:19
  v_mfma_f32_16x16x32_bf16 v[48:51], a[100:103], v[132:135], v[48:51]
  v_mfma_f32_16x16x32_bf16 v[52:55], a[104:107], v[132:135], v[52:55]
  v_mfma_f32_16x16x32_bf16 v[56:59], a[96:99], v[136:139], v[56:59]
  ds_read2st64_b64 v[152:155], v10 offset0:18 offset1:19
  v_mfma_f32_16x16x32_bf16 v[60:63], a[100:103], v[136:139], v[60:63]
  v_mfma_f32_16x16x32_bf16 v[64:67], a[104:107], v[136:139], v[64:67]
  v_mfma_f32_16x16x32_bf16 v[68:71], a[96:99], v[140:143], v[68:71]
  ds_read2st64_b64 v[156:159], v11 offset0:18 offset1:19
  v_mfma_f32_16x16x32_bf16 v[72:75], a[100:103], v[140:143], v[72:75]
  v_mfma_f32_16x16x32_bf16 v[76:79], a[104:107], v[140:143], v[76:79]
  s_waitcnt vmcnt(35)
  s_barrier
  s_waitcnt lgkmcnt(0)
  v_mfma_f32_16x16x32_bf16 v[32:35], a[108:111], v[144:147], v[32:35]
  ds_read2st64_b64 v[128:131], v8 offset0:20 offset1:21
  v_mfma_f32_16x16x32_bf16 v[36:39], a[112:115], v[144:147], v[36:39]
  v_mfma_f32_16x16x32_bf16 v[40:43], a[116:119], v[144:147], v[40:43]
  v_mfma_f32_16x16x32_bf16 v[44:47], a[108:111], v[148:151], v[44:47]
  ds_read2st64_b64 v[132:135], v9 offset0:20 offset1:21
  v_mfma_f32_16x16x32_bf16 v[48:51], a[112:115], v[148:151], v[48:51]
  v_mfma_f32_16x16x32_bf16 v[52:55], a[116:119], v[148:151], v[52:55]
  v_mfma_f32_16x16x32_bf16 v[56:59], a[108:111], v[152:155], v[56:59]
  ds_read2st64_b64 v[136:139], v10 offset0:20 offset1:21
  v_mfma_f32_16x16x32_bf16 v[60:63], a[112:115], v[152:155], v[60:63]
  v_mfma_f32_16x16x32_bf16 v[64:67], a[116:119], v[152:155], v[64:67]
  v_mfma_f32_16x16x32_bf16 v[68:71], a[108:111], v[156:159], v[68:71]
  ds_read2st64_b64 v[140:143], v11 offset0:20 offset1:21
  v_mfma_f32_16x16x32_bf16 v[72:75], a[112:115], v[156:159], v[72:75]
  v_mfma_f32_16x16x32_bf16 v[76:79], a[116:119], v[156:159], v[76:79]
  s_waitcnt vmcnt(34)
  s_barrier
  s_waitcnt lgkmcnt(0)
  v_mfma_f32_16x16x32_bf16 v[32:35], a[120:123], v[128:131], v[32:35]
  ds_read2st64_b64 v[144:147], v8 offset0:22 offset1:23
  v_mfma_f32_16x16x32_bf16 v[36:39], a[124:127], v[128:131], v[36:39]
  v_mfma_f32_16x16x32_bf16 v[40:43], a[128:131], v[128:131], v[40:43]
  v_mfma_f32_16x16x32_bf16 v[44:47], a[120:123], v[132:135], v[44:47]
  ds_read2st64_b64 v[148:151], v9 offset0:22 offset1:23
  v_mfma_f32_16x16x32_bf16 v[48:51], a[124:127], v[132:135], v[48:51]
  v_mfma_f32_16x16x32_bf16 v[52:55], a[128:131], v[132:135], v[52:55]
  v_mfma_f32_16x16x32_bf16 v[56:59], a[120:123], v[136:139], v[56:59]
  ds_read2st64_b64 v[152:155], v10 offset0:22 offset1:23
  v_mfma_f32_16x16x32_bf16 v[60:63], a[124:127], v[136:139], v[60:63]
  v_mfma_f32_16x16x32_bf16 v[64:67], a[128:131], v[136:139], v[64:67]
  v_mfma_f32_16x16x32_bf16 v[68:71], a[120:123], v[140:143], v[68:71]
  ds_read2st64_b64 v[156:159], v11 offset0:22 offset1:23
  v_mfma_f32_16x16x32_bf16 v[72:75], a[124:127], v[140:143], v[72:75]
  v_mfma_f32_16x16x32_bf16 v[76:79], a[128:131], v[140:143], v[76:79]
  s_waitcnt vmcnt(2)
  s_mov_b32 s35, 0
  s_nop 5
HBW1:
  v_cmp_ne_u64 vcc, s[90:91], v[180:181]
  s_nop 4
  s_cbranch_vccz HBK1
  s_add_u32 s35, s35, 1
  s_cmp_ge_u32 s35, 0x8000
  s_cbranch_scc1 HBK1
  s_sleep 1
  buffer_load_dwordx2 v[180:181], v189, s[92:95], s12 offen sc1
  s_waitcnt vmcnt(0)
  s_branch HBW1
HBK1:
  s_barrier
  s_waitcnt lgkmcnt(0)
  v_mfma_f32_16x16x32_bf16 v[32:35], a[132:135], v[144:147], v[32:35]
  ds_read2st64_b64 v[128:131], v8 offset0:24 offset1:25
  v_mfma_f32_16x16x32_bf16 v[36:39], a[136:139], v[144:147], v[36:39]
  v_mfma_f32_16x16x32_bf16 v[40:43], a[140:143], v[144:147], v[40:43]
  v_mfma_f32_16x16x32_bf16 v[44:47], a[132:135], v[148:151], v[44:47]
  ds_read2st64_b64 v[132:135], v9 offset0:24 offset1:25
  s_add_u32 s21, s21, 77824
  buffer_load_dwordx4 v[192:195], v2, s[44:47], s21 offen offset:0 sc1
  buffer_load_dwordx4 v[196:199], v2, s[44:47], s21 offen offset:1024 sc1
  buffer_load_dwordx4 v[200:203], v2, s[44:47], s21 offen offset:2048 sc1
  buffer_load_dwordx4 v[204:207], v2, s[44:47], s21 offen offset:3072 sc1
  s_add_u32 s21, s21, 4096
  buffer_load_dwordx4 v[208:211], v2, s[44:47], s21 offen offset:0 sc1
  v_mfma_f32_16x16x32_bf16 v[48:51], a[136:139], v[148:151], v[48:51]
  s_add_u32 m0, s6, 81920
  s_add_u32 s10, s7, 81920
  buffer_load_dwordx4 v2, s[44:47], s10 offen offset:0 sc1 lds
  buffer_load_dwordx4 v2, s[44:47], s10 offen offset:1024 sc1 lds
  v_mfma_f32_16x16x32_bf16 v[52:55], a[140:143], v[148:151], v[52:55]
  v_mfma_f32_16x16x32_bf16 v[56:59], a[132:135], v[152:155], v[56:59]
  ds_read2st64_b64 v[136:139], v10 offset0:24 offset1:25
  v_mfma_f32_16x16x32_bf16 v[60:63], a[136:139], v[152:155], v[60:63]
  v_mfma_f32_16x16x32_bf16 v[64:67], a[140:143], v[152:155], v[64:67]
  v_mfma_f32_16x16x32_bf16 v[68:71], a[132:135], v[156:159], v[68:71]
  ds_read2st64_b64 v[140:143], v11 offset0:24 offset1:25
  v_mfma_f32_16x16x32_bf16 v[72:75], a[136:139], v[156:159], v[72:75]
  v_mfma_f32_16x16x32_bf16 v[76:79], a[140:143], v[156:159], v[76:79]
  s_barrier
  s_waitcnt lgkmcnt(0)
  v_mfma_f32_16x16x32_bf16 v[32:35], a[144:147], v[128:131], v[32:35]
  ds_read2st64_b64 v[144:147], v8 offset0:26 offset1:27
  v_mfma_f32_16x16x32_bf16 v[36:39], a[148:151], v[128:131], v[36:39]
  v_mfma_f32_16x16x32_bf16 v[40:43], a[152:155], v[128:131], v[40:43]
  v_mfma_f32_16x16x32_bf16 v[44:47], a[144:147], v[132:135], v[44:47]
  ds_read2st64_b64 v[148:151], v9 offset0:26 offset1:27
  buffer_load_dwordx4 v2, s[44:47], s10 offen offset:2048 sc1 lds
  v_mfma_f32_16x16x32_bf16 v[48:51], a[148:151], v[132:135], v[48:51]
  buffer_load_dwordx4 v2, s[44:47], s10 offen offset:3072 sc1 lds
  s_add_u32 m0, s6, 86016
  s_add_u32 s10, s7, 86016
  buffer_load_dwordx4 v2, s[44:47], s10 offen offset:0 sc1 lds
  v_mfma_f32_16x16x32_bf16 v[52:55], a[152:155], v[132:135], v[52:55]
  v_mfma_f32_16x16x32_bf16 v[56:59], a[144:147], v[136:139], v[56:59]
  ds_read2st64_b64 v[152:155], v10 offset0:26 offset1:27
  v_mfma_f32_16x16x32_bf16 v[60:63], a[148:151], v[136:139], v[60:63]
  v_mfma_f32_16x16x32_bf16 v[64:67], a[152:155], v[136:139], v[64:67]
  v_mfma_f32_16x16x32_bf16 v[68:71], a[144:147], v[140:143], v[68:71]
  ds_read2st64_b64 v[156:159], v11 offset0:26 offset1:27
  v_mfma_f32_16x16x32_bf16 v[72:75], a[148:151], v[140:143], v[72:75]
  v_mfma_f32_16x16x32_bf16 v[76:79], a[152:155], v[140:143], v[76:79]
  buffer_load_dwordx2 v[190:191], v188, s[92:95], s37 offen sc1
  s_barrier
  s_waitcnt lgkmcnt(0)
  v_mfma_f32_16x16x32_bf16 v[32:35], a[156:159], v[144:147], v[32:35]
  ds_read2st64_b64 v[128:131], v8 offset0:28 offset1:29
  v_mfma_f32_16x16x32_bf16 v[36:39], a[160:163], v[144:147], v[36:39]
  v_mfma_f32_16x16x32_bf16 v[40:43], a[164:167], v[144:147], v[40:43]
  v_mfma_f32_16x16x32_bf16 v[44:47], a[156:159], v[148:151], v[44:47]
  ds_read2st64_b64 v[132:135], v9 offset0:28 offset1:29
  buffer_load_dwordx4 v2, s[44:47], s10 offen offset:1024 sc1 lds
  v_mfma_f32_16x16x32_bf16 v[48:51], a[160:163], v[148:151], v[48:51]
  buffer_load_dwordx4 v2, s[44:47], s10 offen offset:2048 sc1 lds
  buffer_load_dwordx4 v2, s[44:47], s10 offen offset:3072 sc1 lds
  v_mfma_f32_16x16x32_bf16 v[52:55], a[164:167], v[148:151], v[52:55]
  v_mfma_f32_16x16x32_bf16 v[56:59], a[156:159], v[152:155], v[56:59]
  ds_read2st64_b64 v[136:139], v10 offset0:28 offset1:29
  v_mfma_f32_16x16x32_bf16 v[60:63], a[160:163], v[152:155], v[60:63]
  v_mfma_f32_16x16x32_bf16 v[64:67], a[164:167], v[152:155], v[64:67]
  v_mfma_f32_16x16x32_bf16 v[68:71], a[156:159], v[156:159], v[68:71]
  ds_read2st64_b64 v[140:143], v11 offset0:28 offset1:29
  v_mfma_f32_16x16x32_bf16 v[72:75], a[160:163], v[156:159], v[72:75]
  v_mfma_f32_16x16x32_bf16 v[76:79], a[164:167], v[156:159], v[76:79]
  s_barrier
  s_waitcnt lgkmcnt(0)
  v_mfma_f32_16x16x32_bf16 v[32:35], a[168:171], v[128:131], v[32:35]
  ds_read2st64_b64 v[144:147], v8 offset0:30 offset1:31
  v_mfma_f32_16x16x32_bf16 v[36:39], a[172:175], v[128:131], v[36:39]
  v_mfma_f32_16x16x32_bf16 v[40:43], a[176:179], v[128:131], v[40:43]
  v_mfma_f32_16x16x32_bf16 v[44:47], a[168:171], v[132:135], v[44:47]
  ds_read2st64_b64 v[148:151], v9 offset0:30 offset1:31
  v_mfma_f32_16x16x32_bf16 v[48:51], a[172:175], v[132:135], v[48:51]
  v_mfma_f32_16x16x32_bf16 v[52:55], a[176:179], v[132:135], v[52:55]
  v_mfma_f32_16x16x32_bf16 v[56:59], a[168:171], v[136:139], v[56:59]
  ds_read2st64_b64 v[152:155], v10 offset0:30 offset1:31
  v_mfma_f32_16x16x32_bf16 v[60:63], a[172:175], v[136:139], v[60:63]
  v_mfma_f32_16x16x32_bf16 v[64:67], a[176:179], v[136:139], v[64:67]
  v_mfma_f32_16x16x32_bf16 v[68:71], a[168:171], v[140:143], v[68:71]
  ds_read2st64_b64 v[156:159], v11 offset0:30 offset1:31
  v_mfma_f32_16x16x32_bf16 v[72:75], a[172:175], v[140:143], v[72:75]
  v_mfma_f32_16x16x32_bf16 v[76:79], a[176:179], v[140:143], v[76:79]
  s_barrier
  s_waitcnt lgkmcnt(0)
  v_mfma_f32_16x16x32_bf16 v[32:35], a[180:183], v[144:147], v[32:35]
  ds_read2st64_b64 v[128:131], v8 offset0:32 offset1:33
  v_mfma_f32_16x16x32_bf16 v[36:39], a[184:187], v[144:147], v[36:39]
  v_mfma_f32_16x16x32_bf16 v[40:43], a[188:191], v[144:147], v[40:43]
  v_mfma_f32_16x16x32_bf16 v[44:47], a[180:183], v[148:151], v[44:47]
  ds_read2st64_b64 v[132:135], v9 offset0:32 offset1:33
  v_mfma_f32_16x16x32_bf16 v[48:51], a[184:187], v[148:151], v[48:51]
  v_mfma_f32_16x16x32_bf16 v[52:55], a[188:191], v[148:151], v[52:55]
  v_mfma_f32_16x16x32_bf16 v[56:59], a[180:183], v[152:155], v[56:59]
  ds_read2st64_b64 v[136:139], v10 offset0:32 offset1:33
  v_mfma_f32_16x16x32_bf16 v[60:63], a[184:187], v[152:155], v[60:63]
  v_mfma_f32_16x16x32_bf16 v[64:67], a[188:191], v[152:155], v[64:67]
  v_mfma_f32_16x16x32_bf16 v[68:71], a[180:183], v[156:159], v[68:71]
  ds_read2st64_b64 v[140:143], v11 offset0:32 offset1:33
  v_mfma_f32_16x16x32_bf16 v[72:75], a[184:187], v[156:159], v[72:75]
  v_mfma_f32_16x16x32_bf16 v[76:79], a[188:191], v[156:159], v[76:79]
  s_barrier
  s_waitcnt lgkmcnt(0)
  v_mfma_f32_16x16x32_bf16 v[32:35], a[192:195], v[128:131], v[32:35]
  ds_read2st64_b64 v[144:147], v8 offset0:34 offset1:35
  v_mfma_f32_16x16x32_bf16 v[36:39], a[196:199], v[128:131], v[36:39]
  v_mfma_f32_16x16x32_bf16 v[40:43], a[200:203], v[128:131], v[40:43]
  v_mfma_f32_16x16x32_bf16 v[44:47], a[192:195], v[132:135], v[44:47]
  ds_read2st64_b64 v[148:151], v9 offset0:34 offset1:35
  v_mfma_f32_16x16x32_bf16 v[48:51], a[196:199], v[132:135], v[48:51]
  v_mfma_f32_16x16x32_bf16 v[52:55], a[200:203], v[132:135], v[52:55]
  v_mfma_f32_16x16x32_bf16 v[56:59], a[192:195], v[136:139], v[56:59]
  ds_read2st64_b64 v[152:155], v10 offset0:34 offset1:35
  v_mfma_f32_16x16x32_bf16 v[60:63], a[196:199], v[136:139], v[60:63]
  v_mfma_f32_16x16x32_bf16 v[64:67], a[200:203], v[136:139], v[64:67]
  v_mfma_f32_16x16x32_bf16 v[68:71], a[192:195], v[140:143], v[68:71]
  ds_read2st64_b64 v[156:159], v11 offset0:34 offset1:35
  v_mfma_f32_16x16x32_bf16 v[72:75], a[196:199], v[140:143], v[72:75]
  v_mfma_f32_16x16x32_bf16 v[76:79], a[200:203], v[140:143], v[76:79]
  s_waitcnt vmcnt(9)
  v_dot2_f32_bf16 v252, v192, s16, 0
  v_dot2_f32_bf16 v253, v192, v192, 0
  v_dot2_f32_bf16 v252, v193, s16, v252
  v_dot2_f32_bf16 v253, v193, v193, v253
  v_dot2_f32_bf16 v254, v194, s16, 0
  v_dot2_f32_bf16 v255, v194, v194, 0
  v_dot2_f32_bf16 v254, v195, s16, v254
  v_dot2_f32_bf16 v255, v195, v195, v255
  v_dot2_f32_bf16 v252, v196, s16, v252
  v_dot2_f32_bf16 v253, v196, v196, v253
  v_dot2_f32_bf16 v252, v197, s16, v252
  v_dot2_f32_bf16 v253, v197, v197, v253
  v_dot2_f32_bf16 v254, v198, s16, v254
  v_dot2_f32_bf16 v255, v198, v198, v255
  v_dot2_f32_bf16 v254, v199, s16, v254
  v_dot2_f32_bf16 v255, v199, v199, v255
  v_dot2_f32_bf16 v252, v200, s16, v252
  v_dot2_f32_bf16 v253, v200, v200, v253
  v_dot2_f32_bf16 v252, v201, s16, v252
  v_dot2_f32_bf16 v253, v201, v201, v253
  v_dot2_f32_bf16 v254, v202, s16, v254
  v_dot2_f32_bf16 v255, v202, v202, v255
  v_dot2_f32_bf16 v254, v203, s16, v254
  v_dot2_f32_bf16 v255, v203, v203, v255
  v_dot2_f32_bf16 v252, v204, s16, v252
  v_dot2_f32_bf16 v253, v204, v204, v253
  v_dot2_f32_bf16 v252, v205, s16, v252
  v_dot2_f32_bf16 v253, v205, v205, v253
  v_dot2_f32_bf16 v254, v206, s16, v254
  v_dot2_f32_bf16 v255, v206, v206, v255
  v_dot2_f32_bf16 v254, v207, s16, v254
  v_dot2_f32_bf16 v255, v207, v207, v255
  v_dot2_f32_bf16 v252, v208, s16, v252
  v_dot2_f32_bf16 v253, v208, v208, v253
  v_dot2_f32_bf16 v252, v209, s16, v252
  v_dot2_f32_bf16 v253, v209, v209, v253
  v_dot2_f32_bf16 v254, v210, s16, v254
  v_dot2_f32_bf16 v255, v210, v210, v255
  v_dot2_f32_bf16 v254, v211, s16, v254
  v_dot2_f32_bf16 v255, v211, v211, v255
  v_mov_b32 v192, v252
  v_mov_b32 v193, v253
  v_mov_b32 v194, v254
  v_mov_b32 v195, v255
  v_permlane32_swap_b32 v252, v192
  v_permlane32_swap_b32 v253, v193
  v_permlane32_swap_b32 v254, v194
  v_permlane32_swap_b32 v255, v195
  v_pk_add_f32 v[252:253], v[252:253], v[192:193]
  v_pk_add_f32 v[254:255], v[254:255], v[194:195]
  v_mov_b32 v192, v252
  v_mov_b32 v193, v253
  v_mov_b32 v194, v254
  v_mov_b32 v195, v255
  v_permlane16_swap_b32 v252, v192
  v_permlane16_swap_b32 v253, v193
  v_permlane16_swap_b32 v254, v194
  v_permlane16_swap_b32 v255, v195
  v_pk_add_f32 v[252:253], v[252:253], v[192:193]
  v_pk_add_f32 v[254:255], v[254:255], v[194:195]
  s_nop 0
  v_add_f32_dpp v252, v252, v252 row_ror:8 row_mask:0xf bank_mask:0xf
  v_add_f32_dpp v253, v253, v253 row_ror:8 row_mask:0xf bank_mask:0xf
  v_add_f32_dpp v254, v254, v254 row_ror:8 row_mask:0xf bank_mask:0xf
  v_add_f32_dpp v255, v255, v255 row_ror:8 row_mask:0xf bank_mask:0xf
  v_add_u32 v6, 6144, v182
  v_add_u32 v6, s27, v6
  ds_write_b128 v6, v[252:255]
  s_waitcnt lgkmcnt(0)
  s_barrier
  v_mfma_f32_16x16x32_bf16 v[32:35], a[204:207], v[144:147], v[32:35]
  ds_read2st64_b64 v[128:131], v8 offset0:36 offset1:37
  v_mfma_f32_16x16x32_bf16 v[36:39], a[208:211], v[144:147], v[36:39]
  v_mfma_f32_16x16x32_bf16 v[40:43], a[212:215], v[144:147], v[40:43]
  v_mfma_f32_16x16x32_bf16 v[44:47], a[204:207], v[148:151], v[44:47]
  ds_read2st64_b64 v[132:135], v9 offset0:36 offset1:37
  v_mfma_f32_16x16x32_bf16 v[48:51], a[208:211], v[148:151], v[48:51]
  v_mfma_f32_16x16x32_bf16 v[52:55], a[212:215], v[148:151], v[52:55]
  v_mfma_f32_16x16x32_bf16 v[56:59], a[204:207], v[152:155], v[56:59]
  ds_read2st64_b64 v[136:139], v10 offset0:36 offset1:37
  v_mfma_f32_16x16x32_bf16 v[60:63], a[208:211], v[152:155], v[60:63]
  v_mfma_f32_16x16x32_bf16 v[64:67], a[212:215], v[152:155], v[64:67]
  v_mfma_f32_16x16x32_bf16 v[68:71], a[204:207], v[156:159], v[68:71]
  ds_read2st64_b64 v[140:143], v11 offset0:36 offset1:37
  v_mfma_f32_16x16x32_bf16 v[72:75], a[208:211], v[156:159], v[72:75]
  v_mfma_f32_16x16x32_bf16 v[76:79], a[212:215], v[156:159], v[76:79]
  s_barrier
  s_waitcnt lgkmcnt(0)
  v_mfma_f32_16x16x32_bf16 v[32:35], a[216:219], v[128:131], v[32:35]
  ds_read2st64_b64 v[144:147], v8 offset0:38 offset1:39
  v_mfma_f32_16x16x32_bf16 v[36:39], a[220:223], v[128:131], v[36:39]
  v_mfma_f32_16x16x32_bf16 v[40:43], a[224:227], v[128:131], v[40:43]
  v_mfma_f32_16x16x32_bf16 v[44:47], a[216:219], v[132:135], v[44:47]
  ds_read2st64_b64 v[148:151], v9 offset0:38 offset1:39
  buffer_load_dwordx2 v[176:177], v186, s[72:75], s24 offen offset:0 sc1
  v_mfma_f32_16x16x32_bf16 v[48:51], a[220:223], v[132:135], v[48:51]
  s_add_u32 m0, s6, 90112
  s_add_u32 s10, s7, 90112
  buffer_load_dwordx4 v2, s[44:47], s10 offen offset:0 sc1 lds
  v_mfma_f32_16x16x32_bf16 v[52:55], a[224:227], v[132:135], v[52:55]
  v_mfma_f32_16x16x32_bf16 v[56:59], a[216:219], v[136:139], v[56:59]
  ds_read2st64_b64 v[152:155], v10 offset0:38 offset1:39
  v_mfma_f32_16x16x32_bf16 v[60:63], a[220:223], v[136:139], v[60:63]
  v_mfma_f32_16x16x32_bf16 v[64:67], a[224:227], v[136:139], v[64:67]
  v_mfma_f32_16x16x32_bf16 v[68:71], a[216:219], v[140:143], v[68:71]
  ds_read2st64_b64 v[156:159], v11 offset0:38 offset1:39
  v_mfma_f32_16x16x32_bf16 v[72:75], a[220:223], v[140:143], v[72:75]
  v_mfma_f32_16x16x32_bf16 v[76:79], a[224:227], v[140:143], v[76:79]
  s_waitcnt vmcnt(5)
  s_mov_b32 s35, 0
  s_nop 5
W2W1:
  v_cmp_ne_u64 vcc, s[90:91], v[190:191]
  s_nop 4
  s_cbranch_vccz W2K1
  s_add_u32 s35, s35, 1
  s_cmp_ge_u32 s35, 0x8000
  s_cbranch_scc1 W2K1
  s_sleep 2
  buffer_load_dwordx2 v[190:191], v188, s[92:95], s37 offen sc1
  s_waitcnt vmcnt(0)
  s_branch W2W1
W2K1:
  s_barrier
  s_waitcnt lgkmcnt(0)
  v_mfma_f32_16x16x32_bf16 v[32:35], a[228:231], v[144:147], v[32:35]
  ds_read2st64_b64 v[128:131], v12 offset0:0 offset1:1
  v_mfma_f32_16x16x32_bf16 v[36:39], a[232:235], v[144:147], v[36:39]
  v_mfma_f32_16x16x32_bf16 v[40:43], a[236:239], v[144:147], v[40:43]
  v_mfma_f32_16x16x32_bf16 v[44:47], a[228:231], v[148:151], v[44:47]
  ds_read2st64_b64 v[132:135], v13 offset0:0 offset1:1
  v_mfma_f32_16x16x32_bf16 v[48:51], a[232:235], v[148:151], v[48:51]
  v_mfma_f32_16x16x32_bf16 v[52:55], a[236:239], v[148:151], v[52:55]
  v_mfma_f32_16x16x32_bf16 v[56:59], a[228:231], v[152:155], v[56:59]
  ds_read2st64_b64 v[136:139], v14 offset0:0 offset1:1
  v_mfma_f32_16x16x32_bf16 v[60:63], a[232:235], v[152:155], v[60:63]
  v_mfma_f32_16x16x32_bf16 v[64:67], a[236:239], v[152:155], v[64:67]
  v_mfma_f32_16x16x32_bf16 v[68:71], a[228:231], v[156:159], v[68:71]
  ds_read2st64_b64 v[140:143], v15 offset0:0 offset1:1
  v_mfma_f32_16x16x32_bf16 v[72:75], a[232:235], v[156:159], v[72:75]
  v_mfma_f32_16x16x32_bf16 v[76:79], a[236:239], v[156:159], v[76:79]
  s_barrier
  s_waitcnt lgkmcnt(0)
  v_mfma_f32_16x16x32_bf16 v[80:83], a[0:3], v[128:131], 0
  ds_read2st64_b64 v[144:147], v12 offset0:2 offset1:3
  v_mfma_f32_16x16x32_bf16 v[84:87], a[4:7], v[128:131], 0
  v_mfma_f32_16x16x32_bf16 v[88:91], a[8:11], v[128:131], 0
  v_mfma_f32_16x16x32_bf16 v[92:95], a[0:3], v[132:135], 0
  ds_read2st64_b64 v[148:151], v13 offset0:2 offset1:3
  v_mfma_f32_16x16x32_bf16 v[96:99], a[4:7], v[132:135], 0
  v_mfma_f32_16x16x32_bf16 v[100:103], a[8:11], v[132:135], 0
  v_mfma_f32_16x16x32_bf16 v[104:107], a[0:3], v[136:139], 0
  ds_read2st64_b64 v[152:155], v14 offset0:2 offset1:3
  v_mfma_f32_16x16x32_bf16 v[108:111], a[4:7], v[136:139], 0
  v_mfma_f32_16x16x32_bf16 v[112:115], a[8:11], v[136:139], 0
  v_mfma_f32_16x16x32_bf16 v[116:119], a[0:3], v[140:143], 0
  ds_read2st64_b64 v[156:159], v15 offset0:2 offset1:3
  v_mfma_f32_16x16x32_bf16 v[120:123], a[4:7], v[140:143], 0
  v_mfma_f32_16x16x32_bf16 v[124:127], a[8:11], v[140:143], 0
  s_barrier
  s_waitcnt lgkmcnt(0)
  v_mfma_f32_16x16x32_bf16 v[80:83], a[12:15], v[144:147], v[80:83]
  ds_read2st64_b64 v[128:131], v12 offset0:4 offset1:5
  v_mfma_f32_16x16x32_bf16 v[84:87], a[16:19], v[144:147], v[84:87]
  v_mfma_f32_16x16x32_bf16 v[88:91], a[20:23], v[144:147], v[88:91]
  v_mfma_f32_16x16x32_bf16 v[92:95], a[12:15], v[148:151], v[92:95]
  ds_read2st64_b64 v[132:135], v13 offset0:4 offset1:5
  s_add_u32 s11, s22, 0
  buffer_load_dwordx4 a[0:3], v2, s[68:71], s11 offen offset:0 sc1
  v_mfma_f32_16x16x32_bf16 v[96:99], a[16:19], v[148:151], v[96:99]
  buffer_load_dwordx4 a[4:7], v2, s[68:71], s11 offen offset:1024 sc1
  v_mfma_f32_16x16x32_bf16 v[100:103], a[20:23], v[148:151], v[100:103]
  buffer_load_dwordx4 a[8:11], v2, s[68:71], s11 offen offset:2048 sc1
  buffer_load_dwordx4 v2, s[44:47], s10 offen offset:1024 sc1 lds
  v_mfma_f32_16x16x32_bf16 v[104:107], a[12:15], v[152:155], v[104:107]
  ds_read2st64_b64 v[136:139], v14 offset0:4 offset1:5
  v_mfma_f32_16x16x32_bf16 v[108:111], a[16:19], v[152:155], v[108:111]
  v_mfma_f32_16x16x32_bf16 v[112:115], a[20:23], v[152:155], v[112:115]
  v_mfma_f32_16x16x32_bf16 v[116:119], a[12:15], v[156:159], v[116:119]
  ds_read2st64_b64 v[140:143], v15 offset0:4 offset1:5
  v_mfma_f32_16x16x32_bf16 v[120:123], a[16:19], v[156:159], v[120:123]
  v_mfma_f32_16x16x32_bf16 v[124:127], a[20:23], v[156:159], v[124:127]
  s_mov_b32 s35, 0
  s_nop 6
K3_STCHK01:
  s_waitcnt vmcnt(5)
  v_cmp_eq_u32 vcc, 0, v177
  s_nop 4
  s_cbranch_vccz K3_STOK01
  s_add_u32 s35, s35, 1
  s_cmp_ge_u32 s35, 0x4000
  s_cbranch_scc1 K3_STOK01
  s_sleep 2
  buffer_load_dwordx2 v[176:177], v186, s[72:75], s24 offen offset:0 sc1
  s_waitcnt vmcnt(0)
  s_branch K3_STCHK01
K3_STOK01:
  s_barrier
  s_waitcnt lgkmcnt(0)
  v_mfma_f32_16x16x32_bf16 v[80:83], a[24:27], v[128:131], v[80:83]
  ds_read2st64_b64 v[144:147], v12 offset0:6 offset1:7
  ds_write_b64 v183, v[176:177] offset:4096
  v_mov_b32 v232, v228
  v_mfma_f32_16x16x32_bf16 v[84:87], a[28:31], v[128:131], v[84:87]
  v_mov_b32 v233, v229
  v_mov_b32 v234, v230
  v_mov_b32 v235, v231
  v_mfma_f32_16x16x32_bf16 v[88:91], a[32:35], v[128:131], v[88:91]
  v_permlane32_swap_b32 v228, v232
  v_permlane32_swap_b32 v229, v233
  v_permlane32_swap_b32 v230, v234
  v_mfma_f32_16x16x32_bf16 v[92:95], a[24:27], v[132:135], v[92:95]
  ds_read2st64_b64 v[148:151], v13 offset0:6 offset1:7
  buffer_load_dwordx4 a[12:15], v2, s[68:71], s11 offen offset:3072 sc1
  v_mfma_f32_16x16x32_bf16 v[96:99], a[28:31], v[132:135], v[96:99]
  s_add_u32 s11, s22, 4096
  buffer_load_dwordx4 a[16:19], v2, s[68:71], s11 offen offset:0 sc1
  v_mfma_f32_16x16x32_bf16 v[100:103], a[32:35], v[132:135], v[100:103]
  buffer_load_dwordx4 a[20:23], v2, s[68:71], s11 offen offset:1024 sc1
  buffer_load_dwordx4 v2, s[44:47], s10 offen offset:2048 sc1 lds
  v_mfma_f32_16x16x32_bf16 v[104:107], a[24:27], v[136:139], v[104:107]
  ds_read2st64_b64 v[152:155], v14 offset0:6 offset1:7
  v_permlane32_swap_b32 v231, v235
  v_add_f32 v228, v228, v232
  v_mfma_f32_16x16x32_bf16 v[108:111], a[28:31], v[136:139], v[108:111]
  v_add_f32 v229, v229, v233
  v_add_f32 v230, v230, v234
  v_add_f32 v231, v231, v235
  v_mfma_f32_16x16x32_bf16 v[112:115], a[32:35], v[136:139], v[112:115]
  v_mov_b32 v232, v228
  v_mov_b32 v233, v229
  v_mov_b32 v234, v230
  v_mfma_f32_16x16x32_bf16 v[116:119], a[24:27], v[140:143], v[116:119]
  ds_read2st64_b64 v[156:159], v15 offset0:6 offset1:7
  v_mov_b32 v235, v231
  v_permlane16_swap_b32 v228, v232
  v_mfma_f32_16x16x32_bf16 v[120:123], a[28:31], v[140:143], v[120:123]
  v_permlane16_swap_b32 v229, v233
  v_permlane16_swap_b32 v230, v234
  v_permlane16_swap_b32 v231, v235
  v_mfma_f32_16x16x32_bf16 v[124:127], a[32:35], v[140:143], v[124:127]
  v_add_f32 v228, v228, v232
  v_add_f32 v229, v229, v233
  v_add_f32 v230, v230, v234
  s_barrier
  s_waitcnt lgkmcnt(0)
  v_mfma_f32_16x16x32_bf16 v[80:83], a[36:39], v[144:147], v[80:83]
  ds_read2st64_b64 v[128:131], v12 offset0:8 offset1:9
  v_add_f32 v231, v231, v235
  ds_write_b128 v185, v[228:231] offset:5120
  v_mfma_f32_16x16x32_bf16 v[84:87], a[40:43], v[144:147], v[84:87]
  ds_read_b64 v[192:193], v184 offset:4224
  ds_read_b64 v[196:197], v184 offset:4352
  ds_read_b64 v[200:201], v184 offset:4480
  v_mfma_f32_16x16x32_bf16 v[88:91], a[44:47], v[144:147], v[88:91]
  ds_read_b64 v[204:205], v184 offset:4096
  ds_read2_b64 v[16:19], v187 offset0:0 offset1:2
  ds_read2_b64 v[20:23], v187 offset0:8 offset1:10
  v_mfma_f32_16x16x32_bf16 v[92:95], a[36:39], v[148:151], v[92:95]
  ds_read2st64_b64 v[132:135], v13 offset0:8 offset1:9
  buffer_load_dwordx4 a[24:27], v2, s[68:71], s11 offen offset:2048 sc1
  v_mfma_f32_16x16x32_bf16 v[96:99], a[40:43], v[148:151], v[96:99]
  buffer_load_dwordx4 a[28:31], v2, s[68:71], s11 offen offset:3072 sc1
  v_mfma_f32_16x16x32_bf16 v[100:103], a[44:47], v[148:151], v[100:103]
  s_add_u32 s11, s22, 8192
  buffer_load_dwordx4 a[32:35], v2, s[68:71], s11 offen offset:0 sc1
  buffer_load_dwordx4 v2, s[44:47], s10 offen offset:3072 sc1 lds
  v_mfma_f32_16x16x32_bf16 v[104:107], a[36:39], v[152:155], v[104:107]
  ds_read2st64_b64 v[136:139], v14 offset0:8 offset1:9
  ds_read2_b64 v[24:27], v187 offset0:16 offset1:18
  v_mov_b32 v181, v30
  v_mfma_f32_16x16x32_bf16 v[108:111], a[40:43], v[152:155], v[108:111]
  v_mov_b32 v28, 1
  v_mov_b32 v29, 0
  v_mov_b32 v4, 0xbfb8aa3b
  v_mfma_f32_16x16x32_bf16 v[112:115], a[44:47], v[152:155], v[112:115]
  s_waitcnt lgkmcnt(0)
  v_rcp_f32 v194, v193
  v_rcp_f32 v198, v197
  v_mfma_f32_16x16x32_bf16 v[116:119], a[36:39], v[156:159], v[116:119]
  ds_read2st64_b64 v[140:143], v15 offset0:8 offset1:9
  v_rcp_f32 v202, v201
  v_rcp_f32 v206, v205
  v_mfma_f32_16x16x32_bf16 v[120:123], a[40:43], v[156:159], v[120:123]
  v_mul_f32 v193, v193, v193
  v_mul_f32 v197, v197, v197
  v_mul_f32 v201, v201, v201
  v_mfma_f32_16x16x32_bf16 v[124:127], a[44:47], v[156:159], v[124:127]
  v_mul_f32 v205, v205, v205
  v_mul_f32 v194, v194, v4
  v_mul_f32 v198, v198, v4
  s_barrier
  s_waitcnt lgkmcnt(0)
  v_mfma_f32_16x16x32_bf16 v[80:83], a[48:51], v[128:131], v[80:83]
  ds_read2st64_b64 v[144:147], v12 offset0:10 offset1:11
  v_mul_f32 v202, v202, v4
  v_mul_f32 v206, v206, v4
  v_mfma_f32_16x16x32_bf16 v[84:87], a[52:55], v[128:131], v[84:87]
  v_fma_f32 v32, -v192, v16, v32
  v_fma_f32 v36, -v192, v20, v36
  v_fma_f32 v40, -v192, v24, v40
  v_mfma_f32_16x16x32_bf16 v[88:91], a[56:59], v[128:131], v[88:91]
  v_fma_f32 v33, -v192, v17, v33
  v_fma_f32 v37, -v192, v21, v37
  v_fma_f32 v41, -v192, v25, v41
  v_mfma_f32_16x16x32_bf16 v[92:95], a[48:51], v[132:135], v[92:95]
  ds_read2st64_b64 v[148:151], v13 offset0:10 offset1:11
  buffer_load_dwordx4 a[36:39], v2, s[68:71], s11 offen offset:1024 sc1
  v_mfma_f32_16x16x32_bf16 v[96:99], a[52:55], v[132:135], v[96:99]
  buffer_load_dwordx4 a[40:43], v2, s[68:71], s11 offen offset:2048 sc1
  v_mfma_f32_16x16x32_bf16 v[100:103], a[56:59], v[132:135], v[100:103]
  buffer_load_dwordx4 a[44:47], v2, s[68:71], s11 offen offset:3072 sc1
  s_add_u32 m0, s6, 94208
  s_add_u32 s10, s7, 94208
  buffer_load_dwordx4 v2, s[44:47], s10 offen offset:0 sc1 lds
  v_mfma_f32_16x16x32_bf16 v[104:107], a[48:51], v[136:139], v[104:107]
  ds_read2st64_b64 v[152:155], v14 offset0:10 offset1:11
  v_mul_f32 v232, v32, v194
  v_mul_f32 v234, v36, v194
  v_mfma_f32_16x16x32_bf16 v[108:111], a[52:55], v[136:139], v[108:111]
  v_mul_f32 v236, v40, v194
  v_mul_f32 v233, v33, v194
  v_mul_f32 v235, v37, v194
  v_mfma_f32_16x16x32_bf16 v[112:115], a[56:59], v[136:139], v[112:115]
  v_mul_f32 v237, v41, v194
  v_exp_f32 v232, v232
  v_mfma_f32_16x16x32_bf16 v[116:119], a[48:51], v[140:143], v[116:119]
  ds_read2st64_b64 v[156:159], v15 offset0:10 offset1:11
  v_exp_f32 v234, v234
  v_mfma_f32_16x16x32_bf16 v[120:123], a[52:55], v[140:143], v[120:123]
  v_exp_f32 v236, v236
  v_fma_f32 v34, -v192, v18, v34
  v_mfma_f32_16x16x32_bf16 v[124:127], a[56:59], v[140:143], v[124:127]
  v_fma_f32 v38, -v192, v22, v38
  v_fma_f32 v42, -v192, v26, v42
  v_exp_f32 v233, v233
  s_barrier
  s_waitcnt lgkmcnt(0)
  v_mfma_f32_16x16x32_bf16 v[80:83], a[60:63], v[144:147], v[80:83]
  ds_read2st64_b64 v[128:131], v12 offset0:12 offset1:13
  v_exp_f32 v235, v235
  v_mfma_f32_16x16x32_bf16 v[84:87], a[64:67], v[144:147], v[84:87]
  v_exp_f32 v237, v237
  v_fma_f32 v35, -v192, v19, v35
  v_mfma_f32_16x16x32_bf16 v[88:91], a[68:71], v[144:147], v[88:91]
  v_fma_f32 v39, -v192, v23, v39
  v_fma_f32 v43, -v192, v27, v43
  v_mul_f32 v32, v32, v34
  v_mfma_f32_16x16x32_bf16 v[92:95], a[60:63], v[148:151], v[92:95]
  ds_read2st64_b64 v[132:135], v13 offset0:12 offset1:13
  s_add_u32 s11, s22, 12288
  buffer_load_dwordx4 a[48:51], v2, s[68:71], s11 offen offset:0 sc1
  v_mfma_f32_16x16x32_bf16 v[96:99], a[64:67], v[148:151], v[96:99]
  buffer_load_dwordx4 a[52:55], v2, s[68:71], s11 offen offset:1024 sc1
  v_mfma_f32_16x16x32_bf16 v[100:103], a[68:71], v[148:151], v[100:103]
  buffer_load_dwordx4 a[56:59], v2, s[68:71], s11 offen offset:2048 sc1
  buffer_load_dwordx4 v2, s[44:47], s10 offen offset:1024 sc1 lds
  v_mfma_f32_16x16x32_bf16 v[104:107], a[60:63], v[152:155], v[104:107]
  ds_read2st64_b64 v[136:139], v14 offset0:12 offset1:13
  v_mul_f32 v36, v36, v38
  v_mul_f32 v40, v40, v42
  v_mfma_f32_16x16x32_bf16 v[108:111], a[64:67], v[152:155], v[108:111]
  v_mul_f32 v33, v33, v35
  v_mul_f32 v37, v37, v39
  v_mul_f32 v41, v41, v43
  v_mfma_f32_16x16x32_bf16 v[112:115], a[68:71], v[152:155], v[112:115]
  v_fma_f32 v232, v232, v193, v193
  v_fma_f32 v234, v234, v193, v193
  v_fma_f32 v236, v236, v193, v193
  v_mfma_f32_16x16x32_bf16 v[116:119], a[60:63], v[156:159], v[116:119]
  ds_read2st64_b64 v[140:143], v15 offset0:12 offset1:13
  v_fma_f32 v233, v233, v193, v193
  v_fma_f32 v235, v235, v193, v193
  v_mfma_f32_16x16x32_bf16 v[120:123], a[64:67], v[156:159], v[120:123]
  v_fma_f32 v237, v237, v193, v193
  v_rcp_f32 v232, v232
  v_mfma_f32_16x16x32_bf16 v[124:127], a[68:71], v[156:159], v[124:127]
  v_rcp_f32 v234, v234
  v_rcp_f32 v236, v236
  s_barrier
  s_waitcnt lgkmcnt(0)
  v_mfma_f32_16x16x32_bf16 v[80:83], a[72:75], v[128:131], v[80:83]
  ds_read2st64_b64 v[144:147], v12 offset0:14 offset1:15
  v_rcp_f32 v233, v233
  v_mfma_f32_16x16x32_bf16 v[84:87], a[76:79], v[128:131], v[84:87]
  v_rcp_f32 v235, v235
  v_rcp_f32 v237, v237
  v_mfma_f32_16x16x32_bf16 v[88:91], a[80:83], v[128:131], v[88:91]
  v_mul_f32 v32, v32, v232
  v_mul_f32 v36, v36, v234
  v_mul_f32 v40, v40, v236
  v_mfma_f32_16x16x32_bf16 v[92:95], a[72:75], v[132:135], v[92:95]
  ds_read2st64_b64 v[148:151], v13 offset0:14 offset1:15
  buffer_load_dwordx4 a[60:63], v2, s[68:71], s11 offen offset:3072 sc1
  v_mfma_f32_16x16x32_bf16 v[96:99], a[76:79], v[132:135], v[96:99]
  s_add_u32 s11, s22, 16384
  buffer_load_dwordx4 a[64:67], v2, s[68:71], s11 offen offset:0 sc1
  v_mfma_f32_16x16x32_bf16 v[100:103], a[80:83], v[132:135], v[100:103]
  buffer_load_dwordx4 a[68:71], v2, s[68:71], s11 offen offset:1024 sc1
  buffer_load_dwordx4 v2, s[44:47], s10 offen offset:2048 sc1 lds
  v_mfma_f32_16x16x32_bf16 v[104:107], a[72:75], v[136:139], v[104:107]
  ds_read2st64_b64 v[152:155], v14 offset0:14 offset1:15
  v_mul_f32 v33, v33, v233
  v_mul_f32 v37, v37, v235
  v_mfma_f32_16x16x32_bf16 v[108:111], a[76:79], v[136:139], v[108:111]
  v_mul_f32 v41, v41, v237
  v_cvt_pk_bf16_f32 v224, v32, v33
  v_cvt_pk_bf16_f32 v225, v36, v37
  v_mfma_f32_16x16x32_bf16 v[112:115], a[80:83], v[136:139], v[112:115]
  v_cvt_pk_bf16_f32 v226, v40, v41
  v_add_u32 v6, v8, v181
  ds_write_b96 v6, v[224:226] offset:1024
  v_mfma_f32_16x16x32_bf16 v[116:119], a[72:75], v[140:143], v[116:119]
  ds_read2st64_b64 v[156:159], v15 offset0:14 offset1:15
  v_fma_f32 v44, -v196, v16, v44
  v_fma_f32 v48, -v196, v20, v48
  v_mfma_f32_16x16x32_bf16 v[120:123], a[76:79], v[140:143], v[120:123]
  v_fma_f32 v52, -v196, v24, v52
  v_fma_f32 v45, -v196, v17, v45
  v_fma_f32 v49, -v196, v21, v49
  v_mfma_f32_16x16x32_bf16 v[124:127], a[80:83], v[140:143], v[124:127]
  v_fma_f32 v53, -v196, v25, v53
  v_mul_f32 v232, v44, v198
  v_mul_f32 v234, v48, v198
  s_waitcnt vmcnt(24)
  s_barrier
  s_waitcnt lgkmcnt(0)
  v_mfma_f32_16x16x32_bf16 v[80:83], a[84:87], v[144:147], v[80:83]
  ds_read2st64_b64 v[128:131], v12 offset0:16 offset1:17
  v_mul_f32 v236, v52, v198
  v_mul_f32 v233, v45, v198
  v_mfma_f32_16x16x32_bf16 v[84:87], a[88:91], v[144:147], v[84:87]
  v_mul_f32 v235, v49, v198
  v_mul_f32 v237, v53, v198
  v_exp_f32 v232, v232
  v_mfma_f32_16x16x32_bf16 v[88:91], a[92:95], v[144:147], v[88:91]
  v_exp_f32 v234, v234
  v_exp_f32 v236, v236
  v_mfma_f32_16x16x32_bf16 v[92:95], a[84:87], v[148:151], v[92:95]
  ds_read2st64_b64 v[132:135], v13 offset0:16 offset1:17
  buffer_load_dwordx4 a[72:75], v2, s[68:71], s11 offen offset:2048 sc1
  v_mfma_f32_16x16x32_bf16 v[96:99], a[88:91], v[148:151], v[96:99]
  buffer_load_dwordx4 a[76:79], v2, s[68:71], s11 offen offset:3072 sc1
  v_mfma_f32_16x16x32_bf16 v[100:103], a[92:95], v[148:151], v[100:103]
  s_add_u32 s11, s22, 20480
  buffer_load_dwordx4 a[80:83], v2, s[68:71], s11 offen offset:0 sc1
  buffer_load_dwordx4 v2, s[44:47], s10 offen offset:3072 sc1 lds
  v_mfma_f32_16x16x32_bf16 v[104:107], a[84:87], v[152:155], v[104:107]
  ds_read2st64_b64 v[136:139], v14 offset0:16 offset1:17
  v_fma_f32 v46, -v196, v18, v46
  v_fma_f32 v50, -v196, v22, v50
  v_mfma_f32_16x16x32_bf16 v[108:111], a[88:91], v[152:155], v[108:111]
  v_fma_f32 v54, -v196, v26, v54
  v_exp_f32 v233, v233
  v_mfma_f32_16x16x32_bf16 v[112:115], a[92:95], v[152:155], v[112:115]
  v_exp_f32 v235, v235
  v_exp_f32 v237, v237
  v_mfma_f32_16x16x32_bf16 v[116:119], a[84:87], v[156:159], v[116:119]
  ds_read2st64_b64 v[140:143], v15 offset0:16 offset1:17
  v_fma_f32 v47, -v196, v19, v47
  v_fma_f32 v51, -v196, v23, v51
  v_mfma_f32_16x16x32_bf16 v[120:123], a[88:91], v[156:159], v[120:123]
  v_fma_f32 v55, -v196, v27, v55
  v_mul_f32 v44, v44, v46
  v_mul_f32 v48, v48, v50
  v_mfma_f32_16x16x32_bf16 v[124:127], a[92:95], v[156:159], v[124:127]
  v_mul_f32 v52, v52, v54
  v_mul_f32 v45, v45, v47
  v_mul_f32 v49, v49, v51
  s_waitcnt vmcnt(24)
  s_barrier
  s_waitcnt lgkmcnt(0)
  v_mfma_f32_16x16x32_bf16 v[80:83], a[96:99], v[128:131], v[80:83]
  ds_read2st64_b64 v[144:147], v12 offset0:18 offset1:19
  v_mul_f32 v53, v53, v55
  v_fma_f32 v232, v232, v197, v197
  v_mfma_f32_16x16x32_bf16 v[84:87], a[100:103], v[128:131], v[84:87]
  v_fma_f32 v234, v234, v197, v197
  v_fma_f32 v236, v236, v197, v197
  v_fma_f32 v233, v233, v197, v197
  v_mfma_f32_16x16x32_bf16 v[88:91], a[104:107], v[128:131], v[88:91]
  v_fma_f32 v235, v235, v197, v197
  v_fma_f32 v237, v237, v197, v197
  v_rcp_f32 v232, v232
  v_mfma_f32_16x16x32_bf16 v[92:95], a[96:99], v[132:135], v[92:95]
  ds_read2st64_b64 v[148:151], v13 offset0:18 offset1:19
  buffer_load_dwordx4 a[84:87], v2, s[68:71], s11 offen offset:1024 sc1
  v_mfma_f32_16x16x32_bf16 v[96:99], a[100:103], v[132:135], v[96:99]
  buffer_load_dwordx4 a[88:91], v2, s[68:71], s11 offen offset:2048 sc1
  v_mfma_f32_16x16x32_bf16 v[100:103], a[104:107], v[132:135], v[100:103]
  buffer_load_dwordx4 a[92:95], v2, s[68:71], s11 offen offset:3072 sc1
  s_add_u32 m0, s6, 98304
  s_add_u32 s10, s7, 98304
  buffer_load_dwordx4 v2, s[44:47], s10 offen offset:0 sc1 lds
  v_mfma_f32_16x16x32_bf16 v[104:107], a[96:99], v[136:139], v[104:107]
  ds_read2st64_b64 v[152:155], v14 offset0:18 offset1:19
  v_rcp_f32 v234, v234
  v_mfma_f32_16x16x32_bf16 v[108:111], a[100:103], v[136:139], v[108:111]
  v_rcp_f32 v236, v236
  v_rcp_f32 v233, v233
  v_mfma_f32_16x16x32_bf16 v[112:115], a[104:107], v[136:139], v[112:115]
  v_rcp_f32 v235, v235
  v_rcp_f32 v237, v237
  v_mfma_f32_16x16x32_bf16 v[116:119], a[96:99], v[140:143], v[116:119]
  ds_read2st64_b64 v[156:159], v15 offset0:18 offset1:19
  v_mul_f32 v44, v44, v232
  v_mul_f32 v48, v48, v234
  v_mfma_f32_16x16x32_bf16 v[120:123], a[100:103], v[140:143], v[120:123]
  v_mul_f32 v52, v52, v236
  v_mul_f32 v45, v45, v233
  v_mul_f32 v49, v49, v235
  v_mfma_f32_16x16x32_bf16 v[124:127], a[104:107], v[140:143], v[124:127]
  v_mul_f32 v53, v53, v237
  v_cvt_pk_bf16_f32 v228, v44, v45
  v_cvt_pk_bf16_f32 v229, v48, v49
  s_waitcnt vmcnt(24)
  s_barrier
  s_waitcnt lgkmcnt(0)
  v_mfma_f32_16x16x32_bf16 v[80:83], a[108:111], v[144:147], v[80:83]
  ds_read2st64_b64 v[128:131], v12 offset0:20 offset1:21
  v_cvt_pk_bf16_f32 v230, v52, v53
  v_add_u32 v6, v9, v181
  v_mfma_f32_16x16x32_bf16 v[84:87], a[112:115], v[144:147], v[84:87]
  ds_write_b96 v6, v[228:230] offset:1024
  v_fma_f32 v56, -v200, v16, v56
  v_fma_f32 v60, -v200, v20, v60
  v_mfma_f32_16x16x32_bf16 v[88:91], a[116:119], v[144:147], v[88:91]
  v_fma_f32 v64, -v200, v24, v64
  v_fma_f32 v57, -v200, v17, v57
  v_fma_f32 v61, -v200, v21, v61
  v_mfma_f32_16x16x32_bf16 v[92:95], a[108:111], v[148:151], v[92:95]
  ds_read2st64_b64 v[132:135], v13 offset0:20 offset1:21
  s_add_u32 s11, s22, 24576
  buffer_load_dwordx4 a[96:99], v2, s[68:71], s11 offen offset:0 sc1
  v_mfma_f32_16x16x32_bf16 v[96:99], a[112:115], v[148:151], v[96:99]
  buffer_load_dwordx4 a[100:103], v2, s[68:71], s11 offen offset:1024 sc1
  v_mfma_f32_16x16x32_bf16 v[100:103], a[116:119], v[148:151], v[100:103]
  buffer_load_dwordx4 a[104:107], v2, s[68:71], s11 offen offset:2048 sc1
  buffer_load_dwordx4 v2, s[44:47], s10 offen offset:1024 sc1 lds
  v_mfma_f32_16x16x32_bf16 v[104:107], a[108:111], v[152:155], v[104:107]
  ds_read2st64_b64 v[136:139], v14 offset0:20 offset1:21
  v_fma_f32 v65, -v200, v25, v65
  v_mul_f32 v232, v56, v202
  v_mfma_f32_16x16x32_bf16 v[108:111], a[112:115], v[152:155], v[108:111]
  v_mul_f32 v234, v60, v202
  v_mul_f32 v236, v64, v202
  v_mul_f32 v233, v57, v202
  v_mfma_f32_16x16x32_bf16 v[112:115], a[116:119], v[152:155], v[112:115]
  v_mul_f32 v235, v61, v202
  v_mul_f32 v237, v65, v202
  v_exp_f32 v232, v232
  v_mfma_f32_16x16x32_bf16 v[116:119], a[108:111], v[156:159], v[116:119]
  ds_read2st64_b64 v[140:143], v15 offset0:20 offset1:21
  v_exp_f32 v234, v234
  v_mfma_f32_16x16x32_bf16 v[120:123], a[112:115], v[156:159], v[120:123]
  v_exp_f32 v236, v236
  v_fma_f32 v58, -v200, v18, v58
  v_mfma_f32_16x16x32_bf16 v[124:127], a[116:119], v[156:159], v[124:127]
  v_fma_f32 v62, -v200, v22, v62
  v_fma_f32 v66, -v200, v26, v66
  v_exp_f32 v233, v233
  s_waitcnt vmcnt(24)
  s_barrier
  s_waitcnt lgkmcnt(0)
  v_mfma_f32_16x16x32_bf16 v[80:83], a[120:123], v[128:131], v[80:83]
  ds_read2st64_b64 v[144:147], v12 offset0:22 offset1:23
  v_exp_f32 v235, v235
  v_mfma_f32_16x16x32_bf16 v[84:87], a[124:127], v[128:131], v[84:87]
  v_exp_f32 v237, v237
  v_fma_f32 v59, -v200, v19, v59
  v_mfma_f32_16x16x32_bf16 v[88:91], a[128:131], v[128:131], v[88:91]
  v_fma_f32 v63, -v200, v23, v63
  v_fma_f32 v67, -v200, v27, v67
  v_mul_f32 v56, v56, v58
  v_mfma_f32_16x16x32_bf16 v[92:95], a[120:123], v[132:135], v[92:95]
  ds_read2st64_b64 v[148:151], v13 offset0:22 offset1:23
  buffer_load_dwordx4 a[108:111], v2, s[68:71], s11 offen offset:3072 sc1
  v_mfma_f32_16x16x32_bf16 v[96:99], a[124:127], v[132:135], v[96:99]
  s_add_u32 s11, s22, 28672
  buffer_load_dwordx4 a[112:115], v2, s[68:71], s11 offen offset:0 sc1
  v_mfma_f32_16x16x32_bf16 v[100:103], a[128:131], v[132:135], v[100:103]
  buffer_load_dwordx4 a[116:119], v2, s[68:71], s11 offen offset:1024 sc1
  buffer_load_dwordx4 v2, s[44:47], s10 offen offset:2048 sc1 lds
  v_mfma_f32_16x16x32_bf16 v[104:107], a[120:123], v[136:139], v[104:107]
  ds_read2st64_b64 v[152:155], v14 offset0:22 offset1:23
  v_mul_f32 v60, v60, v62
  v_mul_f32 v64, v64, v66
  v_mfma_f32_16x16x32_bf16 v[108:111], a[124:127], v[136:139], v[108:111]
  v_mul_f32 v57, v57, v59
  v_mul_f32 v61, v61, v63
  v_mul_f32 v65, v65, v67
  v_mfma_f32_16x16x32_bf16 v[112:115], a[128:131], v[136:139], v[112:115]
  v_fma_f32 v232, v232, v201, v201
  v_fma_f32 v234, v234, v201, v201
  v_fma_f32 v236, v236, v201, v201
  v_mfma_f32_16x16x32_bf16 v[116:119], a[120:123], v[140:143], v[116:119]
  ds_read2st64_b64 v[156:159], v15 offset0:22 offset1:23
  v_fma_f32 v233, v233, v201, v201
  v_fma_f32 v235, v235, v201, v201
  v_mfma_f32_16x16x32_bf16 v[120:123], a[124:127], v[140:143], v[120:123]
  v_fma_f32 v237, v237, v201, v201
  v_rcp_f32 v232, v232
  v_mfma_f32_16x16x32_bf16 v[124:127], a[128:131], v[140:143], v[124:127]
  v_rcp_f32 v234, v234
  v_rcp_f32 v236, v236
  s_waitcnt vmcnt(24)
  v_rcp_f32 v233, v233
  v_rcp_f32 v235, v235
  v_rcp_f32 v237, v237
  v_mul_f32 v56, v56, v232
  v_mul_f32 v60, v60, v234
  v_mul_f32 v64, v64, v236
  v_mul_f32 v57, v57, v233
  v_mul_f32 v61, v61, v235
  v_mul_f32 v65, v65, v237
  v_cvt_pk_bf16_f32 v224, v56, v57
  v_cvt_pk_bf16_f32 v225, v60, v61
  v_cvt_pk_bf16_f32 v226, v64, v65
  v_add_u32 v6, v10, v181
  ds_write_b96 v6, v[224:226] offset:1024
  v_fma_f32 v68, -v204, v16, v68
  v_fma_f32 v72, -v204, v20, v72
  v_fma_f32 v76, -v204, v24, v76
  v_fma_f32 v69, -v204, v17, v69
  v_fma_f32 v73, -v204, v21, v73
  v_fma_f32 v77, -v204, v25, v77
  v_mul_f32 v232, v68, v206
  v_mul_f32 v234, v72, v206
  v_mul_f32 v236, v76, v206
  v_mul_f32 v233, v69, v206
  v_mul_f32 v235, v73, v206
  v_mul_f32 v237, v77, v206
  v_exp_f32 v232, v232
  v_exp_f32 v234, v234
  v_exp_f32 v236, v236
  v_fma_f32 v70, -v204, v18, v70
  v_fma_f32 v74, -v204, v22, v74
  v_fma_f32 v78, -v204, v26, v78
  v_exp_f32 v233, v233
  v_exp_f32 v235, v235
  v_exp_f32 v237, v237
  v_fma_f32 v71, -v204, v19, v71
  v_fma_f32 v75, -v204, v23, v75
  v_fma_f32 v79, -v204, v27, v79
  v_mul_f32 v68, v68, v70
  v_mul_f32 v72, v72, v74
  v_mul_f32 v76, v76, v78
  v_mul_f32 v69, v69, v71
  v_mul_f32 v73, v73, v75
  v_mul_f32 v77, v77, v79
  v_fma_f32 v232, v232, v205, v205
  v_fma_f32 v234, v234, v205, v205
  v_fma_f32 v236, v236, v205, v205
  v_fma_f32 v233, v233, v205, v205
  v_fma_f32 v235, v235, v205, v205
  v_fma_f32 v237, v237, v205, v205
  v_rcp_f32 v232, v232
  v_rcp_f32 v234, v234
  v_rcp_f32 v236, v236
  v_rcp_f32 v233, v233
  v_rcp_f32 v235, v235
  v_rcp_f32 v237, v237
  v_mul_f32 v68, v68, v232
  v_mul_f32 v72, v72, v234
  v_mul_f32 v76, v76, v236
  v_mul_f32 v69, v69, v233
  v_mul_f32 v73, v73, v235
  v_mul_f32 v77, v77, v237
  v_cvt_pk_bf16_f32 v228, v68, v69
  v_cvt_pk_bf16_f32 v229, v72, v73
  v_cvt_pk_bf16_f32 v230, v76, v77
  v_add_u32 v6, v11, v181
  ds_write_b96 v6, v[228:230] offset:1024
  s_waitcnt lgkmcnt(0)
  s_barrier
  ds_read_b128 v[160:163], v31 offset:0
  ds_read_b128 v[164:167], v31 offset:1024
  ds_read_b128 v[168:171], v31 offset:2048
  v_mfma_f32_16x16x32_bf16 v[80:83], a[132:135], v[144:147], v[80:83]
  ds_read2st64_b64 v[128:131], v12 offset0:24 offset1:25
  v_mfma_f32_16x16x32_bf16 v[84:87], a[136:139], v[144:147], v[84:87]
  v_mfma_f32_16x16x32_bf16 v[88:91], a[140:143], v[144:147], v[88:91]
  v_mfma_f32_16x16x32_bf16 v[92:95], a[132:135], v[148:151], v[92:95]
  ds_read2st64_b64 v[132:135], v13 offset0:24 offset1:25
  buffer_load_dwordx4 a[120:123], v2, s[68:71], s11 offen offset:2048 sc1
  v_mfma_f32_16x16x32_bf16 v[96:99], a[136:139], v[148:151], v[96:99]
  buffer_load_dwordx4 a[124:127], v2, s[68:71], s11 offen offset:3072 sc1
  v_mfma_f32_16x16x32_bf16 v[100:103], a[140:143], v[148:151], v[100:103]
  s_add_u32 s11, s22, 32768
  buffer_load_dwordx4 a[128:131], v2, s[68:71], s11 offen offset:0 sc1
  buffer_load_dwordx4 v2, s[44:47], s10 offen offset:3072 sc1 lds
  v_mfma_f32_16x16x32_bf16 v[104:107], a[132:135], v[152:155], v[104:107]
  ds_read2st64_b64 v[136:139], v14 offset0:24 offset1:25
  v_mfma_f32_16x16x32_bf16 v[108:111], a[136:139], v[152:155], v[108:111]
  v_mfma_f32_16x16x32_bf16 v[112:115], a[140:143], v[152:155], v[112:115]
  v_mfma_f32_16x16x32_bf16 v[116:119], a[132:135], v[156:159], v[116:119]
  ds_read2st64_b64 v[140:143], v15 offset0:24 offset1:25
  v_mfma_f32_16x16x32_bf16 v[120:123], a[136:139], v[156:159], v[120:123]
  v_mfma_f32_16x16x32_bf16 v[124:127], a[140:143], v[156:159], v[124:127]
  s_waitcnt vmcnt(24)
  s_barrier
  s_waitcnt lgkmcnt(4)
  buffer_store_dwordx4 v[160:163], v2, s[56:59], s60 offen offset:0 sc1
  buffer_store_dwordx4 v[164:167], v2, s[56:59], s60 offen offset:1024 sc1
  buffer_store_dwordx4 v[168:171], v2, s[56:59], s60 offen offset:2048 sc1
  s_waitcnt lgkmcnt(0)
  v_mfma_f32_16x16x32_bf16 v[80:83], a[144:147], v[128:131], v[80:83]
  ds_read2st64_b64 v[144:147], v12 offset0:26 offset1:27
  v_mfma_f32_16x16x32_bf16 v[84:87], a[148:151], v[128:131], v[84:87]
  v_mfma_f32_16x16x32_bf16 v[88:91], a[152:155], v[128:131], v[88:91]
  v_mfma_f32_16x16x32_bf16 v[92:95], a[144:147], v[132:135], v[92:95]
  ds_read2st64_b64 v[148:151], v13 offset0:26 offset1:27
  buffer_load_dwordx4 a[132:135], v2, s[68:71], s11 offen offset:1024 sc1
  v_mfma_f32_16x16x32_bf16 v[96:99], a[148:151], v[132:135], v[96:99]
  buffer_load_dwordx4 a[136:139], v2, s[68:71], s11 offen offset:2048 sc1
  v_mfma_f32_16x16x32_bf16 v[100:103], a[152:155], v[132:135], v[100:103]
  buffer_load_dwordx4 a[140:143], v2, s[68:71], s11 offen offset:3072 sc1
  v_mfma_f32_16x16x32_bf16 v[104:107], a[144:147], v[136:139], v[104:107]
  ds_read2st64_b64 v[152:155], v14 offset0:26 offset1:27
  v_mfma_f32_16x16x32_bf16 v[108:111], a[148:151], v[136:139], v[108:111]
  v_mfma_f32_16x16x32_bf16 v[112:115], a[152:155], v[136:139], v[112:115]
  v_mfma_f32_16x16x32_bf16 v[116:119], a[144:147], v[140:143], v[116:119]
  ds_read2st64_b64 v[156:159], v15 offset0:26 offset1:27
  v_mfma_f32_16x16x32_bf16 v[120:123], a[148:151], v[140:143], v[120:123]
  v_mfma_f32_16x16x32_bf16 v[124:127], a[152:155], v[140:143], v[124:127]
  s_waitcnt vmcnt(26)
  s_barrier
  s_waitcnt lgkmcnt(0)
  v_mfma_f32_16x16x32_bf16 v[80:83], a[156:159], v[144:147], v[80:83]
  ds_read2st64_b64 v[128:131], v12 offset0:28 offset1:29
  v_mfma_f32_16x16x32_bf16 v[84:87], a[160:163], v[144:147], v[84:87]
  v_mfma_f32_16x16x32_bf16 v[88:91], a[164:167], v[144:147], v[88:91]
  v_mfma_f32_16x16x32_bf16 v[92:95], a[156:159], v[148:151], v[92:95]
  ds_read2st64_b64 v[132:135], v13 offset0:28 offset1:29
  s_add_u32 s11, s22, 36864
  buffer_load_dwordx4 a[144:147], v2, s[68:71], s11 offen offset:0 sc1
  v_mfma_f32_16x16x32_bf16 v[96:99], a[160:163], v[148:151], v[96:99]
  buffer_load_dwordx4 a[148:151], v2, s[68:71], s11 offen offset:1024 sc1
  v_mfma_f32_16x16x32_bf16 v[100:103], a[164:167], v[148:151], v[100:103]
  buffer_load_dwordx4 a[152:155], v2, s[68:71], s11 offen offset:2048 sc1
  v_mfma_f32_16x16x32_bf16 v[104:107], a[156:159], v[152:155], v[104:107]
  ds_read2st64_b64 v[136:139], v14 offset0:28 offset1:29
  v_mfma_f32_16x16x32_bf16 v[108:111], a[160:163], v[152:155], v[108:111]
  v_mfma_f32_16x16x32_bf16 v[112:115], a[164:167], v[152:155], v[112:115]
  v_mfma_f32_16x16x32_bf16 v[116:119], a[156:159], v[156:159], v[116:119]
  ds_read2st64_b64 v[140:143], v15 offset0:28 offset1:29
  v_mfma_f32_16x16x32_bf16 v[120:123], a[160:163], v[156:159], v[120:123]
  v_mfma_f32_16x16x32_bf16 v[124:127], a[164:167], v[156:159], v[124:127]
  buffer_load_dwordx2 v[176:177], v186, s[72:75], s24 offen offset:512 sc1
  s_waitcnt vmcnt(26)
  s_barrier
  s_waitcnt lgkmcnt(0)
  v_mfma_f32_16x16x32_bf16 v[80:83], a[168:171], v[128:131], v[80:83]
  ds_read2st64_b64 v[144:147], v12 offset0:30 offset1:31
  v_mfma_f32_16x16x32_bf16 v[84:87], a[172:175], v[128:131], v[84:87]
  v_mfma_f32_16x16x32_bf16 v[88:91], a[176:179], v[128:131], v[88:91]
  v_mfma_f32_16x16x32_bf16 v[92:95], a[168:171], v[132:135], v[92:95]
  ds_read2st64_b64 v[148:151], v13 offset0:30 offset1:31
  buffer_load_dwordx4 a[156:159], v2, s[68:71], s11 offen offset:3072 sc1
  v_mfma_f32_16x16x32_bf16 v[96:99], a[172:175], v[132:135], v[96:99]
  s_add_u32 s11, s22, 40960
  buffer_load_dwordx4 a[160:163], v2, s[68:71], s11 offen offset:0 sc1
  v_mfma_f32_16x16x32_bf16 v[100:103], a[176:179], v[132:135], v[100:103]
  buffer_load_dwordx4 a[164:167], v2, s[68:71], s11 offen offset:1024 sc1
  v_mfma_f32_16x16x32_bf16 v[104:107], a[168:171], v[136:139], v[104:107]
  ds_read2st64_b64 v[152:155], v14 offset0:30 offset1:31
  v_mfma_f32_16x16x32_bf16 v[108:111], a[172:175], v[136:139], v[108:111]
  v_mfma_f32_16x16x32_bf16 v[112:115], a[176:179], v[136:139], v[112:115]
  v_mfma_f32_16x16x32_bf16 v[116:119], a[168:171], v[140:143], v[116:119]
  ds_read2st64_b64 v[156:159], v15 offset0:30 offset1:31
  v_mfma_f32_16x16x32_bf16 v[120:123], a[172:175], v[140:143], v[120:123]
  v_mfma_f32_16x16x32_bf16 v[124:127], a[176:179], v[140:143], v[124:127]
  s_waitcnt vmcnt(25)
  s_barrier
  s_waitcnt lgkmcnt(0)
  v_mfma_f32_16x16x32_bf16 v[80:83], a[180:183], v[144:147], v[80:83]
  ds_read2st64_b64 v[128:131], v12 offset0:32 offset1:33
  v_mfma_f32_16x16x32_bf16 v[84:87], a[184:187], v[144:147], v[84:87]
  v_mfma_f32_16x16x32_bf16 v[88:91], a[188:191], v[144:147], v[88:91]
  v_mfma_f32_16x16x32_bf16 v[92:95], a[180:183], v[148:151], v[92:95]
  ds_read2st64_b64 v[132:135], v13 offset0:32 offset1:33
  buffer_load_dwordx4 a[168:171], v2, s[68:71], s11 offen offset:2048 sc1
  v_mfma_f32_16x16x32_bf16 v[96:99], a[184:187], v[148:151], v[96:99]
  buffer_load_dwordx4 a[172:175], v2, s[68:71], s11 offen offset:3072 sc1
  v_mfma_f32_16x16x32_bf16 v[100:103], a[188:191], v[148:151], v[100:103]
  s_add_u32 s11, s22, 45056
  buffer_load_dwordx4 a[176:179], v2, s[68:71], s11 offen offset:0 sc1
  v_mfma_f32_16x16x32_bf16 v[104:107], a[180:183], v[152:155], v[104:107]
  ds_read2st64_b64 v[136:139], v14 offset0:32 offset1:33
  v_mfma_f32_16x16x32_bf16 v[108:111], a[184:187], v[152:155], v[108:111]
  v_mfma_f32_16x16x32_bf16 v[112:115], a[188:191], v[152:155], v[112:115]
  v_mfma_f32_16x16x32_bf16 v[116:119], a[180:183], v[156:159], v[116:119]
  ds_read2st64_b64 v[140:143], v15 offset0:32 offset1:33
  v_mfma_f32_16x16x32_bf16 v[120:123], a[184:187], v[156:159], v[120:123]
  v_mfma_f32_16x16x32_bf16 v[124:127], a[188:191], v[156:159], v[124:127]
  s_waitcnt vmcnt(24)
  s_waitcnt vmcnt(13)
  s_barrier
  s_waitcnt lgkmcnt(0)
  v_mfma_f32_16x16x32_bf16 v[80:83], a[192:195], v[128:131], v[80:83]
  ds_read2st64_b64 v[144:147], v12 offset0:34 offset1:35
  v_mfma_f32_16x16x32_bf16 v[84:87], a[196:199], v[128:131], v[84:87]
  v_mfma_f32_16x16x32_bf16 v[88:91], a[200:203], v[128:131], v[88:91]
  v_mfma_f32_16x16x32_bf16 v[92:95], a[192:195], v[132:135], v[92:95]
  ds_read2st64_b64 v[148:151], v13 offset0:34 offset1:35
  buffer_load_dwordx4 a[180:183], v2, s[68:71], s11 offen offset:1024 sc1
  v_mfma_f32_16x16x32_bf16 v[96:99], a[196:199], v[132:135], v[96:99]
  buffer_load_dwordx4 a[184:187], v2, s[68:71], s11 offen offset:2048 sc1
  v_mfma_f32_16x16x32_bf16 v[100:103], a[200:203], v[132:135], v[100:103]
  buffer_load_dwordx4 a[188:191], v2, s[68:71], s11 offen offset:3072 sc1
  v_mfma_f32_16x16x32_bf16 v[104:107], a[192:195], v[136:139], v[104:107]
  ds_read2st64_b64 v[152:155], v14 offset0:34 offset1:35
  v_mfma_f32_16x16x32_bf16 v[108:111], a[196:199], v[136:139], v[108:111]
  v_mfma_f32_16x16x32_bf16 v[112:115], a[200:203], v[136:139], v[112:115]
  v_mfma_f32_16x16x32_bf16 v[116:119], a[192:195], v[140:143], v[116:119]
  ds_read2st64_b64 v[156:159], v15 offset0:34 offset1:35
  v_mfma_f32_16x16x32_bf16 v[120:123], a[196:199], v[140:143], v[120:123]
  v_mfma_f32_16x16x32_bf16 v[124:127], a[200:203], v[140:143], v[124:127]
  s_barrier
  s_waitcnt lgkmcnt(0)
  v_mfma_f32_16x16x32_bf16 v[80:83], a[204:207], v[144:147], v[80:83]
  ds_read2st64_b64 v[128:131], v12 offset0:36 offset1:37
  v_mfma_f32_16x16x32_bf16 v[84:87], a[208:211], v[144:147], v[84:87]
  v_mfma_f32_16x16x32_bf16 v[88:91], a[212:215], v[144:147], v[88:91]
  v_mfma_f32_16x16x32_bf16 v[92:95], a[204:207], v[148:151], v[92:95]
  ds_read2st64_b64 v[132:135], v13 offset0:36 offset1:37
  s_add_u32 s11, s22, 49152
  buffer_load_dwordx4 a[192:195], v2, s[68:71], s11 offen offset:0 sc1
  v_mfma_f32_16x16x32_bf16 v[96:99], a[208:211], v[148:151], v[96:99]
  buffer_load_dwordx4 a[196:199], v2, s[68:71], s11 offen offset:1024 sc1
  v_mfma_f32_16x16x32_bf16 v[100:103], a[212:215], v[148:151], v[100:103]
  buffer_load_dwordx4 a[200:203], v2, s[68:71], s11 offen offset:2048 sc1
  v_mfma_f32_16x16x32_bf16 v[104:107], a[204:207], v[152:155], v[104:107]
  ds_read2st64_b64 v[136:139], v14 offset0:36 offset1:37
  v_mfma_f32_16x16x32_bf16 v[108:111], a[208:211], v[152:155], v[108:111]
  v_mfma_f32_16x16x32_bf16 v[112:115], a[212:215], v[152:155], v[112:115]
  v_mfma_f32_16x16x32_bf16 v[116:119], a[204:207], v[156:159], v[116:119]
  ds_read2st64_b64 v[140:143], v15 offset0:36 offset1:37
  v_mfma_f32_16x16x32_bf16 v[120:123], a[208:211], v[156:159], v[120:123]
  v_mfma_f32_16x16x32_bf16 v[124:127], a[212:215], v[156:159], v[124:127]
  s_mov_b32 s35, 0
  s_nop 6
K3_STCHK11:
  s_waitcnt vmcnt(12)
  v_cmp_eq_u32 vcc, 0, v177
  s_nop 4
  s_cbranch_vccz K3_STOK11
  s_add_u32 s35, s35, 1
  s_cmp_ge_u32 s35, 0x4000
  s_cbranch_scc1 K3_STOK11
  s_sleep 2
  buffer_load_dwordx2 v[176:177], v186, s[72:75], s24 offen offset:512 sc1
  s_waitcnt vmcnt(0)
  s_branch K3_STCHK11
K3_STOK11:
  s_barrier
  s_waitcnt lgkmcnt(0)
  v_mfma_f32_16x16x32_bf16 v[80:83], a[216:219], v[128:131], v[80:83]
  ds_read2st64_b64 v[144:147], v12 offset0:38 offset1:39
  ds_write_b64 v183, v[176:177] offset:4608
  ds_read_b64 v[208:209], v184 offset:4736
  v_mfma_f32_16x16x32_bf16 v[84:87], a[220:223], v[128:131], v[84:87]
  ds_read_b64 v[212:213], v184 offset:4864
  ds_read_b64 v[216:217], v184 offset:4992
  ds_read_b64 v[220:221], v184 offset:4608
  v_mfma_f32_16x16x32_bf16 v[88:91], a[224:227], v[128:131], v[88:91]
  s_waitcnt lgkmcnt(0)
  v_rcp_f32 v210, v209
  v_rcp_f32 v214, v213
  v_mfma_f32_16x16x32_bf16 v[92:95], a[216:219], v[132:135], v[92:95]
  ds_read2st64_b64 v[148:151], v13 offset0:38 offset1:39
  buffer_load_dwordx4 a[204:207], v2, s[68:71], s11 offen offset:3072 sc1
  v_mfma_f32_16x16x32_bf16 v[96:99], a[220:223], v[132:135], v[96:99]
  s_add_u32 s11, s22, 53248
  buffer_load_dwordx4 a[208:211], v2, s[68:71], s11 offen offset:0 sc1
  v_mfma_f32_16x16x32_bf16 v[100:103], a[224:227], v[132:135], v[100:103]
  buffer_load_dwordx4 a[212:215], v2, s[68:71], s11 offen offset:1024 sc1
  v_mfma_f32_16x16x32_bf16 v[104:107], a[216:219], v[136:139], v[104:107]
  ds_read2st64_b64 v[152:155], v14 offset0:38 offset1:39
  v_rcp_f32 v218, v217
  v_rcp_f32 v222, v221
  v_mfma_f32_16x16x32_bf16 v[108:111], a[220:223], v[136:139], v[108:111]
  v_mul_f32 v209, v209, v209
  v_mul_f32 v213, v213, v213
  v_mul_f32 v217, v217, v217
  v_mfma_f32_16x16x32_bf16 v[112:115], a[224:227], v[136:139], v[112:115]
  v_mul_f32 v221, v221, v221
  v_mul_f32 v210, v210, v4
  v_mul_f32 v214, v214, v4
  v_mfma_f32_16x16x32_bf16 v[116:119], a[216:219], v[140:143], v[116:119]
  ds_read2st64_b64 v[156:159], v15 offset0:38 offset1:39
  v_mul_f32 v218, v218, v4
  v_mul_f32 v222, v222, v4
  v_mfma_f32_16x16x32_bf16 v[120:123], a[220:223], v[140:143], v[120:123]
  v_mfma_f32_16x16x32_bf16 v[124:127], a[224:227], v[140:143], v[124:127]
  buffer_load_dword v30, v29, s[72:75], s63 offen sc1
  s_waitcnt lgkmcnt(0)
  v_mfma_f32_16x16x32_bf16 v[80:83], a[228:231], v[144:147], v[80:83]
  v_mfma_f32_16x16x32_bf16 v[84:87], a[232:235], v[144:147], v[84:87]
  v_mfma_f32_16x16x32_bf16 v[88:91], a[236:239], v[144:147], v[88:91]
  v_mfma_f32_16x16x32_bf16 v[92:95], a[228:231], v[148:151], v[92:95]
  buffer_load_dwordx4 a[216:219], v2, s[68:71], s11 offen offset:2048 sc1
  v_mfma_f32_16x16x32_bf16 v[96:99], a[232:235], v[148:151], v[96:99]
  buffer_load_dwordx4 a[220:223], v2, s[68:71], s11 offen offset:3072 sc1
  v_mfma_f32_16x16x32_bf16 v[100:103], a[236:239], v[148:151], v[100:103]
  s_add_u32 s11, s22, 57344
  buffer_load_dwordx4 a[224:227], v2, s[68:71], s11 offen offset:0 sc1
  v_mfma_f32_16x16x32_bf16 v[104:107], a[228:231], v[152:155], v[104:107]
  v_mfma_f32_16x16x32_bf16 v[108:111], a[232:235], v[152:155], v[108:111]
  v_mfma_f32_16x16x32_bf16 v[112:115], a[236:239], v[152:155], v[112:115]
  v_mfma_f32_16x16x32_bf16 v[116:119], a[228:231], v[156:159], v[116:119]
  v_mfma_f32_16x16x32_bf16 v[120:123], a[232:235], v[156:159], v[120:123]
  v_mfma_f32_16x16x32_bf16 v[124:127], a[236:239], v[156:159], v[124:127]
  v_pk_fma_f32 v[80:81], v[16:17], v[208:209], v[80:81] op_sel_hi:[1,0,1] neg_lo:[0,1,0] neg_hi:[0,1,0]
  v_pk_fma_f32 v[84:85], v[20:21], v[208:209], v[84:85] op_sel_hi:[1,0,1] neg_lo:[0,1,0] neg_hi:[0,1,0]
  v_pk_fma_f32 v[88:89], v[24:25], v[208:209], v[88:89] op_sel_hi:[1,0,1] neg_lo:[0,1,0] neg_hi:[0,1,0]
  v_pk_fma_f32 v[82:83], v[18:19], v[208:209], v[82:83] op_sel_hi:[1,0,1] neg_lo:[0,1,0] neg_hi:[0,1,0]
  v_pk_fma_f32 v[86:87], v[22:23], v[208:209], v[86:87] op_sel_hi:[1,0,1] neg_lo:[0,1,0] neg_hi:[0,1,0]
  v_pk_fma_f32 v[90:91], v[26:27], v[208:209], v[90:91] op_sel_hi:[1,0,1] neg_lo:[0,1,0] neg_hi:[0,1,0]
  v_pk_mul_f32 v[232:233], v[80:81], v[210:211] op_sel_hi:[1,0]
  v_pk_mul_f32 v[234:235], v[84:85], v[210:211] op_sel_hi:[1,0]
  v_pk_mul_f32 v[236:237], v[88:89], v[210:211] op_sel_hi:[1,0]
  v_exp_f32 v232, v232
  v_exp_f32 v234, v234
  v_exp_f32 v236, v236
  v_exp_f32 v233, v233
  v_exp_f32 v235, v235
  v_exp_f32 v237, v237
  v_pk_mul_f32 v[80:81], v[80:81], v[82:83]
  v_pk_mul_f32 v[84:85], v[84:85], v[86:87]
  v_pk_mul_f32 v[88:89], v[88:89], v[90:91]
  v_pk_fma_f32 v[232:233], v[232:233], v[208:209], v[208:209] op_sel:[0,1,1] op_sel_hi:[1,1,1]
  v_pk_fma_f32 v[234:235], v[234:235], v[208:209], v[208:209] op_sel:[0,1,1] op_sel_hi:[1,1,1]
  v_pk_fma_f32 v[236:237], v[236:237], v[208:209], v[208:209] op_sel:[0,1,1] op_sel_hi:[1,1,1]
  v_rcp_f32 v232, v232
  v_rcp_f32 v234, v234
  v_rcp_f32 v236, v236
  v_rcp_f32 v233, v233
  v_rcp_f32 v235, v235
  v_rcp_f32 v237, v237
  v_pk_mul_f32 v[80:81], v[80:81], v[232:233]
  v_pk_mul_f32 v[84:85], v[84:85], v[234:235]
  v_pk_mul_f32 v[88:89], v[88:89], v[236:237]
  v_cvt_pk_bf16_f32 v224, v80, v81
  v_cvt_pk_bf16_f32 v225, v84, v85
  v_cvt_pk_bf16_f32 v226, v88, v89
  v_add_u32 v6, v12, v181
  ds_write_b96 v6, v[224:226] offset:1024
  v_pk_fma_f32 v[92:93], v[16:17], v[212:213], v[92:93] op_sel_hi:[1,0,1] neg_lo:[0,1,0] neg_hi:[0,1,0]
  v_pk_fma_f32 v[96:97], v[20:21], v[212:213], v[96:97] op_sel_hi:[1,0,1] neg_lo:[0,1,0] neg_hi:[0,1,0]
  v_pk_fma_f32 v[100:101], v[24:25], v[212:213], v[100:101] op_sel_hi:[1,0,1] neg_lo:[0,1,0] neg_hi:[0,1,0]
  buffer_load_dwordx4 a[228:231], v2, s[68:71], s11 offen offset:1024 sc1
  v_pk_fma_f32 v[94:95], v[18:19], v[212:213], v[94:95] op_sel_hi:[1,0,1] neg_lo:[0,1,0] neg_hi:[0,1,0]
  v_pk_fma_f32 v[98:99], v[22:23], v[212:213], v[98:99] op_sel_hi:[1,0,1] neg_lo:[0,1,0] neg_hi:[0,1,0]
  v_pk_fma_f32 v[102:103], v[26:27], v[212:213], v[102:103] op_sel_hi:[1,0,1] neg_lo:[0,1,0] neg_hi:[0,1,0]
  v_pk_mul_f32 v[232:233], v[92:93], v[214:215] op_sel_hi:[1,0]
  v_pk_mul_f32 v[234:235], v[96:97], v[214:215] op_sel_hi:[1,0]
  v_pk_mul_f32 v[236:237], v[100:101], v[214:215] op_sel_hi:[1,0]
  v_exp_f32 v232, v232
  v_exp_f32 v234, v234
  v_exp_f32 v236, v236
  v_exp_f32 v233, v233
  v_exp_f32 v235, v235
  v_exp_f32 v237, v237
  v_pk_mul_f32 v[92:93], v[92:93], v[94:95]
  v_pk_mul_f32 v[96:97], v[96:97], v[98:99]
  v_pk_mul_f32 v[100:101], v[100:101], v[102:103]
  v_pk_fma_f32 v[232:233], v[232:233], v[212:213], v[212:213] op_sel:[0,1,1] op_sel_hi:[1,1,1]
  v_pk_fma_f32 v[234:235], v[234:235], v[212:213], v[212:213] op_sel:[0,1,1] op_sel_hi:[1,1,1]
  v_pk_fma_f32 v[236:237], v[236:237], v[212:213], v[212:213] op_sel:[0,1,1] op_sel_hi:[1,1,1]
  v_rcp_f32 v232, v232
  v_rcp_f32 v234, v234
  v_rcp_f32 v236, v236
  v_rcp_f32 v233, v233
  v_rcp_f32 v235, v235
  v_rcp_f32 v237, v237
  v_pk_mul_f32 v[92:93], v[92:93], v[232:233]
  v_pk_mul_f32 v[96:97], v[96:97], v[234:235]
  v_pk_mul_f32 v[100:101], v[100:101], v[236:237]
  v_cvt_pk_bf16_f32 v228, v92, v93
  v_cvt_pk_bf16_f32 v229, v96, v97
  v_cvt_pk_bf16_f32 v230, v100, v101
  v_add_u32 v6, v13, v181
  ds_write_b96 v6, v[228:230] offset:1024
  v_pk_fma_f32 v[104:105], v[16:17], v[216:217], v[104:105] op_sel_hi:[1,0,1] neg_lo:[0,1,0] neg_hi:[0,1,0]
  v_pk_fma_f32 v[108:109], v[20:21], v[216:217], v[108:109] op_sel_hi:[1,0,1] neg_lo:[0,1,0] neg_hi:[0,1,0]
  v_pk_fma_f32 v[112:113], v[24:25], v[216:217], v[112:113] op_sel_hi:[1,0,1] neg_lo:[0,1,0] neg_hi:[0,1,0]
  v_pk_fma_f32 v[106:107], v[18:19], v[216:217], v[106:107] op_sel_hi:[1,0,1] neg_lo:[0,1,0] neg_hi:[0,1,0]
  v_pk_fma_f32 v[110:111], v[22:23], v[216:217], v[110:111] op_sel_hi:[1,0,1] neg_lo:[0,1,0] neg_hi:[0,1,0]
  v_pk_fma_f32 v[114:115], v[26:27], v[216:217], v[114:115] op_sel_hi:[1,0,1] neg_lo:[0,1,0] neg_hi:[0,1,0]
  buffer_load_dwordx4 a[232:235], v2, s[68:71], s11 offen offset:2048 sc1
  v_pk_mul_f32 v[232:233], v[104:105], v[218:219] op_sel_hi:[1,0]
  v_pk_mul_f32 v[234:235], v[108:109], v[218:219] op_sel_hi:[1,0]
  v_pk_mul_f32 v[236:237], v[112:113], v[218:219] op_sel_hi:[1,0]
  v_exp_f32 v232, v232
  v_exp_f32 v234, v234
  v_exp_f32 v236, v236
  v_exp_f32 v233, v233
  v_exp_f32 v235, v235
  v_exp_f32 v237, v237
  v_pk_mul_f32 v[104:105], v[104:105], v[106:107]
  v_pk_mul_f32 v[108:109], v[108:109], v[110:111]
  v_pk_mul_f32 v[112:113], v[112:113], v[114:115]
  v_pk_fma_f32 v[232:233], v[232:233], v[216:217], v[216:217] op_sel:[0,1,1] op_sel_hi:[1,1,1]
  v_pk_fma_f32 v[234:235], v[234:235], v[216:217], v[216:217] op_sel:[0,1,1] op_sel_hi:[1,1,1]
  v_pk_fma_f32 v[236:237], v[236:237], v[216:217], v[216:217] op_sel:[0,1,1] op_sel_hi:[1,1,1]
  v_rcp_f32 v232, v232
  v_rcp_f32 v234, v234
  v_rcp_f32 v236, v236
  v_rcp_f32 v233, v233
  v_rcp_f32 v235, v235
  v_rcp_f32 v237, v237
  v_pk_mul_f32 v[104:105], v[104:105], v[232:233]
  v_pk_mul_f32 v[108:109], v[108:109], v[234:235]
  v_pk_mul_f32 v[112:113], v[112:113], v[236:237]
  v_cvt_pk_bf16_f32 v224, v104, v105
  v_cvt_pk_bf16_f32 v225, v108, v109
  v_cvt_pk_bf16_f32 v226, v112, v113
  v_add_u32 v6, v14, v181
  ds_write_b96 v6, v[224:226] offset:1024
  v_pk_fma_f32 v[116:117], v[16:17], v[220:221], v[116:117] op_sel_hi:[1,0,1] neg_lo:[0,1,0] neg_hi:[0,1,0]
  v_pk_fma_f32 v[120:121], v[20:21], v[220:221], v[120:121] op_sel_hi:[1,0,1] neg_lo:[0,1,0] neg_hi:[0,1,0]
  v_pk_fma_f32 v[124:125], v[24:25], v[220:221], v[124:125] op_sel_hi:[1,0,1] neg_lo:[0,1,0] neg_hi:[0,1,0]
  v_pk_fma_f32 v[118:119], v[18:19], v[220:221], v[118:119] op_sel_hi:[1,0,1] neg_lo:[0,1,0] neg_hi:[0,1,0]
  v_pk_fma_f32 v[122:123], v[22:23], v[220:221], v[122:123] op_sel_hi:[1,0,1] neg_lo:[0,1,0] neg_hi:[0,1,0]
  v_pk_fma_f32 v[126:127], v[26:27], v[220:221], v[126:127] op_sel_hi:[1,0,1] neg_lo:[0,1,0] neg_hi:[0,1,0]
  v_pk_mul_f32 v[232:233], v[116:117], v[222:223] op_sel_hi:[1,0]
  v_pk_mul_f32 v[234:235], v[120:121], v[222:223] op_sel_hi:[1,0]
  v_pk_mul_f32 v[236:237], v[124:125], v[222:223] op_sel_hi:[1,0]
  buffer_load_dwordx4 a[236:239], v2, s[68:71], s11 offen offset:3072 sc1
  v_exp_f32 v232, v232
  v_exp_f32 v234, v234
  v_exp_f32 v236, v236
  v_exp_f32 v233, v233
  v_exp_f32 v235, v235
  v_exp_f32 v237, v237
  v_pk_mul_f32 v[116:117], v[116:117], v[118:119]
  v_pk_mul_f32 v[120:121], v[120:121], v[122:123]
  v_pk_mul_f32 v[124:125], v[124:125], v[126:127]
  v_pk_fma_f32 v[232:233], v[232:233], v[220:221], v[220:221] op_sel:[0,1,1] op_sel_hi:[1,1,1]
  v_pk_fma_f32 v[234:235], v[234:235], v[220:221], v[220:221] op_sel:[0,1,1] op_sel_hi:[1,1,1]
  v_pk_fma_f32 v[236:237], v[236:237], v[220:221], v[220:221] op_sel:[0,1,1] op_sel_hi:[1,1,1]
  v_rcp_f32 v232, v232
  v_rcp_f32 v234, v234
  v_rcp_f32 v236, v236
  v_rcp_f32 v233, v233
  v_rcp_f32 v235, v235
  v_rcp_f32 v237, v237
  v_pk_mul_f32 v[116:117], v[116:117], v[232:233]
  v_pk_mul_f32 v[120:121], v[120:121], v[234:235]
  v_pk_mul_f32 v[124:125], v[124:125], v[236:237]
  v_cvt_pk_bf16_f32 v228, v116, v117
  v_cvt_pk_bf16_f32 v229, v120, v121
  v_cvt_pk_bf16_f32 v230, v124, v125
  v_add_u32 v6, v15, v181
  ds_write_b96 v6, v[228:230] offset:1024
  s_nop 0
  s_branch K3_EPIDONE
K3_VAR2:
  s_waitcnt vmcnt(20)
  s_barrier
  s_waitcnt lgkmcnt(0)
  v_mfma_f32_16x16x32_bf16 v[32:35], a[0:3], v[128:131], 0
  ds_read2st64_b64 v[144:147], v8 offset0:2 offset1:3
  v_mfma_f32_16x16x32_bf16 v[36:39], a[4:7], v[128:131], 0
  s_lshl_b32 s13, s4, 3
  s_add_u32 s13, s13, s3
  v_mfma_f32_16x16x32_bf16 v[40:43], a[8:11], v[128:131], 0
  s_mul_i32 s13, s13, 49152
  s_mul_i32 s14, s5, 3072
  v_mfma_f32_16x16x32_bf16 v[44:47], a[0:3], v[132:135], 0
  ds_read2st64_b64 v[148:151], v9 offset0:2 offset1:3
  v_mfma_f32_16x16x32_bf16 v[48:51], a[4:7], v[132:135], 0
  s_add_u32 s60, s13, s14
  s_add_u32 s61, s60, 196608
  v_mfma_f32_16x16x32_bf16 v[52:55], a[8:11], v[132:135], 0
  s_lshl_b32 s13, s4, 2
  s_lshr_b32 s14, s5, 2
  v_mfma_f32_16x16x32_bf16 v[56:59], a[0:3], v[136:139], 0
  ds_read2st64_b64 v[152:155], v10 offset0:2 offset1:3
  buffer_load_dwordx4 a[172:175], v2, s[48:51], s11 offen offset:3072 sc1
  v_mfma_f32_16x16x32_bf16 v[60:63], a[4:7], v[136:139], 0
  s_add_u32 s11, s9, 45056
  buffer_load_dwordx4 a[176:179], v2, s[48:51], s11 offen offset:0 sc1
  buffer_load_dwordx4 v2, s[44:47], s10 offen offset:3072 sc1 lds
  v_mfma_f32_16x16x32_bf16 v[64:67], a[8:11], v[136:139], 0
  v_mfma_f32_16x16x32_bf16 v[68:71], a[0:3], v[140:143], 0
  ds_read2st64_b64 v[156:159], v11 offset0:2 offset1:3
  v_mfma_f32_16x16x32_bf16 v[72:75], a[4:7], v[140:143], 0
  s_add_u32 s14, s14, s13
  s_lshl_b32 s14, s14, 8
  v_mfma_f32_16x16x32_bf16 v[76:79], a[8:11], v[140:143], 0
  s_add_u32 s62, s14, 0x4000
  s_add_u32 s13, s13, s3
  s_waitcnt vmcnt(22)
  s_barrier
  s_waitcnt lgkmcnt(0)
  v_mfma_f32_16x16x32_bf16 v[32:35], a[12:15], v[144:147], v[32:35]
  ds_read2st64_b64 v[128:131], v8 offset0:4 offset1:5
  v_mfma_f32_16x16x32_bf16 v[36:39], a[16:19], v[144:147], v[36:39]
  s_lshl_b32 s13, s13, 8
  s_add_u32 s63, s13, 0x4000
  v_mfma_f32_16x16x32_bf16 v[40:43], a[20:23], v[144:147], v[40:43]
  s_lshl_b32 s13, s4, 3
  s_lshl_b32 s14, s19, 1
  v_mfma_f32_16x16x32_bf16 v[44:47], a[12:15], v[148:151], v[44:47]
  ds_read2st64_b64 v[132:135], v9 offset0:4 offset1:5
  v_mfma_f32_16x16x32_bf16 v[48:51], a[16:19], v[148:151], v[48:51]
  s_add_u32 s23, s13, s14
  s_mul_i32 s13, s23, 49152
  v_mfma_f32_16x16x32_bf16 v[52:55], a[20:23], v[148:151], v[52:55]
  s_mul_i32 s14, s3, 12288
  s_add_u32 s64, s13, s14
  v_mfma_f32_16x16x32_bf16 v[56:59], a[12:15], v[152:155], v[56:59]
  ds_read2st64_b64 v[136:139], v10 offset0:4 offset1:5
  buffer_load_dwordx4 a[180:183], v2, s[48:51], s11 offen offset:1024 sc1
  v_mfma_f32_16x16x32_bf16 v[60:63], a[16:19], v[152:155], v[60:63]
  buffer_load_dwordx4 a[184:187], v2, s[48:51], s11 offen offset:2048 sc1
  buffer_load_dwordx4 a[188:191], v2, s[48:51], s11 offen offset:3072 sc1
  v_mfma_f32_16x16x32_bf16 v[64:67], a[20:23], v[152:155], v[64:67]
  v_mfma_f32_16x16x32_bf16 v[68:71], a[12:15], v[156:159], v[68:71]
  ds_read2st64_b64 v[140:143], v11 offset0:4 offset1:5
  v_mfma_f32_16x16x32_bf16 v[72:75], a[16:19], v[156:159], v[72:75]
  s_add_u32 s65, s64, 49152
  s_add_u32 s66, s64, 196608
  v_mfma_f32_16x16x32_bf16 v[76:79], a[20:23], v[156:159], v[76:79]
  s_add_u32 s67, s64, 245760
  s_waitcnt vmcnt(24)
  s_barrier
  s_waitcnt lgkmcnt(0)
  v_mfma_f32_16x16x32_bf16 v[32:35], a[24:27], v[128:131], v[32:35]
  ds_read2st64_b64 v[144:147], v8 offset0:6 offset1:7
  v_mfma_f32_16x16x32_bf16 v[36:39], a[28:31], v[128:131], v[36:39]
  v_mfma_f32_16x16x32_bf16 v[40:43], a[32:35], v[128:131], v[40:43]
  v_mfma_f32_16x16x32_bf16 v[44:47], a[24:27], v[132:135], v[44:47]
  ds_read2st64_b64 v[148:151], v9 offset0:6 offset1:7
  v_mfma_f32_16x16x32_bf16 v[48:51], a[28:31], v[132:135], v[48:51]
  v_mfma_f32_16x16x32_bf16 v[52:55], a[32:35], v[132:135], v[52:55]
  v_mfma_f32_16x16x32_bf16 v[56:59], a[24:27], v[136:139], v[56:59]
  ds_read2st64_b64 v[152:155], v10 offset0:6 offset1:7
  s_add_u32 m0, s6, 16384
  s_add_u32 s10, s7, 16384
  buffer_load_dwordx4 v2, s[44:47], s10 offen offset:0 sc1 lds
  v_mfma_f32_16x16x32_bf16 v[60:63], a[28:31], v[136:139], v[60:63]
  s_add_u32 s11, s9, 49152
  buffer_load_dwordx4 a[192:195], v2, s[48:51], s11 offen offset:0 sc1
  buffer_load_dwordx4 a[196:199], v2, s[48:51], s11 offen offset:1024 sc1
  v_mfma_f32_16x16x32_bf16 v[64:67], a[32:35], v[136:139], v[64:67]
  v_mfma_f32_16x16x32_bf16 v[68:71], a[24:27], v[140:143], v[68:71]
  ds_read2st64_b64 v[156:159], v11 offset0:6 offset1:7
  v_mfma_f32_16x16x32_bf16 v[72:75], a[28:31], v[140:143], v[72:75]
  v_mfma_f32_16x16x32_bf16 v[76:79], a[32:35], v[140:143], v[76:79]
  s_waitcnt vmcnt(26)
  s_barrier
  s_waitcnt lgkmcnt(0)
  v_mfma_f32_16x16x32_bf16 v[32:35], a[36:39], v[144:147], v[32:35]
  ds_read2st64_b64 v[128:131], v8 offset0:8 offset1:9
  v_mfma_f32_16x16x32_bf16 v[36:39], a[40:43], v[144:147], v[36:39]
  v_mfma_f32_16x16x32_bf16 v[40:43], a[44:47], v[144:147], v[40:43]
  v_mfma_f32_16x16x32_bf16 v[44:47], a[36:39], v[148:151], v[44:47]
  ds_read2st64_b64 v[132:135], v9 offset0:8 offset1:9
  v_mfma_f32_16x16x32_bf16 v[48:51], a[40:43], v[148:151], v[48:51]
  v_mfma_f32_16x16x32_bf16 v[52:55], a[44:47], v[148:151], v[52:55]
  v_mfma_f32_16x16x32_bf16 v[56:59], a[36:39], v[152:155], v[56:59]
  ds_read2st64_b64 v[136:139], v10 offset0:8 offset1:9
  buffer_load_dwordx4 a[200:203], v2, s[48:51], s11 offen offset:2048 sc1
  v_mfma_f32_16x16x32_bf16 v[60:63], a[40:43], v[152:155], v[60:63]
  buffer_load_dwordx4 v2, s[44:47], s10 offen offset:1024 sc1 lds
  buffer_load_dwordx4 a[204:207], v2, s[48:51], s11 offen offset:3072 sc1
  v_mfma_f32_16x16x32_bf16 v[64:67], a[44:47], v[152:155], v[64:67]
  v_mfma_f32_16x16x32_bf16 v[68:71], a[36:39], v[156:159], v[68:71]
  ds_read2st64_b64 v[140:143], v11 offset0:8 offset1:9
  v_mfma_f32_16x16x32_bf16 v[72:75], a[40:43], v[156:159], v[72:75]
  v_mfma_f32_16x16x32_bf16 v[76:79], a[44:47], v[156:159], v[76:79]
  s_waitcnt vmcnt(28)
  s_barrier
  s_waitcnt lgkmcnt(0)
  v_mfma_f32_16x16x32_bf16 v[32:35], a[48:51], v[128:131], v[32:35]
  ds_read2st64_b64 v[144:147], v8 offset0:10 offset1:11
  v_mfma_f32_16x16x32_bf16 v[36:39], a[52:55], v[128:131], v[36:39]
  v_mfma_f32_16x16x32_bf16 v[40:43], a[56:59], v[128:131], v[40:43]
  v_mfma_f32_16x16x32_bf16 v[44:47], a[48:51], v[132:135], v[44:47]
  ds_read2st64_b64 v[148:151], v9 offset0:10 offset1:11
  v_mfma_f32_16x16x32_bf16 v[48:51], a[52:55], v[132:135], v[48:51]
  v_mfma_f32_16x16x32_bf16 v[52:55], a[56:59], v[132:135], v[52:55]
  v_mfma_f32_16x16x32_bf16 v[56:59], a[48:51], v[136:139], v[56:59]
  ds_read2st64_b64 v[152:155], v10 offset0:10 offset1:11
  s_add_u32 s11, s9, 53248
  buffer_load_dwordx4 a[208:211], v2, s[48:51], s11 offen offset:0 sc1
  v_mfma_f32_16x16x32_bf16 v[60:63], a[52:55], v[136:139], v[60:63]
  buffer_load_dwordx4 a[212:215], v2, s[48:51], s11 offen offset:1024 sc1
  buffer_load_dwordx4 v2, s[44:47], s10 offen offset:2048 sc1 lds
  v_mfma_f32_16x16x32_bf16 v[64:67], a[56:59], v[136:139], v[64:67]
  v_mfma_f32_16x16x32_bf16 v[68:71], a[48:51], v[140:143], v[68:71]
  ds_read2st64_b64 v[156:159], v11 offset0:10 offset1:11
  v_mfma_f32_16x16x32_bf16 v[72:75], a[52:55], v[140:143], v[72:75]
  v_mfma_f32_16x16x32_bf16 v[76:79], a[56:59], v[140:143], v[76:79]
  s_waitcnt vmcnt(30)
  s_barrier
  s_waitcnt lgkmcnt(0)
  v_mfma_f32_16x16x32_bf16 v[32:35], a[60:63], v[144:147], v[32:35]
  ds_read2st64_b64 v[128:131], v8 offset0:12 offset1:13
  v_mfma_f32_16x16x32_bf16 v[36:39], a[64:67], v[144:147], v[36:39]
  v_mfma_f32_16x16x32_bf16 v[40:43], a[68:71], v[144:147], v[40:43]
  v_mfma_f32_16x16x32_bf16 v[44:47], a[60:63], v[148:151], v[44:47]
  ds_read2st64_b64 v[132:135], v9 offset0:12 offset1:13
  v_mfma_f32_16x16x32_bf16 v[48:51], a[64:67], v[148:151], v[48:51]
  v_mfma_f32_16x16x32_bf16 v[52:55], a[68:71], v[148:151], v[52:55]
  v_mfma_f32_16x16x32_bf16 v[56:59], a[60:63], v[152:155], v[56:59]
  ds_read2st64_b64 v[136:139], v10 offset0:12 offset1:13
  buffer_load_dwordx4 a[216:219], v2, s[48:51], s11 offen offset:2048 sc1
  v_mfma_f32_16x16x32_bf16 v[60:63], a[64:67], v[152:155], v[60:63]
  buffer_load_dwordx4 a[220:223], v2, s[48:51], s11 offen offset:3072 sc1
  s_add_u32 s11, s9, 57344
  buffer_load_dwordx4 a[224:227], v2, s[48:51], s11 offen offset:0 sc1
  v_mfma_f32_16x16x32_bf16 v[64:67], a[68:71], v[152:155], v[64:67]
  v_mfma_f32_16x16x32_bf16 v[68:71], a[60:63], v[156:159], v[68:71]
  ds_read2st64_b64 v[140:143], v11 offset0:12 offset1:13
  v_mfma_f32_16x16x32_bf16 v[72:75], a[64:67], v[156:159], v[72:75]
  v_mfma_f32_16x16x32_bf16 v[76:79], a[68:71], v[156:159], v[76:79]
  s_waitcnt vmcnt(32)
  s_barrier
  s_waitcnt lgkmcnt(0)
  v_mfma_f32_16x16x32_bf16 v[32:35], a[72:75], v[128:131], v[32:35]
  ds_read2st64_b64 v[144:147], v8 offset0:14 offset1:15
  v_mfma_f32_16x16x32_bf16 v[36:39], a[76:79], v[128:131], v[36:39]
  v_mfma_f32_16x16x32_bf16 v[40:43], a[80:83], v[128:131], v[40:43]
  v_mfma_f32_16x16x32_bf16 v[44:47], a[72:75], v[132:135], v[44:47]
  ds_read2st64_b64 v[148:151], v9 offset0:14 offset1:15
  v_mfma_f32_16x16x32_bf16 v[48:51], a[76:79], v[132:135], v[48:51]
  v_mfma_f32_16x16x32_bf16 v[52:55], a[80:83], v[132:135], v[52:55]
  v_mfma_f32_16x16x32_bf16 v[56:59], a[72:75], v[136:139], v[56:59]
  ds_read2st64_b64 v[152:155], v10 offset0:14 offset1:15
  buffer_load_dwordx4 v2, s[44:47], s10 offen offset:3072 sc1 lds
  v_mfma_f32_16x16x32_bf16 v[60:63], a[76:79], v[136:139], v[60:63]
  buffer_load_dwordx4 a[228:231], v2, s[48:51], s11 offen offset:1024 sc1
  buffer_load_dwordx4 a[232:235], v2, s[48:51], s11 offen offset:2048 sc1
  v_mfma_f32_16x16x32_bf16 v[64:67], a[80:83], v[136:139], v[64:67]
  v_mfma_f32_16x16x32_bf16 v[68:71], a[72:75], v[140:143], v[68:71]
  ds_read2st64_b64 v[156:159], v11 offset0:14 offset1:15
  v_mfma_f32_16x16x32_bf16 v[72:75], a[76:79], v[140:143], v[72:75]
  v_mfma_f32_16x16x32_bf16 v[76:79], a[80:83], v[140:143], v[76:79]
  buffer_load_dwordx2 v[180:181], v189, s[92:95], s12 offen sc1
  s_waitcnt vmcnt(35)
  s_barrier
  s_waitcnt lgkmcnt(0)
  v_mfma_f32_16x16x32_bf16 v[32:35], a[84:87], v[144:147], v[32:35]
  ds_read2st64_b64 v[128:131], v8 offset0:16 offset1:17
  v_mfma_f32_16x16x32_bf16 v[36:39], a[88:91], v[144:147], v[36:39]
  v_mfma_f32_16x16x32_bf16 v[40:43], a[92:95], v[144:147], v[40:43]
  v_mfma_f32_16x16x32_bf16 v[44:47], a[84:87], v[148:151], v[44:47]
  ds_read2st64_b64 v[132:135], v9 offset0:16 offset1:17
  v_mfma_f32_16x16x32_bf16 v[48:51], a[88:91], v[148:151], v[48:51]
  v_mfma_f32_16x16x32_bf16 v[52:55], a[92:95], v[148:151], v[52:55]
  v_mfma_f32_16x16x32_bf16 v[56:59], a[84:87], v[152:155], v[56:59]
  ds_read2st64_b64 v[136:139], v10 offset0:16 offset1:17
  buffer_load_dwordx4 a[236:239], v2, s[48:51], s11 offen offset:3072 sc1
  v_mfma_f32_16x16x32_bf16 v[60:63], a[88:91], v[152:155], v[60:63]
  buffer_load_dwordx4 v[228:231], v2, s[52:55], s17 offen sc1
  v_mfma_f32_16x16x32_bf16 v[64:67], a[92:95], v[152:155], v[64:67]
  v_mfma_f32_16x16x32_bf16 v[68:71], a[84:87], v[156:159], v[68:71]
  ds_read2st64_b64 v[140:143], v11 offset0:16 offset1:17
  v_mfma_f32_16x16x32_bf16 v[72:75], a[88:91], v[156:159], v[72:75]
  v_mfma_f32_16x16x32_bf16 v[76:79], a[92:95], v[156:159], v[76:79]
  s_waitcnt vmcnt(36)
  s_barrier
  s_waitcnt lgkmcnt(0)
  v_mfma_f32_16x16x32_bf16 v[32:35], a[96:99], v[128:131], v[32:35]
  ds_read2st64_b64 v[144:147], v8 offset0:18 offset1:19
  v_mfma_f32_16x16x32_bf16 v[36:39], a[100:103], v[128:131], v[36:39]
  v_mfma_f32_16x16x32_bf16 v[40:43], a[104:107], v[128:131], v[40:43]
  v_mfma_f32_16x16x32_bf16 v[44:47], a[96:99], v[132:135], v[44:47]
  ds_read2st64_b64 v[148:151], v9 offset0:18 offset1:19
  v_mfma_f32_16x16x32_bf16 v[48:51], a[100:103], v[132:135], v[48:51]
  v_mfma_f32_16x16x32_bf16 v[52:55], a[104:107], v[132:135], v[52:55]
  v_mfma_f32_16x16x32_bf16 v[56:59], a[96:99], v[136:139], v[56:59]
  ds_read2st64_b64 v[152:155], v10 offset0:18 offset1:19
  v_mfma_f32_16x16x32_bf16 v[60:63], a[100:103], v[136:139], v[60:63]
  v_mfma_f32_16x16x32_bf16 v[64:67], a[104:107], v[136:139], v[64:67]
  v_mfma_f32_16x16x32_bf16 v[68:71], a[96:99], v[140:143], v[68:71]
  ds_read2st64_b64 v[156:159], v11 offset0:18 offset1:19
  v_mfma_f32_16x16x32_bf16 v[72:75], a[100:103], v[140:143], v[72:75]
  v_mfma_f32_16x16x32_bf16 v[76:79], a[104:107], v[140:143], v[76:79]
  s_waitcnt vmcnt(35)
  s_barrier
  s_waitcnt lgkmcnt(0)
  v_mfma_f32_16x16x32_bf16 v[32:35], a[108:111], v[144:147], v[32:35]
  ds_read2st64_b64 v[128:131], v8 offset0:20 offset1:21
  v_mfma_f32_16x16x32_bf16 v[36:39], a[112:115], v[144:147], v[36:39]
  v_mfma_f32_16x16x32_bf16 v[40:43], a[116:119], v[144:147], v[40:43]
  v_mfma_f32_16x16x32_bf16 v[44:47], a[108:111], v[148:151], v[44:47]
  ds_read2st64_b64 v[132:135], v9 offset0:20 offset1:21
  v_mfma_f32_16x16x32_bf16 v[48:51], a[112:115], v[148:151], v[48:51]
  v_mfma_f32_16x16x32_bf16 v[52:55], a[116:119], v[148:151], v[52:55]
  v_mfma_f32_16x16x32_bf16 v[56:59], a[108:111], v[152:155], v[56:59]
  ds_read2st64_b64 v[136:139], v10 offset0:20 offset1:21
  v_mfma_f32_16x16x32_bf16 v[60:63], a[112:115], v[152:155], v[60:63]
  v_mfma_f32_16x16x32_bf16 v[64:67], a[116:119], v[152:155], v[64:67]
  v_mfma_f32_16x16x32_bf16 v[68:71], a[108:111], v[156:159], v[68:71]
  ds_read2st64_b64 v[140:143], v11 offset0:20 offset1:21
  v_mfma_f32_16x16x32_bf16 v[72:75], a[112:115], v[156:159], v[72:75]
  v_mfma_f32_16x16x32_bf16 v[76:79], a[116:119], v[156:159], v[76:79]
  s_waitcnt vmcnt(34)
  s_barrier
  s_waitcnt lgkmcnt(0)
  v_mfma_f32_16x16x32_bf16 v[32:35], a[120:123], v[128:131], v[32:35]
  ds_read2st64_b64 v[144:147], v8 offset0:22 offset1:23
  v_mfma_f32_16x16x32_bf16 v[36:39], a[124:127], v[128:131], v[36:39]
  v_mfma_f32_16x16x32_bf16 v[40:43], a[128:131], v[128:131], v[40:43]
  v_mfma_f32_16x16x32_bf16 v[44:47], a[120:123], v[132:135], v[44:47]
  ds_read2st64_b64 v[148:151], v9 offset0:22 offset1:23
  v_mfma_f32_16x16x32_bf16 v[48:51], a[124:127], v[132:135], v[48:51]
  v_mfma_f32_16x16x32_bf16 v[52:55], a[128:131], v[132:135], v[52:55]
  v_mfma_f32_16x16x32_bf16 v[56:59], a[120:123], v[136:139], v[56:59]
  ds_read2st64_b64 v[152:155], v10 offset0:22 offset1:23
  v_mfma_f32_16x16x32_bf16 v[60:63], a[124:127], v[136:139], v[60:63]
  v_mfma_f32_16x16x32_bf16 v[64:67], a[128:131], v[136:139], v[64:67]
  v_mfma_f32_16x16x32_bf16 v[68:71], a[120:123], v[140:143], v[68:71]
  ds_read2st64_b64 v[156:159], v11 offset0:22 offset1:23
  v_mfma_f32_16x16x32_bf16 v[72:75], a[124:127], v[140:143], v[72:75]
  v_mfma_f32_16x16x32_bf16 v[76:79], a[128:131], v[140:143], v[76:79]
  s_waitcnt vmcnt(2)
  s_mov_b32 s35, 0
  s_nop 5
HBW2:
  v_cmp_ne_u64 vcc, s[90:91], v[180:181]
  s_nop 4
  s_cbranch_vccz HBK2
  s_add_u32 s35, s35, 1
  s_cmp_ge_u32 s35, 0x8000
  s_cbranch_scc1 HBK2
  s_sleep 1
  buffer_load_dwordx2 v[180:181], v189, s[92:95], s12 offen sc1
  s_waitcnt vmcnt(0)
  s_branch HBW2
HBK2:
  s_barrier
  s_waitcnt lgkmcnt(0)
  v_mfma_f32_16x16x32_bf16 v[32:35], a[132:135], v[144:147], v[32:35]
  ds_read2st64_b64 v[128:131], v8 offset0:24 offset1:25
  v_mfma_f32_16x16x32_bf16 v[36:39], a[136:139], v[144:147], v[36:39]
  v_mfma_f32_16x16x32_bf16 v[40:43], a[140:143], v[144:147], v[40:43]
  v_mfma_f32_16x16x32_bf16 v[44:47], a[132:135], v[148:151], v[44:47]
  ds_read2st64_b64 v[132:135], v9 offset0:24 offset1:25
  v_mfma_f32_16x16x32_bf16 v[48:51], a[136:139], v[148:151], v[48:51]
  v_mfma_f32_16x16x32_bf16 v[52:55], a[140:143], v[148:151], v[52:55]
  v_mfma_f32_16x16x32_bf16 v[56:59], a[132:135], v[152:155], v[56:59]
  ds_read2st64_b64 v[136:139], v10 offset0:24 offset1:25
  s_add_u32 s21, s21, 77824
  buffer_load_dwordx4 v[192:195], v2, s[44:47], s21 offen offset:0 sc1
  buffer_load_dwordx4 v[196:199], v2, s[44:47], s21 offen offset:1024 sc1
  buffer_load_dwordx4 v[200:203], v2, s[44:47], s21 offen offset:2048 sc1
  buffer_load_dwordx4 v[204:207], v2, s[44:47], s21 offen offset:3072 sc1
  s_add_u32 s21, s21, 4096
  buffer_load_dwordx4 v[208:211], v2, s[44:47], s21 offen offset:0 sc1
  v_mfma_f32_16x16x32_bf16 v[60:63], a[136:139], v[152:155], v[60:63]
  s_add_u32 m0, s6, 81920
  s_add_u32 s10, s7, 81920
  buffer_load_dwordx4 v2, s[44:47], s10 offen offset:0 sc1 lds
  buffer_load_dwordx4 v2, s[44:47], s10 offen offset:1024 sc1 lds
  v_mfma_f32_16x16x32_bf16 v[64:67], a[140:143], v[152:155], v[64:67]
  v_mfma_f32_16x16x32_bf16 v[68:71], a[132:135], v[156:159], v[68:71]
  ds_read2st64_b64 v[140:143], v11 offset0:24 offset1:25
  v_mfma_f32_16x16x32_bf16 v[72:75], a[136:139], v[156:159], v[72:75]
  v_mfma_f32_16x16x32_bf16 v[76:79], a[140:143], v[156:159], v[76:79]
  s_barrier
  s_waitcnt lgkmcnt(0)
  v_mfma_f32_16x16x32_bf16 v[32:35], a[144:147], v[128:131], v[32:35]
  ds_read2st64_b64 v[144:147], v8 offset0:26 offset1:27
  v_mfma_f32_16x16x32_bf16 v[36:39], a[148:151], v[128:131], v[36:39]
  v_mfma_f32_16x16x32_bf16 v[40:43], a[152:155], v[128:131], v[40:43]
  v_mfma_f32_16x16x32_bf16 v[44:47], a[144:147], v[132:135], v[44:47]
  ds_read2st64_b64 v[148:151], v9 offset0:26 offset1:27
  v_mfma_f32_16x16x32_bf16 v[48:51], a[148:151], v[132:135], v[48:51]
  v_mfma_f32_16x16x32_bf16 v[52:55], a[152:155], v[132:135], v[52:55]
  v_mfma_f32_16x16x32_bf16 v[56:59], a[144:147], v[136:139], v[56:59]
  ds_read2st64_b64 v[152:155], v10 offset0:26 offset1:27
  buffer_load_dwordx4 v2, s[44:47], s10 offen offset:2048 sc1 lds
  v_mfma_f32_16x16x32_bf16 v[60:63], a[148:151], v[136:139], v[60:63]
  buffer_load_dwordx4 v2, s[44:47], s10 offen offset:3072 sc1 lds
  s_add_u32 m0, s6, 86016
  s_add_u32 s10, s7, 86016
  buffer_load_dwordx4 v2, s[44:47], s10 offen offset:0 sc1 lds
  v_mfma_f32_16x16x32_bf16 v[64:67], a[152:155], v[136:139], v[64:67]
  v_mfma_f32_16x16x32_bf16 v[68:71], a[144:147], v[140:143], v[68:71]
  ds_read2st64_b64 v[156:159], v11 offset0:26 offset1:27
  v_mfma_f32_16x16x32_bf16 v[72:75], a[148:151], v[140:143], v[72:75]
  v_mfma_f32_16x16x32_bf16 v[76:79], a[152:155], v[140:143], v[76:79]
  buffer_load_dwordx2 v[190:191], v188, s[92:95], s37 offen sc1
  s_barrier
  s_waitcnt lgkmcnt(0)
  v_mfma_f32_16x16x32_bf16 v[32:35], a[156:159], v[144:147], v[32:35]
  ds_read2st64_b64 v[128:131], v8 offset0:28 offset1:29
  v_mfma_f32_16x16x32_bf16 v[36:39], a[160:163], v[144:147], v[36:39]
  v_mfma_f32_16x16x32_bf16 v[40:43], a[164:167], v[144:147], v[40:43]
  v_mfma_f32_16x16x32_bf16 v[44:47], a[156:159], v[148:151], v[44:47]
  ds_read2st64_b64 v[132:135], v9 offset0:28 offset1:29
  v_mfma_f32_16x16x32_bf16 v[48:51], a[160:163], v[148:151], v[48:51]
  v_mfma_f32_16x16x32_bf16 v[52:55], a[164:167], v[148:151], v[52:55]
  v_mfma_f32_16x16x32_bf16 v[56:59], a[156:159], v[152:155], v[56:59]
  ds_read2st64_b64 v[136:139], v10 offset0:28 offset1:29
  buffer_load_dwordx4 v2, s[44:47], s10 offen offset:1024 sc1 lds
  v_mfma_f32_16x16x32_bf16 v[60:63], a[160:163], v[152:155], v[60:63]
  buffer_load_dwordx4 v2, s[44:47], s10 offen offset:2048 sc1 lds
  buffer_load_dwordx4 v2, s[44:47], s10 offen offset:3072 sc1 lds
  v_mfma_f32_16x16x32_bf16 v[64:67], a[164:167], v[152:155], v[64:67]
  v_mfma_f32_16x16x32_bf16 v[68:71], a[156:159], v[156:159], v[68:71]
  ds_read2st64_b64 v[140:143], v11 offset0:28 offset1:29
  v_mfma_f32_16x16x32_bf16 v[72:75], a[160:163], v[156:159], v[72:75]
  v_mfma_f32_16x16x32_bf16 v[76:79], a[164:167], v[156:159], v[76:79]
  s_barrier
  s_waitcnt lgkmcnt(0)
  v_mfma_f32_16x16x32_bf16 v[32:35], a[168:171], v[128:131], v[32:35]
  ds_read2st64_b64 v[144:147], v8 offset0:30 offset1:31
  v_mfma_f32_16x16x32_bf16 v[36:39], a[172:175], v[128:131], v[36:39]
  v_mfma_f32_16x16x32_bf16 v[40:43], a[176:179], v[128:131], v[40:43]
  v_mfma_f32_16x16x32_bf16 v[44:47], a[168:171], v[132:135], v[44:47]
  ds_read2st64_b64 v[148:151], v9 offset0:30 offset1:31
  v_mfma_f32_16x16x32_bf16 v[48:51], a[172:175], v[132:135], v[48:51]
  v_mfma_f32_16x16x32_bf16 v[52:55], a[176:179], v[132:135], v[52:55]
  v_mfma_f32_16x16x32_bf16 v[56:59], a[168:171], v[136:139], v[56:59]
  ds_read2st64_b64 v[152:155], v10 offset0:30 offset1:31
  v_mfma_f32_16x16x32_bf16 v[60:63], a[172:175], v[136:139], v[60:63]
  v_mfma_f32_16x16x32_bf16 v[64:67], a[176:179], v[136:139], v[64:67]
  v_mfma_f32_16x16x32_bf16 v[68:71], a[168:171], v[140:143], v[68:71]
  ds_read2st64_b64 v[156:159], v11 offset0:30 offset1:31
  v_mfma_f32_16x16x32_bf16 v[72:75], a[172:175], v[140:143], v[72:75]
  v_mfma_f32_16x16x32_bf16 v[76:79], a[176:179], v[140:143], v[76:79]
  s_barrier
  s_waitcnt lgkmcnt(0)
  v_mfma_f32_16x16x32_bf16 v[32:35], a[180:183], v[144:147], v[32:35]
  ds_read2st64_b64 v[128:131], v8 offset0:32 offset1:33
  v_mfma_f32_16x16x32_bf16 v[36:39], a[184:187], v[144:147], v[36:39]
  v_mfma_f32_16x16x32_bf16 v[40:43], a[188:191], v[144:147], v[40:43]
  v_mfma_f32_16x16x32_bf16 v[44:47], a[180:183], v[148:151], v[44:47]
  ds_read2st64_b64 v[132:135], v9 offset0:32 offset1:33
  v_mfma_f32_16x16x32_bf16 v[48:51], a[184:187], v[148:151], v[48:51]
  v_mfma_f32_16x16x32_bf16 v[52:55], a[188:191], v[148:151], v[52:55]
  v_mfma_f32_16x16x32_bf16 v[56:59], a[180:183], v[152:155], v[56:59]
  ds_read2st64_b64 v[136:139], v10 offset0:32 offset1:33
  v_mfma_f32_16x16x32_bf16 v[60:63], a[184:187], v[152:155], v[60:63]
  v_mfma_f32_16x16x32_bf16 v[64:67], a[188:191], v[152:155], v[64:67]
  v_mfma_f32_16x16x32_bf16 v[68:71], a[180:183], v[156:159], v[68:71]
  ds_read2st64_b64 v[140:143], v11 offset0:32 offset1:33
  v_mfma_f32_16x16x32_bf16 v[72:75], a[184:187], v[156:159], v[72:75]
  v_mfma_f32_16x16x32_bf16 v[76:79], a[188:191], v[156:159], v[76:79]
  s_barrier
  s_waitcnt lgkmcnt(0)
  v_mfma_f32_16x16x32_bf16 v[32:35], a[192:195], v[128:131], v[32:35]
  ds_read2st64_b64 v[144:147], v8 offset0:34 offset1:35
  v_mfma_f32_16x16x32_bf16 v[36:39], a[196:199], v[128:131], v[36:39]
  v_mfma_f32_16x16x32_bf16 v[40:43], a[200:203], v[128:131], v[40:43]
  v_mfma_f32_16x16x32_bf16 v[44:47], a[192:195], v[132:135], v[44:47]
  ds_read2st64_b64 v[148:151], v9 offset0:34 offset1:35
  v_mfma_f32_16x16x32_bf16 v[48:51], a[196:199], v[132:135], v[48:51]
  v_mfma_f32_16x16x32_bf16 v[52:55], a[200:203], v[132:135], v[52:55]
  v_mfma_f32_16x16x32_bf16 v[56:59], a[192:195], v[136:139], v[56:59]
  ds_read2st64_b64 v[152:155], v10 offset0:34 offset1:35
  v_mfma_f32_16x16x32_bf16 v[60:63], a[196:199], v[136:139], v[60:63]
  v_mfma_f32_16x16x32_bf16 v[64:67], a[200:203], v[136:139], v[64:67]
  v_mfma_f32_16x16x32_bf16 v[68:71], a[192:195], v[140:143], v[68:71]
  ds_read2st64_b64 v[156:159], v11 offset0:34 offset1:35
  v_mfma_f32_16x16x32_bf16 v[72:75], a[196:199], v[140:143], v[72:75]
  v_mfma_f32_16x16x32_bf16 v[76:79], a[200:203], v[140:143], v[76:79]
  s_waitcnt vmcnt(9)
  v_dot2_f32_bf16 v252, v192, s16, 0
  v_dot2_f32_bf16 v253, v192, v192, 0
  v_dot2_f32_bf16 v252, v193, s16, v252
  v_dot2_f32_bf16 v253, v193, v193, v253
  v_dot2_f32_bf16 v254, v194, s16, 0
  v_dot2_f32_bf16 v255, v194, v194, 0
  v_dot2_f32_bf16 v254, v195, s16, v254
  v_dot2_f32_bf16 v255, v195, v195, v255
  v_dot2_f32_bf16 v252, v196, s16, v252
  v_dot2_f32_bf16 v253, v196, v196, v253
  v_dot2_f32_bf16 v252, v197, s16, v252
  v_dot2_f32_bf16 v253, v197, v197, v253
  v_dot2_f32_bf16 v254, v198, s16, v254
  v_dot2_f32_bf16 v255, v198, v198, v255
  v_dot2_f32_bf16 v254, v199, s16, v254
  v_dot2_f32_bf16 v255, v199, v199, v255
  v_dot2_f32_bf16 v252, v200, s16, v252
  v_dot2_f32_bf16 v253, v200, v200, v253
  v_dot2_f32_bf16 v252, v201, s16, v252
  v_dot2_f32_bf16 v253, v201, v201, v253
  v_dot2_f32_bf16 v254, v202, s16, v254
  v_dot2_f32_bf16 v255, v202, v202, v255
  v_dot2_f32_bf16 v254, v203, s16, v254
  v_dot2_f32_bf16 v255, v203, v203, v255
  v_dot2_f32_bf16 v252, v204, s16, v252
  v_dot2_f32_bf16 v253, v204, v204, v253
  v_dot2_f32_bf16 v252, v205, s16, v252
  v_dot2_f32_bf16 v253, v205, v205, v253
  v_dot2_f32_bf16 v254, v206, s16, v254
  v_dot2_f32_bf16 v255, v206, v206, v255
  v_dot2_f32_bf16 v254, v207, s16, v254
  v_dot2_f32_bf16 v255, v207, v207, v255
  v_dot2_f32_bf16 v252, v208, s16, v252
  v_dot2_f32_bf16 v253, v208, v208, v253
  v_dot2_f32_bf16 v252, v209, s16, v252
  v_dot2_f32_bf16 v253, v209, v209, v253
  v_dot2_f32_bf16 v254, v210, s16, v254
  v_dot2_f32_bf16 v255, v210, v210, v255
  v_dot2_f32_bf16 v254, v211, s16, v254
  v_dot2_f32_bf16 v255, v211, v211, v255
  v_mov_b32 v192, v252
  v_mov_b32 v193, v253
  v_mov_b32 v194, v254
  v_mov_b32 v195, v255
  v_permlane32_swap_b32 v252, v192
  v_permlane32_swap_b32 v253, v193
  v_permlane32_swap_b32 v254, v194
  v_permlane32_swap_b32 v255, v195
  v_pk_add_f32 v[252:253], v[252:253], v[192:193]
  v_pk_add_f32 v[254:255], v[254:255], v[194:195]
  v_mov_b32 v192, v252
  v_mov_b32 v193, v253
  v_mov_b32 v194, v254
  v_mov_b32 v195, v255
  v_permlane16_swap_b32 v252, v192
  v_permlane16_swap_b32 v253, v193
  v_permlane16_swap_b32 v254, v194
  v_permlane16_swap_b32 v255, v195
  v_pk_add_f32 v[252:253], v[252:253], v[192:193]
  v_pk_add_f32 v[254:255], v[254:255], v[194:195]
  s_nop 0
  v_add_f32_dpp v252, v252, v252 row_ror:8 row_mask:0xf bank_mask:0xf
  v_add_f32_dpp v253, v253, v253 row_ror:8 row_mask:0xf bank_mask:0xf
  v_add_f32_dpp v254, v254, v254 row_ror:8 row_mask:0xf bank_mask:0xf
  v_add_f32_dpp v255, v255, v255 row_ror:8 row_mask:0xf bank_mask:0xf
  v_add_u32 v6, 6144, v182
  v_add_u32 v6, s27, v6
  ds_write_b128 v6, v[252:255]
  s_waitcnt lgkmcnt(0)
  s_barrier
  v_mfma_f32_16x16x32_bf16 v[32:35], a[204:207], v[144:147], v[32:35]
  ds_read2st64_b64 v[128:131], v8 offset0:36 offset1:37
  v_mfma_f32_16x16x32_bf16 v[36:39], a[208:211], v[144:147], v[36:39]
  v_mfma_f32_16x16x32_bf16 v[40:43], a[212:215], v[144:147], v[40:43]
  v_mfma_f32_16x16x32_bf16 v[44:47], a[204:207], v[148:151], v[44:47]
  ds_read2st64_b64 v[132:135], v9 offset0:36 offset1:37
  v_mfma_f32_16x16x32_bf16 v[48:51], a[208:211], v[148:151], v[48:51]
  v_mfma_f32_16x16x32_bf16 v[52:55], a[212:215], v[148:151], v[52:55]
  v_mfma_f32_16x16x32_bf16 v[56:59], a[204:207], v[152:155], v[56:59]
  ds_read2st64_b64 v[136:139], v10 offset0:36 offset1:37
  v_mfma_f32_16x16x32_bf16 v[60:63], a[208:211], v[152:155], v[60:63]
  v_mfma_f32_16x16x32_bf16 v[64:67], a[212:215], v[152:155], v[64:67]
  v_mfma_f32_16x16x32_bf16 v[68:71], a[204:207], v[156:159], v[68:71]
  ds_read2st64_b64 v[140:143], v11 offset0:36 offset1:37
  v_mfma_f32_16x16x32_bf16 v[72:75], a[208:211], v[156:159], v[72:75]
  v_mfma_f32_16x16x32_bf16 v[76:79], a[212:215], v[156:159], v[76:79]
  s_barrier
  s_waitcnt lgkmcnt(0)
  v_mfma_f32_16x16x32_bf16 v[32:35], a[216:219], v[128:131], v[32:35]
  ds_read2st64_b64 v[144:147], v8 offset0:38 offset1:39
  v_mfma_f32_16x16x32_bf16 v[36:39], a[220:223], v[128:131], v[36:39]
  v_mfma_f32_16x16x32_bf16 v[40:43], a[224:227], v[128:131], v[40:43]
  v_mfma_f32_16x16x32_bf16 v[44:47], a[216:219], v[132:135], v[44:47]
  ds_read2st64_b64 v[148:151], v9 offset0:38 offset1:39
  v_mfma_f32_16x16x32_bf16 v[48:51], a[220:223], v[132:135], v[48:51]
  v_mfma_f32_16x16x32_bf16 v[52:55], a[224:227], v[132:135], v[52:55]
  v_mfma_f32_16x16x32_bf16 v[56:59], a[216:219], v[136:139], v[56:59]
  ds_read2st64_b64 v[152:155], v10 offset0:38 offset1:39
  buffer_load_dwordx2 v[176:177], v186, s[72:75], s24 offen offset:0 sc1
  v_mfma_f32_16x16x32_bf16 v[60:63], a[220:223], v[136:139], v[60:63]
  s_add_u32 m0, s6, 90112
  s_add_u32 s10, s7, 90112
  buffer_load_dwordx4 v2, s[44:47], s10 offen offset:0 sc1 lds
  v_mfma_f32_16x16x32_bf16 v[64:67], a[224:227], v[136:139], v[64:67]
  v_mfma_f32_16x16x32_bf16 v[68:71], a[216:219], v[140:143], v[68:71]
  ds_read2st64_b64 v[156:159], v11 offset0:38 offset1:39
  v_mfma_f32_16x16x32_bf16 v[72:75], a[220:223], v[140:143], v[72:75]
  v_mfma_f32_16x16x32_bf16 v[76:79], a[224:227], v[140:143], v[76:79]
  s_waitcnt vmcnt(5)
  s_mov_b32 s35, 0
  s_nop 5
W2W2:
  v_cmp_ne_u64 vcc, s[90:91], v[190:191]
  s_nop 4
  s_cbranch_vccz W2K2
  s_add_u32 s35, s35, 1
  s_cmp_ge_u32 s35, 0x8000
  s_cbranch_scc1 W2K2
  s_sleep 2
  buffer_load_dwordx2 v[190:191], v188, s[92:95], s37 offen sc1
  s_waitcnt vmcnt(0)
  s_branch W2W2
W2K2:
  s_barrier
  s_waitcnt lgkmcnt(0)
  v_mfma_f32_16x16x32_bf16 v[32:35], a[228:231], v[144:147], v[32:35]
  ds_read2st64_b64 v[128:131], v12 offset0:0 offset1:1
  v_mfma_f32_16x16x32_bf16 v[36:39], a[232:235], v[144:147], v[36:39]
  v_mfma_f32_16x16x32_bf16 v[40:43], a[236:239], v[144:147], v[40:43]
  v_mfma_f32_16x16x32_bf16 v[44:47], a[228:231], v[148:151], v[44:47]
  ds_read2st64_b64 v[132:135], v13 offset0:0 offset1:1
  v_mfma_f32_16x16x32_bf16 v[48:51], a[232:235], v[148:151], v[48:51]
  v_mfma_f32_16x16x32_bf16 v[52:55], a[236:239], v[148:151], v[52:55]
  v_mfma_f32_16x16x32_bf16 v[56:59], a[228:231], v[152:155], v[56:59]
  ds_read2st64_b64 v[136:139], v14 offset0:0 offset1:1
  v_mfma_f32_16x16x32_bf16 v[60:63], a[232:235], v[152:155], v[60:63]
  v_mfma_f32_16x16x32_bf16 v[64:67], a[236:239], v[152:155], v[64:67]
  v_mfma_f32_16x16x32_bf16 v[68:71], a[228:231], v[156:159], v[68:71]
  ds_read2st64_b64 v[140:143], v15 offset0:0 offset1:1
  v_mfma_f32_16x16x32_bf16 v[72:75], a[232:235], v[156:159], v[72:75]
  v_mfma_f32_16x16x32_bf16 v[76:79], a[236:239], v[156:159], v[76:79]
  s_barrier
  s_waitcnt lgkmcnt(0)
  v_mfma_f32_16x16x32_bf16 v[80:83], a[0:3], v[128:131], 0
  ds_read2st64_b64 v[144:147], v12 offset0:2 offset1:3
  v_mfma_f32_16x16x32_bf16 v[84:87], a[4:7], v[128:131], 0
  v_mfma_f32_16x16x32_bf16 v[88:91], a[8:11], v[128:131], 0
  v_mfma_f32_16x16x32_bf16 v[92:95], a[0:3], v[132:135], 0
  ds_read2st64_b64 v[148:151], v13 offset0:2 offset1:3
  v_mfma_f32_16x16x32_bf16 v[96:99], a[4:7], v[132:135], 0
  v_mfma_f32_16x16x32_bf16 v[100:103], a[8:11], v[132:135], 0
  v_mfma_f32_16x16x32_bf16 v[104:107], a[0:3], v[136:139], 0
  ds_read2st64_b64 v[152:155], v14 offset0:2 offset1:3
  v_mfma_f32_16x16x32_bf16 v[108:111], a[4:7], v[136:139], 0
  v_mfma_f32_16x16x32_bf16 v[112:115], a[8:11], v[136:139], 0
  v_mfma_f32_16x16x32_bf16 v[116:119], a[0:3], v[140:143], 0
  ds_read2st64_b64 v[156:159], v15 offset0:2 offset1:3
  v_mfma_f32_16x16x32_bf16 v[120:123], a[4:7], v[140:143], 0
  v_mfma_f32_16x16x32_bf16 v[124:127], a[8:11], v[140:143], 0
  s_barrier
  s_waitcnt lgkmcnt(0)
  v_mfma_f32_16x16x32_bf16 v[80:83], a[12:15], v[144:147], v[80:83]
  ds_read2st64_b64 v[128:131], v12 offset0:4 offset1:5
  v_mfma_f32_16x16x32_bf16 v[84:87], a[16:19], v[144:147], v[84:87]
  v_mfma_f32_16x16x32_bf16 v[88:91], a[20:23], v[144:147], v[88:91]
  v_mfma_f32_16x16x32_bf16 v[92:95], a[12:15], v[148:151], v[92:95]
  ds_read2st64_b64 v[132:135], v13 offset0:4 offset1:5
  v_mfma_f32_16x16x32_bf16 v[96:99], a[16:19], v[148:151], v[96:99]
  v_mfma_f32_16x16x32_bf16 v[100:103], a[20:23], v[148:151], v[100:103]
  v_mfma_f32_16x16x32_bf16 v[104:107], a[12:15], v[152:155], v[104:107]
  ds_read2st64_b64 v[136:139], v14 offset0:4 offset1:5
  s_add_u32 s11, s22, 0
  buffer_load_dwordx4 a[0:3], v2, s[68:71], s11 offen offset:0 sc1
  v_mfma_f32_16x16x32_bf16 v[108:111], a[16:19], v[152:155], v[108:111]
  buffer_load_dwordx4 a[4:7], v2, s[68:71], s11 offen offset:1024 sc1
  v_mfma_f32_16x16x32_bf16 v[112:115], a[20:23], v[152:155], v[112:115]
  buffer_load_dwordx4 a[8:11], v2, s[68:71], s11 offen offset:2048 sc1
  buffer_load_dwordx4 v2, s[44:47], s10 offen offset:1024 sc1 lds
  v_mfma_f32_16x16x32_bf16 v[116:119], a[12:15], v[156:159], v[116:119]
  ds_read2st64_b64 v[140:143], v15 offset0:4 offset1:5
  v_mfma_f32_16x16x32_bf16 v[120:123], a[16:19], v[156:159], v[120:123]
  v_mfma_f32_16x16x32_bf16 v[124:127], a[20:23], v[156:159], v[124:127]
  s_mov_b32 s35, 0
  s_nop 6
K3_STCHK02:
  s_waitcnt vmcnt(5)
  v_cmp_eq_u32 vcc, 0, v177
  s_nop 4
  s_cbranch_vccz K3_STOK02
  s_add_u32 s35, s35, 1
  s_cmp_ge_u32 s35, 0x4000
  s_cbranch_scc1 K3_STOK02
  s_sleep 2
  buffer_load_dwordx2 v[176:177], v186, s[72:75], s24 offen offset:0 sc1
  s_waitcnt vmcnt(0)
  s_branch K3_STCHK02
K3_STOK02:
  s_barrier
  s_waitcnt lgkmcnt(0)
  v_mfma_f32_16x16x32_bf16 v[80:83], a[24:27], v[128:131], v[80:83]
  ds_read2st64_b64 v[144:147], v12 offset0:6 offset1:7
  ds_write_b64 v183, v[176:177] offset:4096
  v_mov_b32 v232, v228
  v_mfma_f32_16x16x32_bf16 v[84:87], a[28:31], v[128:131], v[84:87]
  v_mov_b32 v233, v229
  v_mov_b32 v234, v230
  v_mov_b32 v235, v231
  v_mfma_f32_16x16x32_bf16 v[88:91], a[32:35], v[128:131], v[88:91]
  v_permlane32_swap_b32 v228, v232
  v_permlane32_swap_b32 v229, v233
  v_permlane32_swap_b32 v230, v234
  v_mfma_f32_16x16x32_bf16 v[92:95], a[24:27], v[132:135], v[92:95]
  ds_read2st64_b64 v[148:151], v13 offset0:6 offset1:7
  v_permlane32_swap_b32 v231, v235
  v_add_f32 v228, v228, v232
  v_mfma_f32_16x16x32_bf16 v[96:99], a[28:31], v[132:135], v[96:99]
  v_add_f32 v229, v229, v233
  v_add_f32 v230, v230, v234
  v_add_f32 v231, v231, v235
  v_mfma_f32_16x16x32_bf16 v[100:103], a[32:35], v[132:135], v[100:103]
  v_mov_b32 v232, v228
  v_mov_b32 v233, v229
  v_mov_b32 v234, v230
  v_mfma_f32_16x16x32_bf16 v[104:107], a[24:27], v[136:139], v[104:107]
  ds_read2st64_b64 v[152:155], v14 offset0:6 offset1:7
  buffer_load_dwordx4 a[12:15], v2, s[68:71], s11 offen offset:3072 sc1
  v_mfma_f32_16x16x32_bf16 v[108:111], a[28:31], v[136:139], v[108:111]
  s_add_u32 s11, s22, 4096
  buffer_load_dwordx4 a[16:19], v2, s[68:71], s11 offen offset:0 sc1
  v_mfma_f32_16x16x32_bf16 v[112:115], a[32:35], v[136:139], v[112:115]
  buffer_load_dwordx4 a[20:23], v2, s[68:71], s11 offen offset:1024 sc1
  buffer_load_dwordx4 v2, s[44:47], s10 offen offset:2048 sc1 lds
  v_mfma_f32_16x16x32_bf16 v[116:119], a[24:27], v[140:143], v[116:119]
  ds_read2st64_b64 v[156:159], v15 offset0:6 offset1:7
  v_mov_b32 v235, v231
  v_permlane16_swap_b32 v228, v232
  v_mfma_f32_16x16x32_bf16 v[120:123], a[28:31], v[140:143], v[120:123]
  v_permlane16_swap_b32 v229, v233
  v_permlane16_swap_b32 v230, v234
  v_permlane16_swap_b32 v231, v235
  v_mfma_f32_16x16x32_bf16 v[124:127], a[32:35], v[140:143], v[124:127]
  v_add_f32 v228, v228, v232
  v_add_f32 v229, v229, v233
  v_add_f32 v230, v230, v234
  s_barrier
  s_waitcnt lgkmcnt(0)
  v_mfma_f32_16x16x32_bf16 v[80:83], a[36:39], v[144:147], v[80:83]
  ds_read2st64_b64 v[128:131], v12 offset0:8 offset1:9
  v_add_f32 v231, v231, v235
  ds_write_b128 v185, v[228:231] offset:5120
  v_mfma_f32_16x16x32_bf16 v[84:87], a[40:43], v[144:147], v[84:87]
  ds_read_b64 v[192:193], v184 offset:4352
  ds_read_b64 v[196:197], v184 offset:4480
  ds_read_b64 v[200:201], v184 offset:4096
  v_mfma_f32_16x16x32_bf16 v[88:91], a[44:47], v[144:147], v[88:91]
  ds_read_b64 v[204:205], v184 offset:4224
  ds_read2_b64 v[16:19], v187 offset0:0 offset1:2
  ds_read2_b64 v[20:23], v187 offset0:8 offset1:10
  v_mfma_f32_16x16x32_bf16 v[92:95], a[36:39], v[148:151], v[92:95]
  ds_read2st64_b64 v[132:135], v13 offset0:8 offset1:9
  ds_read2_b64 v[24:27], v187 offset0:16 offset1:18
  v_mov_b32 v181, v30
  v_mfma_f32_16x16x32_bf16 v[96:99], a[40:43], v[148:151], v[96:99]
  v_mov_b32 v28, 1
  v_mov_b32 v29, 0
  v_mov_b32 v4, 0xbfb8aa3b
  v_mfma_f32_16x16x32_bf16 v[100:103], a[44:47], v[148:151], v[100:103]
  s_waitcnt lgkmcnt(0)
  v_rcp_f32 v194, v193
  v_rcp_f32 v198, v197
  v_mfma_f32_16x16x32_bf16 v[104:107], a[36:39], v[152:155], v[104:107]
  ds_read2st64_b64 v[136:139], v14 offset0:8 offset1:9
  buffer_load_dwordx4 a[24:27], v2, s[68:71], s11 offen offset:2048 sc1
  v_mfma_f32_16x16x32_bf16 v[108:111], a[40:43], v[152:155], v[108:111]
  buffer_load_dwordx4 a[28:31], v2, s[68:71], s11 offen offset:3072 sc1
  v_mfma_f32_16x16x32_bf16 v[112:115], a[44:47], v[152:155], v[112:115]
  s_add_u32 s11, s22, 8192
  buffer_load_dwordx4 a[32:35], v2, s[68:71], s11 offen offset:0 sc1
  buffer_load_dwordx4 v2, s[44:47], s10 offen offset:3072 sc1 lds
  v_mfma_f32_16x16x32_bf16 v[116:119], a[36:39], v[156:159], v[116:119]
  ds_read2st64_b64 v[140:143], v15 offset0:8 offset1:9
  v_rcp_f32 v202, v201
  v_rcp_f32 v206, v205
  v_mfma_f32_16x16x32_bf16 v[120:123], a[40:43], v[156:159], v[120:123]
  v_mul_f32 v193, v193, v193
  v_mul_f32 v197, v197, v197
  v_mul_f32 v201, v201, v201
  v_mfma_f32_16x16x32_bf16 v[124:127], a[44:47], v[156:159], v[124:127]
  v_mul_f32 v205, v205, v205
  v_mul_f32 v194, v194, v4
  v_mul_f32 v198, v198, v4
  s_barrier
  s_waitcnt lgkmcnt(0)
  v_mfma_f32_16x16x32_bf16 v[80:83], a[48:51], v[128:131], v[80:83]
  ds_read2st64_b64 v[144:147], v12 offset0:10 offset1:11
  v_mul_f32 v202, v202, v4
  v_mul_f32 v206, v206, v4
  v_mfma_f32_16x16x32_bf16 v[84:87], a[52:55], v[128:131], v[84:87]
  v_fma_f32 v32, -v192, v16, v32
  v_fma_f32 v36, -v192, v20, v36
  v_fma_f32 v40, -v192, v24, v40
  v_mfma_f32_16x16x32_bf16 v[88:91], a[56:59], v[128:131], v[88:91]
  v_fma_f32 v33, -v192, v17, v33
  v_fma_f32 v37, -v192, v21, v37
  v_fma_f32 v41, -v192, v25, v41
  v_mfma_f32_16x16x32_bf16 v[92:95], a[48:51], v[132:135], v[92:95]
  ds_read2st64_b64 v[148:151], v13 offset0:10 offset1:11
  v_mul_f32 v232, v32, v194
  v_mul_f32 v234, v36, v194
  v_mfma_f32_16x16x32_bf16 v[96:99], a[52:55], v[132:135], v[96:99]
  v_mul_f32 v236, v40, v194
  v_mul_f32 v233, v33, v194
  v_mul_f32 v235, v37, v194
  v_mfma_f32_16x16x32_bf16 v[100:103], a[56:59], v[132:135], v[100:103]
  v_mul_f32 v237, v41, v194
  v_exp_f32 v232, v232
  v_mfma_f32_16x16x32_bf16 v[104:107], a[48:51], v[136:139], v[104:107]
  ds_read2st64_b64 v[152:155], v14 offset0:10 offset1:11
  buffer_load_dwordx4 a[36:39], v2, s[68:71], s11 offen offset:1024 sc1
  v_mfma_f32_16x16x32_bf16 v[108:111], a[52:55], v[136:139], v[108:111]
  buffer_load_dwordx4 a[40:43], v2, s[68:71], s11 offen offset:2048 sc1
  v_mfma_f32_16x16x32_bf16 v[112:115], a[56:59], v[136:139], v[112:115]
  buffer_load_dwordx4 a[44:47], v2, s[68:71], s11 offen offset:3072 sc1
  s_add_u32 m0, s6, 94208
  s_add_u32 s10, s7, 94208
  buffer_load_dwordx4 v2, s[44:47], s10 offen offset:0 sc1 lds
  v_mfma_f32_16x16x32_bf16 v[116:119], a[48:51], v[140:143], v[116:119]
  ds_read2st64_b64 v[156:159], v15 offset0:10 offset1:11
  v_exp_f32 v234, v234
  v_mfma_f32_16x16x32_bf16 v[120:123], a[52:55], v[140:143], v[120:123]
  v_exp_f32 v236, v236
  v_fma_f32 v34, -v192, v18, v34
  v_mfma_f32_16x16x32_bf16 v[124:127], a[56:59], v[140:143], v[124:127]
  v_fma_f32 v38, -v192, v22, v38
  v_fma_f32 v42, -v192, v26, v42
  v_exp_f32 v233, v233
  s_barrier
  s_waitcnt lgkmcnt(0)
  v_mfma_f32_16x16x32_bf16 v[80:83], a[60:63], v[144:147], v[80:83]
  ds_read2st64_b64 v[128:131], v12 offset0:12 offset1:13
  v_exp_f32 v235, v235
  v_mfma_f32_16x16x32_bf16 v[84:87], a[64:67], v[144:147], v[84:87]
  v_exp_f32 v237, v237
  v_fma_f32 v35, -v192, v19, v35
  v_mfma_f32_16x16x32_bf16 v[88:91], a[68:71], v[144:147], v[88:91]
  v_fma_f32 v39, -v192, v23, v39
  v_fma_f32 v43, -v192, v27, v43
  v_mul_f32 v32, v32, v34
  v_mfma_f32_16x16x32_bf16 v[92:95], a[60:63], v[148:151], v[92:95]
  ds_read2st64_b64 v[132:135], v13 offset0:12 offset1:13
  v_mul_f32 v36, v36, v38
  v_mul_f32 v40, v40, v42
  v_mfma_f32_16x16x32_bf16 v[96:99], a[64:67], v[148:151], v[96:99]
  v_mul_f32 v33, v33, v35
  v_mul_f32 v37, v37, v39
  v_mul_f32 v41, v41, v43
  v_mfma_f32_16x16x32_bf16 v[100:103], a[68:71], v[148:151], v[100:103]
  v_fma_f32 v232, v232, v193, v193
  v_fma_f32 v234, v234, v193, v193
  v_fma_f32 v236, v236, v193, v193
  v_mfma_f32_16x16x32_bf16 v[104:107], a[60:63], v[152:155], v[104:107]
  ds_read2st64_b64 v[136:139], v14 offset0:12 offset1:13
  s_add_u32 s11, s22, 12288
  buffer_load_dwordx4 a[48:51], v2, s[68:71], s11 offen offset:0 sc1
  v_mfma_f32_16x16x32_bf16 v[108:111], a[64:67], v[152:155], v[108:111]
  buffer_load_dwordx4 a[52:55], v2, s[68:71], s11 offen offset:1024 sc1
  v_mfma_f32_16x16x32_bf16 v[112:115], a[68:71], v[152:155], v[112:115]
  buffer_load_dwordx4 a[56:59], v2, s[68:71], s11 offen offset:2048 sc1
  buffer_load_dwordx4 v2, s[44:47], s10 offen offset:1024 sc1 lds
  v_mfma_f32_16x16x32_bf16 v[116:119], a[60:63], v[156:159], v[116:119]
  ds_read2st64_b64 v[140:143], v15 offset0:12 offset1:13
  v_fma_f32 v233, v233, v193, v193
  v_fma_f32 v235, v235, v193, v193
  v_mfma_f32_16x16x32_bf16 v[120:123], a[64:67], v[156:159], v[120:123]
  v_fma_f32 v237, v237, v193, v193
  v_rcp_f32 v232, v232
  v_mfma_f32_16x16x32_bf16 v[124:127], a[68:71], v[156:159], v[124:127]
  v_rcp_f32 v234, v234
  v_rcp_f32 v236, v236
  s_barrier
  s_waitcnt lgkmcnt(0)
  v_mfma_f32_16x16x32_bf16 v[80:83], a[72:75], v[128:131], v[80:83]
  ds_read2st64_b64 v[144:147], v12 offset0:14 offset1:15
  v_rcp_f32 v233, v233
  v_mfma_f32_16x16x32_bf16 v[84:87], a[76:79], v[128:131], v[84:87]
  v_rcp_f32 v235, v235
  v_rcp_f32 v237, v237
  v_mfma_f32_16x16x32_bf16 v[88:91], a[80:83], v[128:131], v[88:91]
  v_mul_f32 v32, v32, v232
  v_mul_f32 v36, v36, v234
  v_mul_f32 v40, v40, v236
  v_mfma_f32_16x16x32_bf16 v[92:95], a[72:75], v[132:135], v[92:95]
  ds_read2st64_b64 v[148:151], v13 offset0:14 offset1:15
  v_mul_f32 v33, v33, v233
  v_mul_f32 v37, v37, v235
  v_mfma_f32_16x16x32_bf16 v[96:99], a[76:79], v[132:135], v[96:99]
  v_mul_f32 v41, v41, v237
  v_cvt_pk_bf16_f32 v224, v32, v33
  v_cvt_pk_bf16_f32 v225, v36, v37
  v_mfma_f32_16x16x32_bf16 v[100:103], a[80:83], v[132:135], v[100:103]
  v_cvt_pk_bf16_f32 v226, v40, v41
  v_add_u32 v6, v8, v181
  ds_write_b96 v6, v[224:226] offset:2048
  v_mfma_f32_16x16x32_bf16 v[104:107], a[72:75], v[136:139], v[104:107]
  ds_read2st64_b64 v[152:155], v14 offset0:14 offset1:15
  buffer_load_dwordx4 a[60:63], v2, s[68:71], s11 offen offset:3072 sc1
  v_mfma_f32_16x16x32_bf16 v[108:111], a[76:79], v[136:139], v[108:111]
  s_add_u32 s11, s22, 16384
  buffer_load_dwordx4 a[64:67], v2, s[68:71], s11 offen offset:0 sc1
  v_mfma_f32_16x16x32_bf16 v[112:115], a[80:83], v[136:139], v[112:115]
  buffer_load_dwordx4 a[68:71], v2, s[68:71], s11 offen offset:1024 sc1
  buffer_load_dwordx4 v2, s[44:47], s10 offen offset:2048 sc1 lds
  v_mfma_f32_16x16x32_bf16 v[116:119], a[72:75], v[140:143], v[116:119]
  ds_read2st64_b64 v[156:159], v15 offset0:14 offset1:15
  v_fma_f32 v44, -v196, v16, v44
  v_fma_f32 v48, -v196, v20, v48
  v_mfma_f32_16x16x32_bf16 v[120:123], a[76:79], v[140:143], v[120:123]
  v_fma_f32 v52, -v196, v24, v52
  v_fma_f32 v45, -v196, v17, v45
  v_fma_f32 v49, -v196, v21, v49
  v_mfma_f32_16x16x32_bf16 v[124:127], a[80:83], v[140:143], v[124:127]
  v_fma_f32 v53, -v196, v25, v53
  v_mul_f32 v232, v44, v198
  v_mul_f32 v234, v48, v198
  s_waitcnt vmcnt(24)
  s_barrier
  s_waitcnt lgkmcnt(0)
  v_mfma_f32_16x16x32_bf16 v[80:83], a[84:87], v[144:147], v[80:83]
  ds_read2st64_b64 v[128:131], v12 offset0:16 offset1:17
  v_mul_f32 v236, v52, v198
  v_mul_f32 v233, v45, v198
  v_mfma_f32_16x16x32_bf16 v[84:87], a[88:91], v[144:147], v[84:87]
  v_mul_f32 v235, v49, v198
  v_mul_f32 v237, v53, v198
  v_exp_f32 v232, v232
  v_mfma_f32_16x16x32_bf16 v[88:91], a[92:95], v[144:147], v[88:91]
  v_exp_f32 v234, v234
  v_exp_f32 v236, v236
  v_mfma_f32_16x16x32_bf16 v[92:95], a[84:87], v[148:151], v[92:95]
  ds_read2st64_b64 v[132:135], v13 offset0:16 offset1:17
  v_fma_f32 v46, -v196, v18, v46
  v_fma_f32 v50, -v196, v22, v50
  v_mfma_f32_16x16x32_bf16 v[96:99], a[88:91], v[148:151], v[96:99]
  v_fma_f32 v54, -v196, v26, v54
  v_exp_f32 v233, v233
  v_mfma_f32_16x16x32_bf16 v[100:103], a[92:95], v[148:151], v[100:103]
  v_exp_f32 v235, v235
  v_exp_f32 v237, v237
  v_mfma_f32_16x16x32_bf16 v[104:107], a[84:87], v[152:155], v[104:107]
  ds_read2st64_b64 v[136:139], v14 offset0:16 offset1:17
  buffer_load_dwordx4 a[72:75], v2, s[68:71], s11 offen offset:2048 sc1
  v_mfma_f32_16x16x32_bf16 v[108:111], a[88:91], v[152:155], v[108:111]
  buffer_load_dwordx4 a[76:79], v2, s[68:71], s11 offen offset:3072 sc1
  v_mfma_f32_16x16x32_bf16 v[112:115], a[92:95], v[152:155], v[112:115]
  s_add_u32 s11, s22, 20480
  buffer_load_dwordx4 a[80:83], v2, s[68:71], s11 offen offset:0 sc1
  buffer_load_dwordx4 v2, s[44:47], s10 offen offset:3072 sc1 lds
  v_mfma_f32_16x16x32_bf16 v[116:119], a[84:87], v[156:159], v[116:119]
  ds_read2st64_b64 v[140:143], v15 offset0:16 offset1:17
  v_fma_f32 v47, -v196, v19, v47
  v_fma_f32 v51, -v196, v23, v51
  v_mfma_f32_16x16x32_bf16 v[120:123], a[88:91], v[156:159], v[120:123]
  v_fma_f32 v55, -v196, v27, v55
  v_mul_f32 v44, v44, v46
  v_mul_f32 v48, v48, v50
  v_mfma_f32_16x16x32_bf16 v[124:127], a[92:95], v[156:159], v[124:127]
  v_mul_f32 v52, v52, v54
  v_mul_f32 v45, v45, v47
  v_mul_f32 v49, v49, v51
  s_waitcnt vmcnt(24)
  s_barrier
  s_waitcnt lgkmcnt(0)
  v_mfma_f32_16x16x32_bf16 v[80:83], a[96:99], v[128:131], v[80:83]
  ds_read2st64_b64 v[144:147], v12 offset0:18 offset1:19
  v_mul_f32 v53, v53, v55
  v_fma_f32 v232, v232, v197, v197
  v_mfma_f32_16x16x32_bf16 v[84:87], a[100:103], v[128:131], v[84:87]
  v_fma_f32 v234, v234, v197, v197
  v_fma_f32 v236, v236, v197, v197
  v_fma_f32 v233, v233, v197, v197
  v_mfma_f32_16x16x32_bf16 v[88:91], a[104:107], v[128:131], v[88:91]
  v_fma_f32 v235, v235, v197, v197
  v_fma_f32 v237, v237, v197, v197
  v_rcp_f32 v232, v232
  v_mfma_f32_16x16x32_bf16 v[92:95], a[96:99], v[132:135], v[92:95]
  ds_read2st64_b64 v[148:151], v13 offset0:18 offset1:19
  v_rcp_f32 v234, v234
  v_mfma_f32_16x16x32_bf16 v[96:99], a[100:103], v[132:135], v[96:99]
  v_rcp_f32 v236, v236
  v_rcp_f32 v233, v233
  v_mfma_f32_16x16x32_bf16 v[100:103], a[104:107], v[132:135], v[100:103]
  v_rcp_f32 v235, v235
  v_rcp_f32 v237, v237
  v_mfma_f32_16x16x32_bf16 v[104:107], a[96:99], v[136:139], v[104:107]
  ds_read2st64_b64 v[152:155], v14 offset0:18 offset1:19
  buffer_load_dwordx4 a[84:87], v2, s[68:71], s11 offen offset:1024 sc1
  v_mfma_f32_16x16x32_bf16 v[108:111], a[100:103], v[136:139], v[108:111]
  buffer_load_dwordx4 a[88:91], v2, s[68:71], s11 offen offset:2048 sc1
  v_mfma_f32_16x16x32_bf16 v[112:115], a[104:107], v[136:139], v[112:115]
  buffer_load_dwordx4 a[92:95], v2, s[68:71], s11 offen offset:3072 sc1
  s_add_u32 m0, s6, 98304
  s_add_u32 s10, s7, 98304
  buffer_load_dwordx4 v2, s[44:47], s10 offen offset:0 sc1 lds
  v_mfma_f32_16x16x32_bf16 v[116:119], a[96:99], v[140:143], v[116:119]
  ds_read2st64_b64 v[156:159], v15 offset0:18 offset1:19
  v_mul_f32 v44, v44, v232
  v_mul_f32 v48, v48, v234
  v_mfma_f32_16x16x32_bf16 v[120:123], a[100:103], v[140:143], v[120:123]
  v_mul_f32 v52, v52, v236
  v_mul_f32 v45, v45, v233
  v_mul_f32 v49, v49, v235
  v_mfma_f32_16x16x32_bf16 v[124:127], a[104:107], v[140:143], v[124:127]
  v_mul_f32 v53, v53, v237
  v_cvt_pk_bf16_f32 v228, v44, v45
  v_cvt_pk_bf16_f32 v229, v48, v49
  s_waitcnt vmcnt(24)
  s_barrier
  s_waitcnt lgkmcnt(0)
  v_mfma_f32_16x16x32_bf16 v[80:83], a[108:111], v[144:147], v[80:83]
  ds_read2st64_b64 v[128:131], v12 offset0:20 offset1:21
  v_cvt_pk_bf16_f32 v230, v52, v53
  v_add_u32 v6, v9, v181
  v_mfma_f32_16x16x32_bf16 v[84:87], a[112:115], v[144:147], v[84:87]
  ds_write_b96 v6, v[228:230] offset:2048
  v_fma_f32 v56, -v200, v16, v56
  v_fma_f32 v60, -v200, v20, v60
  v_mfma_f32_16x16x32_bf16 v[88:91], a[116:119], v[144:147], v[88:91]
  v_fma_f32 v64, -v200, v24, v64
  v_fma_f32 v57, -v200, v17, v57
  v_fma_f32 v61, -v200, v21, v61
  v_mfma_f32_16x16x32_bf16 v[92:95], a[108:111], v[148:151], v[92:95]
  ds_read2st64_b64 v[132:135], v13 offset0:20 offset1:21
  v_fma_f32 v65, -v200, v25, v65
  v_mul_f32 v232, v56, v202
  v_mfma_f32_16x16x32_bf16 v[96:99], a[112:115], v[148:151], v[96:99]
  v_mul_f32 v234, v60, v202
  v_mul_f32 v236, v64, v202
  v_mul_f32 v233, v57, v202
  v_mfma_f32_16x16x32_bf16 v[100:103], a[116:119], v[148:151], v[100:103]
  v_mul_f32 v235, v61, v202
  v_mul_f32 v237, v65, v202
  v_exp_f32 v232, v232
  v_mfma_f32_16x16x32_bf16 v[104:107], a[108:111], v[152:155], v[104:107]
  ds_read2st64_b64 v[136:139], v14 offset0:20 offset1:21
  s_add_u32 s11, s22, 24576
  buffer_load_dwordx4 a[96:99], v2, s[68:71], s11 offen offset:0 sc1
  v_mfma_f32_16x16x32_bf16 v[108:111], a[112:115], v[152:155], v[108:111]
  buffer_load_dwordx4 a[100:103], v2, s[68:71], s11 offen offset:1024 sc1
  v_mfma_f32_16x16x32_bf16 v[112:115], a[116:119], v[152:155], v[112:115]
  buffer_load_dwordx4 a[104:107], v2, s[68:71], s11 offen offset:2048 sc1
  buffer_load_dwordx4 v2, s[44:47], s10 offen offset:1024 sc1 lds
  v_mfma_f32_16x16x32_bf16 v[116:119], a[108:111], v[156:159], v[116:119]
  ds_read2st64_b64 v[140:143], v15 offset0:20 offset1:21
  v_exp_f32 v234, v234
  v_mfma_f32_16x16x32_bf16 v[120:123], a[112:115], v[156:159], v[120:123]
  v_exp_f32 v236, v236
  v_fma_f32 v58, -v200, v18, v58
  v_mfma_f32_16x16x32_bf16 v[124:127], a[116:119], v[156:159], v[124:127]
  v_fma_f32 v62, -v200, v22, v62
  v_fma_f32 v66, -v200, v26, v66
  v_exp_f32 v233, v233
  s_waitcnt vmcnt(24)
  s_barrier
  s_waitcnt lgkmcnt(0)
  v_mfma_f32_16x16x32_bf16 v[80:83], a[120:123], v[128:131], v[80:83]
  ds_read2st64_b64 v[144:147], v12 offset0:22 offset1:23
  v_exp_f32 v235, v235
  v_mfma_f32_16x16x32_bf16 v[84:87], a[124:127], v[128:131], v[84:87]
  v_exp_f32 v237, v237
  v_fma_f32 v59, -v200, v19, v59
  v_mfma_f32_16x16x32_bf16 v[88:91], a[128:131], v[128:131], v[88:91]
  v_fma_f32 v63, -v200, v23, v63
  v_fma_f32 v67, -v200, v27, v67
  v_mul_f32 v56, v56, v58
  v_mfma_f32_16x16x32_bf16 v[92:95], a[120:123], v[132:135], v[92:95]
  ds_read2st64_b64 v[148:151], v13 offset0:22 offset1:23
  v_mul_f32 v60, v60, v62
  v_mul_f32 v64, v64, v66
  v_mfma_f32_16x16x32_bf16 v[96:99], a[124:127], v[132:135], v[96:99]
  v_mul_f32 v57, v57, v59
  v_mul_f32 v61, v61, v63
  v_mul_f32 v65, v65, v67
  v_mfma_f32_16x16x32_bf16 v[100:103], a[128:131], v[132:135], v[100:103]
  v_fma_f32 v232, v232, v201, v201
  v_fma_f32 v234, v234, v201, v201
  v_fma_f32 v236, v236, v201, v201
  v_mfma_f32_16x16x32_bf16 v[104:107], a[120:123], v[136:139], v[104:107]
  ds_read2st64_b64 v[152:155], v14 offset0:22 offset1:23
  buffer_load_dwordx4 a[108:111], v2, s[68:71], s11 offen offset:3072 sc1
  v_mfma_f32_16x16x32_bf16 v[108:111], a[124:127], v[136:139], v[108:111]
  s_add_u32 s11, s22, 28672
  buffer_load_dwordx4 a[112:115], v2, s[68:71], s11 offen offset:0 sc1
  v_mfma_f32_16x16x32_bf16 v[112:115], a[128:131], v[136:139], v[112:115]
  buffer_load_dwordx4 a[116:119], v2, s[68:71], s11 offen offset:1024 sc1
  buffer_load_dwordx4 v2, s[44:47], s10 offen offset:2048 sc1 lds
  v_mfma_f32_16x16x32_bf16 v[116:119], a[120:123], v[140:143], v[116:119]
  ds_read2st64_b64 v[156:159], v15 offset0:22 offset1:23
  v_fma_f32 v233, v233, v201, v201
  v_fma_f32 v235, v235, v201, v201
  v_mfma_f32_16x16x32_bf16 v[120:123], a[124:127], v[140:143], v[120:123]
  v_fma_f32 v237, v237, v201, v201
  v_rcp_f32 v232, v232
  v_mfma_f32_16x16x32_bf16 v[124:127], a[128:131], v[140:143], v[124:127]
  v_rcp_f32 v234, v234
  v_rcp_f32 v236, v236
  s_waitcnt vmcnt(24)
  v_rcp_f32 v233, v233
  v_rcp_f32 v235, v235
  v_rcp_f32 v237, v237
  v_mul_f32 v56, v56, v232
  v_mul_f32 v60, v60, v234
  v_mul_f32 v64, v64, v236
  v_mul_f32 v57, v57, v233
  v_mul_f32 v61, v61, v235
  v_mul_f32 v65, v65, v237
  v_cvt_pk_bf16_f32 v224, v56, v57
  v_cvt_pk_bf16_f32 v225, v60, v61
  v_cvt_pk_bf16_f32 v226, v64, v65
  v_add_u32 v6, v10, v181
  ds_write_b96 v6, v[224:226] offset:2048
  v_fma_f32 v68, -v204, v16, v68
  v_fma_f32 v72, -v204, v20, v72
  v_fma_f32 v76, -v204, v24, v76
  v_fma_f32 v69, -v204, v17, v69
  v_fma_f32 v73, -v204, v21, v73
  v_fma_f32 v77, -v204, v25, v77
  v_mul_f32 v232, v68, v206
  v_mul_f32 v234, v72, v206
  v_mul_f32 v236, v76, v206
  v_mul_f32 v233, v69, v206
  v_mul_f32 v235, v73, v206
  v_mul_f32 v237, v77, v206
  v_exp_f32 v232, v232
  v_exp_f32 v234, v234
  v_exp_f32 v236, v236
  v_fma_f32 v70, -v204, v18, v70
  v_fma_f32 v74, -v204, v22, v74
  v_fma_f32 v78, -v204, v26, v78
  v_exp_f32 v233, v233
  v_exp_f32 v235, v235
  v_exp_f32 v237, v237
  v_fma_f32 v71, -v204, v19, v71
  v_fma_f32 v75, -v204, v23, v75
  v_fma_f32 v79, -v204, v27, v79
  v_mul_f32 v68, v68, v70
  v_mul_f32 v72, v72, v74
  v_mul_f32 v76, v76, v78
  v_mul_f32 v69, v69, v71
  v_mul_f32 v73, v73, v75
  v_mul_f32 v77, v77, v79
  v_fma_f32 v232, v232, v205, v205
  v_fma_f32 v234, v234, v205, v205
  v_fma_f32 v236, v236, v205, v205
  v_fma_f32 v233, v233, v205, v205
  v_fma_f32 v235, v235, v205, v205
  v_fma_f32 v237, v237, v205, v205
  v_rcp_f32 v232, v232
  v_rcp_f32 v234, v234
  v_rcp_f32 v236, v236
  v_rcp_f32 v233, v233
  v_rcp_f32 v235, v235
  v_rcp_f32 v237, v237
  v_mul_f32 v68, v68, v232
  v_mul_f32 v72, v72, v234
  v_mul_f32 v76, v76, v236
  v_mul_f32 v69, v69, v233
  v_mul_f32 v73, v73, v235
  v_mul_f32 v77, v77, v237
  v_cvt_pk_bf16_f32 v228, v68, v69
  v_cvt_pk_bf16_f32 v229, v72, v73
  v_cvt_pk_bf16_f32 v230, v76, v77
  v_add_u32 v6, v11, v181
  ds_write_b96 v6, v[228:230] offset:2048
  s_waitcnt lgkmcnt(0)
  s_barrier
  ds_read_b128 v[160:163], v31 offset:0
  ds_read_b128 v[164:167], v31 offset:1024
  ds_read_b128 v[168:171], v31 offset:2048
  v_mfma_f32_16x16x32_bf16 v[80:83], a[132:135], v[144:147], v[80:83]
  ds_read2st64_b64 v[128:131], v12 offset0:24 offset1:25
  v_mfma_f32_16x16x32_bf16 v[84:87], a[136:139], v[144:147], v[84:87]
  v_mfma_f32_16x16x32_bf16 v[88:91], a[140:143], v[144:147], v[88:91]
  v_mfma_f32_16x16x32_bf16 v[92:95], a[132:135], v[148:151], v[92:95]
  ds_read2st64_b64 v[132:135], v13 offset0:24 offset1:25
  v_mfma_f32_16x16x32_bf16 v[96:99], a[136:139], v[148:151], v[96:99]
  v_mfma_f32_16x16x32_bf16 v[100:103], a[140:143], v[148:151], v[100:103]
  v_mfma_f32_16x16x32_bf16 v[104:107], a[132:135], v[152:155], v[104:107]
  ds_read2st64_b64 v[136:139], v14 offset0:24 offset1:25
  buffer_load_dwordx4 a[120:123], v2, s[68:71], s11 offen offset:2048 sc1
  v_mfma_f32_16x16x32_bf16 v[108:111], a[136:139], v[152:155], v[108:111]
  buffer_load_dwordx4 a[124:127], v2, s[68:71], s11 offen offset:3072 sc1
  v_mfma_f32_16x16x32_bf16 v[112:115], a[140:143], v[152:155], v[112:115]
  s_add_u32 s11, s22, 32768
  buffer_load_dwordx4 a[128:131], v2, s[68:71], s11 offen offset:0 sc1
  buffer_load_dwordx4 v2, s[44:47], s10 offen offset:3072 sc1 lds
  v_mfma_f32_16x16x32_bf16 v[116:119], a[132:135], v[156:159], v[116:119]
  ds_read2st64_b64 v[140:143], v15 offset0:24 offset1:25
  v_mfma_f32_16x16x32_bf16 v[120:123], a[136:139], v[156:159], v[120:123]
  v_mfma_f32_16x16x32_bf16 v[124:127], a[140:143], v[156:159], v[124:127]
  s_waitcnt vmcnt(24)
  s_barrier
  s_waitcnt lgkmcnt(4)
  buffer_store_dwordx4 v[160:163], v2, s[56:59], s60 offen offset:0 sc1
  buffer_store_dwordx4 v[164:167], v2, s[56:59], s60 offen offset:1024 sc1
  buffer_store_dwordx4 v[168:171], v2, s[56:59], s60 offen offset:2048 sc1
  s_waitcnt lgkmcnt(0)
  v_mfma_f32_16x16x32_bf16 v[80:83], a[144:147], v[128:131], v[80:83]
  ds_read2st64_b64 v[144:147], v12 offset0:26 offset1:27
  v_mfma_f32_16x16x32_bf16 v[84:87], a[148:151], v[128:131], v[84:87]
  v_mfma_f32_16x16x32_bf16 v[88:91], a[152:155], v[128:131], v[88:91]
  v_mfma_f32_16x16x32_bf16 v[92:95], a[144:147], v[132:135], v[92:95]
  ds_read2st64_b64 v[148:151], v13 offset0:26 offset1:27
  v_mfma_f32_16x16x32_bf16 v[96:99], a[148:151], v[132:135], v[96:99]
  v_mfma_f32_16x16x32_bf16 v[100:103], a[152:155], v[132:135], v[100:103]
  v_mfma_f32_16x16x32_bf16 v[104:107], a[144:147], v[136:139], v[104:107]
  ds_read2st64_b64 v[152:155], v14 offset0:26 offset1:27
  buffer_load_dwordx4 a[132:135], v2, s[68:71], s11 offen offset:1024 sc1
  v_mfma_f32_16x16x32_bf16 v[108:111], a[148:151], v[136:139], v[108:111]
  buffer_load_dwordx4 a[136:139], v2, s[68:71], s11 offen offset:2048 sc1
  v_mfma_f32_16x16x32_bf16 v[112:115], a[152:155], v[136:139], v[112:115]
  buffer_load_dwordx4 a[140:143], v2, s[68:71], s11 offen offset:3072 sc1
  v_mfma_f32_16x16x32_bf16 v[116:119], a[144:147], v[140:143], v[116:119]
  ds_read2st64_b64 v[156:159], v15 offset0:26 offset1:27
  v_mfma_f32_16x16x32_bf16 v[120:123], a[148:151], v[140:143], v[120:123]
  v_mfma_f32_16x16x32_bf16 v[124:127], a[152:155], v[140:143], v[124:127]
  s_waitcnt vmcnt(26)
  s_barrier
  s_waitcnt lgkmcnt(0)
  v_mfma_f32_16x16x32_bf16 v[80:83], a[156:159], v[144:147], v[80:83]
  ds_read2st64_b64 v[128:131], v12 offset0:28 offset1:29
  v_mfma_f32_16x16x32_bf16 v[84:87], a[160:163], v[144:147], v[84:87]
  v_mfma_f32_16x16x32_bf16 v[88:91], a[164:167], v[144:147], v[88:91]
  v_mfma_f32_16x16x32_bf16 v[92:95], a[156:159], v[148:151], v[92:95]
  ds_read2st64_b64 v[132:135], v13 offset0:28 offset1:29
  v_mfma_f32_16x16x32_bf16 v[96:99], a[160:163], v[148:151], v[96:99]
  v_mfma_f32_16x16x32_bf16 v[100:103], a[164:167], v[148:151], v[100:103]
  v_mfma_f32_16x16x32_bf16 v[104:107], a[156:159], v[152:155], v[104:107]
  ds_read2st64_b64 v[136:139], v14 offset0:28 offset1:29
  s_add_u32 s11, s22, 36864
  buffer_load_dwordx4 a[144:147], v2, s[68:71], s11 offen offset:0 sc1
  v_mfma_f32_16x16x32_bf16 v[108:111], a[160:163], v[152:155], v[108:111]
  buffer_load_dwordx4 a[148:151], v2, s[68:71], s11 offen offset:1024 sc1
  v_mfma_f32_16x16x32_bf16 v[112:115], a[164:167], v[152:155], v[112:115]
  buffer_load_dwordx4 a[152:155], v2, s[68:71], s11 offen offset:2048 sc1
  v_mfma_f32_16x16x32_bf16 v[116:119], a[156:159], v[156:159], v[116:119]
  ds_read2st64_b64 v[140:143], v15 offset0:28 offset1:29
  v_mfma_f32_16x16x32_bf16 v[120:123], a[160:163], v[156:159], v[120:123]
  v_mfma_f32_16x16x32_bf16 v[124:127], a[164:167], v[156:159], v[124:127]
  buffer_load_dwordx2 v[176:177], v186, s[72:75], s24 offen offset:512 sc1
  s_waitcnt vmcnt(26)
  s_barrier
  s_waitcnt lgkmcnt(0)
  v_mfma_f32_16x16x32_bf16 v[80:83], a[168:171], v[128:131], v[80:83]
  ds_read2st64_b64 v[144:147], v12 offset0:30 offset1:31
  v_mfma_f32_16x16x32_bf16 v[84:87], a[172:175], v[128:131], v[84:87]
  v_mfma_f32_16x16x32_bf16 v[88:91], a[176:179], v[128:131], v[88:91]
  v_mfma_f32_16x16x32_bf16 v[92:95], a[168:171], v[132:135], v[92:95]
  ds_read2st64_b64 v[148:151], v13 offset0:30 offset1:31
  v_mfma_f32_16x16x32_bf16 v[96:99], a[172:175], v[132:135], v[96:99]
  v_mfma_f32_16x16x32_bf16 v[100:103], a[176:179], v[132:135], v[100:103]
  v_mfma_f32_16x16x32_bf16 v[104:107], a[168:171], v[136:139], v[104:107]
  ds_read2st64_b64 v[152:155], v14 offset0:30 offset1:31
  buffer_load_dwordx4 a[156:159], v2, s[68:71], s11 offen offset:3072 sc1
  v_mfma_f32_16x16x32_bf16 v[108:111], a[172:175], v[136:139], v[108:111]
  s_add_u32 s11, s22, 40960
  buffer_load_dwordx4 a[160:163], v2, s[68:71], s11 offen offset:0 sc1
  v_mfma_f32_16x16x32_bf16 v[112:115], a[176:179], v[136:139], v[112:115]
  buffer_load_dwordx4 a[164:167], v2, s[68:71], s11 offen offset:1024 sc1
  v_mfma_f32_16x16x32_bf16 v[116:119], a[168:171], v[140:143], v[116:119]
  ds_read2st64_b64 v[156:159], v15 offset0:30 offset1:31
  v_mfma_f32_16x16x32_bf16 v[120:123], a[172:175], v[140:143], v[120:123]
  v_mfma_f32_16x16x32_bf16 v[124:127], a[176:179], v[140:143], v[124:127]
  s_waitcnt vmcnt(25)
  s_barrier
  s_waitcnt lgkmcnt(0)
  v_mfma_f32_16x16x32_bf16 v[80:83], a[180:183], v[144:147], v[80:83]
  ds_read2st64_b64 v[128:131], v12 offset0:32 offset1:33
  v_mfma_f32_16x16x32_bf16 v[84:87], a[184:187], v[144:147], v[84:87]
  v_mfma_f32_16x16x32_bf16 v[88:91], a[188:191], v[144:147], v[88:91]
  v_mfma_f32_16x16x32_bf16 v[92:95], a[180:183], v[148:151], v[92:95]
  ds_read2st64_b64 v[132:135], v13 offset0:32 offset1:33
  v_mfma_f32_16x16x32_bf16 v[96:99], a[184:187], v[148:151], v[96:99]
  v_mfma_f32_16x16x32_bf16 v[100:103], a[188:191], v[148:151], v[100:103]
  v_mfma_f32_16x16x32_bf16 v[104:107], a[180:183], v[152:155], v[104:107]
  ds_read2st64_b64 v[136:139], v14 offset0:32 offset1:33
  buffer_load_dwordx4 a[168:171], v2, s[68:71], s11 offen offset:2048 sc1
  v_mfma_f32_16x16x32_bf16 v[108:111], a[184:187], v[152:155], v[108:111]
  buffer_load_dwordx4 a[172:175], v2, s[68:71], s11 offen offset:3072 sc1
  v_mfma_f32_16x16x32_bf16 v[112:115], a[188:191], v[152:155], v[112:115]
  s_add_u32 s11, s22, 45056
  buffer_load_dwordx4 a[176:179], v2, s[68:71], s11 offen offset:0 sc1
  v_mfma_f32_16x16x32_bf16 v[116:119], a[180:183], v[156:159], v[116:119]
  ds_read2st64_b64 v[140:143], v15 offset0:32 offset1:33
  v_mfma_f32_16x16x32_bf16 v[120:123], a[184:187], v[156:159], v[120:123]
  v_mfma_f32_16x16x32_bf16 v[124:127], a[188:191], v[156:159], v[124:127]
  s_waitcnt vmcnt(24)
  s_waitcnt vmcnt(13)
  s_barrier
  s_waitcnt lgkmcnt(0)
  v_mfma_f32_16x16x32_bf16 v[80:83], a[192:195], v[128:131], v[80:83]
  ds_read2st64_b64 v[144:147], v12 offset0:34 offset1:35
  v_mfma_f32_16x16x32_bf16 v[84:87], a[196:199], v[128:131], v[84:87]
  v_mfma_f32_16x16x32_bf16 v[88:91], a[200:203], v[128:131], v[88:91]
  v_mfma_f32_16x16x32_bf16 v[92:95], a[192:195], v[132:135], v[92:95]
  ds_read2st64_b64 v[148:151], v13 offset0:34 offset1:35
  v_mfma_f32_16x16x32_bf16 v[96:99], a[196:199], v[132:135], v[96:99]
  v_mfma_f32_16x16x32_bf16 v[100:103], a[200:203], v[132:135], v[100:103]
  v_mfma_f32_16x16x32_bf16 v[104:107], a[192:195], v[136:139], v[104:107]
  ds_read2st64_b64 v[152:155], v14 offset0:34 offset1:35
  buffer_load_dwordx4 a[180:183], v2, s[68:71], s11 offen offset:1024 sc1
  v_mfma_f32_16x16x32_bf16 v[108:111], a[196:199], v[136:139], v[108:111]
  buffer_load_dwordx4 a[184:187], v2, s[68:71], s11 offen offset:2048 sc1
  v_mfma_f32_16x16x32_bf16 v[112:115], a[200:203], v[136:139], v[112:115]
  buffer_load_dwordx4 a[188:191], v2, s[68:71], s11 offen offset:3072 sc1
  v_mfma_f32_16x16x32_bf16 v[116:119], a[192:195], v[140:143], v[116:119]
  ds_read2st64_b64 v[156:159], v15 offset0:34 offset1:35
  v_mfma_f32_16x16x32_bf16 v[120:123], a[196:199], v[140:143], v[120:123]
  v_mfma_f32_16x16x32_bf16 v[124:127], a[200:203], v[140:143], v[124:127]
  s_barrier
  s_waitcnt lgkmcnt(0)
  v_mfma_f32_16x16x32_bf16 v[80:83], a[204:207], v[144:147], v[80:83]
  ds_read2st64_b64 v[128:131], v12 offset0:36 offset1:37
  v_mfma_f32_16x16x32_bf16 v[84:87], a[208:211], v[144:147], v[84:87]
  v_mfma_f32_16x16x32_bf16 v[88:91], a[212:215], v[144:147], v[88:91]
  v_mfma_f32_16x16x32_bf16 v[92:95], a[204:207], v[148:151], v[92:95]
  ds_read2st64_b64 v[132:135], v13 offset0:36 offset1:37
  v_mfma_f32_16x16x32_bf16 v[96:99], a[208:211], v[148:151], v[96:99]
  v_mfma_f32_16x16x32_bf16 v[100:103], a[212:215], v[148:151], v[100:103]
  v_mfma_f32_16x16x32_bf16 v[104:107], a[204:207], v[152:155], v[104:107]
  ds_read2st64_b64 v[136:139], v14 offset0:36 offset1:37
  s_add_u32 s11, s22, 49152
  buffer_load_dwordx4 a[192:195], v2, s[68:71], s11 offen offset:0 sc1
  v_mfma_f32_16x16x32_bf16 v[108:111], a[208:211], v[152:155], v[108:111]
  buffer_load_dwordx4 a[196:199], v2, s[68:71], s11 offen offset:1024 sc1
  v_mfma_f32_16x16x32_bf16 v[112:115], a[212:215], v[152:155], v[112:115]
  buffer_load_dwordx4 a[200:203], v2, s[68:71], s11 offen offset:2048 sc1
  v_mfma_f32_16x16x32_bf16 v[116:119], a[204:207], v[156:159], v[116:119]
  ds_read2st64_b64 v[140:143], v15 offset0:36 offset1:37
  v_mfma_f32_16x16x32_bf16 v[120:123], a[208:211], v[156:159], v[120:123]
  v_mfma_f32_16x16x32_bf16 v[124:127], a[212:215], v[156:159], v[124:127]
  s_mov_b32 s35, 0
  s_nop 6
K3_STCHK12:
  s_waitcnt vmcnt(12)
  v_cmp_eq_u32 vcc, 0, v177
  s_nop 4
  s_cbranch_vccz K3_STOK12
  s_add_u32 s35, s35, 1
  s_cmp_ge_u32 s35, 0x4000
  s_cbranch_scc1 K3_STOK12
  s_sleep 2
  buffer_load_dwordx2 v[176:177], v186, s[72:75], s24 offen offset:512 sc1
  s_waitcnt vmcnt(0)
  s_branch K3_STCHK12
K3_STOK12:
  s_barrier
  s_waitcnt lgkmcnt(0)
  v_mfma_f32_16x16x32_bf16 v[80:83], a[216:219], v[128:131], v[80:83]
  ds_read2st64_b64 v[144:147], v12 offset0:38 offset1:39
  ds_write_b64 v183, v[176:177] offset:4608
  ds_read_b64 v[208:209], v184 offset:4864
  v_mfma_f32_16x16x32_bf16 v[84:87], a[220:223], v[128:131], v[84:87]
  ds_read_b64 v[212:213], v184 offset:4992
  ds_read_b64 v[216:217], v184 offset:4608
  ds_read_b64 v[220:221], v184 offset:4736
  v_mfma_f32_16x16x32_bf16 v[88:91], a[224:227], v[128:131], v[88:91]
  s_waitcnt lgkmcnt(0)
  v_rcp_f32 v210, v209
  v_rcp_f32 v214, v213
  v_mfma_f32_16x16x32_bf16 v[92:95], a[216:219], v[132:135], v[92:95]
  ds_read2st64_b64 v[148:151], v13 offset0:38 offset1:39
  v_rcp_f32 v218, v217
  v_rcp_f32 v222, v221
  v_mfma_f32_16x16x32_bf16 v[96:99], a[220:223], v[132:135], v[96:99]
  v_mul_f32 v209, v209, v209
  v_mul_f32 v213, v213, v213
  v_mul_f32 v217, v217, v217
  v_mfma_f32_16x16x32_bf16 v[100:103], a[224:227], v[132:135], v[100:103]
  v_mul_f32 v221, v221, v221
  v_mul_f32 v210, v210, v4
  v_mul_f32 v214, v214, v4
  v_mfma_f32_16x16x32_bf16 v[104:107], a[216:219], v[136:139], v[104:107]
  ds_read2st64_b64 v[152:155], v14 offset0:38 offset1:39
  buffer_load_dwordx4 a[204:207], v2, s[68:71], s11 offen offset:3072 sc1
  v_mfma_f32_16x16x32_bf16 v[108:111], a[220:223], v[136:139], v[108:111]
  s_add_u32 s11, s22, 53248
  buffer_load_dwordx4 a[208:211], v2, s[68:71], s11 offen offset:0 sc1
  v_mfma_f32_16x16x32_bf16 v[112:115], a[224:227], v[136:139], v[112:115]
  buffer_load_dwordx4 a[212:215], v2, s[68:71], s11 offen offset:1024 sc1
  v_mfma_f32_16x16x32_bf16 v[116:119], a[216:219], v[140:143], v[116:119]
  ds_read2st64_b64 v[156:159], v15 offset0:38 offset1:39
  v_mul_f32 v218, v218, v4
  v_mul_f32 v222, v222, v4
  v_mfma_f32_16x16x32_bf16 v[120:123], a[220:223], v[140:143], v[120:123]
  v_mfma_f32_16x16x32_bf16 v[124:127], a[224:227], v[140:143], v[124:127]
  buffer_load_dword v30, v29, s[72:75], s63 offen sc1
  s_waitcnt lgkmcnt(0)
  v_mfma_f32_16x16x32_bf16 v[80:83], a[228:231], v[144:147], v[80:83]
  v_mfma_f32_16x16x32_bf16 v[84:87], a[232:235], v[144:147], v[84:87]
  v_mfma_f32_16x16x32_bf16 v[88:91], a[236:239], v[144:147], v[88:91]
  v_mfma_f32_16x16x32_bf16 v[92:95], a[228:231], v[148:151], v[92:95]
  v_mfma_f32_16x16x32_bf16 v[96:99], a[232:235], v[148:151], v[96:99]
  v_mfma_f32_16x16x32_bf16 v[100:103], a[236:239], v[148:151], v[100:103]
  v_mfma_f32_16x16x32_bf16 v[104:107], a[228:231], v[152:155], v[104:107]
  buffer_load_dwordx4 a[216:219], v2, s[68:71], s11 offen offset:2048 sc1
  v_mfma_f32_16x16x32_bf16 v[108:111], a[232:235], v[152:155], v[108:111]
  buffer_load_dwordx4 a[220:223], v2, s[68:71], s11 offen offset:3072 sc1
  v_mfma_f32_16x16x32_bf16 v[112:115], a[236:239], v[152:155], v[112:115]
  s_add_u32 s11, s22, 57344
  buffer_load_dwordx4 a[224:227], v2, s[68:71], s11 offen offset:0 sc1
  v_mfma_f32_16x16x32_bf16 v[116:119], a[228:231], v[156:159], v[116:119]
  v_mfma_f32_16x16x32_bf16 v[120:123], a[232:235], v[156:159], v[120:123]
  v_mfma_f32_16x16x32_bf16 v[124:127], a[236:239], v[156:159], v[124:127]
  v_pk_fma_f32 v[80:81], v[16:17], v[208:209], v[80:81] op_sel_hi:[1,0,1] neg_lo:[0,1,0] neg_hi:[0,1,0]
  v_pk_fma_f32 v[84:85], v[20:21], v[208:209], v[84:85] op_sel_hi:[1,0,1] neg_lo:[0,1,0] neg_hi:[0,1,0]
  v_pk_fma_f32 v[88:89], v[24:25], v[208:209], v[88:89] op_sel_hi:[1,0,1] neg_lo:[0,1,0] neg_hi:[0,1,0]
  v_pk_fma_f32 v[82:83], v[18:19], v[208:209], v[82:83] op_sel_hi:[1,0,1] neg_lo:[0,1,0] neg_hi:[0,1,0]
  v_pk_fma_f32 v[86:87], v[22:23], v[208:209], v[86:87] op_sel_hi:[1,0,1] neg_lo:[0,1,0] neg_hi:[0,1,0]
  v_pk_fma_f32 v[90:91], v[26:27], v[208:209], v[90:91] op_sel_hi:[1,0,1] neg_lo:[0,1,0] neg_hi:[0,1,0]
  v_pk_mul_f32 v[232:233], v[80:81], v[210:211] op_sel_hi:[1,0]
  v_pk_mul_f32 v[234:235], v[84:85], v[210:211] op_sel_hi:[1,0]
  v_pk_mul_f32 v[236:237], v[88:89], v[210:211] op_sel_hi:[1,0]
  v_exp_f32 v232, v232
  v_exp_f32 v234, v234
  v_exp_f32 v236, v236
  v_exp_f32 v233, v233
  v_exp_f32 v235, v235
  v_exp_f32 v237, v237
  v_pk_mul_f32 v[80:81], v[80:81], v[82:83]
  v_pk_mul_f32 v[84:85], v[84:85], v[86:87]
  v_pk_mul_f32 v[88:89], v[88:89], v[90:91]
  v_pk_fma_f32 v[232:233], v[232:233], v[208:209], v[208:209] op_sel:[0,1,1] op_sel_hi:[1,1,1]
  v_pk_fma_f32 v[234:235], v[234:235], v[208:209], v[208:209] op_sel:[0,1,1] op_sel_hi:[1,1,1]
  v_pk_fma_f32 v[236:237], v[236:237], v[208:209], v[208:209] op_sel:[0,1,1] op_sel_hi:[1,1,1]
  v_rcp_f32 v232, v232
  v_rcp_f32 v234, v234
  v_rcp_f32 v236, v236
  v_rcp_f32 v233, v233
  v_rcp_f32 v235, v235
  v_rcp_f32 v237, v237
  v_pk_mul_f32 v[80:81], v[80:81], v[232:233]
  v_pk_mul_f32 v[84:85], v[84:85], v[234:235]
  v_pk_mul_f32 v[88:89], v[88:89], v[236:237]
  v_cvt_pk_bf16_f32 v224, v80, v81
  v_cvt_pk_bf16_f32 v225, v84, v85
  v_cvt_pk_bf16_f32 v226, v88, v89
  v_add_u32 v6, v12, v181
  ds_write_b96 v6, v[224:226] offset:2048
  v_pk_fma_f32 v[92:93], v[16:17], v[212:213], v[92:93] op_sel_hi:[1,0,1] neg_lo:[0,1,0] neg_hi:[0,1,0]
  v_pk_fma_f32 v[96:97], v[20:21], v[212:213], v[96:97] op_sel_hi:[1,0,1] neg_lo:[0,1,0] neg_hi:[0,1,0]
  v_pk_fma_f32 v[100:101], v[24:25], v[212:213], v[100:101] op_sel_hi:[1,0,1] neg_lo:[0,1,0] neg_hi:[0,1,0]
  buffer_load_dwordx4 a[228:231], v2, s[68:71], s11 offen offset:1024 sc1
  v_pk_fma_f32 v[94:95], v[18:19], v[212:213], v[94:95] op_sel_hi:[1,0,1] neg_lo:[0,1,0] neg_hi:[0,1,0]
  v_pk_fma_f32 v[98:99], v[22:23], v[212:213], v[98:99] op_sel_hi:[1,0,1] neg_lo:[0,1,0] neg_hi:[0,1,0]
  v_pk_fma_f32 v[102:103], v[26:27], v[212:213], v[102:103] op_sel_hi:[1,0,1] neg_lo:[0,1,0] neg_hi:[0,1,0]
  v_pk_mul_f32 v[232:233], v[92:93], v[214:215] op_sel_hi:[1,0]
  v_pk_mul_f32 v[234:235], v[96:97], v[214:215] op_sel_hi:[1,0]
  v_pk_mul_f32 v[236:237], v[100:101], v[214:215] op_sel_hi:[1,0]
  v_exp_f32 v232, v232
  v_exp_f32 v234, v234
  v_exp_f32 v236, v236
  v_exp_f32 v233, v233
  v_exp_f32 v235, v235
  v_exp_f32 v237, v237
  v_pk_mul_f32 v[92:93], v[92:93], v[94:95]
  v_pk_mul_f32 v[96:97], v[96:97], v[98:99]
  v_pk_mul_f32 v[100:101], v[100:101], v[102:103]
  v_pk_fma_f32 v[232:233], v[232:233], v[212:213], v[212:213] op_sel:[0,1,1] op_sel_hi:[1,1,1]
  v_pk_fma_f32 v[234:235], v[234:235], v[212:213], v[212:213] op_sel:[0,1,1] op_sel_hi:[1,1,1]
  v_pk_fma_f32 v[236:237], v[236:237], v[212:213], v[212:213] op_sel:[0,1,1] op_sel_hi:[1,1,1]
  v_rcp_f32 v232, v232
  v_rcp_f32 v234, v234
  v_rcp_f32 v236, v236
  v_rcp_f32 v233, v233
  v_rcp_f32 v235, v235
  v_rcp_f32 v237, v237
  v_pk_mul_f32 v[92:93], v[92:93], v[232:233]
  v_pk_mul_f32 v[96:97], v[96:97], v[234:235]
  v_pk_mul_f32 v[100:101], v[100:101], v[236:237]
  v_cvt_pk_bf16_f32 v228, v92, v93
  v_cvt_pk_bf16_f32 v229, v96, v97
  v_cvt_pk_bf16_f32 v230, v100, v101
  v_add_u32 v6, v13, v181
  ds_write_b96 v6, v[228:230] offset:2048
  v_pk_fma_f32 v[104:105], v[16:17], v[216:217], v[104:105] op_sel_hi:[1,0,1] neg_lo:[0,1,0] neg_hi:[0,1,0]
  v_pk_fma_f32 v[108:109], v[20:21], v[216:217], v[108:109] op_sel_hi:[1,0,1] neg_lo:[0,1,0] neg_hi:[0,1,0]
  v_pk_fma_f32 v[112:113], v[24:25], v[216:217], v[112:113] op_sel_hi:[1,0,1] neg_lo:[0,1,0] neg_hi:[0,1,0]
  v_pk_fma_f32 v[106:107], v[18:19], v[216:217], v[106:107] op_sel_hi:[1,0,1] neg_lo:[0,1,0] neg_hi:[0,1,0]
  v_pk_fma_f32 v[110:111], v[22:23], v[216:217], v[110:111] op_sel_hi:[1,0,1] neg_lo:[0,1,0] neg_hi:[0,1,0]
  v_pk_fma_f32 v[114:115], v[26:27], v[216:217], v[114:115] op_sel_hi:[1,0,1] neg_lo:[0,1,0] neg_hi:[0,1,0]
  buffer_load_dwordx4 a[232:235], v2, s[68:71], s11 offen offset:2048 sc1
  v_pk_mul_f32 v[232:233], v[104:105], v[218:219] op_sel_hi:[1,0]
  v_pk_mul_f32 v[234:235], v[108:109], v[218:219] op_sel_hi:[1,0]
  v_pk_mul_f32 v[236:237], v[112:113], v[218:219] op_sel_hi:[1,0]
  v_exp_f32 v232, v232
  v_exp_f32 v234, v234
  v_exp_f32 v236, v236
  v_exp_f32 v233, v233
  v_exp_f32 v235, v235
  v_exp_f32 v237, v237
  v_pk_mul_f32 v[104:105], v[104:105], v[106:107]
  v_pk_mul_f32 v[108:109], v[108:109], v[110:111]
  v_pk_mul_f32 v[112:113], v[112:113], v[114:115]
  v_pk_fma_f32 v[232:233], v[232:233], v[216:217], v[216:217] op_sel:[0,1,1] op_sel_hi:[1,1,1]
  v_pk_fma_f32 v[234:235], v[234:235], v[216:217], v[216:217] op_sel:[0,1,1] op_sel_hi:[1,1,1]
  v_pk_fma_f32 v[236:237], v[236:237], v[216:217], v[216:217] op_sel:[0,1,1] op_sel_hi:[1,1,1]
  v_rcp_f32 v232, v232
  v_rcp_f32 v234, v234
  v_rcp_f32 v236, v236
  v_rcp_f32 v233, v233
  v_rcp_f32 v235, v235
  v_rcp_f32 v237, v237
  v_pk_mul_f32 v[104:105], v[104:105], v[232:233]
  v_pk_mul_f32 v[108:109], v[108:109], v[234:235]
  v_pk_mul_f32 v[112:113], v[112:113], v[236:237]
  v_cvt_pk_bf16_f32 v224, v104, v105
  v_cvt_pk_bf16_f32 v225, v108, v109
  v_cvt_pk_bf16_f32 v226, v112, v113
  v_add_u32 v6, v14, v181
  ds_write_b96 v6, v[224:226] offset:2048
  v_pk_fma_f32 v[116:117], v[16:17], v[220:221], v[116:117] op_sel_hi:[1,0,1] neg_lo:[0,1,0] neg_hi:[0,1,0]
  v_pk_fma_f32 v[120:121], v[20:21], v[220:221], v[120:121] op_sel_hi:[1,0,1] neg_lo:[0,1,0] neg_hi:[0,1,0]
  v_pk_fma_f32 v[124:125], v[24:25], v[220:221], v[124:125] op_sel_hi:[1,0,1] neg_lo:[0,1,0] neg_hi:[0,1,0]
  v_pk_fma_f32 v[118:119], v[18:19], v[220:221], v[118:119] op_sel_hi:[1,0,1] neg_lo:[0,1,0] neg_hi:[0,1,0]
  v_pk_fma_f32 v[122:123], v[22:23], v[220:221], v[122:123] op_sel_hi:[1,0,1] neg_lo:[0,1,0] neg_hi:[0,1,0]
  v_pk_fma_f32 v[126:127], v[26:27], v[220:221], v[126:127] op_sel_hi:[1,0,1] neg_lo:[0,1,0] neg_hi:[0,1,0]
  v_pk_mul_f32 v[232:233], v[116:117], v[222:223] op_sel_hi:[1,0]
  v_pk_mul_f32 v[234:235], v[120:121], v[222:223] op_sel_hi:[1,0]
  v_pk_mul_f32 v[236:237], v[124:125], v[222:223] op_sel_hi:[1,0]
  buffer_load_dwordx4 a[236:239], v2, s[68:71], s11 offen offset:3072 sc1
  v_exp_f32 v232, v232
  v_exp_f32 v234, v234
  v_exp_f32 v236, v236
  v_exp_f32 v233, v233
  v_exp_f32 v235, v235
  v_exp_f32 v237, v237
  v_pk_mul_f32 v[116:117], v[116:117], v[118:119]
  v_pk_mul_f32 v[120:121], v[120:121], v[122:123]
  v_pk_mul_f32 v[124:125], v[124:125], v[126:127]
  v_pk_fma_f32 v[232:233], v[232:233], v[220:221], v[220:221] op_sel:[0,1,1] op_sel_hi:[1,1,1]
  v_pk_fma_f32 v[234:235], v[234:235], v[220:221], v[220:221] op_sel:[0,1,1] op_sel_hi:[1,1,1]
  v_pk_fma_f32 v[236:237], v[236:237], v[220:221], v[220:221] op_sel:[0,1,1] op_sel_hi:[1,1,1]
  v_rcp_f32 v232, v232
  v_rcp_f32 v234, v234
  v_rcp_f32 v236, v236
  v_rcp_f32 v233, v233
  v_rcp_f32 v235, v235
  v_rcp_f32 v237, v237
  v_pk_mul_f32 v[116:117], v[116:117], v[232:233]
  v_pk_mul_f32 v[120:121], v[120:121], v[234:235]
  v_pk_mul_f32 v[124:125], v[124:125], v[236:237]
  v_cvt_pk_bf16_f32 v228, v116, v117
  v_cvt_pk_bf16_f32 v229, v120, v121
  v_cvt_pk_bf16_f32 v230, v124, v125
  v_add_u32 v6, v15, v181
  ds_write_b96 v6, v[228:230] offset:2048
  s_nop 0
  s_branch K3_EPIDONE
K3_VAR3:
  s_waitcnt vmcnt(20)
  s_barrier
  s_waitcnt lgkmcnt(0)
  v_mfma_f32_16x16x32_bf16 v[32:35], a[0:3], v[128:131], 0
  ds_read2st64_b64 v[144:147], v8 offset0:2 offset1:3
  v_mfma_f32_16x16x32_bf16 v[36:39], a[4:7], v[128:131], 0
  s_lshl_b32 s13, s4, 3
  s_add_u32 s13, s13, s3
  v_mfma_f32_16x16x32_bf16 v[40:43], a[8:11], v[128:131], 0
  s_mul_i32 s13, s13, 49152
  s_mul_i32 s14, s5, 3072
  v_mfma_f32_16x16x32_bf16 v[44:47], a[0:3], v[132:135], 0
  ds_read2st64_b64 v[148:151], v9 offset0:2 offset1:3
  v_mfma_f32_16x16x32_bf16 v[48:51], a[4:7], v[132:135], 0
  s_add_u32 s60, s13, s14
  s_add_u32 s61, s60, 196608
  v_mfma_f32_16x16x32_bf16 v[52:55], a[8:11], v[132:135], 0
  s_lshl_b32 s13, s4, 2
  s_lshr_b32 s14, s5, 2
  v_mfma_f32_16x16x32_bf16 v[56:59], a[0:3], v[136:139], 0
  ds_read2st64_b64 v[152:155], v10 offset0:2 offset1:3
  v_mfma_f32_16x16x32_bf16 v[60:63], a[4:7], v[136:139], 0
  s_add_u32 s14, s14, s13
  s_lshl_b32 s14, s14, 8
  v_mfma_f32_16x16x32_bf16 v[64:67], a[8:11], v[136:139], 0
  s_add_u32 s62, s14, 0x4000
  s_add_u32 s13, s13, s3
  v_mfma_f32_16x16x32_bf16 v[68:71], a[0:3], v[140:143], 0
  ds_read2st64_b64 v[156:159], v11 offset0:2 offset1:3
  buffer_load_dwordx4 a[172:175], v2, s[48:51], s11 offen offset:3072 sc1
  v_mfma_f32_16x16x32_bf16 v[72:75], a[4:7], v[140:143], 0
  s_add_u32 s11, s9, 45056
  buffer_load_dwordx4 a[176:179], v2, s[48:51], s11 offen offset:0 sc1
  buffer_load_dwordx4 v2, s[44:47], s10 offen offset:3072 sc1 lds
  v_mfma_f32_16x16x32_bf16 v[76:79], a[8:11], v[140:143], 0
  s_waitcnt vmcnt(22)
  s_barrier
  s_waitcnt lgkmcnt(0)
  v_mfma_f32_16x16x32_bf16 v[32:35], a[12:15], v[144:147], v[32:35]
  ds_read2st64_b64 v[128:131], v8 offset0:4 offset1:5
  v_mfma_f32_16x16x32_bf16 v[36:39], a[16:19], v[144:147], v[36:39]
  s_lshl_b32 s13, s13, 8
  s_add_u32 s63, s13, 0x4000
  v_mfma_f32_16x16x32_bf16 v[40:43], a[20:23], v[144:147], v[40:43]
  s_lshl_b32 s13, s4, 3
  s_lshl_b32 s14, s19, 1
  v_mfma_f32_16x16x32_bf16 v[44:47], a[12:15], v[148:151], v[44:47]
  ds_read2st64_b64 v[132:135], v9 offset0:4 offset1:5
  v_mfma_f32_16x16x32_bf16 v[48:51], a[16:19], v[148:151], v[48:51]
  s_add_u32 s23, s13, s14
  s_mul_i32 s13, s23, 49152
  v_mfma_f32_16x16x32_bf16 v[52:55], a[20:23], v[148:151], v[52:55]
  s_mul_i32 s14, s3, 12288
  s_add_u32 s64, s13, s14
  v_mfma_f32_16x16x32_bf16 v[56:59], a[12:15], v[152:155], v[56:59]
  ds_read2st64_b64 v[136:139], v10 offset0:4 offset1:5
  v_mfma_f32_16x16x32_bf16 v[60:63], a[16:19], v[152:155], v[60:63]
  s_add_u32 s65, s64, 49152
  s_add_u32 s66, s64, 196608
  v_mfma_f32_16x16x32_bf16 v[64:67], a[20:23], v[152:155], v[64:67]
  s_add_u32 s67, s64, 245760
  v_mfma_f32_16x16x32_bf16 v[68:71], a[12:15], v[156:159], v[68:71]
  ds_read2st64_b64 v[140:143], v11 offset0:4 offset1:5
  buffer_load_dwordx4 a[180:183], v2, s[48:51], s11 offen offset:1024 sc1
  v_mfma_f32_16x16x32_bf16 v[72:75], a[16:19], v[156:159], v[72:75]
  buffer_load_dwordx4 a[184:187], v2, s[48:51], s11 offen offset:2048 sc1
  buffer_load_dwordx4 a[188:191], v2, s[48:51], s11 offen offset:3072 sc1
  v_mfma_f32_16x16x32_bf16 v[76:79], a[20:23], v[156:159], v[76:79]
  s_waitcnt vmcnt(24)
  s_barrier
  s_waitcnt lgkmcnt(0)
  v_mfma_f32_16x16x32_bf16 v[32:35], a[24:27], v[128:131], v[32:35]
  ds_read2st64_b64 v[144:147], v8 offset0:6 offset1:7
  v_mfma_f32_16x16x32_bf16 v[36:39], a[28:31], v[128:131], v[36:39]
  v_mfma_f32_16x16x32_bf16 v[40:43], a[32:35], v[128:131], v[40:43]
  v_mfma_f32_16x16x32_bf16 v[44:47], a[24:27], v[132:135], v[44:47]
  ds_read2st64_b64 v[148:151], v9 offset0:6 offset1:7
  v_mfma_f32_16x16x32_bf16 v[48:51], a[28:31], v[132:135], v[48:51]
  v_mfma_f32_16x16x32_bf16 v[52:55], a[32:35], v[132:135], v[52:55]
  v_mfma_f32_16x16x32_bf16 v[56:59], a[24:27], v[136:139], v[56:59]
  ds_read2st64_b64 v[152:155], v10 offset0:6 offset1:7
  v_mfma_f32_16x16x32_bf16 v[60:63], a[28:31], v[136:139], v[60:63]
  v_mfma_f32_16x16x32_bf16 v[64:67], a[32:35], v[136:139], v[64:67]
  v_mfma_f32_16x16x32_bf16 v[68:71], a[24:27], v[140:143], v[68:71]
  ds_read2st64_b64 v[156:159], v11 offset0:6 offset1:7
  s_add_u32 m0, s6, 16384
  s_add_u32 s10, s7, 16384
  buffer_load_dwordx4 v2, s[44:47], s10 offen offset:0 sc1 lds
  v_mfma_f32_16x16x32_bf16 v[72:75], a[28:31], v[140:143], v[72:75]
  s_add_u32 s11, s9, 49152
  buffer_load_dwordx4 a[192:195], v2, s[48:51], s11 offen offset:0 sc1
  buffer_load_dwordx4 a[196:199], v2, s[48:51], s11 offen offset:1024 sc1
  v_mfma_f32_16x16x32_bf16 v[76:79], a[32:35], v[140:143], v[76:79]
  s_waitcnt vmcnt(26)
  s_barrier
  s_waitcnt lgkmcnt(0)
  v_mfma_f32_16x16x32_bf16 v[32:35], a[36:39], v[144:147], v[32:35]
  ds_read2st64_b64 v[128:131], v8 offset0:8 offset1:9
  v_mfma_f32_16x16x32_bf16 v[36:39], a[40:43], v[144:147], v[36:39]
  v_mfma_f32_16x16x32_bf16 v[40:43], a[44:47], v[144:147], v[40:43]
  v_mfma_f32_16x16x32_bf16 v[44:47], a[36:39], v[148:151], v[44:47]
  ds_read2st64_b64 v[132:135], v9 offset0:8 offset1:9
  v_mfma_f32_16x16x32_bf16 v[48:51], a[40:43], v[148:151], v[48:51]
  v_mfma_f32_16x16x32_bf16 v[52:55], a[44:47], v[148:151], v[52:55]
  v_mfma_f32_16x16x32_bf16 v[56:59], a[36:39], v[152:155], v[56:59]
  ds_read2st64_b64 v[136:139], v10 offset0:8 offset1:9
  v_mfma_f32_16x16x32_bf16 v[60:63], a[40:43], v[152:155], v[60:63]
  v_mfma_f32_16x16x32_bf16 v[64:67], a[44:47], v[152:155], v[64:67]
  v_mfma_f32_16x16x32_bf16 v[68:71], a[36:39], v[156:159], v[68:71]
  ds_read2st64_b64 v[140:143], v11 offset0:8 offset1:9
  buffer_load_dwordx4 a[200:203], v2, s[48:51], s11 offen offset:2048 sc1
  v_mfma_f32_16x16x32_bf16 v[72:75], a[40:43], v[156:159], v[72:75]
  buffer_load_dwordx4 v2, s[44:47], s10 offen offset:1024 sc1 lds
  buffer_load_dwordx4 a[204:207], v2, s[48:51], s11 offen offset:3072 sc1
  v_mfma_f32_16x16x32_bf16 v[76:79], a[44:47], v[156:159], v[76:79]
  s_waitcnt vmcnt(28)
  s_barrier
  s_waitcnt lgkmcnt(0)
  v_mfma_f32_16x16x32_bf16 v[32:35], a[48:51], v[128:131], v[32:35]
  ds_read2st64_b64 v[144:147], v8 offset0:10 offset1:11
  v_mfma_f32_16x16x32_bf16 v[36:39], a[52:55], v[128:131], v[36:39]
  v_mfma_f32_16x16x32_bf16 v[40:43], a[56:59], v[128:131], v[40:43]
  v_mfma_f32_16x16x32_bf16 v[44:47], a[48:51], v[132:135], v[44:47]
  ds_read2st64_b64 v[148:151], v9 offset0:10 offset1:11
  v_mfma_f32_16x16x32_bf16 v[48:51], a[52:55], v[132:135], v[48:51]
  v_mfma_f32_16x16x32_bf16 v[52:55], a[56:59], v[132:135], v[52:55]
  v_mfma_f32_16x16x32_bf16 v[56:59], a[48:51], v[136:139], v[56:59]
  ds_read2st64_b64 v[152:155], v10 offset0:10 offset1:11
  v_mfma_f32_16x16x32_bf16 v[60:63], a[52:55], v[136:139], v[60:63]
  v_mfma_f32_16x16x32_bf16 v[64:67], a[56:59], v[136:139], v[64:67]
  v_mfma_f32_16x16x32_bf16 v[68:71], a[48:51], v[140:143], v[68:71]
  ds_read2st64_b64 v[156:159], v11 offset0:10 offset1:11
  s_add_u32 s11, s9, 53248
  buffer_load_dwordx4 a[208:211], v2, s[48:51], s11 offen offset:0 sc1
  v_mfma_f32_16x16x32_bf16 v[72:75], a[52:55], v[140:143], v[72:75]
  buffer_load_dwordx4 a[212:215], v2, s[48:51], s11 offen offset:1024 sc1
  buffer_load_dwordx4 v2, s[44:47], s10 offen offset:2048 sc1 lds
  v_mfma_f32_16x16x32_bf16 v[76:79], a[56:59], v[140:143], v[76:79]
  s_waitcnt vmcnt(30)
  s_barrier
  s_waitcnt lgkmcnt(0)
  v_mfma_f32_16x16x32_bf16 v[32:35], a[60:63], v[144:147], v[32:35]
  ds_read2st64_b64 v[128:131], v8 offset0:12 offset1:13
  v_mfma_f32_16x16x32_bf16 v[36:39], a[64:67], v[144:147], v[36:39]
  v_mfma_f32_16x16x32_bf16 v[40:43], a[68:71], v[144:147], v[40:43]
  v_mfma_f32_16x16x32_bf16 v[44:47], a[60:63], v[148:151], v[44:47]
  ds_read2st64_b64 v[132:135], v9 offset0:12 offset1:13
  v_mfma_f32_16x16x32_bf16 v[48:51], a[64:67], v[148:151], v[48:51]
  v_mfma_f32_16x16x32_bf16 v[52:55], a[68:71], v[148:151], v[52:55]
  v_mfma_f32_16x16x32_bf16 v[56:59], a[60:63], v[152:155], v[56:59]
  ds_read2st64_b64 v[136:139], v10 offset0:12 offset1:13
  v_mfma_f32_16x16x32_bf16 v[60:63], a[64:67], v[152:155], v[60:63]
  v_mfma_f32_16x16x32_bf16 v[64:67], a[68:71], v[152:155], v[64:67]
  v_mfma_f32_16x16x32_bf16 v[68:71], a[60:63], v[156:159], v[68:71]
  ds_read2st64_b64 v[140:143], v11 offset0:12 offset1:13
  buffer_load_dwordx4 a[216:219], v2, s[48:51], s11 offen offset:2048 sc1
  v_mfma_f32_16x16x32_bf16 v[72:75], a[64:67], v[156:159], v[72:75]
  buffer_load_dwordx4 a[220:223], v2, s[48:51], s11 offen offset:3072 sc1
  s_add_u32 s11, s9, 57344
  buffer_load_dwordx4 a[224:227], v2, s[48:51], s11 offen offset:0 sc1
  v_mfma_f32_16x16x32_bf16 v[76:79], a[68:71], v[156:159], v[76:79]
  s_waitcnt vmcnt(32)
  s_barrier
  s_waitcnt lgkmcnt(0)
  v_mfma_f32_16x16x32_bf16 v[32:35], a[72:75], v[128:131], v[32:35]
  ds_read2st64_b64 v[144:147], v8 offset0:14 offset1:15
  v_mfma_f32_16x16x32_bf16 v[36:39], a[76:79], v[128:131], v[36:39]
  v_mfma_f32_16x16x32_bf16 v[40:43], a[80:83], v[128:131], v[40:43]
  v_mfma_f32_16x16x32_bf16 v[44:47], a[72:75], v[132:135], v[44:47]
  ds_read2st64_b64 v[148:151], v9 offset0:14 offset1:15
  v_mfma_f32_16x16x32_bf16 v[48:51], a[76:79], v[132:135], v[48:51]
  v_mfma_f32_16x16x32_bf16 v[52:55], a[80:83], v[132:135], v[52:55]
  v_mfma_f32_16x16x32_bf16 v[56:59], a[72:75], v[136:139], v[56:59]
  ds_read2st64_b64 v[152:155], v10 offset0:14 offset1:15
  v_mfma_f32_16x16x32_bf16 v[60:63], a[76:79], v[136:139], v[60:63]
  v_mfma_f32_16x16x32_bf16 v[64:67], a[80:83], v[136:139], v[64:67]
  v_mfma_f32_16x16x32_bf16 v[68:71], a[72:75], v[140:143], v[68:71]
  ds_read2st64_b64 v[156:159], v11 offset0:14 offset1:15
  buffer_load_dwordx4 v2, s[44:47], s10 offen offset:3072 sc1 lds
  v_mfma_f32_16x16x32_bf16 v[72:75], a[76:79], v[140:143], v[72:75]
  buffer_load_dwordx4 a[228:231], v2, s[48:51], s11 offen offset:1024 sc1
  buffer_load_dwordx4 a[232:235], v2, s[48:51], s11 offen offset:2048 sc1
  v_mfma_f32_16x16x32_bf16 v[76:79], a[80:83], v[140:143], v[76:79]
  buffer_load_dwordx2 v[180:181], v189, s[92:95], s12 offen sc1
  s_waitcnt vmcnt(35)
  s_barrier
  s_waitcnt lgkmcnt(0)
  v_mfma_f32_16x16x32_bf16 v[32:35], a[84:87], v[144:147], v[32:35]
  ds_read2st64_b64 v[128:131], v8 offset0:16 offset1:17
  v_mfma_f32_16x16x32_bf16 v[36:39], a[88:91], v[144:147], v[36:39]
  v_mfma_f32_16x16x32_bf16 v[40:43], a[92:95], v[144:147], v[40:43]
  v_mfma_f32_16x16x32_bf16 v[44:47], a[84:87], v[148:151], v[44:47]
  ds_read2st64_b64 v[132:135], v9 offset0:16 offset1:17
  v_mfma_f32_16x16x32_bf16 v[48:51], a[88:91], v[148:151], v[48:51]
  v_mfma_f32_16x16x32_bf16 v[52:55], a[92:95], v[148:151], v[52:55]
  v_mfma_f32_16x16x32_bf16 v[56:59], a[84:87], v[152:155], v[56:59]
  ds_read2st64_b64 v[136:139], v10 offset0:16 offset1:17
  v_mfma_f32_16x16x32_bf16 v[60:63], a[88:91], v[152:155], v[60:63]
  v_mfma_f32_16x16x32_bf16 v[64:67], a[92:95], v[152:155], v[64:67]
  v_mfma_f32_16x16x32_bf16 v[68:71], a[84:87], v[156:159], v[68:71]
  ds_read2st64_b64 v[140:143], v11 offset0:16 offset1:17
  buffer_load_dwordx4 a[236:239], v2, s[48:51], s11 offen offset:3072 sc1
  v_mfma_f32_16x16x32_bf16 v[72:75], a[88:91], v[156:159], v[72:75]
  buffer_load_dwordx4 v[228:231], v2, s[52:55], s17 offen sc1
  v_mfma_f32_16x16x32_bf16 v[76:79], a[92:95], v[156:159], v[76:79]
  s_waitcnt vmcnt(36)
  s_barrier
  s_waitcnt lgkmcnt(0)
  v_mfma_f32_16x16x32_bf16 v[32:35], a[96:99], v[128:131], v[32:35]
  ds_read2st64_b64 v[144:147], v8 offset0:18 offset1:19
  v_mfma_f32_16x16x32_bf16 v[36:39], a[100:103], v[128:131], v[36:39]
  v_mfma_f32_16x16x32_bf16 v[40:43], a[104:107], v[128:131], v[40:43]
  v_mfma_f32_16x16x32_bf16 v[44:47], a[96:99], v[132:135], v[44:47]
  ds_read2st64_b64 v[148:151], v9 offset0:18 offset1:19
  v_mfma_f32_16x16x32_bf16 v[48:51], a[100:103], v[132:135], v[48:51]
  v_mfma_f32_16x16x32_bf16 v[52:55], a[104:107], v[132:135], v[52:55]
  v_mfma_f32_16x16x32_bf16 v[56:59], a[96:99], v[136:139], v[56:59]
  ds_read2st64_b64 v[152:155], v10 offset0:18 offset1:19
  v_mfma_f32_16x16x32_bf16 v[60:63], a[100:103], v[136:139], v[60:63]
  v_mfma_f32_16x16x32_bf16 v[64:67], a[104:107], v[136:139], v[64:67]
  v_mfma_f32_16x16x32_bf16 v[68:71], a[96:99], v[140:143], v[68:71]
  ds_read2st64_b64 v[156:159], v11 offset0:18 offset1:19
  v_mfma_f32_16x16x32_bf16 v[72:75], a[100:103], v[140:143], v[72:75]
  v_mfma_f32_16x16x32_bf16 v[76:79], a[104:107], v[140:143], v[76:79]
  s_waitcnt vmcnt(35)
  s_barrier
  s_waitcnt lgkmcnt(0)
  v_mfma_f32_16x16x32_bf16 v[32:35], a[108:111], v[144:147], v[32:35]
  ds_read2st64_b64 v[128:131], v8 offset0:20 offset1:21
  v_mfma_f32_16x16x32_bf16 v[36:39], a[112:115], v[144:147], v[36:39]
  v_mfma_f32_16x16x32_bf16 v[40:43], a[116:119], v[144:147], v[40:43]
  v_mfma_f32_16x16x32_bf16 v[44:47], a[108:111], v[148:151], v[44:47]
  ds_read2st64_b64 v[132:135], v9 offset0:20 offset1:21
  v_mfma_f32_16x16x32_bf16 v[48:51], a[112:115], v[148:151], v[48:51]
  v_mfma_f32_16x16x32_bf16 v[52:55], a[116:119], v[148:151], v[52:55]
  v_mfma_f32_16x16x32_bf16 v[56:59], a[108:111], v[152:155], v[56:59]
  ds_read2st64_b64 v[136:139], v10 offset0:20 offset1:21
  v_mfma_f32_16x16x32_bf16 v[60:63], a[112:115], v[152:155], v[60:63]
  v_mfma_f32_16x16x32_bf16 v[64:67], a[116:119], v[152:155], v[64:67]
  v_mfma_f32_16x16x32_bf16 v[68:71], a[108:111], v[156:159], v[68:71]
  ds_read2st64_b64 v[140:143], v11 offset0:20 offset1:21
  v_mfma_f32_16x16x32_bf16 v[72:75], a[112:115], v[156:159], v[72:75]
  v_mfma_f32_16x16x32_bf16 v[76:79], a[116:119], v[156:159], v[76:79]
  s_waitcnt vmcnt(34)
  s_barrier
  s_waitcnt lgkmcnt(0)
  v_mfma_f32_16x16x32_bf16 v[32:35], a[120:123], v[128:131], v[32:35]
  ds_read2st64_b64 v[144:147], v8 offset0:22 offset1:23
  v_mfma_f32_16x16x32_bf16 v[36:39], a[124:127], v[128:131], v[36:39]
  v_mfma_f32_16x16x32_bf16 v[40:43], a[128:131], v[128:131], v[40:43]
  v_mfma_f32_16x16x32_bf16 v[44:47], a[120:123], v[132:135], v[44:47]
  ds_read2st64_b64 v[148:151], v9 offset0:22 offset1:23
  v_mfma_f32_16x16x32_bf16 v[48:51], a[124:127], v[132:135], v[48:51]
  v_mfma_f32_16x16x32_bf16 v[52:55], a[128:131], v[132:135], v[52:55]
  v_mfma_f32_16x16x32_bf16 v[56:59], a[120:123], v[136:139], v[56:59]
  ds_read2st64_b64 v[152:155], v10 offset0:22 offset1:23
  v_mfma_f32_16x16x32_bf16 v[60:63], a[124:127], v[136:139], v[60:63]
  v_mfma_f32_16x16x32_bf16 v[64:67], a[128:131], v[136:139], v[64:67]
  v_mfma_f32_16x16x32_bf16 v[68:71], a[120:123], v[140:143], v[68:71]
  ds_read2st64_b64 v[156:159], v11 offset0:22 offset1:23
  v_mfma_f32_16x16x32_bf16 v[72:75], a[124:127], v[140:143], v[72:75]
  v_mfma_f32_16x16x32_bf16 v[76:79], a[128:131], v[140:143], v[76:79]
  s_waitcnt vmcnt(2)
  s_mov_b32 s35, 0
  s_nop 5
HBW3:
  v_cmp_ne_u64 vcc, s[90:91], v[180:181]
  s_nop 4
  s_cbranch_vccz HBK3
  s_add_u32 s35, s35, 1
  s_cmp_ge_u32 s35, 0x8000
  s_cbranch_scc1 HBK3
  s_sleep 1
  buffer_load_dwordx2 v[180:181], v189, s[92:95], s12 offen sc1
  s_waitcnt vmcnt(0)
  s_branch HBW3
HBK3:
  s_barrier
  s_waitcnt lgkmcnt(0)
  v_mfma_f32_16x16x32_bf16 v[32:35], a[132:135], v[144:147], v[32:35]
  ds_read2st64_b64 v[128:131], v8 offset0:24 offset1:25
  v_mfma_f32_16x16x32_bf16 v[36:39], a[136:139], v[144:147], v[36:39]
  v_mfma_f32_16x16x32_bf16 v[40:43], a[140:143], v[144:147], v[40:43]
  v_mfma_f32_16x16x32_bf16 v[44:47], a[132:135], v[148:151], v[44:47]
  ds_read2st64_b64 v[132:135], v9 offset0:24 offset1:25
  v_mfma_f32_16x16x32_bf16 v[48:51], a[136:139], v[148:151], v[48:51]
  v_mfma_f32_16x16x32_bf16 v[52:55], a[140:143], v[148:151], v[52:55]
  v_mfma_f32_16x16x32_bf16 v[56:59], a[132:135], v[152:155], v[56:59]
  ds_read2st64_b64 v[136:139], v10 offset0:24 offset1:25
  v_mfma_f32_16x16x32_bf16 v[60:63], a[136:139], v[152:155], v[60:63]
  v_mfma_f32_16x16x32_bf16 v[64:67], a[140:143], v[152:155], v[64:67]
  v_mfma_f32_16x16x32_bf16 v[68:71], a[132:135], v[156:159], v[68:71]
  ds_read2st64_b64 v[140:143], v11 offset0:24 offset1:25
  s_add_u32 s21, s21, 77824
  buffer_load_dwordx4 v[192:195], v2, s[44:47], s21 offen offset:0 sc1
  buffer_load_dwordx4 v[196:199], v2, s[44:47], s21 offen offset:1024 sc1
  buffer_load_dwordx4 v[200:203], v2, s[44:47], s21 offen offset:2048 sc1
  buffer_load_dwordx4 v[204:207], v2, s[44:47], s21 offen offset:3072 sc1
  s_add_u32 s21, s21, 4096
  buffer_load_dwordx4 v[208:211], v2, s[44:47], s21 offen offset:0 sc1
  v_mfma_f32_16x16x32_bf16 v[72:75], a[136:139], v[156:159], v[72:75]
  s_add_u32 m0, s6, 81920
  s_add_u32 s10, s7, 81920
  buffer_load_dwordx4 v2, s[44:47], s10 offen offset:0 sc1 lds
  buffer_load_dwordx4 v2, s[44:47], s10 offen offset:1024 sc1 lds
  v_mfma_f32_16x16x32_bf16 v[76:79], a[140:143], v[156:159], v[76:79]
  s_barrier
  s_waitcnt lgkmcnt(0)
  v_mfma_f32_16x16x32_bf16 v[32:35], a[144:147], v[128:131], v[32:35]
  ds_read2st64_b64 v[144:147], v8 offset0:26 offset1:27
  v_mfma_f32_16x16x32_bf16 v[36:39], a[148:151], v[128:131], v[36:39]
  v_mfma_f32_16x16x32_bf16 v[40:43], a[152:155], v[128:131], v[40:43]
  v_mfma_f32_16x16x32_bf16 v[44:47], a[144:147], v[132:135], v[44:47]
  ds_read2st64_b64 v[148:151], v9 offset0:26 offset1:27
  v_mfma_f32_16x16x32_bf16 v[48:51], a[148:151], v[132:135], v[48:51]
  v_mfma_f32_16x16x32_bf16 v[52:55], a[152:155], v[132:135], v[52:55]
  v_mfma_f32_16x16x32_bf16 v[56:59], a[144:147], v[136:139], v[56:59]
  ds_read2st64_b64 v[152:155], v10 offset0:26 offset1:27
  v_mfma_f32_16x16x32_bf16 v[60:63], a[148:151], v[136:139], v[60:63]
  v_mfma_f32_16x16x32_bf16 v[64:67], a[152:155], v[136:139], v[64:67]
  v_mfma_f32_16x16x32_bf16 v[68:71], a[144:147], v[140:143], v[68:71]
  ds_read2st64_b64 v[156:159], v11 offset0:26 offset1:27
  buffer_load_dwordx4 v2, s[44:47], s10 offen offset:2048 sc1 lds
  v_mfma_f32_16x16x32_bf16 v[72:75], a[148:151], v[140:143], v[72:75]
  buffer_load_dwordx4 v2, s[44:47], s10 offen offset:3072 sc1 lds
  s_add_u32 m0, s6, 86016
  s_add_u32 s10, s7, 86016
  buffer_load_dwordx4 v2, s[44:47], s10 offen offset:0 sc1 lds
  v_mfma_f32_16x16x32_bf16 v[76:79], a[152:155], v[140:143], v[76:79]
  buffer_load_dwordx2 v[190:191], v188, s[92:95], s37 offen sc1
  s_barrier
  s_waitcnt lgkmcnt(0)
  v_mfma_f32_16x16x32_bf16 v[32:35], a[156:159], v[144:147], v[32:35]
  ds_read2st64_b64 v[128:131], v8 offset0:28 offset1:29
  v_mfma_f32_16x16x32_bf16 v[36:39], a[160:163], v[144:147], v[36:39]
  v_mfma_f32_16x16x32_bf16 v[40:43], a[164:167], v[144:147], v[40:43]
  v_mfma_f32_16x16x32_bf16 v[44:47], a[156:159], v[148:151], v[44:47]
  ds_read2st64_b64 v[132:135], v9 offset0:28 offset1:29
  v_mfma_f32_16x16x32_bf16 v[48:51], a[160:163], v[148:151], v[48:51]
  v_mfma_f32_16x16x32_bf16 v[52:55], a[164:167], v[148:151], v[52:55]
  v_mfma_f32_16x16x32_bf16 v[56:59], a[156:159], v[152:155], v[56:59]
  ds_read2st64_b64 v[136:139], v10 offset0:28 offset1:29
  v_mfma_f32_16x16x32_bf16 v[60:63], a[160:163], v[152:155], v[60:63]
  v_mfma_f32_16x16x32_bf16 v[64:67], a[164:167], v[152:155], v[64:67]
  v_mfma_f32_16x16x32_bf16 v[68:71], a[156:159], v[156:159], v[68:71]
  ds_read2st64_b64 v[140:143], v11 offset0:28 offset1:29
  buffer_load_dwordx4 v2, s[44:47], s10 offen offset:1024 sc1 lds
  v_mfma_f32_16x16x32_bf16 v[72:75], a[160:163], v[156:159], v[72:75]
  buffer_load_dwordx4 v2, s[44:47], s10 offen offset:2048 sc1 lds
  buffer_load_dwordx4 v2, s[44:47], s10 offen offset:3072 sc1 lds
  v_mfma_f32_16x16x32_bf16 v[76:79], a[164:167], v[156:159], v[76:79]
  s_barrier
  s_waitcnt lgkmcnt(0)
  v_mfma_f32_16x16x32_bf16 v[32:35], a[168:171], v[128:131], v[32:35]
  ds_read2st64_b64 v[144:147], v8 offset0:30 offset1:31
  v_mfma_f32_16x16x32_bf16 v[36:39], a[172:175], v[128:131], v[36:39]
  v_mfma_f32_16x16x32_bf16 v[40:43], a[176:179], v[128:131], v[40:43]
  v_mfma_f32_16x16x32_bf16 v[44:47], a[168:171], v[132:135], v[44:47]
  ds_read2st64_b64 v[148:151], v9 offset0:30 offset1:31
  v_mfma_f32_16x16x32_bf16 v[48:51], a[172:175], v[132:135], v[48:51]
  v_mfma_f32_16x16x32_bf16 v[52:55], a[176:179], v[132:135], v[52:55]
  v_mfma_f32_16x16x32_bf16 v[56:59], a[168:171], v[136:139], v[56:59]
  ds_read2st64_b64 v[152:155], v10 offset0:30 offset1:31
  v_mfma_f32_16x16x32_bf16 v[60:63], a[172:175], v[136:139], v[60:63]
  v_mfma_f32_16x16x32_bf16 v[64:67], a[176:179], v[136:139], v[64:67]
  v_mfma_f32_16x16x32_bf16 v[68:71], a[168:171], v[140:143], v[68:71]
  ds_read2st64_b64 v[156:159], v11 offset0:30 offset1:31
  v_mfma_f32_16x16x32_bf16 v[72:75], a[172:175], v[140:143], v[72:75]
  v_mfma_f32_16x16x32_bf16 v[76:79], a[176:179], v[140:143], v[76:79]
  s_barrier
  s_waitcnt lgkmcnt(0)
  v_mfma_f32_16x16x32_bf16 v[32:35], a[180:183], v[144:147], v[32:35]
  ds_read2st64_b64 v[128:131], v8 offset0:32 offset1:33
  v_mfma_f32_16x16x32_bf16 v[36:39], a[184:187], v[144:147], v[36:39]
  v_mfma_f32_16x16x32_bf16 v[40:43], a[188:191], v[144:147], v[40:43]
  v_mfma_f32_16x16x32_bf16 v[44:47], a[180:183], v[148:151], v[44:47]
  ds_read2st64_b64 v[132:135], v9 offset0:32 offset1:33
  v_mfma_f32_16x16x32_bf16 v[48:51], a[184:187], v[148:151], v[48:51]
  v_mfma_f32_16x16x32_bf16 v[52:55], a[188:191], v[148:151], v[52:55]
  v_mfma_f32_16x16x32_bf16 v[56:59], a[180:183], v[152:155], v[56:59]
  ds_read2st64_b64 v[136:139], v10 offset0:32 offset1:33
  v_mfma_f32_16x16x32_bf16 v[60:63], a[184:187], v[152:155], v[60:63]
  v_mfma_f32_16x16x32_bf16 v[64:67], a[188:191], v[152:155], v[64:67]
  v_mfma_f32_16x16x32_bf16 v[68:71], a[180:183], v[156:159], v[68:71]
  ds_read2st64_b64 v[140:143], v11 offset0:32 offset1:33
  v_mfma_f32_16x16x32_bf16 v[72:75], a[184:187], v[156:159], v[72:75]
  v_mfma_f32_16x16x32_bf16 v[76:79], a[188:191], v[156:159], v[76:79]
  s_barrier
  s_waitcnt lgkmcnt(0)
  v_mfma_f32_16x16x32_bf16 v[32:35], a[192:195], v[128:131], v[32:35]
  ds_read2st64_b64 v[144:147], v8 offset0:34 offset1:35
  v_mfma_f32_16x16x32_bf16 v[36:39], a[196:199], v[128:131], v[36:39]
  v_mfma_f32_16x16x32_bf16 v[40:43], a[200:203], v[128:131], v[40:43]
  v_mfma_f32_16x16x32_bf16 v[44:47], a[192:195], v[132:135], v[44:47]
  ds_read2st64_b64 v[148:151], v9 offset0:34 offset1:35
  v_mfma_f32_16x16x32_bf16 v[48:51], a[196:199], v[132:135], v[48:51]
  v_mfma_f32_16x16x32_bf16 v[52:55], a[200:203], v[132:135], v[52:55]
  v_mfma_f32_16x16x32_bf16 v[56:59], a[192:195], v[136:139], v[56:59]
  ds_read2st64_b64 v[152:155], v10 offset0:34 offset1:35
  v_mfma_f32_16x16x32_bf16 v[60:63], a[196:199], v[136:139], v[60:63]
  v_mfma_f32_16x16x32_bf16 v[64:67], a[200:203], v[136:139], v[64:67]
  v_mfma_f32_16x16x32_bf16 v[68:71], a[192:195], v[140:143], v[68:71]
  ds_read2st64_b64 v[156:159], v11 offset0:34 offset1:35
  v_mfma_f32_16x16x32_bf16 v[72:75], a[196:199], v[140:143], v[72:75]
  v_mfma_f32_16x16x32_bf16 v[76:79], a[200:203], v[140:143], v[76:79]
  s_waitcnt vmcnt(9)
  v_dot2_f32_bf16 v252, v192, s16, 0
  v_dot2_f32_bf16 v253, v192, v192, 0
  v_dot2_f32_bf16 v252, v193, s16, v252
  v_dot2_f32_bf16 v253, v193, v193, v253
  v_dot2_f32_bf16 v254, v194, s16, 0
  v_dot2_f32_bf16 v255, v194, v194, 0
  v_dot2_f32_bf16 v254, v195, s16, v254
  v_dot2_f32_bf16 v255, v195, v195, v255
  v_dot2_f32_bf16 v252, v196, s16, v252
  v_dot2_f32_bf16 v253, v196, v196, v253
  v_dot2_f32_bf16 v252, v197, s16, v252
  v_dot2_f32_bf16 v253, v197, v197, v253
  v_dot2_f32_bf16 v254, v198, s16, v254
  v_dot2_f32_bf16 v255, v198, v198, v255
  v_dot2_f32_bf16 v254, v199, s16, v254
  v_dot2_f32_bf16 v255, v199, v199, v255
  v_dot2_f32_bf16 v252, v200, s16, v252
  v_dot2_f32_bf16 v253, v200, v200, v253
  v_dot2_f32_bf16 v252, v201, s16, v252
  v_dot2_f32_bf16 v253, v201, v201, v253
  v_dot2_f32_bf16 v254, v202, s16, v254
  v_dot2_f32_bf16 v255, v202, v202, v255
  v_dot2_f32_bf16 v254, v203, s16, v254
  v_dot2_f32_bf16 v255, v203, v203, v255
  v_dot2_f32_bf16 v252, v204, s16, v252
  v_dot2_f32_bf16 v253, v204, v204, v253
  v_dot2_f32_bf16 v252, v205, s16, v252
  v_dot2_f32_bf16 v253, v205, v205, v253
  v_dot2_f32_bf16 v254, v206, s16, v254
  v_dot2_f32_bf16 v255, v206, v206, v255
  v_dot2_f32_bf16 v254, v207, s16, v254
  v_dot2_f32_bf16 v255, v207, v207, v255
  v_dot2_f32_bf16 v252, v208, s16, v252
  v_dot2_f32_bf16 v253, v208, v208, v253
  v_dot2_f32_bf16 v252, v209, s16, v252
  v_dot2_f32_bf16 v253, v209, v209, v253
  v_dot2_f32_bf16 v254, v210, s16, v254
  v_dot2_f32_bf16 v255, v210, v210, v255
  v_dot2_f32_bf16 v254, v211, s16, v254
  v_dot2_f32_bf16 v255, v211, v211, v255
  v_mov_b32 v192, v252
  v_mov_b32 v193, v253
  v_mov_b32 v194, v254
  v_mov_b32 v195, v255
  v_permlane32_swap_b32 v252, v192
  v_permlane32_swap_b32 v253, v193
  v_permlane32_swap_b32 v254, v194
  v_permlane32_swap_b32 v255, v195
  v_pk_add_f32 v[252:253], v[252:253], v[192:193]
  v_pk_add_f32 v[254:255], v[254:255], v[194:195]
  v_mov_b32 v192, v252
  v_mov_b32 v193, v253
  v_mov_b32 v194, v254
  v_mov_b32 v195, v255
  v_permlane16_swap_b32 v252, v192
  v_permlane16_swap_b32 v253, v193
  v_permlane16_swap_b32 v254, v194
  v_permlane16_swap_b32 v255, v195
  v_pk_add_f32 v[252:253], v[252:253], v[192:193]
  v_pk_add_f32 v[254:255], v[254:255], v[194:195]
  s_nop 0
  v_add_f32_dpp v252, v252, v252 row_ror:8 row_mask:0xf bank_mask:0xf
  v_add_f32_dpp v253, v253, v253 row_ror:8 row_mask:0xf bank_mask:0xf
  v_add_f32_dpp v254, v254, v254 row_ror:8 row_mask:0xf bank_mask:0xf
  v_add_f32_dpp v255, v255, v255 row_ror:8 row_mask:0xf bank_mask:0xf
  v_add_u32 v6, 6144, v182
  v_add_u32 v6, s27, v6
  ds_write_b128 v6, v[252:255]
  s_waitcnt lgkmcnt(0)
  s_barrier
  v_mfma_f32_16x16x32_bf16 v[32:35], a[204:207], v[144:147], v[32:35]
  ds_read2st64_b64 v[128:131], v8 offset0:36 offset1:37
  v_mfma_f32_16x16x32_bf16 v[36:39], a[208:211], v[144:147], v[36:39]
  v_mfma_f32_16x16x32_bf16 v[40:43], a[212:215], v[144:147], v[40:43]
  v_mfma_f32_16x16x32_bf16 v[44:47], a[204:207], v[148:151], v[44:47]
  ds_read2st64_b64 v[132:135], v9 offset0:36 offset1:37
  v_mfma_f32_16x16x32_bf16 v[48:51], a[208:211], v[148:151], v[48:51]
  v_mfma_f32_16x16x32_bf16 v[52:55], a[212:215], v[148:151], v[52:55]
  v_mfma_f32_16x16x32_bf16 v[56:59], a[204:207], v[152:155], v[56:59]
  ds_read2st64_b64 v[136:139], v10 offset0:36 offset1:37
  v_mfma_f32_16x16x32_bf16 v[60:63], a[208:211], v[152:155], v[60:63]
  v_mfma_f32_16x16x32_bf16 v[64:67], a[212:215], v[152:155], v[64:67]
  v_mfma_f32_16x16x32_bf16 v[68:71], a[204:207], v[156:159], v[68:71]
  ds_read2st64_b64 v[140:143], v11 offset0:36 offset1:37
  v_mfma_f32_16x16x32_bf16 v[72:75], a[208:211], v[156:159], v[72:75]
  v_mfma_f32_16x16x32_bf16 v[76:79], a[212:215], v[156:159], v[76:79]
  s_barrier
  s_waitcnt lgkmcnt(0)
  v_mfma_f32_16x16x32_bf16 v[32:35], a[216:219], v[128:131], v[32:35]
  ds_read2st64_b64 v[144:147], v8 offset0:38 offset1:39
  v_mfma_f32_16x16x32_bf16 v[36:39], a[220:223], v[128:131], v[36:39]
  v_mfma_f32_16x16x32_bf16 v[40:43], a[224:227], v[128:131], v[40:43]
  v_mfma_f32_16x16x32_bf16 v[44:47], a[216:219], v[132:135], v[44:47]
  ds_read2st64_b64 v[148:151], v9 offset0:38 offset1:39
  v_mfma_f32_16x16x32_bf16 v[48:51], a[220:223], v[132:135], v[48:51]
  v_mfma_f32_16x16x32_bf16 v[52:55], a[224:227], v[132:135], v[52:55]
  v_mfma_f32_16x16x32_bf16 v[56:59], a[216:219], v[136:139], v[56:59]
  ds_read2st64_b64 v[152:155], v10 offset0:38 offset1:39
  v_mfma_f32_16x16x32_bf16 v[60:63], a[220:223], v[136:139], v[60:63]
  v_mfma_f32_16x16x32_bf16 v[64:67], a[224:227], v[136:139], v[64:67]
  v_mfma_f32_16x16x32_bf16 v[68:71], a[216:219], v[140:143], v[68:71]
  ds_read2st64_b64 v[156:159], v11 offset0:38 offset1:39
  buffer_load_dwordx2 v[176:177], v186, s[72:75], s24 offen offset:0 sc1
  v_mfma_f32_16x16x32_bf16 v[72:75], a[220:223], v[140:143], v[72:75]
  s_add_u32 m0, s6, 90112
  s_add_u32 s10, s7, 90112
  buffer_load_dwordx4 v2, s[44:47], s10 offen offset:0 sc1 lds
  v_mfma_f32_16x16x32_bf16 v[76:79], a[224:227], v[140:143], v[76:79]
  s_waitcnt vmcnt(5)
  s_mov_b32 s35, 0
  s_nop 5
W2W3:
  v_cmp_ne_u64 vcc, s[90:91], v[190:191]
  s_nop 4
  s_cbranch_vccz W2K3
  s_add_u32 s35, s35, 1
  s_cmp_ge_u32 s35, 0x8000
  s_cbranch_scc1 W2K3
  s_sleep 2
  buffer_load_dwordx2 v[190:191], v188, s[92:95], s37 offen sc1
  s_waitcnt vmcnt(0)
  s_branch W2W3
W2K3:
  s_barrier
  s_waitcnt lgkmcnt(0)
  v_mfma_f32_16x16x32_bf16 v[32:35], a[228:231], v[144:147], v[32:35]
  ds_read2st64_b64 v[128:131], v12 offset0:0 offset1:1
  v_mfma_f32_16x16x32_bf16 v[36:39], a[232:235], v[144:147], v[36:39]
  v_mfma_f32_16x16x32_bf16 v[40:43], a[236:239], v[144:147], v[40:43]
  v_mfma_f32_16x16x32_bf16 v[44:47], a[228:231], v[148:151], v[44:47]
  ds_read2st64_b64 v[132:135], v13 offset0:0 offset1:1
  v_mfma_f32_16x16x32_bf16 v[48:51], a[232:235], v[148:151], v[48:51]
  v_mfma_f32_16x16x32_bf16 v[52:55], a[236:239], v[148:151], v[52:55]
  v_mfma_f32_16x16x32_bf16 v[56:59], a[228:231], v[152:155], v[56:59]
  ds_read2st64_b64 v[136:139], v14 offset0:0 offset1:1
  v_mfma_f32_16x16x32_bf16 v[60:63], a[232:235], v[152:155], v[60:63]
  v_mfma_f32_16x16x32_bf16 v[64:67], a[236:239], v[152:155], v[64:67]
  v_mfma_f32_16x16x32_bf16 v[68:71], a[228:231], v[156:159], v[68:71]
  ds_read2st64_b64 v[140:143], v15 offset0:0 offset1:1
  v_mfma_f32_16x16x32_bf16 v[72:75], a[232:235], v[156:159], v[72:75]
  v_mfma_f32_16x16x32_bf16 v[76:79], a[236:239], v[156:159], v[76:79]
  s_barrier
  s_waitcnt lgkmcnt(0)
  v_mfma_f32_16x16x32_bf16 v[80:83], a[0:3], v[128:131], 0
  ds_read2st64_b64 v[144:147], v12 offset0:2 offset1:3
  v_mfma_f32_16x16x32_bf16 v[84:87], a[4:7], v[128:131], 0
  v_mfma_f32_16x16x32_bf16 v[88:91], a[8:11], v[128:131], 0
  v_mfma_f32_16x16x32_bf16 v[92:95], a[0:3], v[132:135], 0
  ds_read2st64_b64 v[148:151], v13 offset0:2 offset1:3
  v_mfma_f32_16x16x32_bf16 v[96:99], a[4:7], v[132:135], 0
  v_mfma_f32_16x16x32_bf16 v[100:103], a[8:11], v[132:135], 0
  v_mfma_f32_16x16x32_bf16 v[104:107], a[0:3], v[136:139], 0
  ds_read2st64_b64 v[152:155], v14 offset0:2 offset1:3
  v_mfma_f32_16x16x32_bf16 v[108:111], a[4:7], v[136:139], 0
  v_mfma_f32_16x16x32_bf16 v[112:115], a[8:11], v[136:139], 0
  v_mfma_f32_16x16x32_bf16 v[116:119], a[0:3], v[140:143], 0
  ds_read2st64_b64 v[156:159], v15 offset0:2 offset1:3
  v_mfma_f32_16x16x32_bf16 v[120:123], a[4:7], v[140:143], 0
  v_mfma_f32_16x16x32_bf16 v[124:127], a[8:11], v[140:143], 0
  s_barrier
  s_waitcnt lgkmcnt(0)
  v_mfma_f32_16x16x32_bf16 v[80:83], a[12:15], v[144:147], v[80:83]
  ds_read2st64_b64 v[128:131], v12 offset0:4 offset1:5
  v_mfma_f32_16x16x32_bf16 v[84:87], a[16:19], v[144:147], v[84:87]
  v_mfma_f32_16x16x32_bf16 v[88:91], a[20:23], v[144:147], v[88:91]
  v_mfma_f32_16x16x32_bf16 v[92:95], a[12:15], v[148:151], v[92:95]
  ds_read2st64_b64 v[132:135], v13 offset0:4 offset1:5
  v_mfma_f32_16x16x32_bf16 v[96:99], a[16:19], v[148:151], v[96:99]
  v_mfma_f32_16x16x32_bf16 v[100:103], a[20:23], v[148:151], v[100:103]
  v_mfma_f32_16x16x32_bf16 v[104:107], a[12:15], v[152:155], v[104:107]
  ds_read2st64_b64 v[136:139], v14 offset0:4 offset1:5
  v_mfma_f32_16x16x32_bf16 v[108:111], a[16:19], v[152:155], v[108:111]
  v_mfma_f32_16x16x32_bf16 v[112:115], a[20:23], v[152:155], v[112:115]
  v_mfma_f32_16x16x32_bf16 v[116:119], a[12:15], v[156:159], v[116:119]
  ds_read2st64_b64 v[140:143], v15 offset0:4 offset1:5
  s_add_u32 s11, s22, 0
  buffer_load_dwordx4 a[0:3], v2, s[68:71], s11 offen offset:0 sc1
  v_mfma_f32_16x16x32_bf16 v[120:123], a[16:19], v[156:159], v[120:123]
  buffer_load_dwordx4 a[4:7], v2, s[68:71], s11 offen offset:1024 sc1
  v_mfma_f32_16x16x32_bf16 v[124:127], a[20:23], v[156:159], v[124:127]
  buffer_load_dwordx4 a[8:11], v2, s[68:71], s11 offen offset:2048 sc1
  buffer_load_dwordx4 v2, s[44:47], s10 offen offset:1024 sc1 lds
  s_mov_b32 s35, 0
  s_nop 4
K3_STCHK03:
  s_waitcnt vmcnt(5)
  v_cmp_eq_u32 vcc, 0, v177
  s_nop 4
  s_cbranch_vccz K3_STOK03
  s_add_u32 s35, s35, 1
  s_cmp_ge_u32 s35, 0x4000
  s_cbranch_scc1 K3_STOK03
  s_sleep 2
  buffer_load_dwordx2 v[176:177], v186, s[72:75], s24 offen offset:0 sc1
  s_waitcnt vmcnt(0)
  s_branch K3_STCHK03
K3_STOK03:
  s_barrier
  s_waitcnt lgkmcnt(0)
  v_mfma_f32_16x16x32_bf16 v[80:83], a[24:27], v[128:131], v[80:83]
  ds_read2st64_b64 v[144:147], v12 offset0:6 offset1:7
  ds_write_b64 v183, v[176:177] offset:4096
  v_mov_b32 v232, v228
  v_mfma_f32_16x16x32_bf16 v[84:87], a[28:31], v[128:131], v[84:87]
  v_mov_b32 v233, v229
  v_mov_b32 v234, v230
  v_mov_b32 v235, v231
  v_mfma_f32_16x16x32_bf16 v[88:91], a[32:35], v[128:131], v[88:91]
  v_permlane32_swap_b32 v228, v232
  v_permlane32_swap_b32 v229, v233
  v_permlane32_swap_b32 v230, v234
  v_mfma_f32_16x16x32_bf16 v[92:95], a[24:27], v[132:135], v[92:95]
  ds_read2st64_b64 v[148:151], v13 offset0:6 offset1:7
  v_permlane32_swap_b32 v231, v235
  v_add_f32 v228, v228, v232
  v_mfma_f32_16x16x32_bf16 v[96:99], a[28:31], v[132:135], v[96:99]
  v_add_f32 v229, v229, v233
  v_add_f32 v230, v230, v234
  v_add_f32 v231, v231, v235
  v_mfma_f32_16x16x32_bf16 v[100:103], a[32:35], v[132:135], v[100:103]
  v_mov_b32 v232, v228
  v_mov_b32 v233, v229
  v_mov_b32 v234, v230
  v_mfma_f32_16x16x32_bf16 v[104:107], a[24:27], v[136:139], v[104:107]
  ds_read2st64_b64 v[152:155], v14 offset0:6 offset1:7
  v_mov_b32 v235, v231
  v_permlane16_swap_b32 v228, v232
  v_mfma_f32_16x16x32_bf16 v[108:111], a[28:31], v[136:139], v[108:111]
  v_permlane16_swap_b32 v229, v233
  v_permlane16_swap_b32 v230, v234
  v_permlane16_swap_b32 v231, v235
  v_mfma_f32_16x16x32_bf16 v[112:115], a[32:35], v[136:139], v[112:115]
  v_add_f32 v228, v228, v232
  v_add_f32 v229, v229, v233
  v_add_f32 v230, v230, v234
  v_mfma_f32_16x16x32_bf16 v[116:119], a[24:27], v[140:143], v[116:119]
  ds_read2st64_b64 v[156:159], v15 offset0:6 offset1:7
  buffer_load_dwordx4 a[12:15], v2, s[68:71], s11 offen offset:3072 sc1
  v_mfma_f32_16x16x32_bf16 v[120:123], a[28:31], v[140:143], v[120:123]
  s_add_u32 s11, s22, 4096
  buffer_load_dwordx4 a[16:19], v2, s[68:71], s11 offen offset:0 sc1
  v_mfma_f32_16x16x32_bf16 v[124:127], a[32:35], v[140:143], v[124:127]
  buffer_load_dwordx4 a[20:23], v2, s[68:71], s11 offen offset:1024 sc1
  buffer_load_dwordx4 v2, s[44:47], s10 offen offset:2048 sc1 lds
  s_barrier
  s_waitcnt lgkmcnt(0)
  v_mfma_f32_16x16x32_bf16 v[80:83], a[36:39], v[144:147], v[80:83]
  ds_read2st64_b64 v[128:131], v12 offset0:8 offset1:9
  v_add_f32 v231, v231, v235
  ds_write_b128 v185, v[228:231] offset:5120
  v_mfma_f32_16x16x32_bf16 v[84:87], a[40:43], v[144:147], v[84:87]
  ds_read_b64 v[192:193], v184 offset:4480
  ds_read_b64 v[196:197], v184 offset:4096
  ds_read_b64 v[200:201], v184 offset:4224
  v_mfma_f32_16x16x32_bf16 v[88:91], a[44:47], v[144:147], v[88:91]
  ds_read_b64 v[204:205], v184 offset:4352
  ds_read2_b64 v[16:19], v187 offset0:0 offset1:2
  ds_read2_b64 v[20:23], v187 offset0:8 offset1:10
  v_mfma_f32_16x16x32_bf16 v[92:95], a[36:39], v[148:151], v[92:95]
  ds_read2st64_b64 v[132:135], v13 offset0:8 offset1:9
  ds_read2_b64 v[24:27], v187 offset0:16 offset1:18
  v_mov_b32 v181, v30
  v_mfma_f32_16x16x32_bf16 v[96:99], a[40:43], v[148:151], v[96:99]
  v_mov_b32 v28, 1
  v_mov_b32 v29, 0
  v_mov_b32 v4, 0xbfb8aa3b
  v_mfma_f32_16x16x32_bf16 v[100:103], a[44:47], v[148:151], v[100:103]
  s_waitcnt lgkmcnt(0)
  v_rcp_f32 v194, v193
  v_rcp_f32 v198, v197
  v_mfma_f32_16x16x32_bf16 v[104:107], a[36:39], v[152:155], v[104:107]
  ds_read2st64_b64 v[136:139], v14 offset0:8 offset1:9
  v_rcp_f32 v202, v201
  v_rcp_f32 v206, v205
  v_mfma_f32_16x16x32_bf16 v[108:111], a[40:43], v[152:155], v[108:111]
  v_mul_f32 v193, v193, v193
  v_mul_f32 v197, v197, v197
  v_mul_f32 v201, v201, v201
  v_mfma_f32_16x16x32_bf16 v[112:115], a[44:47], v[152:155], v[112:115]
  v_mul_f32 v205, v205, v205
  v_mul_f32 v194, v194, v4
  v_mul_f32 v198, v198, v4
  v_mfma_f32_16x16x32_bf16 v[116:119], a[36:39], v[156:159], v[116:119]
  ds_read2st64_b64 v[140:143], v15 offset0:8 offset1:9
  buffer_load_dwordx4 a[24:27], v2, s[68:71], s11 offen offset:2048 sc1
  v_mfma_f32_16x16x32_bf16 v[120:123], a[40:43], v[156:159], v[120:123]
  buffer_load_dwordx4 a[28:31], v2, s[68:71], s11 offen offset:3072 sc1
  v_mfma_f32_16x16x32_bf16 v[124:127], a[44:47], v[156:159], v[124:127]
  s_add_u32 s11, s22, 8192
  buffer_load_dwordx4 a[32:35], v2, s[68:71], s11 offen offset:0 sc1
  buffer_load_dwordx4 v2, s[44:47], s10 offen offset:3072 sc1 lds
  s_barrier
  s_waitcnt lgkmcnt(0)
  v_mfma_f32_16x16x32_bf16 v[80:83], a[48:51], v[128:131], v[80:83]
  ds_read2st64_b64 v[144:147], v12 offset0:10 offset1:11
  v_mul_f32 v202, v202, v4
  v_mul_f32 v206, v206, v4
  v_mfma_f32_16x16x32_bf16 v[84:87], a[52:55], v[128:131], v[84:87]
  v_fma_f32 v32, -v192, v16, v32
  v_fma_f32 v36, -v192, v20, v36
  v_fma_f32 v40, -v192, v24, v40
  v_mfma_f32_16x16x32_bf16 v[88:91], a[56:59], v[128:131], v[88:91]
  v_fma_f32 v33, -v192, v17, v33
  v_fma_f32 v37, -v192, v21, v37
  v_fma_f32 v41, -v192, v25, v41
  v_mfma_f32_16x16x32_bf16 v[92:95], a[48:51], v[132:135], v[92:95]
  ds_read2st64_b64 v[148:151], v13 offset0:10 offset1:11
  v_mul_f32 v232, v32, v194
  v_mul_f32 v234, v36, v194
  v_mfma_f32_16x16x32_bf16 v[96:99], a[52:55], v[132:135], v[96:99]
  v_mul_f32 v236, v40, v194
  v_mul_f32 v233, v33, v194
  v_mul_f32 v235, v37, v194
  v_mfma_f32_16x16x32_bf16 v[100:103], a[56:59], v[132:135], v[100:103]
  v_mul_f32 v237, v41, v194
  v_exp_f32 v232, v232
  v_mfma_f32_16x16x32_bf16 v[104:107], a[48:51], v[136:139], v[104:107]
  ds_read2st64_b64 v[152:155], v14 offset0:10 offset1:11
  v_exp_f32 v234, v234
  v_mfma_f32_16x16x32_bf16 v[108:111], a[52:55], v[136:139], v[108:111]
  v_exp_f32 v236, v236
  v_fma_f32 v34, -v192, v18, v34
  v_mfma_f32_16x16x32_bf16 v[112:115], a[56:59], v[136:139], v[112:115]
  v_fma_f32 v38, -v192, v22, v38
  v_fma_f32 v42, -v192, v26, v42
  v_exp_f32 v233, v233
  v_mfma_f32_16x16x32_bf16 v[116:119], a[48:51], v[140:143], v[116:119]
  ds_read2st64_b64 v[156:159], v15 offset0:10 offset1:11
  buffer_load_dwordx4 a[36:39], v2, s[68:71], s11 offen offset:1024 sc1
  v_mfma_f32_16x16x32_bf16 v[120:123], a[52:55], v[140:143], v[120:123]
  buffer_load_dwordx4 a[40:43], v2, s[68:71], s11 offen offset:2048 sc1
  v_mfma_f32_16x16x32_bf16 v[124:127], a[56:59], v[140:143], v[124:127]
  buffer_load_dwordx4 a[44:47], v2, s[68:71], s11 offen offset:3072 sc1
  s_add_u32 m0, s6, 94208
  s_add_u32 s10, s7, 94208
  buffer_load_dwordx4 v2, s[44:47], s10 offen offset:0 sc1 lds
  s_barrier
  s_waitcnt lgkmcnt(0)
  v_mfma_f32_16x16x32_bf16 v[80:83], a[60:63], v[144:147], v[80:83]
  ds_read2st64_b64 v[128:131], v12 offset0:12 offset1:13
  v_exp_f32 v235, v235
  v_mfma_f32_16x16x32_bf16 v[84:87], a[64:67], v[144:147], v[84:87]
  v_exp_f32 v237, v237
  v_fma_f32 v35, -v192, v19, v35
  v_mfma_f32_16x16x32_bf16 v[88:91], a[68:71], v[144:147], v[88:91]
  v_fma_f32 v39, -v192, v23, v39
  v_fma_f32 v43, -v192, v27, v43
  v_mul_f32 v32, v32, v34
  v_mfma_f32_16x16x32_bf16 v[92:95], a[60:63], v[148:151], v[92:95]
  ds_read2st64_b64 v[132:135], v13 offset0:12 offset1:13
  v_mul_f32 v36, v36, v38
  v_mul_f32 v40, v40, v42
  v_mfma_f32_16x16x32_bf16 v[96:99], a[64:67], v[148:151], v[96:99]
  v_mul_f32 v33, v33, v35
  v_mul_f32 v37, v37, v39
  v_mul_f32 v41, v41, v43
  v_mfma_f32_16x16x32_bf16 v[100:103], a[68:71], v[148:151], v[100:103]
  v_fma_f32 v232, v232, v193, v193
  v_fma_f32 v234, v234, v193, v193
  v_fma_f32 v236, v236, v193, v193
  v_mfma_f32_16x16x32_bf16 v[104:107], a[60:63], v[152:155], v[104:107]
  ds_read2st64_b64 v[136:139], v14 offset0:12 offset1:13
  v_fma_f32 v233, v233, v193, v193
  v_fma_f32 v235, v235, v193, v193
  v_mfma_f32_16x16x32_bf16 v[108:111], a[64:67], v[152:155], v[108:111]
  v_fma_f32 v237, v237, v193, v193
  v_rcp_f32 v232, v232
  v_mfma_f32_16x16x32_bf16 v[112:115], a[68:71], v[152:155], v[112:115]
  v_rcp_f32 v234, v234
  v_rcp_f32 v236, v236
  v_mfma_f32_16x16x32_bf16 v[116:119], a[60:63], v[156:159], v[116:119]
  ds_read2st64_b64 v[140:143], v15 offset0:12 offset1:13
  s_add_u32 s11, s22, 12288
  buffer_load_dwordx4 a[48:51], v2, s[68:71], s11 offen offset:0 sc1
  v_mfma_f32_16x16x32_bf16 v[120:123], a[64:67], v[156:159], v[120:123]
  buffer_load_dwordx4 a[52:55], v2, s[68:71], s11 offen offset:1024 sc1
  v_mfma_f32_16x16x32_bf16 v[124:127], a[68:71], v[156:159], v[124:127]
  buffer_load_dwordx4 a[56:59], v2, s[68:71], s11 offen offset:2048 sc1
  buffer_load_dwordx4 v2, s[44:47], s10 offen offset:1024 sc1 lds
  s_barrier
  s_waitcnt lgkmcnt(0)
  v_mfma_f32_16x16x32_bf16 v[80:83], a[72:75], v[128:131], v[80:83]
  ds_read2st64_b64 v[144:147], v12 offset0:14 offset1:15
  v_rcp_f32 v233, v233
  v_mfma_f32_16x16x32_bf16 v[84:87], a[76:79], v[128:131], v[84:87]
  v_rcp_f32 v235, v235
  v_rcp_f32 v237, v237
  v_mfma_f32_16x16x32_bf16 v[88:91], a[80:83], v[128:131], v[88:91]
  v_mul_f32 v32, v32, v232
  v_mul_f32 v36, v36, v234
  v_mul_f32 v40, v40, v236
  v_mfma_f32_16x16x32_bf16 v[92:95], a[72:75], v[132:135], v[92:95]
  ds_read2st64_b64 v[148:151], v13 offset0:14 offset1:15
  v_mul_f32 v33, v33, v233
  v_mul_f32 v37, v37, v235
  v_mfma_f32_16x16x32_bf16 v[96:99], a[76:79], v[132:135], v[96:99]
  v_mul_f32 v41, v41, v237
  v_cvt_pk_bf16_f32 v224, v32, v33
  v_cvt_pk_bf16_f32 v225, v36, v37
  v_mfma_f32_16x16x32_bf16 v[100:103], a[80:83], v[132:135], v[100:103]
  v_cvt_pk_bf16_f32 v226, v40, v41
  v_add_u32 v6, v8, v181
  ds_write_b32 v6, v224 offset:12
  v_mfma_f32_16x16x32_bf16 v[104:107], a[72:75], v[136:139], v[104:107]
  ds_read2st64_b64 v[152:155], v14 offset0:14 offset1:15
  ds_write_b32 v6, v225 offset:1036
  ds_write_b32 v6, v226 offset:2060
  v_mfma_f32_16x16x32_bf16 v[108:111], a[76:79], v[136:139], v[108:111]
  v_fma_f32 v44, -v196, v16, v44
  v_fma_f32 v48, -v196, v20, v48
  v_fma_f32 v52, -v196, v24, v52
  v_mfma_f32_16x16x32_bf16 v[112:115], a[80:83], v[136:139], v[112:115]
  v_fma_f32 v45, -v196, v17, v45
  v_fma_f32 v49, -v196, v21, v49
  v_fma_f32 v53, -v196, v25, v53
  v_mfma_f32_16x16x32_bf16 v[116:119], a[72:75], v[140:143], v[116:119]
  ds_read2st64_b64 v[156:159], v15 offset0:14 offset1:15
  buffer_load_dwordx4 a[60:63], v2, s[68:71], s11 offen offset:3072 sc1
  v_mfma_f32_16x16x32_bf16 v[120:123], a[76:79], v[140:143], v[120:123]
  s_add_u32 s11, s22, 16384
  buffer_load_dwordx4 a[64:67], v2, s[68:71], s11 offen offset:0 sc1
  v_mfma_f32_16x16x32_bf16 v[124:127], a[80:83], v[140:143], v[124:127]
  buffer_load_dwordx4 a[68:71], v2, s[68:71], s11 offen offset:1024 sc1
  buffer_load_dwordx4 v2, s[44:47], s10 offen offset:2048 sc1 lds
  s_waitcnt vmcnt(24)
  s_barrier
  s_waitcnt lgkmcnt(0)
  v_mfma_f32_16x16x32_bf16 v[80:83], a[84:87], v[144:147], v[80:83]
  ds_read2st64_b64 v[128:131], v12 offset0:16 offset1:17
  v_mul_f32 v232, v44, v198
  v_mul_f32 v234, v48, v198
  v_mfma_f32_16x16x32_bf16 v[84:87], a[88:91], v[144:147], v[84:87]
  v_mul_f32 v236, v52, v198
  v_mul_f32 v233, v45, v198
  v_mul_f32 v235, v49, v198
  v_mfma_f32_16x16x32_bf16 v[88:91], a[92:95], v[144:147], v[88:91]
  v_mul_f32 v237, v53, v198
  v_exp_f32 v232, v232
  v_mfma_f32_16x16x32_bf16 v[92:95], a[84:87], v[148:151], v[92:95]
  ds_read2st64_b64 v[132:135], v13 offset0:16 offset1:17
  v_exp_f32 v234, v234
  v_mfma_f32_16x16x32_bf16 v[96:99], a[88:91], v[148:151], v[96:99]
  v_exp_f32 v236, v236
  v_fma_f32 v46, -v196, v18, v46
  v_mfma_f32_16x16x32_bf16 v[100:103], a[92:95], v[148:151], v[100:103]
  v_fma_f32 v50, -v196, v22, v50
  v_fma_f32 v54, -v196, v26, v54
  v_exp_f32 v233, v233
  v_mfma_f32_16x16x32_bf16 v[104:107], a[84:87], v[152:155], v[104:107]
  ds_read2st64_b64 v[136:139], v14 offset0:16 offset1:17
  v_exp_f32 v235, v235
  v_mfma_f32_16x16x32_bf16 v[108:111], a[88:91], v[152:155], v[108:111]
  v_exp_f32 v237, v237
  v_fma_f32 v47, -v196, v19, v47
  v_mfma_f32_16x16x32_bf16 v[112:115], a[92:95], v[152:155], v[112:115]
  v_fma_f32 v51, -v196, v23, v51
  v_fma_f32 v55, -v196, v27, v55
  v_mul_f32 v44, v44, v46
  v_mfma_f32_16x16x32_bf16 v[116:119], a[84:87], v[156:159], v[116:119]
  ds_read2st64_b64 v[140:143], v15 offset0:16 offset1:17
  buffer_load_dwordx4 a[72:75], v2, s[68:71], s11 offen offset:2048 sc1
  v_mfma_f32_16x16x32_bf16 v[120:123], a[88:91], v[156:159], v[120:123]
  buffer_load_dwordx4 a[76:79], v2, s[68:71], s11 offen offset:3072 sc1
  v_mfma_f32_16x16x32_bf16 v[124:127], a[92:95], v[156:159], v[124:127]
  s_add_u32 s11, s22, 20480
  buffer_load_dwordx4 a[80:83], v2, s[68:71], s11 offen offset:0 sc1
  buffer_load_dwordx4 v2, s[44:47], s10 offen offset:3072 sc1 lds
  s_waitcnt vmcnt(24)
  s_barrier
  s_waitcnt lgkmcnt(0)
  v_mfma_f32_16x16x32_bf16 v[80:83], a[96:99], v[128:131], v[80:83]
  ds_read2st64_b64 v[144:147], v12 offset0:18 offset1:19
  v_mul_f32 v48, v48, v50
  v_mul_f32 v52, v52, v54
  v_mfma_f32_16x16x32_bf16 v[84:87], a[100:103], v[128:131], v[84:87]
  v_mul_f32 v45, v45, v47
  v_mul_f32 v49, v49, v51
  v_mul_f32 v53, v53, v55
  v_mfma_f32_16x16x32_bf16 v[88:91], a[104:107], v[128:131], v[88:91]
  v_fma_f32 v232, v232, v197, v197
  v_fma_f32 v234, v234, v197, v197
  v_fma_f32 v236, v236, v197, v197
  v_mfma_f32_16x16x32_bf16 v[92:95], a[96:99], v[132:135], v[92:95]
  ds_read2st64_b64 v[148:151], v13 offset0:18 offset1:19
  v_fma_f32 v233, v233, v197, v197
  v_fma_f32 v235, v235, v197, v197
  v_mfma_f32_16x16x32_bf16 v[96:99], a[100:103], v[132:135], v[96:99]
  v_fma_f32 v237, v237, v197, v197
  v_rcp_f32 v232, v232
  v_mfma_f32_16x16x32_bf16 v[100:103], a[104:107], v[132:135], v[100:103]
  v_rcp_f32 v234, v234
  v_rcp_f32 v236, v236
  v_mfma_f32_16x16x32_bf16 v[104:107], a[96:99], v[136:139], v[104:107]
  ds_read2st64_b64 v[152:155], v14 offset0:18 offset1:19
  v_rcp_f32 v233, v233
  v_mfma_f32_16x16x32_bf16 v[108:111], a[100:103], v[136:139], v[108:111]
  v_rcp_f32 v235, v235
  v_rcp_f32 v237, v237
  v_mfma_f32_16x16x32_bf16 v[112:115], a[104:107], v[136:139], v[112:115]
  v_mul_f32 v44, v44, v232
  v_mul_f32 v48, v48, v234
  v_mul_f32 v52, v52, v236
  v_mfma_f32_16x16x32_bf16 v[116:119], a[96:99], v[140:143], v[116:119]
  ds_read2st64_b64 v[156:159], v15 offset0:18 offset1:19
  buffer_load_dwordx4 a[84:87], v2, s[68:71], s11 offen offset:1024 sc1
  v_mfma_f32_16x16x32_bf16 v[120:123], a[100:103], v[140:143], v[120:123]
  buffer_load_dwordx4 a[88:91], v2, s[68:71], s11 offen offset:2048 sc1
  v_mfma_f32_16x16x32_bf16 v[124:127], a[104:107], v[140:143], v[124:127]
  buffer_load_dwordx4 a[92:95], v2, s[68:71], s11 offen offset:3072 sc1
  s_add_u32 m0, s6, 98304
  s_add_u32 s10, s7, 98304
  buffer_load_dwordx4 v2, s[44:47], s10 offen offset:0 sc1 lds
  s_waitcnt vmcnt(24)
  s_barrier
  s_waitcnt lgkmcnt(0)
  v_mfma_f32_16x16x32_bf16 v[80:83], a[108:111], v[144:147], v[80:83]
  ds_read2st64_b64 v[128:131], v12 offset0:20 offset1:21
  v_mul_f32 v45, v45, v233
  v_mul_f32 v49, v49, v235
  v_mfma_f32_16x16x32_bf16 v[84:87], a[112:115], v[144:147], v[84:87]
  v_mul_f32 v53, v53, v237
  v_cvt_pk_bf16_f32 v228, v44, v45
  v_cvt_pk_bf16_f32 v229, v48, v49
  v_mfma_f32_16x16x32_bf16 v[88:91], a[116:119], v[144:147], v[88:91]
  v_cvt_pk_bf16_f32 v230, v52, v53
  v_add_u32 v6, v9, v181
  ds_write_b32 v6, v228 offset:12
  v_mfma_f32_16x16x32_bf16 v[92:95], a[108:111], v[148:151], v[92:95]
  ds_read2st64_b64 v[132:135], v13 offset0:20 offset1:21
  ds_write_b32 v6, v229 offset:1036
  ds_write_b32 v6, v230 offset:2060
  v_mfma_f32_16x16x32_bf16 v[96:99], a[112:115], v[148:151], v[96:99]
  v_fma_f32 v56, -v200, v16, v56
  v_fma_f32 v60, -v200, v20, v60
  v_fma_f32 v64, -v200, v24, v64
  v_mfma_f32_16x16x32_bf16 v[100:103], a[116:119], v[148:151], v[100:103]
  v_fma_f32 v57, -v200, v17, v57
  v_fma_f32 v61, -v200, v21, v61
  v_fma_f32 v65, -v200, v25, v65
  v_mfma_f32_16x16x32_bf16 v[104:107], a[108:111], v[152:155], v[104:107]
  ds_read2st64_b64 v[136:139], v14 offset0:20 offset1:21
  v_mul_f32 v232, v56, v202
  v_mul_f32 v234, v60, v202
  v_mfma_f32_16x16x32_bf16 v[108:111], a[112:115], v[152:155], v[108:111]
  v_mul_f32 v236, v64, v202
  v_mul_f32 v233, v57, v202
  v_mul_f32 v235, v61, v202
  v_mfma_f32_16x16x32_bf16 v[112:115], a[116:119], v[152:155], v[112:115]
  v_mul_f32 v237, v65, v202
  v_exp_f32 v232, v232
  v_mfma_f32_16x16x32_bf16 v[116:119], a[108:111], v[156:159], v[116:119]
  ds_read2st64_b64 v[140:143], v15 offset0:20 offset1:21
  s_add_u32 s11, s22, 24576
  buffer_load_dwordx4 a[96:99], v2, s[68:71], s11 offen offset:0 sc1
  v_mfma_f32_16x16x32_bf16 v[120:123], a[112:115], v[156:159], v[120:123]
  buffer_load_dwordx4 a[100:103], v2, s[68:71], s11 offen offset:1024 sc1
  v_mfma_f32_16x16x32_bf16 v[124:127], a[116:119], v[156:159], v[124:127]
  buffer_load_dwordx4 a[104:107], v2, s[68:71], s11 offen offset:2048 sc1
  buffer_load_dwordx4 v2, s[44:47], s10 offen offset:1024 sc1 lds
  s_waitcnt vmcnt(24)
  s_barrier
  s_waitcnt lgkmcnt(0)
  v_mfma_f32_16x16x32_bf16 v[80:83], a[120:123], v[128:131], v[80:83]
  ds_read2st64_b64 v[144:147], v12 offset0:22 offset1:23
  v_exp_f32 v234, v234
  v_mfma_f32_16x16x32_bf16 v[84:87], a[124:127], v[128:131], v[84:87]
  v_exp_f32 v236, v236
  v_fma_f32 v58, -v200, v18, v58
  v_mfma_f32_16x16x32_bf16 v[88:91], a[128:131], v[128:131], v[88:91]
  v_fma_f32 v62, -v200, v22, v62
  v_fma_f32 v66, -v200, v26, v66
  v_exp_f32 v233, v233
  v_mfma_f32_16x16x32_bf16 v[92:95], a[120:123], v[132:135], v[92:95]
  ds_read2st64_b64 v[148:151], v13 offset0:22 offset1:23
  v_exp_f32 v235, v235
  v_mfma_f32_16x16x32_bf16 v[96:99], a[124:127], v[132:135], v[96:99]
  v_exp_f32 v237, v237
  v_fma_f32 v59, -v200, v19, v59
  v_mfma_f32_16x16x32_bf16 v[100:103], a[128:131], v[132:135], v[100:103]
  v_fma_f32 v63, -v200, v23, v63
  v_fma_f32 v67, -v200, v27, v67
  v_mul_f32 v56, v56, v58
  v_mfma_f32_16x16x32_bf16 v[104:107], a[120:123], v[136:139], v[104:107]
  ds_read2st64_b64 v[152:155], v14 offset0:22 offset1:23
  v_mul_f32 v60, v60, v62
  v_mul_f32 v64, v64, v66
  v_mfma_f32_16x16x32_bf16 v[108:111], a[124:127], v[136:139], v[108:111]
  v_mul_f32 v57, v57, v59
  v_mul_f32 v61, v61, v63
  v_mul_f32 v65, v65, v67
  v_mfma_f32_16x16x32_bf16 v[112:115], a[128:131], v[136:139], v[112:115]
  v_fma_f32 v232, v232, v201, v201
  v_fma_f32 v234, v234, v201, v201
  v_fma_f32 v236, v236, v201, v201
  v_mfma_f32_16x16x32_bf16 v[116:119], a[120:123], v[140:143], v[116:119]
  ds_read2st64_b64 v[156:159], v15 offset0:22 offset1:23
  buffer_load_dwordx4 a[108:111], v2, s[68:71], s11 offen offset:3072 sc1
  v_mfma_f32_16x16x32_bf16 v[120:123], a[124:127], v[140:143], v[120:123]
  s_add_u32 s11, s22, 28672
  buffer_load_dwordx4 a[112:115], v2, s[68:71], s11 offen offset:0 sc1
  v_mfma_f32_16x16x32_bf16 v[124:127], a[128:131], v[140:143], v[124:127]
  buffer_load_dwordx4 a[116:119], v2, s[68:71], s11 offen offset:1024 sc1
  buffer_load_dwordx4 v2, s[44:47], s10 offen offset:2048 sc1 lds
  s_waitcnt vmcnt(24)
  v_fma_f32 v233, v233, v201, v201
  v_fma_f32 v235, v235, v201, v201
  v_fma_f32 v237, v237, v201, v201
  v_rcp_f32 v232, v232
  v_rcp_f32 v234, v234
  v_rcp_f32 v236, v236
  v_rcp_f32 v233, v233
  v_rcp_f32 v235, v235
  v_rcp_f32 v237, v237
  v_mul_f32 v56, v56, v232
  v_mul_f32 v60, v60, v234
  v_mul_f32 v64, v64, v236
  v_mul_f32 v57, v57, v233
  v_mul_f32 v61, v61, v235
  v_mul_f32 v65, v65, v237
  v_cvt_pk_bf16_f32 v224, v56, v57
  v_cvt_pk_bf16_f32 v225, v60, v61
  v_cvt_pk_bf16_f32 v226, v64, v65
  v_add_u32 v6, v10, v181
  ds_write_b32 v6, v224 offset:12
  ds_write_b32 v6, v225 offset:1036
  ds_write_b32 v6, v226 offset:2060
  v_fma_f32 v68, -v204, v16, v68
  v_fma_f32 v72, -v204, v20, v72
  v_fma_f32 v76, -v204, v24, v76
  v_fma_f32 v69, -v204, v17, v69
  v_fma_f32 v73, -v204, v21, v73
  v_fma_f32 v77, -v204, v25, v77
  v_mul_f32 v232, v68, v206
  v_mul_f32 v234, v72, v206
  v_mul_f32 v236, v76, v206
  v_mul_f32 v233, v69, v206
  v_mul_f32 v235, v73, v206
  v_mul_f32 v237, v77, v206
  v_exp_f32 v232, v232
  v_exp_f32 v234, v234
  v_exp_f32 v236, v236
  v_fma_f32 v70, -v204, v18, v70
  v_fma_f32 v74, -v204, v22, v74
  v_fma_f32 v78, -v204, v26, v78
  v_exp_f32 v233, v233
  v_exp_f32 v235, v235
  v_exp_f32 v237, v237
  v_fma_f32 v71, -v204, v19, v71
  v_fma_f32 v75, -v204, v23, v75
  v_fma_f32 v79, -v204, v27, v79
  v_mul_f32 v68, v68, v70
  v_mul_f32 v72, v72, v74
  v_mul_f32 v76, v76, v78
  v_mul_f32 v69, v69, v71
  v_mul_f32 v73, v73, v75
  v_mul_f32 v77, v77, v79
  v_fma_f32 v232, v232, v205, v205
  v_fma_f32 v234, v234, v205, v205
  v_fma_f32 v236, v236, v205, v205
  v_fma_f32 v233, v233, v205, v205
  v_fma_f32 v235, v235, v205, v205
  v_fma_f32 v237, v237, v205, v205
  v_rcp_f32 v232, v232
  v_rcp_f32 v234, v234
  v_rcp_f32 v236, v236
  v_rcp_f32 v233, v233
  v_rcp_f32 v235, v235
  v_rcp_f32 v237, v237
  v_mul_f32 v68, v68, v232
  v_mul_f32 v72, v72, v234
  v_mul_f32 v76, v76, v236
  v_mul_f32 v69, v69, v233
  v_mul_f32 v73, v73, v235
  v_mul_f32 v77, v77, v237
  v_cvt_pk_bf16_f32 v228, v68, v69
  v_cvt_pk_bf16_f32 v229, v72, v73
  v_cvt_pk_bf16_f32 v230, v76, v77
  v_add_u32 v6, v11, v181
  ds_write_b32 v6, v228 offset:12
  ds_write_b32 v6, v229 offset:1036
  ds_write_b32 v6, v230 offset:2060
  s_waitcnt lgkmcnt(0)
  s_barrier
  ds_read_b128 v[160:163], v31 offset:0
  ds_read_b128 v[164:167], v31 offset:1024
  ds_read_b128 v[168:171], v31 offset:2048
  v_mfma_f32_16x16x32_bf16 v[80:83], a[132:135], v[144:147], v[80:83]
  ds_read2st64_b64 v[128:131], v12 offset0:24 offset1:25
  v_mfma_f32_16x16x32_bf16 v[84:87], a[136:139], v[144:147], v[84:87]
  v_mfma_f32_16x16x32_bf16 v[88:91], a[140:143], v[144:147], v[88:91]
  v_mfma_f32_16x16x32_bf16 v[92:95], a[132:135], v[148:151], v[92:95]
  ds_read2st64_b64 v[132:135], v13 offset0:24 offset1:25
  v_mfma_f32_16x16x32_bf16 v[96:99], a[136:139], v[148:151], v[96:99]
  v_mfma_f32_16x16x32_bf16 v[100:103], a[140:143], v[148:151], v[100:103]
  v_mfma_f32_16x16x32_bf16 v[104:107], a[132:135], v[152:155], v[104:107]
  ds_read2st64_b64 v[136:139], v14 offset0:24 offset1:25
  v_mfma_f32_16x16x32_bf16 v[108:111], a[136:139], v[152:155], v[108:111]
  v_mfma_f32_16x16x32_bf16 v[112:115], a[140:143], v[152:155], v[112:115]
  v_mfma_f32_16x16x32_bf16 v[116:119], a[132:135], v[156:159], v[116:119]
  ds_read2st64_b64 v[140:143], v15 offset0:24 offset1:25
  buffer_load_dwordx4 a[120:123], v2, s[68:71], s11 offen offset:2048 sc1
  v_mfma_f32_16x16x32_bf16 v[120:123], a[136:139], v[156:159], v[120:123]
  buffer_load_dwordx4 a[124:127], v2, s[68:71], s11 offen offset:3072 sc1
  v_mfma_f32_16x16x32_bf16 v[124:127], a[140:143], v[156:159], v[124:127]
  s_add_u32 s11, s22, 32768
  buffer_load_dwordx4 a[128:131], v2, s[68:71], s11 offen offset:0 sc1
  buffer_load_dwordx4 v2, s[44:47], s10 offen offset:3072 sc1 lds
  s_waitcnt vmcnt(24)
  s_barrier
  s_waitcnt lgkmcnt(4)
  buffer_store_dwordx4 v[160:163], v2, s[56:59], s60 offen offset:0 sc1
  buffer_store_dwordx4 v[164:167], v2, s[56:59], s60 offen offset:1024 sc1
  buffer_store_dwordx4 v[168:171], v2, s[56:59], s60 offen offset:2048 sc1
  s_waitcnt lgkmcnt(0)
  v_mfma_f32_16x16x32_bf16 v[80:83], a[144:147], v[128:131], v[80:83]
  ds_read2st64_b64 v[144:147], v12 offset0:26 offset1:27
  v_mfma_f32_16x16x32_bf16 v[84:87], a[148:151], v[128:131], v[84:87]
  v_mfma_f32_16x16x32_bf16 v[88:91], a[152:155], v[128:131], v[88:91]
  v_mfma_f32_16x16x32_bf16 v[92:95], a[144:147], v[132:135], v[92:95]
  ds_read2st64_b64 v[148:151], v13 offset0:26 offset1:27
  v_mfma_f32_16x16x32_bf16 v[96:99], a[148:151], v[132:135], v[96:99]
  v_mfma_f32_16x16x32_bf16 v[100:103], a[152:155], v[132:135], v[100:103]
  v_mfma_f32_16x16x32_bf16 v[104:107], a[144:147], v[136:139], v[104:107]
  ds_read2st64_b64 v[152:155], v14 offset0:26 offset1:27
  v_mfma_f32_16x16x32_bf16 v[108:111], a[148:151], v[136:139], v[108:111]
  v_mfma_f32_16x16x32_bf16 v[112:115], a[152:155], v[136:139], v[112:115]
  v_mfma_f32_16x16x32_bf16 v[116:119], a[144:147], v[140:143], v[116:119]
  ds_read2st64_b64 v[156:159], v15 offset0:26 offset1:27
  buffer_load_dwordx4 a[132:135], v2, s[68:71], s11 offen offset:1024 sc1
  v_mfma_f32_16x16x32_bf16 v[120:123], a[148:151], v[140:143], v[120:123]
  buffer_load_dwordx4 a[136:139], v2, s[68:71], s11 offen offset:2048 sc1
  v_mfma_f32_16x16x32_bf16 v[124:127], a[152:155], v[140:143], v[124:127]
  buffer_load_dwordx4 a[140:143], v2, s[68:71], s11 offen offset:3072 sc1
  s_waitcnt vmcnt(26)
  s_barrier
  s_waitcnt lgkmcnt(0)
  v_mfma_f32_16x16x32_bf16 v[80:83], a[156:159], v[144:147], v[80:83]
  ds_read2st64_b64 v[128:131], v12 offset0:28 offset1:29
  v_mfma_f32_16x16x32_bf16 v[84:87], a[160:163], v[144:147], v[84:87]
  v_mfma_f32_16x16x32_bf16 v[88:91], a[164:167], v[144:147], v[88:91]
  v_mfma_f32_16x16x32_bf16 v[92:95], a[156:159], v[148:151], v[92:95]
  ds_read2st64_b64 v[132:135], v13 offset0:28 offset1:29
  v_mfma_f32_16x16x32_bf16 v[96:99], a[160:163], v[148:151], v[96:99]
  v_mfma_f32_16x16x32_bf16 v[100:103], a[164:167], v[148:151], v[100:103]
  v_mfma_f32_16x16x32_bf16 v[104:107], a[156:159], v[152:155], v[104:107]
  ds_read2st64_b64 v[136:139], v14 offset0:28 offset1:29
  v_mfma_f32_16x16x32_bf16 v[108:111], a[160:163], v[152:155], v[108:111]
  v_mfma_f32_16x16x32_bf16 v[112:115], a[164:167], v[152:155], v[112:115]
  v_mfma_f32_16x16x32_bf16 v[116:119], a[156:159], v[156:159], v[116:119]
  ds_read2st64_b64 v[140:143], v15 offset0:28 offset1:29
  s_add_u32 s11, s22, 36864
  buffer_load_dwordx4 a[144:147], v2, s[68:71], s11 offen offset:0 sc1
  v_mfma_f32_16x16x32_bf16 v[120:123], a[160:163], v[156:159], v[120:123]
  buffer_load_dwordx4 a[148:151], v2, s[68:71], s11 offen offset:1024 sc1
  v_mfma_f32_16x16x32_bf16 v[124:127], a[164:167], v[156:159], v[124:127]
  buffer_load_dwordx4 a[152:155], v2, s[68:71], s11 offen offset:2048 sc1
  buffer_load_dwordx2 v[176:177], v186, s[72:75], s24 offen offset:512 sc1
  s_waitcnt vmcnt(26)
  s_barrier
  s_waitcnt lgkmcnt(0)
  v_mfma_f32_16x16x32_bf16 v[80:83], a[168:171], v[128:131], v[80:83]
  ds_read2st64_b64 v[144:147], v12 offset0:30 offset1:31
  v_mfma_f32_16x16x32_bf16 v[84:87], a[172:175], v[128:131], v[84:87]
  v_mfma_f32_16x16x32_bf16 v[88:91], a[176:179], v[128:131], v[88:91]
  v_mfma_f32_16x16x32_bf16 v[92:95], a[168:171], v[132:135], v[92:95]
  ds_read2st64_b64 v[148:151], v13 offset0:30 offset1:31
  v_mfma_f32_16x16x32_bf16 v[96:99], a[172:175], v[132:135], v[96:99]
  v_mfma_f32_16x16x32_bf16 v[100:103], a[176:179], v[132:135], v[100:103]
  v_mfma_f32_16x16x32_bf16 v[104:107], a[168:171], v[136:139], v[104:107]
  ds_read2st64_b64 v[152:155], v14 offset0:30 offset1:31
  v_mfma_f32_16x16x32_bf16 v[108:111], a[172:175], v[136:139], v[108:111]
  v_mfma_f32_16x16x32_bf16 v[112:115], a[176:179], v[136:139], v[112:115]
  v_mfma_f32_16x16x32_bf16 v[116:119], a[168:171], v[140:143], v[116:119]
  ds_read2st64_b64 v[156:159], v15 offset0:30 offset1:31
  buffer_load_dwordx4 a[156:159], v2, s[68:71], s11 offen offset:3072 sc1
  v_mfma_f32_16x16x32_bf16 v[120:123], a[172:175], v[140:143], v[120:123]
  s_add_u32 s11, s22, 40960
  buffer_load_dwordx4 a[160:163], v2, s[68:71], s11 offen offset:0 sc1
  v_mfma_f32_16x16x32_bf16 v[124:127], a[176:179], v[140:143], v[124:127]
  buffer_load_dwordx4 a[164:167], v2, s[68:71], s11 offen offset:1024 sc1
  s_waitcnt vmcnt(25)
  s_barrier
  s_waitcnt lgkmcnt(0)
  v_mfma_f32_16x16x32_bf16 v[80:83], a[180:183], v[144:147], v[80:83]
  ds_read2st64_b64 v[128:131], v12 offset0:32 offset1:33
  v_mfma_f32_16x16x32_bf16 v[84:87], a[184:187], v[144:147], v[84:87]
  v_mfma_f32_16x16x32_bf16 v[88:91], a[188:191], v[144:147], v[88:91]
  v_mfma_f32_16x16x32_bf16 v[92:95], a[180:183], v[148:151], v[92:95]
  ds_read2st64_b64 v[132:135], v13 offset0:32 offset1:33
  v_mfma_f32_16x16x32_bf16 v[96:99], a[184:187], v[148:151], v[96:99]
  v_mfma_f32_16x16x32_bf16 v[100:103], a[188:191], v[148:151], v[100:103]
  v_mfma_f32_16x16x32_bf16 v[104:107], a[180:183], v[152:155], v[104:107]
  ds_read2st64_b64 v[136:139], v14 offset0:32 offset1:33
  v_mfma_f32_16x16x32_bf16 v[108:111], a[184:187], v[152:155], v[108:111]
  v_mfma_f32_16x16x32_bf16 v[112:115], a[188:191], v[152:155], v[112:115]
  v_mfma_f32_16x16x32_bf16 v[116:119], a[180:183], v[156:159], v[116:119]
  ds_read2st64_b64 v[140:143], v15 offset0:32 offset1:33
  buffer_load_dwordx4 a[168:171], v2, s[68:71], s11 offen offset:2048 sc1
  v_mfma_f32_16x16x32_bf16 v[120:123], a[184:187], v[156:159], v[120:123]
  buffer_load_dwordx4 a[172:175], v2, s[68:71], s11 offen offset:3072 sc1
  v_mfma_f32_16x16x32_bf16 v[124:127], a[188:191], v[156:159], v[124:127]
  s_add_u32 s11, s22, 45056
  buffer_load_dwordx4 a[176:179], v2, s[68:71], s11 offen offset:0 sc1
  s_waitcnt vmcnt(24)
  s_waitcnt vmcnt(13)
  s_barrier
  s_waitcnt lgkmcnt(0)
  v_mfma_f32_16x16x32_bf16 v[80:83], a[192:195], v[128:131], v[80:83]
  ds_read2st64_b64 v[144:147], v12 offset0:34 offset1:35
  v_mfma_f32_16x16x32_bf16 v[84:87], a[196:199], v[128:131], v[84:87]
  v_mfma_f32_16x16x32_bf16 v[88:91], a[200:203], v[128:131], v[88:91]
  v_mfma_f32_16x16x32_bf16 v[92:95], a[192:195], v[132:135], v[92:95]
  ds_read2st64_b64 v[148:151], v13 offset0:34 offset1:35
  v_mfma_f32_16x16x32_bf16 v[96:99], a[196:199], v[132:135], v[96:99]
  v_mfma_f32_16x16x32_bf16 v[100:103], a[200:203], v[132:135], v[100:103]
  v_mfma_f32_16x16x32_bf16 v[104:107], a[192:195], v[136:139], v[104:107]
  ds_read2st64_b64 v[152:155], v14 offset0:34 offset1:35
  v_mfma_f32_16x16x32_bf16 v[108:111], a[196:199], v[136:139], v[108:111]
  v_mfma_f32_16x16x32_bf16 v[112:115], a[200:203], v[136:139], v[112:115]
  v_mfma_f32_16x16x32_bf16 v[116:119], a[192:195], v[140:143], v[116:119]
  ds_read2st64_b64 v[156:159], v15 offset0:34 offset1:35
  buffer_load_dwordx4 a[180:183], v2, s[68:71], s11 offen offset:1024 sc1
  v_mfma_f32_16x16x32_bf16 v[120:123], a[196:199], v[140:143], v[120:123]
  buffer_load_dwordx4 a[184:187], v2, s[68:71], s11 offen offset:2048 sc1
  v_mfma_f32_16x16x32_bf16 v[124:127], a[200:203], v[140:143], v[124:127]
  buffer_load_dwordx4 a[188:191], v2, s[68:71], s11 offen offset:3072 sc1
  s_barrier
  s_waitcnt lgkmcnt(0)
  v_mfma_f32_16x16x32_bf16 v[80:83], a[204:207], v[144:147], v[80:83]
  ds_read2st64_b64 v[128:131], v12 offset0:36 offset1:37
  v_mfma_f32_16x16x32_bf16 v[84:87], a[208:211], v[144:147], v[84:87]
  v_mfma_f32_16x16x32_bf16 v[88:91], a[212:215], v[144:147], v[88:91]
  v_mfma_f32_16x16x32_bf16 v[92:95], a[204:207], v[148:151], v[92:95]
  ds_read2st64_b64 v[132:135], v13 offset0:36 offset1:37
  v_mfma_f32_16x16x32_bf16 v[96:99], a[208:211], v[148:151], v[96:99]
  v_mfma_f32_16x16x32_bf16 v[100:103], a[212:215], v[148:151], v[100:103]
  v_mfma_f32_16x16x32_bf16 v[104:107], a[204:207], v[152:155], v[104:107]
  ds_read2st64_b64 v[136:139], v14 offset0:36 offset1:37
  v_mfma_f32_16x16x32_bf16 v[108:111], a[208:211], v[152:155], v[108:111]
  v_mfma_f32_16x16x32_bf16 v[112:115], a[212:215], v[152:155], v[112:115]
  v_mfma_f32_16x16x32_bf16 v[116:119], a[204:207], v[156:159], v[116:119]
  ds_read2st64_b64 v[140:143], v15 offset0:36 offset1:37
  s_add_u32 s11, s22, 49152
  buffer_load_dwordx4 a[192:195], v2, s[68:71], s11 offen offset:0 sc1
  v_mfma_f32_16x16x32_bf16 v[120:123], a[208:211], v[156:159], v[120:123]
  buffer_load_dwordx4 a[196:199], v2, s[68:71], s11 offen offset:1024 sc1
  v_mfma_f32_16x16x32_bf16 v[124:127], a[212:215], v[156:159], v[124:127]
  buffer_load_dwordx4 a[200:203], v2, s[68:71], s11 offen offset:2048 sc1
  s_mov_b32 s35, 0
  s_nop 5
K3_STCHK13:
  s_waitcnt vmcnt(12)
  v_cmp_eq_u32 vcc, 0, v177
  s_nop 4
  s_cbranch_vccz K3_STOK13
  s_add_u32 s35, s35, 1
  s_cmp_ge_u32 s35, 0x4000
  s_cbranch_scc1 K3_STOK13
  s_sleep 2
  buffer_load_dwordx2 v[176:177], v186, s[72:75], s24 offen offset:512 sc1
  s_waitcnt vmcnt(0)
  s_branch K3_STCHK13
K3_STOK13:
  s_barrier
  s_waitcnt lgkmcnt(0)
  v_mfma_f32_16x16x32_bf16 v[80:83], a[216:219], v[128:131], v[80:83]
  ds_read2st64_b64 v[144:147], v12 offset0:38 offset1:39
  ds_write_b64 v183, v[176:177] offset:4608
  ds_read_b64 v[208:209], v184 offset:4992
  v_mfma_f32_16x16x32_bf16 v[84:87], a[220:223], v[128:131], v[84:87]
  ds_read_b64 v[212:213], v184 offset:4608
  ds_read_b64 v[216:217], v184 offset:4736
  ds_read_b64 v[220:221], v184 offset:4864
  v_mfma_f32_16x16x32_bf16 v[88:91], a[224:227], v[128:131], v[88:91]
  s_waitcnt lgkmcnt(0)
  v_rcp_f32 v210, v209
  v_rcp_f32 v214, v213
  v_mfma_f32_16x16x32_bf16 v[92:95], a[216:219], v[132:135], v[92:95]
  ds_read2st64_b64 v[148:151], v13 offset0:38 offset1:39
  v_rcp_f32 v218, v217
  v_rcp_f32 v222, v221
  v_mfma_f32_16x16x32_bf16 v[96:99], a[220:223], v[132:135], v[96:99]
  v_mul_f32 v209, v209, v209
  v_mul_f32 v213, v213, v213
  v_mul_f32 v217, v217, v217
  v_mfma_f32_16x16x32_bf16 v[100:103], a[224:227], v[132:135], v[100:103]
  v_mul_f32 v221, v221, v221
  v_mul_f32 v210, v210, v4
  v_mul_f32 v214, v214, v4
  v_mfma_f32_16x16x32_bf16 v[104:107], a[216:219], v[136:139], v[104:107]
  ds_read2st64_b64 v[152:155], v14 offset0:38 offset1:39
  v_mul_f32 v218, v218, v4
  v_mul_f32 v222, v222, v4
  v_mfma_f32_16x16x32_bf16 v[108:111], a[220:223], v[136:139], v[108:111]
  v_mfma_f32_16x16x32_bf16 v[112:115], a[224:227], v[136:139], v[112:115]
  v_mfma_f32_16x16x32_bf16 v[116:119], a[216:219], v[140:143], v[116:119]
  ds_read2st64_b64 v[156:159], v15 offset0:38 offset1:39
  buffer_load_dwordx4 a[204:207], v2, s[68:71], s11 offen offset:3072 sc1
  v_mfma_f32_16x16x32_bf16 v[120:123], a[220:223], v[140:143], v[120:123]
  s_add_u32 s11, s22, 53248
  buffer_load_dwordx4 a[208:211], v2, s[68:71], s11 offen offset:0 sc1
  v_mfma_f32_16x16x32_bf16 v[124:127], a[224:227], v[140:143], v[124:127]
  buffer_load_dwordx4 a[212:215], v2, s[68:71], s11 offen offset:1024 sc1
  buffer_load_dword v30, v29, s[72:75], s63 offen sc1
  s_waitcnt lgkmcnt(0)
  v_mfma_f32_16x16x32_bf16 v[80:83], a[228:231], v[144:147], v[80:83]
  v_mfma_f32_16x16x32_bf16 v[84:87], a[232:235], v[144:147], v[84:87]
  v_mfma_f32_16x16x32_bf16 v[88:91], a[236:239], v[144:147], v[88:91]
  v_mfma_f32_16x16x32_bf16 v[92:95], a[228:231], v[148:151], v[92:95]
  v_mfma_f32_16x16x32_bf16 v[96:99], a[232:235], v[148:151], v[96:99]
  v_mfma_f32_16x16x32_bf16 v[100:103], a[236:239], v[148:151], v[100:103]
  v_mfma_f32_16x16x32_bf16 v[104:107], a[228:231], v[152:155], v[104:107]
  v_mfma_f32_16x16x32_bf16 v[108:111], a[232:235], v[152:155], v[108:111]
  v_mfma_f32_16x16x32_bf16 v[112:115], a[236:239], v[152:155], v[112:115]
  v_mfma_f32_16x16x32_bf16 v[116:119], a[228:231], v[156:159], v[116:119]
  buffer_load_dwordx4 a[216:219], v2, s[68:71], s11 offen offset:2048 sc1
  v_mfma_f32_16x16x32_bf16 v[120:123], a[232:235], v[156:159], v[120:123]
  buffer_load_dwordx4 a[220:223], v2, s[68:71], s11 offen offset:3072 sc1
  v_mfma_f32_16x16x32_bf16 v[124:127], a[236:239], v[156:159], v[124:127]
  s_add_u32 s11, s22, 57344
  buffer_load_dwordx4 a[224:227], v2, s[68:71], s11 offen offset:0 sc1
  v_pk_fma_f32 v[80:81], v[16:17], v[208:209], v[80:81] op_sel_hi:[1,0,1] neg_lo:[0,1,0] neg_hi:[0,1,0]
  v_pk_fma_f32 v[84:85], v[20:21], v[208:209], v[84:85] op_sel_hi:[1,0,1] neg_lo:[0,1,0] neg_hi:[0,1,0]
  v_pk_fma_f32 v[88:89], v[24:25], v[208:209], v[88:89] op_sel_hi:[1,0,1] neg_lo:[0,1,0] neg_hi:[0,1,0]
  v_pk_fma_f32 v[82:83], v[18:19], v[208:209], v[82:83] op_sel_hi:[1,0,1] neg_lo:[0,1,0] neg_hi:[0,1,0]
  v_pk_fma_f32 v[86:87], v[22:23], v[208:209], v[86:87] op_sel_hi:[1,0,1] neg_lo:[0,1,0] neg_hi:[0,1,0]
  v_pk_fma_f32 v[90:91], v[26:27], v[208:209], v[90:91] op_sel_hi:[1,0,1] neg_lo:[0,1,0] neg_hi:[0,1,0]
  v_pk_mul_f32 v[232:233], v[80:81], v[210:211] op_sel_hi:[1,0]
  v_pk_mul_f32 v[234:235], v[84:85], v[210:211] op_sel_hi:[1,0]
  v_pk_mul_f32 v[236:237], v[88:89], v[210:211] op_sel_hi:[1,0]
  v_exp_f32 v232, v232
  v_exp_f32 v234, v234
  v_exp_f32 v236, v236
  v_exp_f32 v233, v233
  v_exp_f32 v235, v235
  v_exp_f32 v237, v237
  v_pk_mul_f32 v[80:81], v[80:81], v[82:83]
  v_pk_mul_f32 v[84:85], v[84:85], v[86:87]
  v_pk_mul_f32 v[88:89], v[88:89], v[90:91]
  v_pk_fma_f32 v[232:233], v[232:233], v[208:209], v[208:209] op_sel:[0,1,1] op_sel_hi:[1,1,1]
  v_pk_fma_f32 v[234:235], v[234:235], v[208:209], v[208:209] op_sel:[0,1,1] op_sel_hi:[1,1,1]
  v_pk_fma_f32 v[236:237], v[236:237], v[208:209], v[208:209] op_sel:[0,1,1] op_sel_hi:[1,1,1]
  v_rcp_f32 v232, v232
  v_rcp_f32 v234, v234
  v_rcp_f32 v236, v236
  v_rcp_f32 v233, v233
  v_rcp_f32 v235, v235
  v_rcp_f32 v237, v237
  v_pk_mul_f32 v[80:81], v[80:81], v[232:233]
  v_pk_mul_f32 v[84:85], v[84:85], v[234:235]
  v_pk_mul_f32 v[88:89], v[88:89], v[236:237]
  v_cvt_pk_bf16_f32 v224, v80, v81
  v_cvt_pk_bf16_f32 v225, v84, v85
  v_cvt_pk_bf16_f32 v226, v88, v89
  v_add_u32 v6, v12, v181
  ds_write_b32 v6, v224 offset:12
  ds_write_b32 v6, v225 offset:1036
  ds_write_b32 v6, v226 offset:2060
  v_pk_fma_f32 v[92:93], v[16:17], v[212:213], v[92:93] op_sel_hi:[1,0,1] neg_lo:[0,1,0] neg_hi:[0,1,0]
  buffer_load_dwordx4 a[228:231], v2, s[68:71], s11 offen offset:1024 sc1
  v_pk_fma_f32 v[96:97], v[20:21], v[212:213], v[96:97] op_sel_hi:[1,0,1] neg_lo:[0,1,0] neg_hi:[0,1,0]
  v_pk_fma_f32 v[100:101], v[24:25], v[212:213], v[100:101] op_sel_hi:[1,0,1] neg_lo:[0,1,0] neg_hi:[0,1,0]
  v_pk_fma_f32 v[94:95], v[18:19], v[212:213], v[94:95] op_sel_hi:[1,0,1] neg_lo:[0,1,0] neg_hi:[0,1,0]
  v_pk_fma_f32 v[98:99], v[22:23], v[212:213], v[98:99] op_sel_hi:[1,0,1] neg_lo:[0,1,0] neg_hi:[0,1,0]
  v_pk_fma_f32 v[102:103], v[26:27], v[212:213], v[102:103] op_sel_hi:[1,0,1] neg_lo:[0,1,0] neg_hi:[0,1,0]
  v_pk_mul_f32 v[232:233], v[92:93], v[214:215] op_sel_hi:[1,0]
  v_pk_mul_f32 v[234:235], v[96:97], v[214:215] op_sel_hi:[1,0]
  v_pk_mul_f32 v[236:237], v[100:101], v[214:215] op_sel_hi:[1,0]
  v_exp_f32 v232, v232
  v_exp_f32 v234, v234
  v_exp_f32 v236, v236
  v_exp_f32 v233, v233
  v_exp_f32 v235, v235
  v_exp_f32 v237, v237
  v_pk_mul_f32 v[92:93], v[92:93], v[94:95]
  v_pk_mul_f32 v[96:97], v[96:97], v[98:99]
  v_pk_mul_f32 v[100:101], v[100:101], v[102:103]
  v_pk_fma_f32 v[232:233], v[232:233], v[212:213], v[212:213] op_sel:[0,1,1] op_sel_hi:[1,1,1]
  v_pk_fma_f32 v[234:235], v[234:235], v[212:213], v[212:213] op_sel:[0,1,1] op_sel_hi:[1,1,1]
  v_pk_fma_f32 v[236:237], v[236:237], v[212:213], v[212:213] op_sel:[0,1,1] op_sel_hi:[1,1,1]
  v_rcp_f32 v232, v232
  v_rcp_f32 v234, v234
  v_rcp_f32 v236, v236
  v_rcp_f32 v233, v233
  v_rcp_f32 v235, v235
  v_rcp_f32 v237, v237
  v_pk_mul_f32 v[92:93], v[92:93], v[232:233]
  v_pk_mul_f32 v[96:97], v[96:97], v[234:235]
  v_pk_mul_f32 v[100:101], v[100:101], v[236:237]
  v_cvt_pk_bf16_f32 v228, v92, v93
  v_cvt_pk_bf16_f32 v229, v96, v97
  v_cvt_pk_bf16_f32 v230, v100, v101
  v_add_u32 v6, v13, v181
  ds_write_b32 v6, v228 offset:12
  ds_write_b32 v6, v229 offset:1036
  ds_write_b32 v6, v230 offset:2060
  v_pk_fma_f32 v[104:105], v[16:17], v[216:217], v[104:105] op_sel_hi:[1,0,1] neg_lo:[0,1,0] neg_hi:[0,1,0]
  v_pk_fma_f32 v[108:109], v[20:21], v[216:217], v[108:109] op_sel_hi:[1,0,1] neg_lo:[0,1,0] neg_hi:[0,1,0]
  buffer_load_dwordx4 a[232:235], v2, s[68:71], s11 offen offset:2048 sc1
  v_pk_fma_f32 v[112:113], v[24:25], v[216:217], v[112:113] op_sel_hi:[1,0,1] neg_lo:[0,1,0] neg_hi:[0,1,0]
  v_pk_fma_f32 v[106:107], v[18:19], v[216:217], v[106:107] op_sel_hi:[1,0,1] neg_lo:[0,1,0] neg_hi:[0,1,0]
  v_pk_fma_f32 v[110:111], v[22:23], v[216:217], v[110:111] op_sel_hi:[1,0,1] neg_lo:[0,1,0] neg_hi:[0,1,0]
  v_pk_fma_f32 v[114:115], v[26:27], v[216:217], v[114:115] op_sel_hi:[1,0,1] neg_lo:[0,1,0] neg_hi:[0,1,0]
  v_pk_mul_f32 v[232:233], v[104:105], v[218:219] op_sel_hi:[1,0]
  v_pk_mul_f32 v[234:235], v[108:109], v[218:219] op_sel_hi:[1,0]
  v_pk_mul_f32 v[236:237], v[112:113], v[218:219] op_sel_hi:[1,0]
  v_exp_f32 v232, v232
  v_exp_f32 v234, v234
  v_exp_f32 v236, v236
  v_exp_f32 v233, v233
  v_exp_f32 v235, v235
  v_exp_f32 v237, v237
  v_pk_mul_f32 v[104:105], v[104:105], v[106:107]
  v_pk_mul_f32 v[108:109], v[108:109], v[110:111]
  v_pk_mul_f32 v[112:113], v[112:113], v[114:115]
  v_pk_fma_f32 v[232:233], v[232:233], v[216:217], v[216:217] op_sel:[0,1,1] op_sel_hi:[1,1,1]
  v_pk_fma_f32 v[234:235], v[234:235], v[216:217], v[216:217] op_sel:[0,1,1] op_sel_hi:[1,1,1]
  v_pk_fma_f32 v[236:237], v[236:237], v[216:217], v[216:217] op_sel:[0,1,1] op_sel_hi:[1,1,1]
  v_rcp_f32 v232, v232
  v_rcp_f32 v234, v234
  v_rcp_f32 v236, v236
  v_rcp_f32 v233, v233
  v_rcp_f32 v235, v235
  v_rcp_f32 v237, v237
  v_pk_mul_f32 v[104:105], v[104:105], v[232:233]
  v_pk_mul_f32 v[108:109], v[108:109], v[234:235]
  v_pk_mul_f32 v[112:113], v[112:113], v[236:237]
  v_cvt_pk_bf16_f32 v224, v104, v105
  v_cvt_pk_bf16_f32 v225, v108, v109
  v_cvt_pk_bf16_f32 v226, v112, v113
  v_add_u32 v6, v14, v181
  ds_write_b32 v6, v224 offset:12
  ds_write_b32 v6, v225 offset:1036
  ds_write_b32 v6, v226 offset:2060
  v_pk_fma_f32 v[116:117], v[16:17], v[220:221], v[116:117] op_sel_hi:[1,0,1] neg_lo:[0,1,0] neg_hi:[0,1,0]
  v_pk_fma_f32 v[120:121], v[20:21], v[220:221], v[120:121] op_sel_hi:[1,0,1] neg_lo:[0,1,0] neg_hi:[0,1,0]
  v_pk_fma_f32 v[124:125], v[24:25], v[220:221], v[124:125] op_sel_hi:[1,0,1] neg_lo:[0,1,0] neg_hi:[0,1,0]
  buffer_load_dwordx4 a[236:239], v2, s[68:71], s11 offen offset:3072 sc1
  v_pk_fma_f32 v[118:119], v[18:19], v[220:221], v[118:119] op_sel_hi:[1,0,1] neg_lo:[0,1,0] neg_hi:[0,1,0]
  v_pk_fma_f32 v[122:123], v[22:23], v[220:221], v[122:123] op_sel_hi:[1,0,1] neg_lo:[0,1,0] neg_hi:[0,1,0]
  v_pk_fma_f32 v[126:127], v[26:27], v[220:221], v[126:127] op_sel_hi:[1,0,1] neg_lo:[0,1,0] neg_hi:[0,1,0]
  v_pk_mul_f32 v[232:233], v[116:117], v[222:223] op_sel_hi:[1,0]
  v_pk_mul_f32 v[234:235], v[120:121], v[222:223] op_sel_hi:[1,0]
  v_pk_mul_f32 v[236:237], v[124:125], v[222:223] op_sel_hi:[1,0]
  v_exp_f32 v232, v232
  v_exp_f32 v234, v234
  v_exp_f32 v236, v236
  v_exp_f32 v233, v233
  v_exp_f32 v235, v235
  v_exp_f32 v237, v237
  v_pk_mul_f32 v[116:117], v[116:117], v[118:119]
  v_pk_mul_f32 v[120:121], v[120:121], v[122:123]
  v_pk_mul_f32 v[124:125], v[124:125], v[126:127]
  v_pk_fma_f32 v[232:233], v[232:233], v[220:221], v[220:221] op_sel:[0,1,1] op_sel_hi:[1,1,1]
  v_pk_fma_f32 v[234:235], v[234:235], v[220:221], v[220:221] op_sel:[0,1,1] op_sel_hi:[1,1,1]
  v_pk_fma_f32 v[236:237], v[236:237], v[220:221], v[220:221] op_sel:[0,1,1] op_sel_hi:[1,1,1]
  v_rcp_f32 v232, v232
  v_rcp_f32 v234, v234
  v_rcp_f32 v236, v236
  v_rcp_f32 v233, v233
  v_rcp_f32 v235, v235
  v_rcp_f32 v237, v237
  v_pk_mul_f32 v[116:117], v[116:117], v[232:233]
  v_pk_mul_f32 v[120:121], v[120:121], v[234:235]
  v_pk_mul_f32 v[124:125], v[124:125], v[236:237]
  v_cvt_pk_bf16_f32 v228, v116, v117
  v_cvt_pk_bf16_f32 v229, v120, v121
  v_cvt_pk_bf16_f32 v230, v124, v125
  v_add_u32 v6, v15, v181
  ds_write_b32 v6, v228 offset:12
  ds_write_b32 v6, v229 offset:1036
  ds_write_b32 v6, v230 offset:2060
K3_EPIDONE:
  s_waitcnt lgkmcnt(0)
  s_barrier
  v_add_u32 v12, 81920, v31
  ds_read_b128 v[192:195], v12 offset:0
  ds_read_b128 v[196:199], v12 offset:1024
  ds_read_b128 v[200:203], v12 offset:2048
  s_mul_i32 s13, s3, 5120
  v_add_u32 v8, s13, v2
  v_add_u32 v9, 40960, v8
  v_lshrrev_b32 v4, 5, v1
  v_lshlrev_b32 v4, 7, v4
  v_and_b32 v5, 15, v1
  v_lshl_add_u32 v4, v5, 3, v4
  v_bfe_u32 v6, v1, 4, 1
  v_lshl_add_u32 v4, v6, 9, v4
  v_mul_u32_u24 v5, 1280, v5
  v_lshrrev_b32 v7, 4, v1
  v_lshl_add_u32 v5, v7, 3, v5
  s_mul_i32 s16, s18, 5
  s_mul_i32 s17, s18, 160
  s_add_u32 s12, s3, 0
  s_cmp_ge_u32 s12, 5
  s_cselect_b32 s13, 1, 0
  s_mul_i32 s14, s13, 5
  s_sub_u32 s12, s12, s14
  s_mul_i32 s14, s13, 20480
  s_lshl_b32 s15, s12, 10
  s_add_u32 s15, s15, s14
  v_add_u32 v10, s15, v2
  s_add_u32 s13, s13, s23
  s_mul_i32 s13, s13, 20480
  s_add_u32 s14, s12, s16
  s_lshr_b32 s15, s14, 1
  s_lshl_b32 s15, s15, 10
  s_and_b32 s14, s14, 1
  s_lshl_b32 s14, s14, 8
  s_add_u32 s14, s14, s15
  s_add_u32 s24, s13, s14
  s_sub_u32 s15, s24, s20
  v_add_u32 v16, s15, v4
  v_add_u32 v20, 81920, v16
  s_mul_i32 s15, s4, 81920
  s_sub_u32 s13, s13, s15
  s_lshl_b32 s14, s12, 5
  s_add_u32 s14, s14, s17
  s_add_u32 s28, s13, s14
  s_add_u32 s12, s3, 4
  s_cmp_ge_u32 s12, 5
  s_cselect_b32 s13, 1, 0
  s_mul_i32 s14, s13, 5
  s_sub_u32 s12, s12, s14
  s_mul_i32 s14, s13, 20480
  s_lshl_b32 s15, s12, 10
  s_add_u32 s15, s15, s14
  v_add_u32 v11, s15, v2
  s_add_u32 s13, s13, s23
  s_mul_i32 s13, s13, 20480
  s_add_u32 s14, s12, s16
  s_lshr_b32 s15, s14, 1
  s_lshl_b32 s15, s15, 10
  s_and_b32 s14, s14, 1
  s_lshl_b32 s14, s14, 8
  s_add_u32 s14, s14, s15
  s_add_u32 s25, s13, s14
  s_sub_u32 s15, s25, s20
  v_add_u32 v17, s15, v4
  v_add_u32 v21, 81920, v17
  s_mul_i32 s15, s4, 81920
  s_sub_u32 s13, s13, s15
  s_lshl_b32 s14, s12, 5
  s_add_u32 s14, s14, s17
  s_add_u32 s29, s13, s14
  s_add_u32 s12, s3, 8
  s_cmp_ge_u32 s12, 10
  s_cselect_b32 s13, 2, 0
  s_sub_u32 s12, s12, s13
  s_cmp_ge_u32 s12, 5
  s_cselect_b32 s13, 1, 0
  s_mul_i32 s14, s13, 5
  s_sub_u32 s12, s12, s14
  s_mul_i32 s14, s13, 20480
  s_lshl_b32 s15, s12, 10
  s_add_u32 s15, s15, s14
  v_add_u32 v13, s15, v2
  s_add_u32 s13, s13, s23
  s_mul_i32 s13, s13, 20480
  s_add_u32 s14, s12, s16
  s_lshr_b32 s15, s14, 1
  s_lshl_b32 s15, s15, 10
  s_and_b32 s14, s14, 1
  s_lshl_b32 s14, s14, 8
  s_add_u32 s14, s14, s15
  s_add_u32 s26, s13, s14
  s_sub_u32 s15, s26, s20
  v_add_u32 v18, s15, v4
  v_add_u32 v22, 81920, v18
  s_mul_i32 s15, s4, 81920
  s_sub_u32 s13, s13, s15
  s_lshl_b32 s14, s12, 5
  s_add_u32 s14, s14, s17
  s_add_u32 s30, s13, s14
  s_mov_b32 s52, s38
  s_mov_b32 s53, s39
  s_mov_b32 s54, 0x280000
  s_mov_b32 s55, 0x20000
  s_waitcnt lgkmcnt(2)
  buffer_store_dwordx4 v[192:195], v2, s[56:59], s61 offen offset:0 sc1
  s_waitcnt lgkmcnt(1)
  buffer_store_dwordx4 v[196:199], v2, s[56:59], s61 offen offset:1024 sc1
  s_waitcnt lgkmcnt(0)
  buffer_store_dwordx4 v[200:203], v2, s[56:59], s61 offen offset:2048 sc1
  ds_read_b64 v[224:225], v16
  ds_read_b64 v[226:227], v17
  ds_read_b64 v[228:229], v18
  ds_read_b64 v[230:231], v20
  ds_read_b64 v[232:233], v21
  ds_read_b64 v[234:235], v22
  s_waitcnt vmcnt(9)
  s_mov_b32 s35, 0
  s_branch K3_PA_CHK
K3_PA:
  buffer_load_dword v30, v29, s[72:75], s63 offen sc1
  s_waitcnt vmcnt(0)
K3_PA_CHK:
  v_readfirstlane_b32 s14, v30
  s_add_u32 s35, s35, 1
  s_cmp_ge_u32 s14, 4
  s_nop 2
  s_cbranch_scc1 K3_GOA
  s_cmp_lt_u32 s35, 0x8000
  s_cbranch_scc1 K3_PA
K3_GOA:
  s_add_u32 s10, s64, 0
  buffer_load_dwordx4 v[32:35], v2, s[56:59], s10 offen offset:0 sc1
  buffer_load_dwordx4 v[36:39], v2, s[56:59], s10 offen offset:1024 sc1
  buffer_load_dwordx4 v[40:43], v2, s[56:59], s10 offen offset:2048 sc1
  buffer_load_dwordx4 v[44:47], v2, s[56:59], s10 offen offset:3072 sc1
  s_add_u32 s10, s64, 4096
  buffer_load_dwordx4 v[48:51], v2, s[56:59], s10 offen offset:0 sc1
  buffer_load_dwordx4 v[52:55], v2, s[56:59], s10 offen offset:1024 sc1
  buffer_load_dwordx4 v[56:59], v2, s[56:59], s10 offen offset:2048 sc1
  buffer_load_dwordx4 v[60:63], v2, s[56:59], s10 offen offset:3072 sc1
  s_waitcnt vmcnt(8)
  s_waitcnt lgkmcnt(0)
  s_barrier
  s_cmp_lg_u32 s3, 0
  s_cbranch_scc1 K3_NOSIG1_9
  s_mov_b64 exec, 1
  buffer_atomic_add v28, v29, s[72:75], s62 offen offset:128 sc1
  s_mov_b64 exec, -1
K3_NOSIG1_9:
  s_waitcnt vmcnt(7)
  v_mfma_f32_16x16x32_bf16 v[80:83], a[0:3], v[32:35], 0
  s_add_u32 s10, s64, 8192
  buffer_load_dwordx4 v[64:67], v2, s[56:59], s10 offen offset:0 sc1
  v_mfma_f32_16x16x32_bf16 v[84:87], a[4:7], v[32:35], 0
  v_mfma_f32_16x16x32_bf16 v[88:91], a[8:11], v[32:35], 0
  v_mfma_f32_16x16x32_bf16 v[92:95], a[12:15], v[32:35], 0
  buffer_load_dwordx4 v[68:71], v2, s[56:59], s10 offen offset:1024 sc1
  v_mfma_f32_16x16x32_bf16 v[96:99], a[16:19], v[32:35], 0
  s_waitcnt vmcnt(8)
  v_mfma_f32_16x16x32_bf16 v[80:83], a[20:23], v[36:39], v[80:83]
  buffer_load_dwordx4 v[72:75], v2, s[56:59], s10 offen offset:2048 sc1
  v_mfma_f32_16x16x32_bf16 v[84:87], a[24:27], v[36:39], v[84:87]
  v_mfma_f32_16x16x32_bf16 v[88:91], a[28:31], v[36:39], v[88:91]
  v_mfma_f32_16x16x32_bf16 v[92:95], a[32:35], v[36:39], v[92:95]
  buffer_load_dwordx4 v[76:79], v2, s[56:59], s10 offen offset:3072 sc1
  v_mfma_f32_16x16x32_bf16 v[96:99], a[36:39], v[36:39], v[96:99]
  s_waitcnt vmcnt(9)
  v_mfma_f32_16x16x32_bf16 v[80:83], a[40:43], v[40:43], v[80:83]
  s_add_u32 s10, s65, 0
  buffer_load_dwordx4 v[160:163], v2, s[56:59], s10 offen offset:0 sc1
  v_mfma_f32_16x16x32_bf16 v[84:87], a[44:47], v[40:43], v[84:87]
  v_mfma_f32_16x16x32_bf16 v[88:91], a[48:51], v[40:43], v[88:91]
  v_mfma_f32_16x16x32_bf16 v[92:95], a[52:55], v[40:43], v[92:95]
  buffer_load_dwordx4 v[164:167], v2, s[56:59], s10 offen offset:1024 sc1
  v_mfma_f32_16x16x32_bf16 v[96:99], a[56:59], v[40:43], v[96:99]
  s_waitcnt vmcnt(10)
  v_mfma_f32_16x16x32_bf16 v[80:83], a[60:63], v[44:47], v[80:83]
  buffer_load_dwordx4 v[168:171], v2, s[56:59], s10 offen offset:2048 sc1
  v_mfma_f32_16x16x32_bf16 v[84:87], a[64:67], v[44:47], v[84:87]
  v_mfma_f32_16x16x32_bf16 v[88:91], a[68:71], v[44:47], v[88:91]
  v_mfma_f32_16x16x32_bf16 v[92:95], a[72:75], v[44:47], v[92:95]
  buffer_load_dwordx4 v[172:175], v2, s[56:59], s10 offen offset:3072 sc1
  v_mfma_f32_16x16x32_bf16 v[96:99], a[76:79], v[44:47], v[96:99]
  s_waitcnt vmcnt(11)
  v_mfma_f32_16x16x32_bf16 v[80:83], a[80:83], v[48:51], v[80:83]
  s_add_u32 s10, s65, 4096
  buffer_load_dwordx4 v[176:179], v2, s[56:59], s10 offen offset:0 sc1
  v_mfma_f32_16x16x32_bf16 v[84:87], a[84:87], v[48:51], v[84:87]
  v_mfma_f32_16x16x32_bf16 v[88:91], a[88:91], v[48:51], v[88:91]
  v_mfma_f32_16x16x32_bf16 v[92:95], a[92:95], v[48:51], v[92:95]
  buffer_load_dwordx4 v[180:183], v2, s[56:59], s10 offen offset:1024 sc1
  v_mfma_f32_16x16x32_bf16 v[96:99], a[96:99], v[48:51], v[96:99]
  s_waitcnt vmcnt(12)
  v_mfma_f32_16x16x32_bf16 v[80:83], a[100:103], v[52:55], v[80:83]
  buffer_load_dwordx4 v[184:187], v2, s[56:59], s10 offen offset:2048 sc1
  v_mfma_f32_16x16x32_bf16 v[84:87], a[104:107], v[52:55], v[84:87]
  v_mfma_f32_16x16x32_bf16 v[88:91], a[108:111], v[52:55], v[88:91]
  v_mfma_f32_16x16x32_bf16 v[92:95], a[112:115], v[52:55], v[92:95]
  buffer_load_dwordx4 v[188:191], v2, s[56:59], s10 offen offset:3072 sc1
  v_mfma_f32_16x16x32_bf16 v[96:99], a[116:119], v[52:55], v[96:99]
  s_waitcnt vmcnt(13)
  v_mfma_f32_16x16x32_bf16 v[80:83], a[120:123], v[56:59], v[80:83]
  s_add_u32 s10, s65, 8192
  buffer_load_dwordx4 v[240:243], v2, s[56:59], s10 offen offset:0 sc1
  v_mfma_f32_16x16x32_bf16 v[84:87], a[124:127], v[56:59], v[84:87]
  v_mfma_f32_16x16x32_bf16 v[88:91], a[128:131], v[56:59], v[88:91]
  v_mfma_f32_16x16x32_bf16 v[92:95], a[132:135], v[56:59], v[92:95]
  buffer_load_dwordx4 v[244:247], v2, s[56:59], s10 offen offset:1024 sc1
  v_mfma_f32_16x16x32_bf16 v[96:99], a[136:139], v[56:59], v[96:99]
  s_waitcnt vmcnt(14)
  v_mfma_f32_16x16x32_bf16 v[80:83], a[140:143], v[60:63], v[80:83]
  buffer_load_dwordx4 v[248:251], v2, s[56:59], s10 offen offset:2048 sc1
  v_mfma_f32_16x16x32_bf16 v[84:87], a[144:147], v[60:63], v[84:87]
  v_mfma_f32_16x16x32_bf16 v[88:91], a[148:151], v[60:63], v[88:91]
  v_mfma_f32_16x16x32_bf16 v[92:95], a[152:155], v[60:63], v[92:95]
  buffer_load_dwordx4 v[252:255], v2, s[56:59], s10 offen offset:3072 sc1
  v_mfma_f32_16x16x32_bf16 v[96:99], a[156:159], v[60:63], v[96:99]
  s_waitcnt vmcnt(15)
  v_mfma_f32_16x16x32_bf16 v[80:83], a[160:163], v[64:67], v[80:83]
  v_mfma_f32_16x16x32_bf16 v[84:87], a[164:167], v[64:67], v[84:87]
  v_mfma_f32_16x16x32_bf16 v[88:91], a[168:171], v[64:67], v[88:91]
  v_mfma_f32_16x16x32_bf16 v[92:95], a[172:175], v[64:67], v[92:95]
  v_mfma_f32_16x16x32_bf16 v[96:99], a[176:179], v[64:67], v[96:99]
  s_waitcnt vmcnt(14)
  v_mfma_f32_16x16x32_bf16 v[80:83], a[180:183], v[68:71], v[80:83]
  v_mfma_f32_16x16x32_bf16 v[84:87], a[184:187], v[68:71], v[84:87]
  v_mfma_f32_16x16x32_bf16 v[88:91], a[188:191], v[68:71], v[88:91]
  v_mfma_f32_16x16x32_bf16 v[92:95], a[192:195], v[68:71], v[92:95]
  v_mfma_f32_16x16x32_bf16 v[96:99], a[196:199], v[68:71], v[96:99]
  s_waitcnt vmcnt(13)
  v_mfma_f32_16x16x32_bf16 v[80:83], a[200:203], v[72:75], v[80:83]
  v_mfma_f32_16x16x32_bf16 v[84:87], a[204:207], v[72:75], v[84:87]
  v_mfma_f32_16x16x32_bf16 v[88:91], a[208:211], v[72:75], v[88:91]
  v_mfma_f32_16x16x32_bf16 v[92:95], a[212:215], v[72:75], v[92:95]
  v_mfma_f32_16x16x32_bf16 v[96:99], a[216:219], v[72:75], v[96:99]
  s_waitcnt vmcnt(12)
  v_mfma_f32_16x16x32_bf16 v[80:83], a[220:223], v[76:79], v[80:83]
  v_mfma_f32_16x16x32_bf16 v[84:87], a[224:227], v[76:79], v[84:87]
  v_mfma_f32_16x16x32_bf16 v[88:91], a[228:231], v[76:79], v[88:91]
  v_mfma_f32_16x16x32_bf16 v[92:95], a[232:235], v[76:79], v[92:95]
  v_mfma_f32_16x16x32_bf16 v[96:99], a[236:239], v[76:79], v[96:99]
  s_waitcnt vmcnt(11)
  v_mfma_f32_16x16x32_bf16 v[100:103], a[0:3], v[160:163], 0
  v_mfma_f32_16x16x32_bf16 v[104:107], a[4:7], v[160:163], 0
  v_mfma_f32_16x16x32_bf16 v[108:111], a[8:11], v[160:163], 0
  v_mfma_f32_16x16x32_bf16 v[112:115], a[12:15], v[160:163], 0
  v_mfma_f32_16x16x32_bf16 v[116:119], a[16:19], v[160:163], 0
  buffer_load_dword v30, v29, s[72:75], s63 offen offset:128 sc1
  s_waitcnt vmcnt(11)
  v_mfma_f32_16x16x32_bf16 v[100:103], a[20:23], v[164:167], v[100:103]
  v_mfma_f32_16x16x32_bf16 v[104:107], a[24:27], v[164:167], v[104:107]
  v_mfma_f32_16x16x32_bf16 v[108:111], a[28:31], v[164:167], v[108:111]
  ds_write_b128 v8, v[80:83] offset:0
  v_mfma_f32_16x16x32_bf16 v[112:115], a[32:35], v[164:167], v[112:115]
  v_mfma_f32_16x16x32_bf16 v[116:119], a[36:39], v[164:167], v[116:119]
  s_waitcnt vmcnt(10)
  v_mfma_f32_16x16x32_bf16 v[100:103], a[40:43], v[168:171], v[100:103]
  v_mfma_f32_16x16x32_bf16 v[104:107], a[44:47], v[168:171], v[104:107]
  v_mfma_f32_16x16x32_bf16 v[108:111], a[48:51], v[168:171], v[108:111]
  ds_write_b128 v8, v[84:87] offset:1024
  v_mfma_f32_16x16x32_bf16 v[112:115], a[52:55], v[168:171], v[112:115]
  v_mfma_f32_16x16x32_bf16 v[116:119], a[56:59], v[168:171], v[116:119]
  s_waitcnt vmcnt(9)
  v_mfma_f32_16x16x32_bf16 v[100:103], a[60:63], v[172:175], v[100:103]
  v_mfma_f32_16x16x32_bf16 v[104:107], a[64:67], v[172:175], v[104:107]
  v_mfma_f32_16x16x32_bf16 v[108:111], a[68:71], v[172:175], v[108:111]
  ds_write_b128 v8, v[88:91] offset:2048
  v_mfma_f32_16x16x32_bf16 v[112:115], a[72:75], v[172:175], v[112:115]
  v_mfma_f32_16x16x32_bf16 v[116:119], a[76:79], v[172:175], v[116:119]
  s_mov_b32 s35, 0
  s_waitcnt vmcnt(0)
  s_nop 5
  s_branch K3_PB_CHK
K3_PB:
  buffer_load_dword v30, v29, s[72:75], s63 offen offset:128 sc1
  s_waitcnt vmcnt(0)
K3_PB_CHK:
  v_readfirstlane_b32 s14, v30
  s_add_u32 s35, s35, 1
  s_cmp_ge_u32 s14, 4
  s_nop 2
  s_cbranch_scc1 K3_GOB
  s_cmp_lt_u32 s35, 0x8000
  s_cbranch_scc1 K3_PB
K3_GOB:
  s_add_u32 s10, s66, 0
  buffer_load_dwordx4 v[32:35], v2, s[56:59], s10 offen offset:0 sc1
  buffer_load_dwordx4 v[36:39], v2, s[56:59], s10 offen offset:1024 sc1
  buffer_load_dwordx4 v[40:43], v2, s[56:59], s10 offen offset:2048 sc1
  buffer_load_dwordx4 v[44:47], v2, s[56:59], s10 offen offset:3072 sc1
  v_mfma_f32_16x16x32_bf16 v[100:103], a[80:83], v[176:179], v[100:103]
  s_add_u32 s10, s66, 4096
  buffer_load_dwordx4 v[48:51], v2, s[56:59], s10 offen offset:0 sc1
  v_mfma_f32_16x16x32_bf16 v[104:107], a[84:87], v[176:179], v[104:107]
  v_mfma_f32_16x16x32_bf16 v[108:111], a[88:91], v[176:179], v[108:111]
  ds_write_b128 v8, v[92:95] offset:3072
  v_mfma_f32_16x16x32_bf16 v[112:115], a[92:95], v[176:179], v[112:115]
  buffer_load_dwordx4 v[52:55], v2, s[56:59], s10 offen offset:1024 sc1
  v_mfma_f32_16x16x32_bf16 v[116:119], a[96:99], v[176:179], v[116:119]
  v_mfma_f32_16x16x32_bf16 v[100:103], a[100:103], v[180:183], v[100:103]
  buffer_load_dwordx4 v[56:59], v2, s[56:59], s10 offen offset:2048 sc1
  v_mfma_f32_16x16x32_bf16 v[104:107], a[104:107], v[180:183], v[104:107]
  v_mfma_f32_16x16x32_bf16 v[108:111], a[108:111], v[180:183], v[108:111]
  ds_write_b128 v8, v[96:99] offset:4096
  v_mfma_f32_16x16x32_bf16 v[112:115], a[112:115], v[180:183], v[112:115]
  buffer_load_dwordx4 v[60:63], v2, s[56:59], s10 offen offset:3072 sc1
  v_mfma_f32_16x16x32_bf16 v[116:119], a[116:119], v[180:183], v[116:119]
  v_mfma_f32_16x16x32_bf16 v[100:103], a[120:123], v[184:187], v[100:103]
  s_add_u32 s10, s66, 8192
  buffer_load_dwordx4 v[64:67], v2, s[56:59], s10 offen offset:0 sc1
  v_mfma_f32_16x16x32_bf16 v[104:107], a[124:127], v[184:187], v[104:107]
  v_mfma_f32_16x16x32_bf16 v[108:111], a[128:131], v[184:187], v[108:111]
  v_mfma_f32_16x16x32_bf16 v[112:115], a[132:135], v[184:187], v[112:115]
  buffer_load_dwordx4 v[68:71], v2, s[56:59], s10 offen offset:1024 sc1
  v_mfma_f32_16x16x32_bf16 v[116:119], a[136:139], v[184:187], v[116:119]
  v_mfma_f32_16x16x32_bf16 v[100:103], a[140:143], v[188:191], v[100:103]
  buffer_load_dwordx4 v[72:75], v2, s[56:59], s10 offen offset:2048 sc1
  v_mfma_f32_16x16x32_bf16 v[104:107], a[144:147], v[188:191], v[104:107]
  v_mfma_f32_16x16x32_bf16 v[108:111], a[148:151], v[188:191], v[108:111]
  v_mfma_f32_16x16x32_bf16 v[112:115], a[152:155], v[188:191], v[112:115]
  buffer_load_dwordx4 v[76:79], v2, s[56:59], s10 offen offset:3072 sc1
  v_mfma_f32_16x16x32_bf16 v[116:119], a[156:159], v[188:191], v[116:119]
  v_mfma_f32_16x16x32_bf16 v[100:103], a[160:163], v[240:243], v[100:103]
  v_mfma_f32_16x16x32_bf16 v[104:107], a[164:167], v[240:243], v[104:107]
  v_mfma_f32_16x16x32_bf16 v[108:111], a[168:171], v[240:243], v[108:111]
  v_mfma_f32_16x16x32_bf16 v[112:115], a[172:175], v[240:243], v[112:115]
  v_mfma_f32_16x16x32_bf16 v[116:119], a[176:179], v[240:243], v[116:119]
  v_mfma_f32_16x16x32_bf16 v[100:103], a[180:183], v[244:247], v[100:103]
  v_mfma_f32_16x16x32_bf16 v[104:107], a[184:187], v[244:247], v[104:107]
  v_mfma_f32_16x16x32_bf16 v[108:111], a[188:191], v[244:247], v[108:111]
  v_mfma_f32_16x16x32_bf16 v[112:115], a[192:195], v[244:247], v[112:115]
  v_mfma_f32_16x16x32_bf16 v[116:119], a[196:199], v[244:247], v[116:119]
  v_mfma_f32_16x16x32_bf16 v[100:103], a[200:203], v[248:251], v[100:103]
  v_mfma_f32_16x16x32_bf16 v[104:107], a[204:207], v[248:251], v[104:107]
  v_mfma_f32_16x16x32_bf16 v[108:111], a[208:211], v[248:251], v[108:111]
  v_mfma_f32_16x16x32_bf16 v[112:115], a[212:215], v[248:251], v[112:115]
  v_mfma_f32_16x16x32_bf16 v[116:119], a[216:219], v[248:251], v[116:119]
  v_mfma_f32_16x16x32_bf16 v[100:103], a[220:223], v[252:255], v[100:103]
  v_mfma_f32_16x16x32_bf16 v[104:107], a[224:227], v[252:255], v[104:107]
  v_mfma_f32_16x16x32_bf16 v[108:111], a[228:231], v[252:255], v[108:111]
  v_mfma_f32_16x16x32_bf16 v[112:115], a[232:235], v[252:255], v[112:115]
  v_mfma_f32_16x16x32_bf16 v[116:119], a[236:239], v[252:255], v[116:119]
  s_waitcnt vmcnt(11)
  v_mfma_f32_16x16x32_bf16 v[120:123], a[0:3], v[32:35], 0
  s_add_u32 s10, s67, 0
  buffer_load_dwordx4 v[160:163], v2, s[56:59], s10 offen offset:0 sc1
  v_mfma_f32_16x16x32_bf16 v[124:127], a[4:7], v[32:35], 0
  v_mfma_f32_16x16x32_bf16 v[128:131], a[8:11], v[32:35], 0
  v_mfma_f32_16x16x32_bf16 v[132:135], a[12:15], v[32:35], 0
  buffer_load_dwordx4 v[164:167], v2, s[56:59], s10 offen offset:1024 sc1
  v_mfma_f32_16x16x32_bf16 v[136:139], a[16:19], v[32:35], 0
  s_waitcnt vmcnt(12)
  v_mfma_f32_16x16x32_bf16 v[120:123], a[20:23], v[36:39], v[120:123]
  buffer_load_dwordx4 v[168:171], v2, s[56:59], s10 offen offset:2048 sc1
  v_mfma_f32_16x16x32_bf16 v[124:127], a[24:27], v[36:39], v[124:127]
  v_mfma_f32_16x16x32_bf16 v[128:131], a[28:31], v[36:39], v[128:131]
  ds_write_b128 v8, v[100:103] offset:20480
  v_mfma_f32_16x16x32_bf16 v[132:135], a[32:35], v[36:39], v[132:135]
  buffer_load_dwordx4 v[172:175], v2, s[56:59], s10 offen offset:3072 sc1
  v_mfma_f32_16x16x32_bf16 v[136:139], a[36:39], v[36:39], v[136:139]
  s_waitcnt vmcnt(13)
  v_mfma_f32_16x16x32_bf16 v[120:123], a[40:43], v[40:43], v[120:123]
  s_add_u32 s10, s67, 4096
  buffer_load_dwordx4 v[176:179], v2, s[56:59], s10 offen offset:0 sc1
  v_mfma_f32_16x16x32_bf16 v[124:127], a[44:47], v[40:43], v[124:127]
  v_mfma_f32_16x16x32_bf16 v[128:131], a[48:51], v[40:43], v[128:131]
  ds_write_b128 v8, v[104:107] offset:21504
  v_mfma_f32_16x16x32_bf16 v[132:135], a[52:55], v[40:43], v[132:135]
  buffer_load_dwordx4 v[180:183], v2, s[56:59], s10 offen offset:1024 sc1
  v_mfma_f32_16x16x32_bf16 v[136:139], a[56:59], v[40:43], v[136:139]
  s_waitcnt vmcnt(14)
  v_mfma_f32_16x16x32_bf16 v[120:123], a[60:63], v[44:47], v[120:123]
  buffer_load_dwordx4 v[184:187], v2, s[56:59], s10 offen offset:2048 sc1
  v_mfma_f32_16x16x32_bf16 v[124:127], a[64:67], v[44:47], v[124:127]
  v_mfma_f32_16x16x32_bf16 v[128:131], a[68:71], v[44:47], v[128:131]
  ds_write_b128 v8, v[108:111] offset:22528
  v_mfma_f32_16x16x32_bf16 v[132:135], a[72:75], v[44:47], v[132:135]
  buffer_load_dwordx4 v[188:191], v2, s[56:59], s10 offen offset:3072 sc1
  v_mfma_f32_16x16x32_bf16 v[136:139], a[76:79], v[44:47], v[136:139]
  s_waitcnt vmcnt(15)
  v_mfma_f32_16x16x32_bf16 v[120:123], a[80:83], v[48:51], v[120:123]
  s_add_u32 s10, s67, 8192
  buffer_load_dwordx4 v[240:243], v2, s[56:59], s10 offen offset:0 sc1
  v_mfma_f32_16x16x32_bf16 v[124:127], a[84:87], v[48:51], v[124:127]
  v_mfma_f32_16x16x32_bf16 v[128:131], a[88:91], v[48:51], v[128:131]
  ds_write_b128 v8, v[112:115] offset:23552
  v_mfma_f32_16x16x32_bf16 v[132:135], a[92:95], v[48:51], v[132:135]
  buffer_load_dwordx4 v[244:247], v2, s[56:59], s10 offen offset:1024 sc1
  v_mfma_f32_16x16x32_bf16 v[136:139], a[96:99], v[48:51], v[136:139]
  ds_write_b128 v8, v[116:119] offset:24576
  s_waitcnt lgkmcnt(0)
  s_barrier
  ds_read_b128 v[80:83], v10 offset:0
  ds_read_b128 v[84:87], v10 offset:5120
  ds_read_b128 v[88:91], v10 offset:10240
  ds_read_b128 v[92:95], v10 offset:15360
  ds_read_b128 v[96:99], v11 offset:0
  ds_read_b128 v[100:103], v11 offset:5120
  ds_read_b128 v[104:107], v11 offset:10240
  ds_read_b128 v[108:111], v11 offset:15360
  ds_read_b128 v[192:195], v13 offset:0
  ds_read_b128 v[196:199], v13 offset:5120
  s_waitcnt vmcnt(16)
  v_mfma_f32_16x16x32_bf16 v[120:123], a[100:103], v[52:55], v[120:123]
  buffer_load_dwordx4 v[248:251], v2, s[56:59], s10 offen offset:2048 sc1
  v_mfma_f32_16x16x32_bf16 v[124:127], a[104:107], v[52:55], v[124:127]
  v_mfma_f32_16x16x32_bf16 v[128:131], a[108:111], v[52:55], v[128:131]
  v_mfma_f32_16x16x32_bf16 v[132:135], a[112:115], v[52:55], v[132:135]
  buffer_load_dwordx4 v[252:255], v2, s[56:59], s10 offen offset:3072 sc1
  v_mfma_f32_16x16x32_bf16 v[136:139], a[116:119], v[52:55], v[136:139]
  ds_read_b128 v[200:203], v13 offset:10240
  ds_read_b128 v[204:207], v13 offset:15360
  v_lshlrev_b32 v16, 16, v224
  v_and_b32 v17, 0xffff0000, v224
  v_lshlrev_b32 v18, 16, v225
  v_and_b32 v19, 0xffff0000, v225
  v_lshlrev_b32 v20, 16, v226
  v_and_b32 v21, 0xffff0000, v226
  v_lshlrev_b32 v22, 16, v227
  v_and_b32 v23, 0xffff0000, v227
  s_waitcnt vmcnt(17)
  v_mfma_f32_16x16x32_bf16 v[120:123], a[120:123], v[56:59], v[120:123]
  v_mfma_f32_16x16x32_bf16 v[124:127], a[124:127], v[56:59], v[124:127]
  v_mfma_f32_16x16x32_bf16 v[128:131], a[128:131], v[56:59], v[128:131]
  v_mfma_f32_16x16x32_bf16 v[132:135], a[132:135], v[56:59], v[132:135]
  v_mfma_f32_16x16x32_bf16 v[136:139], a[136:139], v[56:59], v[136:139]
  v_lshlrev_b32 v24, 16, v228
  v_and_b32 v25, 0xffff0000, v228
  v_lshlrev_b32 v26, 16, v229
  v_and_b32 v27, 0xffff0000, v229
  s_waitcnt lgkmcnt(8)
  v_pk_add_f32 v[80:81], v[80:81], v[84:85]
  v_pk_add_f32 v[88:89], v[88:89], v[92:93]
  v_pk_add_f32 v[82:83], v[82:83], v[86:87]
  v_pk_add_f32 v[90:91], v[90:91], v[94:95]
  v_pk_add_f32 v[80:81], v[80:81], v[88:89]
  s_waitcnt vmcnt(16)
  v_mfma_f32_16x16x32_bf16 v[120:123], a[140:143], v[60:63], v[120:123]
  v_mfma_f32_16x16x32_bf16 v[124:127], a[144:147], v[60:63], v[124:127]
  v_mfma_f32_16x16x32_bf16 v[128:131], a[148:151], v[60:63], v[128:131]
  v_mfma_f32_16x16x32_bf16 v[132:135], a[152:155], v[60:63], v[132:135]
  v_mfma_f32_16x16x32_bf16 v[136:139], a[156:159], v[60:63], v[136:139]
  v_pk_add_f32 v[82:83], v[82:83], v[90:91]
  v_cvt_pk_bf16_f32 v84, v80, v81
  v_cvt_pk_bf16_f32 v85, v82, v83
  v_lshlrev_b32 v80, 16, v84
  v_and_b32 v81, 0xffff0000, v84
  v_lshlrev_b32 v82, 16, v85
  v_and_b32 v83, 0xffff0000, v85
  v_pk_add_f32 v[80:81], v[80:81], v[16:17]
  v_pk_add_f32 v[82:83], v[82:83], v[18:19]
  v_cvt_pk_bf16_f32 v84, v80, v81
  s_waitcnt vmcnt(15)
  v_mfma_f32_16x16x32_bf16 v[120:123], a[160:163], v[64:67], v[120:123]
  v_mfma_f32_16x16x32_bf16 v[124:127], a[164:167], v[64:67], v[124:127]
  v_mfma_f32_16x16x32_bf16 v[128:131], a[168:171], v[64:67], v[128:131]
  v_mfma_f32_16x16x32_bf16 v[132:135], a[172:175], v[64:67], v[132:135]
  v_mfma_f32_16x16x32_bf16 v[136:139], a[176:179], v[64:67], v[136:139]
  v_cvt_pk_bf16_f32 v85, v82, v83
  buffer_store_dwordx2 v[84:85], v5, s[52:55], s28 offen
  s_waitcnt lgkmcnt(4)
  v_pk_add_f32 v[96:97], v[96:97], v[100:101]
  v_pk_add_f32 v[104:105], v[104:105], v[108:109]
  v_pk_add_f32 v[98:99], v[98:99], v[102:103]
  v_pk_add_f32 v[106:107], v[106:107], v[110:111]
  v_pk_add_f32 v[96:97], v[96:97], v[104:105]
  v_pk_add_f32 v[98:99], v[98:99], v[106:107]
  v_cvt_pk_bf16_f32 v100, v96, v97
  s_waitcnt vmcnt(15)
  v_mfma_f32_16x16x32_bf16 v[120:123], a[180:183], v[68:71], v[120:123]
  v_mfma_f32_16x16x32_bf16 v[124:127], a[184:187], v[68:71], v[124:127]
  v_mfma_f32_16x16x32_bf16 v[128:131], a[188:191], v[68:71], v[128:131]
  v_mfma_f32_16x16x32_bf16 v[132:135], a[192:195], v[68:71], v[132:135]
  v_mfma_f32_16x16x32_bf16 v[136:139], a[196:199], v[68:71], v[136:139]
  v_cvt_pk_bf16_f32 v101, v98, v99
  v_lshlrev_b32 v96, 16, v100
  v_and_b32 v97, 0xffff0000, v100
  v_lshlrev_b32 v98, 16, v101
  v_and_b32 v99, 0xffff0000, v101
  v_pk_add_f32 v[96:97], v[96:97], v[20:21]
  v_pk_add_f32 v[98:99], v[98:99], v[22:23]
  v_cvt_pk_bf16_f32 v100, v96, v97
  v_cvt_pk_bf16_f32 v101, v98, v99
  buffer_store_dwordx2 v[100:101], v5, s[52:55], s29 offen
  s_waitcnt vmcnt(15)
  v_mfma_f32_16x16x32_bf16 v[120:123], a[200:203], v[72:75], v[120:123]
  v_mfma_f32_16x16x32_bf16 v[124:127], a[204:207], v[72:75], v[124:127]
  v_mfma_f32_16x16x32_bf16 v[128:131], a[208:211], v[72:75], v[128:131]
  v_mfma_f32_16x16x32_bf16 v[132:135], a[212:215], v[72:75], v[132:135]
  v_mfma_f32_16x16x32_bf16 v[136:139], a[216:219], v[72:75], v[136:139]
  s_waitcnt lgkmcnt(0)
  v_pk_add_f32 v[192:193], v[192:193], v[196:197]
  v_pk_add_f32 v[200:201], v[200:201], v[204:205]
  v_pk_add_f32 v[194:195], v[194:195], v[198:199]
  v_pk_add_f32 v[202:203], v[202:203], v[206:207]
  v_pk_add_f32 v[192:193], v[192:193], v[200:201]
  v_pk_add_f32 v[194:195], v[194:195], v[202:203]
  v_cvt_pk_bf16_f32 v196, v192, v193
  v_cvt_pk_bf16_f32 v197, v194, v195
  v_lshlrev_b32 v192, 16, v196
  s_waitcnt vmcnt(14)
  v_mfma_f32_16x16x32_bf16 v[120:123], a[220:223], v[76:79], v[120:123]
  v_mfma_f32_16x16x32_bf16 v[124:127], a[224:227], v[76:79], v[124:127]
  v_mfma_f32_16x16x32_bf16 v[128:131], a[228:231], v[76:79], v[128:131]
  v_mfma_f32_16x16x32_bf16 v[132:135], a[232:235], v[76:79], v[132:135]
  v_mfma_f32_16x16x32_bf16 v[136:139], a[236:239], v[76:79], v[136:139]
  v_and_b32 v193, 0xffff0000, v196
  v_lshlrev_b32 v194, 16, v197
  v_and_b32 v195, 0xffff0000, v197
  v_pk_add_f32 v[192:193], v[192:193], v[24:25]
  v_pk_add_f32 v[194:195], v[194:195], v[26:27]
  v_cvt_pk_bf16_f32 v196, v192, v193
  v_cvt_pk_bf16_f32 v197, v194, v195
  buffer_store_dwordx2 v[196:197], v5, s[52:55], s30 offen
  s_waitcnt vmcnt(14)
  v_mfma_f32_16x16x32_bf16 v[140:143], a[0:3], v[160:163], 0
  v_mfma_f32_16x16x32_bf16 v[144:147], a[4:7], v[160:163], 0
  v_mfma_f32_16x16x32_bf16 v[148:151], a[8:11], v[160:163], 0
  v_mfma_f32_16x16x32_bf16 v[152:155], a[12:15], v[160:163], 0
  v_mfma_f32_16x16x32_bf16 v[156:159], a[16:19], v[160:163], 0
  s_waitcnt vmcnt(13)
  v_mfma_f32_16x16x32_bf16 v[140:143], a[20:23], v[164:167], v[140:143]
  v_mfma_f32_16x16x32_bf16 v[144:147], a[24:27], v[164:167], v[144:147]
  v_mfma_f32_16x16x32_bf16 v[148:151], a[28:31], v[164:167], v[148:151]
  ds_write_b128 v9, v[120:123] offset:0
  v_mfma_f32_16x16x32_bf16 v[152:155], a[32:35], v[164:167], v[152:155]
  v_mfma_f32_16x16x32_bf16 v[156:159], a[36:39], v[164:167], v[156:159]
  s_waitcnt vmcnt(12)
  v_mfma_f32_16x16x32_bf16 v[140:143], a[40:43], v[168:171], v[140:143]
  v_mfma_f32_16x16x32_bf16 v[144:147], a[44:47], v[168:171], v[144:147]
  v_mfma_f32_16x16x32_bf16 v[148:151], a[48:51], v[168:171], v[148:151]
  ds_write_b128 v9, v[124:127] offset:1024
  v_mfma_f32_16x16x32_bf16 v[152:155], a[52:55], v[168:171], v[152:155]
  v_mfma_f32_16x16x32_bf16 v[156:159], a[56:59], v[168:171], v[156:159]
  s_waitcnt vmcnt(11)
  v_mfma_f32_16x16x32_bf16 v[140:143], a[60:63], v[172:175], v[140:143]
  v_mfma_f32_16x16x32_bf16 v[144:147], a[64:67], v[172:175], v[144:147]
  v_mfma_f32_16x16x32_bf16 v[148:151], a[68:71], v[172:175], v[148:151]
  ds_write_b128 v9, v[128:131] offset:2048
  v_mfma_f32_16x16x32_bf16 v[152:155], a[72:75], v[172:175], v[152:155]
  v_mfma_f32_16x16x32_bf16 v[156:159], a[76:79], v[172:175], v[156:159]
  s_waitcnt vmcnt(10)
  v_mfma_f32_16x16x32_bf16 v[140:143], a[80:83], v[176:179], v[140:143]
  v_mfma_f32_16x16x32_bf16 v[144:147], a[84:87], v[176:179], v[144:147]
  v_mfma_f32_16x16x32_bf16 v[148:151], a[88:91], v[176:179], v[148:151]
  ds_write_b128 v9, v[132:135] offset:3072
  v_mfma_f32_16x16x32_bf16 v[152:155], a[92:95], v[176:179], v[152:155]
  v_mfma_f32_16x16x32_bf16 v[156:159], a[96:99], v[176:179], v[156:159]
  s_waitcnt vmcnt(9)
  v_mfma_f32_16x16x32_bf16 v[140:143], a[100:103], v[180:183], v[140:143]
  v_mfma_f32_16x16x32_bf16 v[144:147], a[104:107], v[180:183], v[144:147]
  v_mfma_f32_16x16x32_bf16 v[148:151], a[108:111], v[180:183], v[148:151]
  ds_write_b128 v9, v[136:139] offset:4096
  v_mfma_f32_16x16x32_bf16 v[152:155], a[112:115], v[180:183], v[152:155]
  v_mfma_f32_16x16x32_bf16 v[156:159], a[116:119], v[180:183], v[156:159]
  s_waitcnt vmcnt(8)
  v_mfma_f32_16x16x32_bf16 v[140:143], a[120:123], v[184:187], v[140:143]
  v_mfma_f32_16x16x32_bf16 v[144:147], a[124:127], v[184:187], v[144:147]
  v_mfma_f32_16x16x32_bf16 v[148:151], a[128:131], v[184:187], v[148:151]
  v_mfma_f32_16x16x32_bf16 v[152:155], a[132:135], v[184:187], v[152:155]
  v_mfma_f32_16x16x32_bf16 v[156:159], a[136:139], v[184:187], v[156:159]
  s_waitcnt vmcnt(7)
  v_mfma_f32_16x16x32_bf16 v[140:143], a[140:143], v[188:191], v[140:143]
  v_mfma_f32_16x16x32_bf16 v[144:147], a[144:147], v[188:191], v[144:147]
  v_mfma_f32_16x16x32_bf16 v[148:151], a[148:151], v[188:191], v[148:151]
  v_mfma_f32_16x16x32_bf16 v[152:155], a[152:155], v[188:191], v[152:155]
  v_mfma_f32_16x16x32_bf16 v[156:159], a[156:159], v[188:191], v[156:159]
  s_waitcnt vmcnt(6)
  v_mfma_f32_16x16x32_bf16 v[140:143], a[160:163], v[240:243], v[140:143]
  v_mfma_f32_16x16x32_bf16 v[144:147], a[164:167], v[240:243], v[144:147]
  v_mfma_f32_16x16x32_bf16 v[148:151], a[168:171], v[240:243], v[148:151]
  v_mfma_f32_16x16x32_bf16 v[152:155], a[172:175], v[240:243], v[152:155]
  v_mfma_f32_16x16x32_bf16 v[156:159], a[176:179], v[240:243], v[156:159]
  s_waitcnt vmcnt(5)
  v_mfma_f32_16x16x32_bf16 v[140:143], a[180:183], v[244:247], v[140:143]
  v_mfma_f32_16x16x32_bf16 v[144:147], a[184:187], v[244:247], v[144:147]
  v_mfma_f32_16x16x32_bf16 v[148:151], a[188:191], v[244:247], v[148:151]
  v_mfma_f32_16x16x32_bf16 v[152:155], a[192:195], v[244:247], v[152:155]
  v_mfma_f32_16x16x32_bf16 v[156:159], a[196:199], v[244:247], v[156:159]
  s_waitcnt vmcnt(4)
  v_mfma_f32_16x16x32_bf16 v[140:143], a[200:203], v[248:251], v[140:143]
  v_mfma_f32_16x16x32_bf16 v[144:147], a[204:207], v[248:251], v[144:147]
  v_mfma_f32_16x16x32_bf16 v[148:151], a[208:211], v[248:251], v[148:151]
  v_mfma_f32_16x16x32_bf16 v[152:155], a[212:215], v[248:251], v[152:155]
  v_mfma_f32_16x16x32_bf16 v[156:159], a[216:219], v[248:251], v[156:159]
  s_waitcnt vmcnt(3)
  v_mfma_f32_16x16x32_bf16 v[140:143], a[220:223], v[252:255], v[140:143]
  v_mfma_f32_16x16x32_bf16 v[144:147], a[224:227], v[252:255], v[144:147]
  v_mfma_f32_16x16x32_bf16 v[148:151], a[228:231], v[252:255], v[148:151]
  v_mfma_f32_16x16x32_bf16 v[152:155], a[232:235], v[252:255], v[152:155]
  v_mfma_f32_16x16x32_bf16 v[156:159], a[236:239], v[252:255], v[156:159]
  s_nop 3
  ds_write_b128 v9, v[140:143] offset:20480
  ds_write_b128 v9, v[144:147] offset:21504
  ds_write_b128 v9, v[148:151] offset:22528
  ds_write_b128 v9, v[152:155] offset:23552
  ds_write_b128 v9, v[156:159] offset:24576
  s_waitcnt lgkmcnt(0)
  s_barrier
  ds_read_b128 v[32:35], v10 offset:40960
  ds_read_b128 v[36:39], v10 offset:46080
  ds_read_b128 v[40:43], v10 offset:51200
  ds_read_b128 v[44:47], v10 offset:56320
  ds_read_b128 v[48:51], v11 offset:40960
  ds_read_b128 v[52:55], v11 offset:46080
  ds_read_b128 v[56:59], v11 offset:51200
  ds_read_b128 v[60:63], v11 offset:56320
  ds_read_b128 v[64:67], v13 offset:40960
  ds_read_b128 v[68:71], v13 offset:46080
  ds_read_b128 v[72:75], v13 offset:51200
  ds_read_b128 v[76:79], v13 offset:56320
  v_lshlrev_b32 v16, 16, v230
  v_and_b32 v17, 0xffff0000, v230
  v_lshlrev_b32 v18, 16, v231
  v_and_b32 v19, 0xffff0000, v231
  s_add_u32 s28, s28, 1310720
  v_lshlrev_b32 v20, 16, v232
  v_and_b32 v21, 0xffff0000, v232
  v_lshlrev_b32 v22, 16, v233
  v_and_b32 v23, 0xffff0000, v233
  s_add_u32 s29, s29, 1310720
  v_lshlrev_b32 v24, 16, v234
  v_and_b32 v25, 0xffff0000, v234
  v_lshlrev_b32 v26, 16, v235
  v_and_b32 v27, 0xffff0000, v235
  s_add_u32 s30, s30, 1310720
  s_waitcnt lgkmcnt(8)
  v_pk_add_f32 v[32:33], v[32:33], v[36:37]
  v_pk_add_f32 v[40:41], v[40:41], v[44:45]
  v_pk_add_f32 v[34:35], v[34:35], v[38:39]
  v_pk_add_f32 v[42:43], v[42:43], v[46:47]
  v_pk_add_f32 v[32:33], v[32:33], v[40:41]
  v_pk_add_f32 v[34:35], v[34:35], v[42:43]
  v_cvt_pk_bf16_f32 v36, v32, v33
  v_cvt_pk_bf16_f32 v37, v34, v35
  v_lshlrev_b32 v32, 16, v36
  v_and_b32 v33, 0xffff0000, v36
  v_lshlrev_b32 v34, 16, v37
  v_and_b32 v35, 0xffff0000, v37
  v_pk_add_f32 v[32:33], v[32:33], v[16:17]
  v_pk_add_f32 v[34:35], v[34:35], v[18:19]
  v_cvt_pk_bf16_f32 v36, v32, v33
  v_cvt_pk_bf16_f32 v37, v34, v35
  buffer_store_dwordx2 v[36:37], v5, s[52:55], s28 offen
  s_waitcnt lgkmcnt(4)
  v_pk_add_f32 v[48:49], v[48:49], v[52:53]
  v_pk_add_f32 v[56:57], v[56:57], v[60:61]
  v_pk_add_f32 v[50:51], v[50:51], v[54:55]
  v_pk_add_f32 v[58:59], v[58:59], v[62:63]
  v_pk_add_f32 v[48:49], v[48:49], v[56:57]
  v_pk_add_f32 v[50:51], v[50:51], v[58:59]
  v_cvt_pk_bf16_f32 v52, v48, v49
  v_cvt_pk_bf16_f32 v53, v50, v51
  v_lshlrev_b32 v48, 16, v52
  v_and_b32 v49, 0xffff0000, v52
  v_lshlrev_b32 v50, 16, v53
  v_and_b32 v51, 0xffff0000, v53
  v_pk_add_f32 v[48:49], v[48:49], v[20:21]
  v_pk_add_f32 v[50:51], v[50:51], v[22:23]
  v_cvt_pk_bf16_f32 v52, v48, v49
  v_cvt_pk_bf16_f32 v53, v50, v51
  buffer_store_dwordx2 v[52:53], v5, s[52:55], s29 offen
  s_waitcnt lgkmcnt(0)
  v_pk_add_f32 v[64:65], v[64:65], v[68:69]
  v_pk_add_f32 v[72:73], v[72:73], v[76:77]
  v_pk_add_f32 v[66:67], v[66:67], v[70:71]
  v_pk_add_f32 v[74:75], v[74:75], v[78:79]
  v_pk_add_f32 v[64:65], v[64:65], v[72:73]
  v_pk_add_f32 v[66:67], v[66:67], v[74:75]
  v_cvt_pk_bf16_f32 v68, v64, v65
  v_cvt_pk_bf16_f32 v69, v66, v67
  v_lshlrev_b32 v64, 16, v68
  v_and_b32 v65, 0xffff0000, v68
  v_lshlrev_b32 v66, 16, v69
  v_and_b32 v67, 0xffff0000, v69
  v_pk_add_f32 v[64:65], v[64:65], v[24:25]
  v_pk_add_f32 v[66:67], v[66:67], v[26:27]
  v_cvt_pk_bf16_f32 v68, v64, v65
  v_cvt_pk_bf16_f32 v69, v66, v67
  buffer_store_dwordx2 v[68:69], v5, s[52:55], s30 offen
  s_nop 0
K3_END:
  s_endpgm
CODE_END:
.section .rodata,"a"
.p2align 6
.amdhsa_kernel sequential_preLN__ssm_conv_s4d__glu_gated_swiglu__prompt_kernel
  .amdhsa_next_free_vgpr 512
  .amdhsa_next_free_sgpr 96
  .amdhsa_accum_offset 256
  .amdhsa_group_segment_fixed_size 0
  .amdhsa_kernarg_size 112
  .amdhsa_user_sgpr_count 2
  .amdhsa_user_sgpr_kernarg_segment_ptr 1
  .amdhsa_system_sgpr_workgroup_id_x 1
.end_amdhsa_kernel
```
